```python
import torch

def _softmax(x, axis=-1):
    return torch.softmax(x, dim=axis)
def _gelu(x):
    return torch.nn.functional.gelu(x, approximate="tanh")
def _silu(x):
    return torch.nn.functional.silu(x)
def _sigmoid(x):
    return torch.sigmoid(x)
def _layernorm(x, axis=-1, eps=1e-5):
    m = x.mean(dim=axis, keepdim=True)
    v = x.var(dim=axis, keepdim=True, unbiased=False)
    return (x - m) / torch.sqrt(v + eps)
def _scatter_add(tgt, idx, src, axis=0):
    return tgt.clone().index_add_(axis, idx, src)
def _segment_sum(src, seg, n):
    out = torch.zeros((n,) + src.shape[1:], dtype=src.dtype)
    return out.index_add_(0, seg, src)
def _pad(x, pw):
    flat = tuple(v for pair in reversed(pw) for v in pair)
    return torch.nn.functional.pad(x, flat)

kernel_name = 'sequential_preLN__sliding_block__mixer_s_mlp__prompt'

def setup_inputs():

    _w = (lambda a: (lambda t: t.to(torch.bfloat16) if t.is_floating_point() else t)(torch.as_tensor(a)))
    def _A_setup():
        B, S, D = 1, 2048, 512
        return {
            "x": _w((lambda *s: torch.randn(*s, dtype=torch.bfloat16) * 0.05)(B, S, D)),
            "wqkv": _w((lambda *s: torch.randn(*s, dtype=torch.bfloat16) * 0.05)(D, 3 * D)),
            "wo": _w((lambda *s: torch.randn(*s, dtype=torch.bfloat16) * 0.05)(D, D)),
        }
    _A_in = _A_setup()

    def _B_setup():
        B, S, D, F = 1, 2048, 512, 1792
        return {
            "x":  _w((lambda *s: torch.randn(*s, dtype=torch.bfloat16) * 0.05)(B, S, D)),
            "w1": _w((lambda *s: torch.randn(*s, dtype=torch.bfloat16) * 3.2)(D, D) * (D ** -0.5)),
            "w2": _w((lambda *s: torch.randn(*s, dtype=torch.bfloat16) * 3.2)(D, D) * (D ** -0.5)),
            "w3": _w((lambda *s: torch.randn(*s, dtype=torch.bfloat16) * 3.2)(D, F) * (D ** -0.5)),
            "w4": _w((lambda *s: torch.randn(*s, dtype=torch.bfloat16) * 3.2)(F, D) * (F ** -0.5)),
        }
    _B_in = _B_setup()

    return {
        "A_x": _A_in["x"],
        "A_wqkv": _A_in["wqkv"],
        "A_wo": _A_in["wo"],
        "B_x": _B_in["x"],
        "B_w1": _B_in["w1"],
        "B_w2": _B_in["w2"],
        "B_w3": _B_in["w3"],
        "B_w4": _B_in["w4"],
    }

def reference(A_x, A_wqkv, A_wo, B_x, B_w1, B_w2, B_w3, B_w4):
    def _A_ref(x, wqkv, wo):
        B, S, D = x.shape
        H = 32; Dh = D // H; W = 256
        qkv = (lambda x, *d: x.permute(*d))((x @ wqkv).reshape(B, S, 3, H, Dh), 2, 0, 3, 1, 4)
        q, k, v = qkv[0], qkv[1], qkv[2]
        scores = torch.einsum("bhqd,bhkd->bhqk", q, k) * (Dh ** -0.5)
        idx = torch.arange(S)
        mask = (idx[:, None] - idx[None, :] >= 0) & (idx[:, None] - idx[None, :] < W)
        scores = torch.where(mask[None, None], scores, -1e9)
        p = _softmax(scores, axis=-1)
        o = torch.einsum("bhqk,bhkd->bhqd", p, v)
        return (lambda x, *d: x.permute(*d))(o, 0, 2, 1, 3).reshape(B, S, D) @ wo

    def _B_ref(x, w1, w2, w3, w4):
        B, S, D = x.shape
        h = _gelu(_layernorm(x, axis=-1) @ w1)
        c = D // 4
        g0 = _pad(h[:, :, 0*c:1*c], ((0, 0), (1, 0), (0, 0)))[:, :S, :]
        g1 = _pad(h[:, :, 1*c:2*c], ((0, 0), (0, 1), (0, 0)))[:, 1:, :]
        g2 = _pad(h[:, :, 2*c:3*c], ((0, 0), (2, 0), (0, 0)))[:, :S, :]
        g3 = _pad(h[:, :, 3*c:   ], ((0, 0), (0, 2), (0, 0)))[:, 2:, :]
        hs = torch.concatenate([g0, g1, g2, g3], axis=-1) @ w2
        x1 = x + hs
        h2 = _gelu(_layernorm(x1, axis=-1) @ w3) @ w4
        return x1 + h2

    x = A_x
    h = x + _A_ref(_layernorm(x, axis=-1), A_wqkv, A_wo)
    h2 = h + _B_ref(_layernorm(h, axis=-1), B_w1, B_w2, B_w3, B_w4)
    return h2
```

```asm
; @launch grid=(256,1,1) block=(256,1,1) lds=163840
.amdgcn_target "amdgcn-amd-amdhsa--gfx950"
.text
.globl sequential_preLN__sliding_block__mixer_s_mlp__prompt_kernel
.p2align 12
.fill 832, 4, 0xbf810000
.p2align 8
.type sequential_preLN__sliding_block__mixer_s_mlp__prompt_kernel,@function
sequential_preLN__sliding_block__mixer_s_mlp__prompt_kernel:
    s_cmp_ge_u32 s2, 256
    s_cbranch_scc1 KEND
    s_load_dwordx2 s[4:5], s[0:1], 0
    s_load_dwordx2 s[8:9], s[0:1], 8
    s_load_dwordx2 s[40:41], s[0:1], 80
    s_load_dwordx2 s[12:13], s[0:1], 16
    s_load_dwordx2 s[16:17], s[0:1], 32
    s_load_dwordx2 s[20:21], s[0:1], 40
    s_load_dwordx2 s[24:25], s[0:1], 48
    s_load_dwordx2 s[28:29], s[0:1], 56
    s_load_dwordx2 s[32:33], s[0:1], 64
    s_load_dwordx2 s[36:37], s[0:1], 72
    v_lshrrev_b32 v8, 6, v0
    v_and_b32 v0, 63, v0
    v_readfirstlane_b32 s46, v8
    s_getpc_b64 s[70:71]
    s_bfe_u32 s72, s2, 0x50003
    s_lshl2_add_u32 s72, s72, s46
    v_min_u32 v9, 2, v0
    v_lshl_add_u32 v9, v9, 7, s72
    v_lshlrev_b32 v9, 7, v9
    v_mov_b32 v13, s71
    v_add_co_u32 v12, vcc, s70, v9
    s_nop 1
    v_addc_co_u32 v13, vcc, 0, v13, vcc
    global_load_dword v6, v[12:13], off
    s_and_b32 s77, s2, 7
    s_lshr_b32 s70, s2, 6
    s_lshl_b32 s44, s77, 2
    s_add_u32 s44, s44, s70
    s_bfe_u32 s45, s2, 0x30003
    s_lshl_b32 s49, s46, 12
    s_lshl_b32 s79, s44, 2
    s_add_u32 s79, s79, s46
    s_lshl_b32 s79, s79, 4
    v_lshrrev_b32 v4, 4, v0
    v_and_b32 v5, 15, v0
    v_lshrrev_b32 v15, 3, v0
    v_lshrrev_b32 v9, 4, v0
    v_and_b32 v10, 7, v0
    v_xor_b32 v9, v9, v10
    v_add_u32 v8, s79, v15
    v_lshlrev_b32 v8, 10, v8
    v_lshl_add_u32 v12, v9, 4, v8
    v_xor_b32 v13, 64, v12
    v_add_u32 v13, 0x2000, v13
    s_and_b32 s93, s44, 3
    s_add_u32 s70, s93, 0
    s_and_b32 s70, s70, 3
    s_lshl_b32 s88, s70, 8
    s_lshl_b32 s84, s70, 17
    s_add_u32 s70, s93, 1
    s_and_b32 s70, s70, 3
    s_lshl_b32 s89, s70, 8
    s_lshl_b32 s85, s70, 17
    s_add_u32 s70, s93, 2
    s_and_b32 s70, s70, 3
    s_lshl_b32 s90, s70, 8
    s_lshl_b32 s86, s70, 17
    s_add_u32 s70, s93, 3
    s_and_b32 s70, s70, 3
    s_lshl_b32 s91, s70, 8
    s_lshl_b32 s87, s70, 17
    s_mov_b32 s6, 0x200000
    s_mov_b32 s7, 0x20000
    s_mov_b32 s10, 0x180000
    s_mov_b32 s11, 0x20000
    s_mov_b32 s42, 0x10000000
    s_mov_b32 s43, 0x20000
    s_lshl_b32 s70, s2, 2
    s_add_u32 s70, s70, s46
    s_mul_i32 s70, s70, 1536
    s_lshl_b32 s71, s44, 3
    s_add_u32 s71, s71, s45
    s_lshl_b32 s71, s71, 2
    s_add_u32 s71, s71, s46
    s_lshl_b32 s71, s71, 11
    v_lshlrev_b32 v8, 7, v0
    v_mov_b32 v9, 0x40000000
    v_cmp_gt_u32 vcc, 16, v0
    s_nop 1
    v_cndmask_b32 v10, v9, v8, vcc
    v_cmp_gt_u32 vcc, 12, v0
    s_nop 1
    v_cndmask_b32 v11, v9, v8, vcc
    s_waitcnt lgkmcnt(0)
    buffer_load_dword v6, v10, s[4:7], s71 offen
    buffer_load_dword v6, v11, s[8:11], s70 offen
    s_add_u32 m0, s49, 0x0
    s_nop 0
    buffer_load_dwordx4 v12, s[4:7], s88 offen offset:0 lds
    s_add_u32 m0, s49, 0x400
    s_nop 0
    buffer_load_dwordx4 v13, s[4:7], s88 offen offset:0 lds
    s_add_u32 m0, s49, 0x780
    s_nop 0
    buffer_load_dwordx4 v12, s[4:7], s88 offen offset:128 lds
    s_add_u32 m0, s49, 0xb80
    s_nop 0
    buffer_load_dwordx4 v13, s[4:7], s88 offen offset:128 lds
    v_and_b32 v8, 6, v15
    v_and_b32 v9, 7, v0
    v_xor_b32 v8, v8, v9
    v_lshlrev_b32 v17, 4, v8
    s_lshl_b32 s71, s45, 7
    v_add_u32 v17, s71, v17
    s_and_b32 s70, s46, 1
    s_lshl_b32 s70, s70, 4
    s_lshr_b32 s72, s46, 1
    s_lshl_b32 s73, s72, 2
    s_add_u32 s73, s73, s70
    v_lshrrev_b32 v8, 5, v0
    v_and_b32 v9, 3, v15
    v_lshl_add_u32 v8, v8, 3, v9
    v_add_u32 v8, s73, v8
    v_mul_u32_u24 v8, 0xc00, v8
    v_xor_b32 v9, 512, v17
    v_add_u32 v7, v8, v9
    s_mov_b32 s50, 0x17c00
    s_mov_b32 s51, 0x2f800
    s_mov_b32 s52, 0x47400
    s_add_u32 m0, s49, 0x10000
    s_mul_i32 s3, s84, 3
    s_add_u32 s3, s3, 1024
    v_add_u32 v14, s3, v7
    buffer_load_dwordx4 v14, s[8:11], 0 offen offset:0 lds
    buffer_load_dwordx4 v14, s[8:11], s50 offen offset:1024 lds
    s_mov_b32 s14, 0x80000
    s_mov_b32 s15, 0x20000
    s_mov_b32 s18, 0x80000
    s_mov_b32 s19, 0x20000
    s_mov_b32 s22, 0x80000
    s_mov_b32 s23, 0x20000
    s_mov_b32 s26, 0x1c0000
    s_mov_b32 s27, 0x20000
    s_mov_b32 s30, 0x1c0000
    s_mov_b32 s31, 0x20000
    s_mov_b32 s34, 0x200000
    s_mov_b32 s35, 0x20000
    s_mov_b32 s38, 0x100
    s_mov_b32 s39, 0x20000
    buffer_load_dwordx4 v14, s[8:11], s51 offen offset:2048 lds
    s_mov_b32 s53, 0x7c00
    s_mov_b32 s54, 0xf800
    s_mov_b32 s55, 0x17400
    s_getreg_b32 s48, hwreg(HW_REG_XCC_ID,0,4)
    s_lshl_b32 s78, s44, 20
    s_lshl_b32 s70, s45, 2
    s_add_u32 s70, s70, s46
    s_lshl_b32 s56, s70, 10
    s_add_u32 s56, s56, s78
    s_add_u32 s56, s56, 0x28000
    s_lshl_b32 s63, s46, 14
    s_add_u32 s63, s63, s78
    buffer_load_dwordx4 v14, s[8:11], s52 offen offset:3072 lds
    v_lshlrev_b32 v1, 4, v0
    s_bitcmp1_b32 s45, 1
    s_cselect_b32 s72, 0, 3
    s_cselect_b32 s73, 0, 14
    s_cmp_eq_u32 s72, s46
    s_cselect_b32 s73, s73, 16
    v_and_b32 v8, 14, v0
    v_cmp_eq_u32 vcc, s73, v8
    v_mov_b32 v9, 0x40000000
    v_and_b32 v8, 1, v0
    v_lshl_add_u32 v8, v4, 1, v8
    v_lshlrev_b32 v8, 4, v8
    v_cndmask_b32 v18, v9, v8, vcc
    s_lshl_b32 s94, s45, 11
    s_add_u32 s94, s94, s63
    s_add_u32 s76, s94, 0x70000
    v_mov_b32 v20, -1
    v_mov_b32 v21, -1
    v_mov_b32 v22, -1
    v_mov_b32 v23, -1
    v_lshlrev_b32 v8, 7, v0
    v_cmp_gt_u32 vcc, 6, v0
    s_nop 1
    v_cndmask_b32 v19, v9, v8, vcc
    s_or_b32 s70, s2, s46
    s_cmp_eq_u32 s70, 0
    s_mov_b32 s95, 0x40000000
    s_cmov_b32 s95, 0x2100000
    v_mov_b32 v25, s95
    buffer_load_dword v6, v19, s[40:43], s56 offen
    buffer_load_dword v24, v25, s[40:43], 0 offen
    v_mov_b32 v3, 0
    v_mov_b32 v2, 0x40000000
    v_cmp_eq_u32 vcc, 0, v0
    s_nop 1
    v_cndmask_b32 v2, v2, v3, vcc
    v_mov_b32 v28, 0x3f803f80
    v_mov_b32 v29, 0x3f803f80
    v_mov_b32 v30, 0x3f803f80
    v_mov_b32 v31, 0x3f803f80
    s_mov_b32 s64, 0x22222222
    s_mov_b32 s65, 0x22222222
    s_mov_b32 s66, 0x44444444
    s_mov_b32 s67, 0x44444444
    s_mov_b32 s68, 0x88888888
    s_mov_b32 s69, 0x88888888
    v_bfe_u32 v8, v0, 2, 3
    s_add_u32 m0, s49, 0x4000
    s_nop 0
    buffer_load_dwordx4 v12, s[4:7], s89 offen offset:0 lds
    v_lshrrev_b32 v9, 1, v8
    v_lshlrev_b32 v9, 5, v9
    v_lshl_add_u32 v9, v8, 7, v9
    v_and_b32 v8, 3, v0
    v_lshl_add_u32 v9, v8, 3, v9
    v_lshrrev_b32 v8, 5, v0
    v_lshl_add_u32 v19, v8, 12, v9
    s_lshl_b32 s70, s46, 5
    v_xor_b32 v32, s70, v19
    v_add_u32 v33, 0x10000, v32
    v_add_u32 v34, 0x20000, v32
    v_lshrrev_b32 v8, 1, v5
    v_xor_b32 v8, v8, v4
    s_add_u32 m0, s49, 0x4400
    s_nop 0
    buffer_load_dwordx4 v13, s[4:7], s89 offen offset:0 lds
    v_lshlrev_b32 v8, 4, v8
    v_lshl_add_u32 v35, v5, 7, v8
    v_xor_b32 v36, 64, v35
    v_add_u32 v37, s49, v35
    v_add_u32 v38, s49, v36
    v_lshrrev_b32 v8, 2, v5
    v_cmp_eq_u32 vcc, v8, v4
    v_lshlrev_b32 v9, 4, v5
    v_mov_b32 v26, 0x40000000
    v_cndmask_b32 v26, v26, v9, vcc
    v_lshlrev_b32 v9, 3, v5
    s_lshl_b32 s70, s46, 7
    s_add_u32 s70, s70, 49152
    v_add_u32 v39, s70, v9
    s_add_u32 m0, s49, 0x4780
    s_nop 0
    buffer_load_dwordx4 v12, s[4:7], s89 offen offset:128 lds
    v_mov_b32 v40, v9
    v_lshlrev_b32 v41, 5, v4
    v_lshrrev_b32 v8, 5, v0
    v_lshl_add_u32 v8, v8, 4, v5
    v_lshlrev_b32 v8, 4, v8
    v_and_b32 v9, 11, v0
    v_cmp_eq_u32 vcc, 0, v9
    v_mov_b32 v10, 0x40000000
    v_mov_b32 v11, 0x90000
    v_add_u32 v8, 0x10000, v8
    v_cndmask_b32 v42, v3, v28, vcc
    v_and_b32 v9, 7, v0
    v_lshl_add_u32 v11, v9, 4, v11
    s_add_u32 m0, s49, 0x4b80
    s_nop 0
    buffer_load_dwordx4 v13, s[4:7], s89 offen offset:128 lds
    s_mov_b32 vcc_lo, 0x00ff0000
    s_mov_b32 vcc_hi, 0x00110000
    v_cndmask_b32 v10, v10, v11, vcc
    v_and_b32 v9, 16, v0
    v_cmp_eq_u32 vcc, 0, v9
    s_nop 1
    v_cndmask_b32 v27, v10, v8, vcc
    v_and_b32 v8, 31, v0
    v_lshrrev_b32 v9, 5, v0
    v_lshlrev_b32 v9, 2, v9
    v_sub_u32 v43, v8, v9
    v_mov_b32 v10, 0xf149f2ca
    v_cmp_le_i32 vcc, 0, v43
    s_nop 1
    v_cndmask_b32 v44, v10, v3, vcc
    s_add_u32 m0, s49, 0x14000
    s_mul_i32 s3, s85, 3
    s_add_u32 s3, s3, 1024
    v_add_u32 v14, s3, v7
    buffer_load_dwordx4 v14, s[8:11], 0 offen offset:0 lds
    v_cndmask_b32 v60, v3, v10, vcc
    v_cmp_le_i32 vcc, 1, v43
    s_nop 1
    v_cndmask_b32 v45, v10, v3, vcc
    v_cndmask_b32 v61, v3, v10, vcc
    v_cmp_le_i32 vcc, 2, v43
    s_nop 1
    v_cndmask_b32 v46, v10, v3, vcc
    v_cndmask_b32 v62, v3, v10, vcc
    v_cmp_le_i32 vcc, 3, v43
    s_nop 1
    v_cndmask_b32 v47, v10, v3, vcc
    v_cndmask_b32 v63, v3, v10, vcc
    v_cmp_le_i32 vcc, 8, v43
    s_nop 1
    v_cndmask_b32 v48, v10, v3, vcc
    v_cndmask_b32 v64, v3, v10, vcc
    buffer_load_dwordx4 v14, s[8:11], s50 offen offset:1024 lds
    v_cmp_le_i32 vcc, 9, v43
    s_nop 1
    v_cndmask_b32 v49, v10, v3, vcc
    v_cndmask_b32 v65, v3, v10, vcc
    v_cmp_le_i32 vcc, 10, v43
    s_nop 1
    v_cndmask_b32 v50, v10, v3, vcc
    v_cndmask_b32 v66, v3, v10, vcc
    v_cmp_le_i32 vcc, 11, v43
    s_nop 1
    v_cndmask_b32 v51, v10, v3, vcc
    v_cndmask_b32 v67, v3, v10, vcc
    v_cmp_le_i32 vcc, 16, v43
    s_nop 1
    v_cndmask_b32 v52, v10, v3, vcc
    v_cndmask_b32 v68, v3, v10, vcc
    v_cmp_le_i32 vcc, 17, v43
    buffer_load_dwordx4 v14, s[8:11], s51 offen offset:2048 lds
    s_nop 0
    v_cndmask_b32 v53, v10, v3, vcc
    v_cndmask_b32 v69, v3, v10, vcc
    v_cmp_le_i32 vcc, 18, v43
    s_nop 1
    v_cndmask_b32 v54, v10, v3, vcc
    v_cndmask_b32 v70, v3, v10, vcc
    v_cmp_le_i32 vcc, 19, v43
    s_nop 1
    v_cndmask_b32 v55, v10, v3, vcc
    v_cndmask_b32 v71, v3, v10, vcc
    v_cmp_le_i32 vcc, 24, v43
    s_nop 1
    v_cndmask_b32 v56, v10, v3, vcc
    v_cndmask_b32 v72, v3, v10, vcc
    v_cmp_le_i32 vcc, 25, v43
    s_nop 1
    v_cndmask_b32 v57, v10, v3, vcc
    buffer_load_dwordx4 v14, s[8:11], s52 offen offset:3072 lds
    v_cndmask_b32 v73, v3, v10, vcc
    v_cmp_le_i32 vcc, 26, v43
    s_nop 1
    v_cndmask_b32 v58, v10, v3, vcc
    v_cndmask_b32 v74, v3, v10, vcc
    v_cmp_le_i32 vcc, 27, v43
    s_nop 1
    v_cndmask_b32 v59, v10, v3, vcc
    v_cndmask_b32 v75, v3, v10, vcc
    s_lshl_b32 s70, s46, 3
    v_add_u32 v8, s70, v15
    v_lshl_add_u32 v76, v8, 10, v17
    s_and_b32 s70, s46, 1
    s_lshl_b32 s70, s70, 4
    s_lshr_b32 s71, s46, 1
    s_lshl_b32 s71, s71, 3
    s_add_u32 s70, s70, s71
    v_add_u32 v8, s70, v15
    buffer_store_dwordx4 v[20:23], v18, s[40:43], s76 offen offset:0 sc1
    v_lshl_add_u32 v77, v8, 10, v17
    s_cmp_ge_u32 s44, 4
    s_mov_b32 s70, 0x40000
    s_cmov_b32 s70, 0xffc00000
    s_add_u32 s96, s94, s70
    s_add_u32 s97, s63, s70
    s_sub_u32 s70, s94, 0x100000
    s_cmp_ge_u32 s44, 1
    s_cselect_b32 s58, s70, s94
    s_cselect_b32 s80, 0, 0x40000000
    s_sub_u32 s70, s94, 0x200000
    s_cmp_ge_u32 s44, 2
    s_cselect_b32 s59, s70, s94
    s_cselect_b32 s81, 0, 0x40000000
    s_sub_u32 s70, s94, 0x300000
    s_cmp_ge_u32 s44, 3
    s_cselect_b32 s60, s70, s94
    s_cselect_b32 s82, 0, 0x40000000
    s_sub_u32 s70, s94, 0x400000
    s_cmp_ge_u32 s44, 4
    s_cselect_b32 s61, s70, s94
    s_cselect_b32 s83, 0, 0x40000000
    v_add_u32 v8, 1, v0
    buffer_store_dwordx4 v[20:23], v18, s[40:43], s76 offen offset:1024 sc1
    v_lshlrev_b32 v9, 20, v8
    v_sub_u32 v9, s56, v9
    s_min_u32 s70, s44, 4
    v_cmp_ge_u32 vcc, s70, v8
    v_mov_b32 v17, 0x40000000
    s_nop 0
    v_cndmask_b32 v17, v17, v9, vcc
    v_lshrrev_b32 v8, 1, v5
    v_lshrrev_b32 v9, 1, v4
    v_xor_b32 v8, v8, v9
    v_lshlrev_b32 v8, 4, v8
    v_lshl_add_u32 v8, v5, 7, v8
    v_and_b32 v9, 1, v4
    v_lshl_add_u32 v8, v9, 3, v8
    s_add_u32 m0, s49, 0x8000
    s_nop 0
    buffer_load_dwordx4 v12, s[4:7], s90 offen offset:0 lds
    s_lshr_b32 s70, s45, 1
    s_sub_u32 s70, s70, s93
    s_and_b32 s92, s70, 3
    s_lshl_b32 s70, s92, 14
    s_and_b32 s71, s45, 1
    s_lshl_b32 s71, s71, 11
    s_add_u32 s70, s70, s71
    s_add_u32 s70, s70, s49
    v_add_u32 v78, s70, v8
    v_lshlrev_b32 v8, 7, v0
    v_mov_b32 v9, 0x40000000
    v_cmp_gt_u32 vcc, 16, v0
    s_nop 1
    v_cndmask_b32 v79, v9, v8, vcc
    s_add_u32 m0, s49, 0x8400
    s_nop 0
    buffer_load_dwordx4 v13, s[4:7], s90 offen offset:0 lds
    v_cmp_gt_u32 vcc, 14, v0
    s_nop 1
    v_cndmask_b32 v89, v9, v8, vcc
    v_cmp_gt_u32 vcc, 8, v0
    s_nop 1
    v_cndmask_b32 v88, v9, v8, vcc
    s_waitcnt vmcnt(14)
    s_waitcnt lgkmcnt(0)
    s_barrier
    ds_read_b64_tr_b16 v[92:93], v33 offset:0
    ds_read_b64_tr_b16 v[94:95], v33 offset:8192
    ds_read_b128 a[0:3], v35 offset:0
    ds_read_b128 a[4:7], v35 offset:4096
    ds_read_b128 a[8:11], v35 offset:8192
    ds_read_b128 a[12:15], v35 offset:12288
    s_add_u32 m0, s49, 0x8780
    s_nop 0
    buffer_load_dwordx4 v12, s[4:7], s90 offen offset:128 lds
    ds_read_b128 v[124:127], v37 offset:0
    ds_read_b64_tr_b16 v[96:97], v33 offset:1024
    ds_read_b64_tr_b16 v[98:99], v33 offset:9216
    ds_read_b128 a[16:19], v36 offset:0
    ds_read_b128 a[20:23], v36 offset:4096
    ds_read_b128 a[24:27], v36 offset:8192
    ds_read_b128 a[28:31], v36 offset:12288
    ds_read_b128 v[128:131], v38 offset:0
    s_waitcnt lgkmcnt(11)
    v_mfma_f32_16x16x32_bf16 v[156:159], v[92:95], a[0:3], 0
    ds_read_b64_tr_b16 v[100:101], v33 offset:2048
    s_add_u32 m0, s49, 0x8b80
    s_nop 0
    buffer_load_dwordx4 v13, s[4:7], s90 offen offset:128 lds
    s_waitcnt lgkmcnt(11)
    v_mfma_f32_16x16x32_bf16 v[160:163], v[92:95], a[4:7], 0
    ds_read_b64_tr_b16 v[102:103], v33 offset:10240
    s_waitcnt lgkmcnt(11)
    v_mfma_f32_16x16x32_bf16 v[164:167], v[92:95], a[8:11], 0
    ds_read_b128 a[32:35], v35 offset:2048
    ds_read_b128 a[36:39], v35 offset:6144
    s_waitcnt lgkmcnt(12)
    v_mfma_f32_16x16x32_bf16 v[168:171], v[92:95], a[12:15], 0
    ds_read_b128 a[40:43], v35 offset:10240
    v_mfma_f32_16x16x32_bf16 v[188:191], v[92:95], v[28:31], 0
    ds_read_b128 a[44:47], v35 offset:14336
    s_add_u32 m0, s49, 0x18000
    s_mul_i32 s3, s86, 3
    s_add_u32 s3, s3, 1024
    v_add_u32 v14, s3, v7
    buffer_load_dwordx4 v14, s[8:11], 0 offen offset:0 lds
    s_waitcnt lgkmcnt(13)
    v_mfma_f32_16x16x32_bf16 v[196:199], v[28:31], v[124:127], 0
    ds_read_b128 v[132:135], v37 offset:2048
    ds_read_b64_tr_b16 v[104:105], v33 offset:3072
    v_mfma_f32_16x16x32_bf16 v[200:203], v[124:127], v[124:127], 0
    ds_read_b64_tr_b16 v[106:107], v33 offset:11264
    s_cmp_lg_u32 s92, 0
    s_cbranch_scc1 nores_1
    v_xor_b32 v8, 0, v78
    ds_read_b64 v[80:81], v8
    v_xor_b32 v8, 32, v78
    ds_read_b64 v[82:83], v8
    v_xor_b32 v8, 64, v78
    ds_read_b64 v[84:85], v8
    v_xor_b32 v8, 96, v78
    ds_read_b64 v[86:87], v8
nores_1:
    s_waitcnt lgkmcnt(13)
    v_mfma_f32_16x16x32_bf16 v[156:159], v[96:99], a[16:19], v[156:159]
    ds_read_b128 a[48:51], v36 offset:2048
    buffer_load_dwordx4 v14, s[8:11], s50 offen offset:1024 lds
    s_waitcnt lgkmcnt(13)
    v_mfma_f32_16x16x32_bf16 v[160:163], v[96:99], a[20:23], v[160:163]
    ds_read_b128 a[52:55], v36 offset:6144
    ds_read_b128 a[56:59], v36 offset:10240
    s_waitcnt lgkmcnt(14)
    v_mfma_f32_16x16x32_bf16 v[164:167], v[96:99], a[24:27], v[164:167]
    ds_read_b128 a[60:63], v36 offset:14336
    s_waitcnt lgkmcnt(14)
    v_mfma_f32_16x16x32_bf16 v[168:171], v[96:99], a[28:31], v[168:171]
    ds_read_b128 v[136:139], v38 offset:2048
    v_mfma_f32_16x16x32_bf16 v[188:191], v[96:99], v[28:31], v[188:191]
    buffer_load_dwordx4 v14, s[8:11], s51 offen offset:2048 lds
    s_waitcnt lgkmcnt(14)
    v_mfma_f32_16x16x32_bf16 v[196:199], v[28:31], v[128:131], v[196:199]
    v_mfma_f32_16x16x32_bf16 v[200:203], v[128:131], v[128:131], v[200:203]
    buffer_load_dwordx4 v14, s[8:11], s52 offen offset:3072 lds
    s_add_u32 m0, s49, 0xc000
    s_nop 0
    buffer_load_dwordx4 v12, s[4:7], s91 offen offset:0 lds
    s_add_u32 m0, s49, 0xc400
    s_nop 0
    buffer_load_dwordx4 v13, s[4:7], s91 offen offset:0 lds
    s_cmp_eq_u32 s46, 0
    s_mov_b64 exec, 0
    s_cbranch_scc1 ahead_k1_0
    s_branch return_k1
return_k1:
    s_mov_b64 exec, -1
    s_waitcnt vmcnt(12)
    s_waitcnt lgkmcnt(0)
    s_barrier
    s_cmp_eq_u32 s95, 0x40000000
    s_cbranch_scc1 notfirst_2
    v_add_u32 v24, 1, v24
    v_max_u32 v24, 1, v24
    buffer_store_dword v24, v2, s[36:39], 0 offen sc1
    buffer_store_dword v24, v2, s[40:43], s95 offen sc1
notfirst_2:
    s_cmp_eq_u32 s46, 0
    s_cselect_b32 s95, 0, 0x40000000
    v_mov_b32 v25, s95
    v_mfma_f32_16x16x32_bf16 v[156:159], v[100:103], a[32:35], v[156:159]
    ds_read_b64_tr_b16 v[108:109], v33 offset:16384
    v_mfma_f32_16x16x32_bf16 v[160:163], v[100:103], a[36:39], v[160:163]
    ds_read_b64_tr_b16 v[110:111], v33 offset:24576
    v_mfma_f32_16x16x32_bf16 v[164:167], v[100:103], a[40:43], v[164:167]
    ds_read_b128 a[64:67], v35 offset:16384
    ds_read_b128 a[68:71], v35 offset:20480
    s_add_u32 m0, s49, 0xc780
    s_nop 0
    buffer_load_dwordx4 v12, s[4:7], s91 offen offset:128 lds
    v_mfma_f32_16x16x32_bf16 v[168:171], v[100:103], a[44:47], v[168:171]
    ds_read_b128 a[72:75], v35 offset:24576
    v_mfma_f32_16x16x32_bf16 v[188:191], v[100:103], v[28:31], v[188:191]
    ds_read_b128 a[76:79], v35 offset:28672
    v_mfma_f32_16x16x32_bf16 v[196:199], v[28:31], v[132:135], v[196:199]
    ds_read_b128 v[140:143], v37 offset:16384
    ds_read_b64_tr_b16 v[112:113], v33 offset:17408
    v_mfma_f32_16x16x32_bf16 v[200:203], v[132:135], v[132:135], v[200:203]
    ds_read_b64_tr_b16 v[114:115], v33 offset:25600
    s_add_u32 m0, s49, 0xcb80
    s_nop 0
    buffer_load_dwordx4 v13, s[4:7], s91 offen offset:128 lds
    v_mfma_f32_16x16x32_bf16 v[156:159], v[104:107], a[48:51], v[156:159]
    ds_read_b128 a[80:83], v36 offset:16384
    v_mfma_f32_16x16x32_bf16 v[160:163], v[104:107], a[52:55], v[160:163]
    ds_read_b128 a[84:87], v36 offset:20480
    ds_read_b128 a[88:91], v36 offset:24576
    v_mfma_f32_16x16x32_bf16 v[164:167], v[104:107], a[56:59], v[164:167]
    ds_read_b128 a[92:95], v36 offset:28672
    v_mfma_f32_16x16x32_bf16 v[168:171], v[104:107], a[60:63], v[168:171]
    ds_read_b128 v[144:147], v38 offset:16384
    s_add_u32 m0, s49, 0x1c000
    s_mul_i32 s3, s87, 3
    s_add_u32 s3, s3, 1024
    v_add_u32 v14, s3, v7
    buffer_load_dwordx4 v14, s[8:11], 0 offen offset:0 lds
    v_mfma_f32_16x16x32_bf16 v[188:191], v[104:107], v[28:31], v[188:191]
    ds_read_b64_tr_b16 v[116:117], v33 offset:18432
    ds_read_b64_tr_b16 v[118:119], v33 offset:26624
    v_mfma_f32_16x16x32_bf16 v[196:199], v[28:31], v[136:139], v[196:199]
    ds_read_b128 a[96:99], v35 offset:18432
    v_mfma_f32_16x16x32_bf16 v[200:203], v[136:139], v[136:139], v[200:203]
    ds_read_b128 a[100:103], v35 offset:22528
    s_waitcnt lgkmcnt(15)
    v_mfma_f32_16x16x32_bf16 v[156:159], v[108:111], a[64:67], v[156:159]
    ds_read_b128 a[104:107], v35 offset:26624
    ds_read_b128 a[108:111], v35 offset:30720
    buffer_load_dwordx4 v14, s[8:11], s50 offen offset:1024 lds
    s_waitcnt lgkmcnt(15)
    v_mfma_f32_16x16x32_bf16 v[160:163], v[108:111], a[68:71], v[160:163]
    ds_read_b128 v[148:151], v37 offset:18432
    v_mfma_f32_16x16x32_bf16 v[164:167], v[108:111], a[72:75], v[164:167]
    ds_read_b64_tr_b16 v[120:121], v33 offset:19456
    s_waitcnt lgkmcnt(15)
    v_mfma_f32_16x16x32_bf16 v[168:171], v[108:111], a[76:79], v[168:171]
    ds_read_b64_tr_b16 v[122:123], v33 offset:27648
    ds_read_b128 a[112:115], v36 offset:18432
    v_mfma_f32_16x16x32_bf16 v[188:191], v[108:111], v[28:31], v[188:191]
    ds_read_b128 a[116:119], v36 offset:22528
    buffer_load_dwordx4 v14, s[8:11], s51 offen offset:2048 lds
    v_mfma_f32_16x16x32_bf16 v[196:199], v[28:31], v[140:143], v[196:199]
    ds_read_b128 a[120:123], v36 offset:26624
    v_mfma_f32_16x16x32_bf16 v[200:203], v[140:143], v[140:143], v[200:203]
    ds_read_b128 a[124:127], v36 offset:30720
    ds_read_b128 v[152:155], v38 offset:18432
    s_cmp_lg_u32 s92, 1
    s_cbranch_scc1 nores_3
    v_xor_b32 v8, 0, v78
    ds_read_b64 v[80:81], v8
    v_xor_b32 v8, 32, v78
    ds_read_b64 v[82:83], v8
    v_xor_b32 v8, 64, v78
    ds_read_b64 v[84:85], v8
    v_xor_b32 v8, 96, v78
    ds_read_b64 v[86:87], v8
nores_3:
    s_waitcnt lgkmcnt(15)
    v_mfma_f32_16x16x32_bf16 v[156:159], v[112:115], a[80:83], v[156:159]
    buffer_load_dwordx4 v14, s[8:11], s52 offen offset:3072 lds
    v_mfma_f32_16x16x32_bf16 v[160:163], v[112:115], a[84:87], v[160:163]
    v_mfma_f32_16x16x32_bf16 v[164:167], v[112:115], a[88:91], v[164:167]
    v_mfma_f32_16x16x32_bf16 v[168:171], v[112:115], a[92:95], v[168:171]
    v_mfma_f32_16x16x32_bf16 v[188:191], v[112:115], v[28:31], v[188:191]
    s_waitcnt lgkmcnt(14)
    v_mfma_f32_16x16x32_bf16 v[196:199], v[28:31], v[144:147], v[196:199]
    s_add_u32 m0, s49, 0x20000
    s_mul_i32 s3, s84, 3
    s_add_u32 s3, s3, 2048
    v_add_u32 v14, s3, v7
    buffer_load_dwordx4 v14, s[8:11], 0 offen offset:0 lds
    v_mfma_f32_16x16x32_bf16 v[200:203], v[144:147], v[144:147], v[200:203]
    buffer_load_dwordx4 v14, s[8:11], s50 offen offset:1024 lds
    s_waitcnt vmcnt(10)
    s_waitcnt lgkmcnt(0)
    s_barrier
    v_mfma_f32_16x16x32_bf16 v[156:159], v[116:119], a[96:99], v[156:159]
    ds_read_b64_tr_b16 v[92:93], v33 offset:32768
    v_mfma_f32_16x16x32_bf16 v[160:163], v[116:119], a[100:103], v[160:163]
    ds_read_b64_tr_b16 v[94:95], v33 offset:40960
    v_mfma_f32_16x16x32_bf16 v[164:167], v[116:119], a[104:107], v[164:167]
    ds_read_b128 a[128:131], v35 offset:32768
    ds_read_b128 a[132:135], v35 offset:36864
    buffer_load_dwordx4 v14, s[8:11], s51 offen offset:2048 lds
    v_mfma_f32_16x16x32_bf16 v[168:171], v[116:119], a[108:111], v[168:171]
    ds_read_b128 a[136:139], v35 offset:40960
    v_mfma_f32_16x16x32_bf16 v[188:191], v[116:119], v[28:31], v[188:191]
    ds_read_b128 a[140:143], v35 offset:45056
    v_mfma_f32_16x16x32_bf16 v[196:199], v[28:31], v[148:151], v[196:199]
    ds_read_b128 v[124:127], v37 offset:32768
    ds_read_b64_tr_b16 v[96:97], v33 offset:33792
    v_mfma_f32_16x16x32_bf16 v[200:203], v[148:151], v[148:151], v[200:203]
    ds_read_b64_tr_b16 v[98:99], v33 offset:41984
    buffer_load_dwordx4 v14, s[8:11], s52 offen offset:3072 lds
    v_mfma_f32_16x16x32_bf16 v[156:159], v[120:123], a[112:115], v[156:159]
    ds_read_b128 a[144:147], v36 offset:32768
    v_mfma_f32_16x16x32_bf16 v[160:163], v[120:123], a[116:119], v[160:163]
    ds_read_b128 a[148:151], v36 offset:36864
    ds_read_b128 a[152:155], v36 offset:40960
    v_mfma_f32_16x16x32_bf16 v[164:167], v[120:123], a[120:123], v[164:167]
    ds_read_b128 a[156:159], v36 offset:45056
    v_mfma_f32_16x16x32_bf16 v[168:171], v[120:123], a[124:127], v[168:171]
    ds_read_b128 v[128:131], v38 offset:32768
    s_add_u32 m0, s49, 0x24000
    s_mul_i32 s3, s85, 3
    s_add_u32 s3, s3, 2048
    v_add_u32 v14, s3, v7
    buffer_load_dwordx4 v14, s[8:11], 0 offen offset:0 lds
    v_mfma_f32_16x16x32_bf16 v[188:191], v[120:123], v[28:31], v[188:191]
    ds_read_b64_tr_b16 v[100:101], v33 offset:34816
    ds_read_b64_tr_b16 v[102:103], v33 offset:43008
    v_mfma_f32_16x16x32_bf16 v[196:199], v[28:31], v[152:155], v[196:199]
    ds_read_b128 a[160:163], v35 offset:34816
    v_mfma_f32_16x16x32_bf16 v[200:203], v[152:155], v[152:155], v[200:203]
    ds_read_b128 a[164:167], v35 offset:38912
    s_waitcnt lgkmcnt(15)
    v_mfma_f32_16x16x32_bf16 v[156:159], v[92:95], a[128:131], v[156:159]
    ds_read_b128 a[168:171], v35 offset:43008
    ds_read_b128 a[172:175], v35 offset:47104
    buffer_load_dwordx4 v14, s[8:11], s50 offen offset:1024 lds
    s_waitcnt lgkmcnt(15)
    v_mfma_f32_16x16x32_bf16 v[160:163], v[92:95], a[132:135], v[160:163]
    ds_read_b128 v[132:135], v37 offset:34816
    v_mfma_f32_16x16x32_bf16 v[164:167], v[92:95], a[136:139], v[164:167]
    ds_read_b64_tr_b16 v[104:105], v33 offset:35840
    s_waitcnt lgkmcnt(15)
    v_mfma_f32_16x16x32_bf16 v[168:171], v[92:95], a[140:143], v[168:171]
    ds_read_b64_tr_b16 v[106:107], v33 offset:44032
    ds_read_b128 a[176:179], v36 offset:34816
    v_mfma_f32_16x16x32_bf16 v[188:191], v[92:95], v[28:31], v[188:191]
    ds_read_b128 a[180:183], v36 offset:38912
    buffer_load_dwordx4 v14, s[8:11], s51 offen offset:2048 lds
    v_mfma_f32_16x16x32_bf16 v[196:199], v[28:31], v[124:127], v[196:199]
    ds_read_b128 a[184:187], v36 offset:43008
    v_mfma_f32_16x16x32_bf16 v[200:203], v[124:127], v[124:127], v[200:203]
    ds_read_b128 a[188:191], v36 offset:47104
    ds_read_b128 v[136:139], v38 offset:34816
    s_cmp_lg_u32 s92, 2
    s_cbranch_scc1 nores_4
    v_xor_b32 v8, 0, v78
    ds_read_b64 v[80:81], v8
    v_xor_b32 v8, 32, v78
    ds_read_b64 v[82:83], v8
    v_xor_b32 v8, 64, v78
    ds_read_b64 v[84:85], v8
    v_xor_b32 v8, 96, v78
    ds_read_b64 v[86:87], v8
nores_4:
    s_waitcnt lgkmcnt(15)
    v_mfma_f32_16x16x32_bf16 v[156:159], v[96:99], a[144:147], v[156:159]
    buffer_load_dwordx4 v14, s[8:11], s52 offen offset:3072 lds
    v_mfma_f32_16x16x32_bf16 v[160:163], v[96:99], a[148:151], v[160:163]
    v_mfma_f32_16x16x32_bf16 v[164:167], v[96:99], a[152:155], v[164:167]
    v_mfma_f32_16x16x32_bf16 v[168:171], v[96:99], a[156:159], v[168:171]
    v_mfma_f32_16x16x32_bf16 v[188:191], v[96:99], v[28:31], v[188:191]
    s_waitcnt lgkmcnt(14)
    v_mfma_f32_16x16x32_bf16 v[196:199], v[28:31], v[128:131], v[196:199]
    s_add_u32 m0, s49, 0x0
    s_mul_i32 s3, s86, 3
    s_add_u32 s3, s3, 2048
    v_add_u32 v14, s3, v7
    buffer_load_dwordx4 v14, s[8:11], 0 offen offset:0 lds
ahead_k1_0:
    s_cbranch_execz return_k1
    v_mfma_f32_16x16x32_bf16 v[200:203], v[128:131], v[128:131], v[200:203]
    buffer_load_dwordx4 v14, s[8:11], s50 offen offset:1024 lds
    buffer_load_dwordx4 v14, s[8:11], s51 offen offset:2048 lds
    buffer_load_dwordx4 v14, s[8:11], s52 offen offset:3072 lds
    s_waitcnt vmcnt(12)
    s_waitcnt lgkmcnt(0)
    s_barrier
    v_mfma_f32_16x16x32_bf16 v[156:159], v[100:103], a[160:163], v[156:159]
    ds_read_b64_tr_b16 v[108:109], v33 offset:49152
    v_mfma_f32_16x16x32_bf16 v[160:163], v[100:103], a[164:167], v[160:163]
    ds_read_b64_tr_b16 v[110:111], v33 offset:57344
    v_mfma_f32_16x16x32_bf16 v[164:167], v[100:103], a[168:171], v[164:167]
    ds_read_b128 a[192:195], v35 offset:49152
    ds_read_b128 a[196:199], v35 offset:53248
    buffer_load_dword v24, v25, s[36:39], 0 offen sc1
    v_mfma_f32_16x16x32_bf16 v[168:171], v[100:103], a[172:175], v[168:171]
    ds_read_b128 a[200:203], v35 offset:57344
    v_mfma_f32_16x16x32_bf16 v[188:191], v[100:103], v[28:31], v[188:191]
    ds_read_b128 a[204:207], v35 offset:61440
    v_mfma_f32_16x16x32_bf16 v[196:199], v[28:31], v[132:135], v[196:199]
    ds_read_b128 v[140:143], v37 offset:49152
    ds_read_b64_tr_b16 v[112:113], v33 offset:50176
    v_mfma_f32_16x16x32_bf16 v[200:203], v[132:135], v[132:135], v[200:203]
    ds_read_b64_tr_b16 v[114:115], v33 offset:58368
    s_add_u32 m0, s49, 0x4000
    s_mul_i32 s3, s87, 3
    s_add_u32 s3, s3, 2048
    v_add_u32 v14, s3, v7
    buffer_load_dwordx4 v14, s[8:11], 0 offen offset:0 lds
    v_mfma_f32_16x16x32_bf16 v[156:159], v[104:107], a[176:179], v[156:159]
    ds_read_b128 a[208:211], v36 offset:49152
    v_mfma_f32_16x16x32_bf16 v[160:163], v[104:107], a[180:183], v[160:163]
    ds_read_b128 a[212:215], v36 offset:53248
    ds_read_b128 a[216:219], v36 offset:57344
    v_mfma_f32_16x16x32_bf16 v[164:167], v[104:107], a[184:187], v[164:167]
    ds_read_b128 a[220:223], v36 offset:61440
    v_mfma_f32_16x16x32_bf16 v[168:171], v[104:107], a[188:191], v[168:171]
    ds_read_b128 v[144:147], v38 offset:49152
    buffer_load_dwordx4 v14, s[8:11], s50 offen offset:1024 lds
    v_mfma_f32_16x16x32_bf16 v[188:191], v[104:107], v[28:31], v[188:191]
    ds_read_b64_tr_b16 v[116:117], v33 offset:51200
    ds_read_b64_tr_b16 v[118:119], v33 offset:59392
    v_mfma_f32_16x16x32_bf16 v[196:199], v[28:31], v[136:139], v[196:199]
    ds_read_b128 a[224:227], v35 offset:51200
    v_mfma_f32_16x16x32_bf16 v[200:203], v[136:139], v[136:139], v[200:203]
    ds_read_b128 a[228:231], v35 offset:55296
    s_waitcnt lgkmcnt(15)
    v_mfma_f32_16x16x32_bf16 v[156:159], v[108:111], a[192:195], v[156:159]
    ds_read_b128 a[232:235], v35 offset:59392
    ds_read_b128 a[236:239], v35 offset:63488
    buffer_load_dwordx4 v14, s[8:11], s51 offen offset:2048 lds
    s_waitcnt lgkmcnt(15)
    v_mfma_f32_16x16x32_bf16 v[160:163], v[108:111], a[196:199], v[160:163]
    ds_read_b128 v[148:151], v37 offset:51200
    v_mfma_f32_16x16x32_bf16 v[164:167], v[108:111], a[200:203], v[164:167]
    ds_read_b64_tr_b16 v[120:121], v33 offset:52224
    s_waitcnt lgkmcnt(15)
    v_mfma_f32_16x16x32_bf16 v[168:171], v[108:111], a[204:207], v[168:171]
    ds_read_b64_tr_b16 v[122:123], v33 offset:60416
    ds_read_b128 a[240:243], v36 offset:51200
    v_mfma_f32_16x16x32_bf16 v[188:191], v[108:111], v[28:31], v[188:191]
    ds_read_b128 a[244:247], v36 offset:55296
    buffer_load_dwordx4 v14, s[8:11], s52 offen offset:3072 lds
    v_mfma_f32_16x16x32_bf16 v[196:199], v[28:31], v[140:143], v[196:199]
    ds_read_b128 a[248:251], v36 offset:59392
    v_mfma_f32_16x16x32_bf16 v[200:203], v[140:143], v[140:143], v[200:203]
    ds_read_b128 a[252:255], v36 offset:63488
    ds_read_b128 v[152:155], v38 offset:51200
    s_cmp_lg_u32 s92, 3
    s_cbranch_scc1 nores_5
    v_xor_b32 v8, 0, v78
    ds_read_b64 v[80:81], v8
    v_xor_b32 v8, 32, v78
    ds_read_b64 v[82:83], v8
    v_xor_b32 v8, 64, v78
    ds_read_b64 v[84:85], v8
    v_xor_b32 v8, 96, v78
    ds_read_b64 v[86:87], v8
nores_5:
    s_waitcnt lgkmcnt(15)
    v_mfma_f32_16x16x32_bf16 v[156:159], v[112:115], a[208:211], v[156:159]
    s_add_u32 m0, s49, 0x10000
    s_mul_i32 s3, s84, 3
    s_add_u32 s3, s3, 0
    v_add_u32 v14, s3, v7
    buffer_load_dwordx4 v14, s[8:11], 0 offen offset:0 lds
    v_mfma_f32_16x16x32_bf16 v[160:163], v[112:115], a[212:215], v[160:163]
    v_mfma_f32_16x16x32_bf16 v[164:167], v[112:115], a[216:219], v[164:167]
    v_mfma_f32_16x16x32_bf16 v[168:171], v[112:115], a[220:223], v[168:171]
    v_mfma_f32_16x16x32_bf16 v[188:191], v[112:115], v[28:31], v[188:191]
    s_waitcnt lgkmcnt(14)
    v_mfma_f32_16x16x32_bf16 v[196:199], v[28:31], v[144:147], v[196:199]
    buffer_load_dwordx4 v14, s[8:11], s50 offen offset:1024 lds
    v_mfma_f32_16x16x32_bf16 v[200:203], v[144:147], v[144:147], v[200:203]
    s_waitcnt vmcnt(15)
    s_waitcnt lgkmcnt(0)
    s_barrier
    v_mfma_f32_16x16x32_bf16 v[156:159], v[116:119], a[224:227], v[156:159]
    ds_read_b64_tr_b16 v[92:93], v34 offset:0
    ds_read_b64_tr_b16 v[94:95], v34 offset:8192
    v_mfma_f32_16x16x32_bf16 v[160:163], v[116:119], a[228:231], v[160:163]
    ds_read_b64_tr_b16 v[96:97], v34 offset:1024
    ds_read_b64_tr_b16 v[98:99], v34 offset:9216
    v_mfma_f32_16x16x32_bf16 v[164:167], v[116:119], a[232:235], v[164:167]
    ds_read_b64_tr_b16 v[100:101], v34 offset:2048
    ds_read_b64_tr_b16 v[102:103], v34 offset:10240
    buffer_load_dwordx4 v14, s[8:11], s51 offen offset:2048 lds
    v_mfma_f32_16x16x32_bf16 v[168:171], v[116:119], a[236:239], v[168:171]
    ds_read_b64_tr_b16 v[104:105], v34 offset:3072
    ds_read_b64_tr_b16 v[106:107], v34 offset:11264
    v_mfma_f32_16x16x32_bf16 v[188:191], v[116:119], v[28:31], v[188:191]
    v_mfma_f32_16x16x32_bf16 v[196:199], v[28:31], v[148:151], v[196:199]
    v_mfma_f32_16x16x32_bf16 v[200:203], v[148:151], v[148:151], v[200:203]
    v_mfma_f32_16x16x32_bf16 v[156:159], v[120:123], a[240:243], v[156:159]
    buffer_load_dwordx4 v14, s[8:11], s52 offen offset:3072 lds
    v_mfma_f32_16x16x32_bf16 v[160:163], v[120:123], a[244:247], v[160:163]
    v_mfma_f32_16x16x32_bf16 v[164:167], v[120:123], a[248:251], v[164:167]
    v_mfma_f32_16x16x32_bf16 v[168:171], v[120:123], a[252:255], v[168:171]
    v_mfma_f32_16x16x32_bf16 v[188:191], v[120:123], v[28:31], v[188:191]
    v_mfma_f32_16x16x32_bf16 v[196:199], v[28:31], v[152:155], v[196:199]
    s_add_u32 m0, s49, 0x14000
    s_mul_i32 s3, s85, 3
    s_add_u32 s3, s3, 0
    v_add_u32 v14, s3, v7
    buffer_load_dwordx4 v14, s[8:11], 0 offen offset:0 lds
    v_mfma_f32_16x16x32_bf16 v[200:203], v[152:155], v[152:155], v[200:203]
    s_waitcnt lgkmcnt(6)
    v_mfma_f32_16x16x32_bf16 v[172:175], a[0:3], v[92:95], 0
    v_mfma_f32_16x16x32_bf16 v[176:179], a[4:7], v[92:95], 0
    v_cndmask_b32 v236, v200, v201, s[64:65]
    v_mfma_f32_16x16x32_bf16 v[180:183], a[8:11], v[92:95], 0
    v_cndmask_b32 v236, v236, v202, s[66:67]
    v_cndmask_b32 v236, v236, v203, s[68:69]
    v_mfma_f32_16x16x32_bf16 v[184:187], a[12:15], v[92:95], 0
    buffer_load_dwordx4 v14, s[8:11], s50 offen offset:1024 lds
    v_mul_f32 v237, 0x3b000000, v196
    v_mfma_f32_16x16x32_bf16 v[192:195], v[28:31], v[92:95], 0
    v_mul_f32 v236, 0x3b000000, v236
    v_fma_f32 v236, -v237, v237, v236
    s_waitcnt lgkmcnt(4)
    v_mfma_f32_16x16x32_bf16 v[172:175], a[16:19], v[96:99], v[172:175]
    v_max_f32 v236, 0, v236
    v_add_f32 v238, 0x3727c5ac, v236
    v_mfma_f32_16x16x32_bf16 v[176:179], a[20:23], v[96:99], v[176:179]
    v_rsq_f32 v238, v238
    v_mfma_f32_16x16x32_bf16 v[180:183], a[24:27], v[96:99], v[180:183]
    buffer_load_dwordx4 v14, s[8:11], s51 offen offset:2048 lds
    v_mul_f32 v239, v237, v238
    v_mfma_f32_16x16x32_bf16 v[184:187], a[28:31], v[96:99], v[184:187]
    v_mfma_f32_16x16x32_bf16 v[192:195], v[28:31], v[96:99], v[192:195]
    s_mov_b32 exec_lo, 0x00f0000f
    s_mov_b32 exec_hi, 0xf0000f00
    ds_write_b64 v39, v[238:239]
    s_mov_b64 exec, -1
    s_waitcnt vmcnt(16)
    s_waitcnt lgkmcnt(0)
    s_barrier
    s_cmp_lg_u32 s46, 0
    s_cbranch_scc1 notag_6
    s_waitcnt vmcnt(11)
    v_cmp_eq_u32 vcc, 0, v24
    s_nop 0
    s_cbranch_vccz polled_8
    s_mov_b32 s57, 0x40000
poll_7:
    buffer_load_dword v24, v25, s[36:39], 0 offen sc1
    s_waitcnt vmcnt(0)
    v_cmp_eq_u32 vcc, 0, v24
    s_nop 0
    s_cbranch_vccz polled_8
    s_sub_u32 s57, s57, 1
    s_cbranch_scc0 poll_7
polled_8:
    ds_write_b32 v3, v24 offset:50176
notag_6:
    v_mfma_f32_16x16x32_bf16 v[172:175], a[32:35], v[100:103], v[172:175]
    ds_read_b64 v[204:205], v40 offset:49152
    ds_read_b64 v[206:207], v40 offset:49280
    s_waitcnt lgkmcnt(1)
    v_mul_f32 v236, v205, v188
    v_mfma_f32_16x16x32_bf16 v[176:179], a[36:39], v[100:103], v[176:179]
    ds_read_b64 v[208:209], v40 offset:49408
    ds_read_b64 v[210:211], v40 offset:49536
    v_mul_f32 v237, v205, v189
    v_mfma_f32_16x16x32_bf16 v[180:183], a[40:43], v[100:103], v[180:183]
    ds_read_b64_tr_b16 v[108:109], v34 offset:16384
    ds_read_b64_tr_b16 v[110:111], v34 offset:24576
    buffer_load_dwordx4 v14, s[8:11], s52 offen offset:3072 lds
    v_mfma_f32_16x16x32_bf16 v[184:187], a[44:47], v[100:103], v[184:187]
    ds_read_b64_tr_b16 v[112:113], v34 offset:17408
    ds_read_b64_tr_b16 v[114:115], v34 offset:25600
    v_mul_f32 v238, v205, v190
    v_mfma_f32_16x16x32_bf16 v[192:195], v[28:31], v[100:103], v[192:195]
    ds_read_b64_tr_b16 v[116:117], v34 offset:18432
    ds_read_b64_tr_b16 v[118:119], v34 offset:26624
    v_mul_f32 v239, v205, v191
    v_mfma_f32_16x16x32_bf16 v[172:175], a[48:51], v[104:107], v[172:175]
    ds_read_b64_tr_b16 v[120:121], v34 offset:19456
    ds_read_b64_tr_b16 v[122:123], v34 offset:27648
    v_fma_f32 v236, v156, v204, -v236
    v_mfma_f32_16x16x32_bf16 v[176:179], a[52:55], v[104:107], v[176:179]
    s_add_u32 m0, s49, 0x18000
    s_mul_i32 s3, s86, 3
    s_add_u32 s3, s3, 0
    v_add_u32 v14, s3, v7
    buffer_load_dwordx4 v14, s[8:11], 0 offen offset:0 lds
    v_mfma_f32_16x16x32_bf16 v[180:183], a[56:59], v[104:107], v[180:183]
    v_fma_f32 v237, v157, v204, -v237
    v_fma_f32 v238, v158, v204, -v238
    v_fma_f32 v239, v159, v204, -v239
    v_mfma_f32_16x16x32_bf16 v[184:187], a[60:63], v[104:107], v[184:187]
    v_cvt_pk_bf16_f32 v212, v236, v237
    v_cvt_pk_bf16_f32 v213, v238, v239
    s_waitcnt lgkmcnt(10)
    v_mul_f32 v240, v207, v188
    v_mfma_f32_16x16x32_bf16 v[192:195], v[28:31], v[104:107], v[192:195]
    v_mul_f32 v241, v207, v189
    v_mul_f32 v242, v207, v190
    v_mul_f32 v243, v207, v191
    s_waitcnt lgkmcnt(6)
    v_mfma_f32_16x16x32_bf16 v[172:175], a[64:67], v[108:111], v[172:175]
    buffer_load_dwordx4 v14, s[8:11], s50 offen offset:1024 lds
    v_fma_f32 v240, v160, v206, -v240
    v_fma_f32 v241, v161, v206, -v241
    v_mfma_f32_16x16x32_bf16 v[176:179], a[68:71], v[108:111], v[176:179]
    v_fma_f32 v242, v162, v206, -v242
    v_fma_f32 v243, v163, v206, -v243
    v_cvt_pk_bf16_f32 v214, v240, v241
    v_mfma_f32_16x16x32_bf16 v[180:183], a[72:75], v[108:111], v[180:183]
    v_cvt_pk_bf16_f32 v215, v242, v243
    v_mul_f32 v204, 0x3eb8aa3b, v204
    v_mul_f32 v205, 0x3eb8aa3b, v205
    v_mfma_f32_16x16x32_bf16 v[184:187], a[76:79], v[108:111], v[184:187]
    v_permlane16_swap_b32 v212, v214
    v_permlane16_swap_b32 v213, v215
    v_mul_f32 v206, 0x3eb8aa3b, v206
    v_mfma_f32_16x16x32_bf16 v[192:195], v[28:31], v[108:111], v[192:195]
    buffer_load_dwordx4 v14, s[8:11], s51 offen offset:2048 lds
    buffer_store_dwordx4 v[212:215], v1, s[40:43], s94 offen offset:0 sc1
    v_mul_f32 v207, 0x3eb8aa3b, v207
    s_waitcnt lgkmcnt(4)
    v_mfma_f32_16x16x32_bf16 v[172:175], a[80:83], v[112:115], v[172:175]
    v_mul_f32 v236, v209, v188
    v_mul_f32 v237, v209, v189
    v_mul_f32 v238, v209, v190
    v_mfma_f32_16x16x32_bf16 v[176:179], a[84:87], v[112:115], v[176:179]
    v_mul_f32 v239, v209, v191
    v_fma_f32 v236, v164, v208, -v236
    v_fma_f32 v237, v165, v208, -v237
    v_mfma_f32_16x16x32_bf16 v[180:183], a[88:91], v[112:115], v[180:183]
    v_fma_f32 v238, v166, v208, -v238
    v_fma_f32 v239, v167, v208, -v239
    v_cvt_pk_bf16_f32 v216, v236, v237
    v_mfma_f32_16x16x32_bf16 v[184:187], a[92:95], v[112:115], v[184:187]
    buffer_load_dwordx4 v14, s[8:11], s52 offen offset:3072 lds
    v_cvt_pk_bf16_f32 v217, v238, v239
    v_mul_f32 v240, v211, v188
    v_mfma_f32_16x16x32_bf16 v[192:195], v[28:31], v[112:115], v[192:195]
    v_mul_f32 v241, v211, v189
    v_mul_f32 v242, v211, v190
    v_mul_f32 v243, v211, v191
    s_waitcnt vmcnt(18)
    s_waitcnt lgkmcnt(0)
    s_barrier
    s_waitcnt vmcnt(17)
    ds_read_b32 v24, v3 offset:50176
    v_mov_b32 v25, s48
    v_mfma_f32_16x16x32_bf16 v[172:175], a[96:99], v[116:119], v[172:175]
    ds_read_b64_tr_b16 v[92:93], v32 offset:0
    ds_read_b64_tr_b16 v[94:95], v32 offset:8192
    s_add_u32 m0, s49, 0x1c000
    s_mul_i32 s3, s87, 3
    s_add_u32 s3, s3, 0
    v_add_u32 v14, s3, v7
    buffer_load_dwordx4 v14, s[8:11], 0 offen offset:0 lds
    v_mfma_f32_16x16x32_bf16 v[176:179], a[100:103], v[116:119], v[176:179]
    ds_read_b64_tr_b16 v[96:97], v32 offset:1024
    ds_read_b64_tr_b16 v[98:99], v32 offset:9216
    v_fma_f32 v240, v168, v210, -v240
    v_mfma_f32_16x16x32_bf16 v[180:183], a[104:107], v[116:119], v[180:183]
    ds_read_b64_tr_b16 v[100:101], v32 offset:2048
    ds_read_b64_tr_b16 v[102:103], v32 offset:10240
    v_fma_f32 v241, v169, v210, -v241
    v_mfma_f32_16x16x32_bf16 v[184:187], a[108:111], v[116:119], v[184:187]
    ds_read_b64_tr_b16 v[104:105], v32 offset:3072
    ds_read_b64_tr_b16 v[106:107], v32 offset:11264
    v_fma_f32 v242, v170, v210, -v242
    v_mfma_f32_16x16x32_bf16 v[192:195], v[28:31], v[116:119], v[192:195]
    ds_read_b128 v[124:127], v41 offset:49152
    ds_read_b128 v[128:131], v41 offset:49168
    buffer_load_dwordx4 v14, s[8:11], s50 offen offset:1024 lds
    v_mfma_f32_16x16x32_bf16 v[172:175], a[112:115], v[120:123], v[172:175]
    ds_read_b128 v[132:135], v41 offset:49280
    ds_read_b128 v[136:139], v41 offset:49296
    v_fma_f32 v243, v171, v210, -v243
    v_mfma_f32_16x16x32_bf16 v[176:179], a[116:119], v[120:123], v[176:179]
    ds_read_b128 v[140:143], v41 offset:49408
    ds_read_b128 v[144:147], v41 offset:49424
    v_cvt_pk_bf16_f32 v218, v240, v241
    v_mfma_f32_16x16x32_bf16 v[180:183], a[120:123], v[120:123], v[180:183]
    ds_read_b128 v[148:151], v41 offset:49536
    ds_read_b128 v[152:155], v41 offset:49552
    buffer_load_dwordx4 v14, s[8:11], s51 offen offset:2048 lds
    v_mfma_f32_16x16x32_bf16 v[184:187], a[124:127], v[120:123], v[184:187]
    v_cvt_pk_bf16_f32 v219, v242, v243
    v_mul_f32 v208, 0x3eb8aa3b, v208
    v_mul_f32 v209, 0x3eb8aa3b, v209
    v_mfma_f32_16x16x32_bf16 v[192:195], v[28:31], v[120:123], v[192:195]
    v_permlane16_swap_b32 v216, v218
    v_permlane16_swap_b32 v217, v219
    v_mul_f32 v210, 0x3eb8aa3b, v210
    s_waitcnt lgkmcnt(14)
    v_mfma_f32_16x16x32_bf16 v[172:175], a[128:131], v[92:95], v[172:175]
    buffer_store_dwordx4 v[216:219], v1, s[40:43], s94 offen offset:1024 sc1
    v_mul_f32 v211, 0x3eb8aa3b, v211
    v_mfma_f32_16x16x32_bf16 v[176:179], a[132:135], v[92:95], v[176:179]
    v_mfma_f32_16x16x32_bf16 v[180:183], a[136:139], v[92:95], v[180:183]
    v_mfma_f32_16x16x32_bf16 v[184:187], a[140:143], v[92:95], v[184:187]
    v_mfma_f32_16x16x32_bf16 v[192:195], v[28:31], v[92:95], v[192:195]
    buffer_load_dwordx4 v14, s[8:11], s52 offen offset:3072 lds
    s_waitcnt lgkmcnt(12)
    v_mfma_f32_16x16x32_bf16 v[172:175], a[144:147], v[96:99], v[172:175]
    v_mfma_f32_16x16x32_bf16 v[176:179], a[148:151], v[96:99], v[176:179]
    v_mfma_f32_16x16x32_bf16 v[180:183], a[152:155], v[96:99], v[180:183]
    v_mfma_f32_16x16x32_bf16 v[184:187], a[156:159], v[96:99], v[184:187]
    v_mfma_f32_16x16x32_bf16 v[192:195], v[28:31], v[96:99], v[192:195]
    s_add_u32 m0, s49, 0x8000
    v_add_u32 v16, s84, v77
    buffer_load_dwordx4 v16, s[12:15], 0 offen offset:0 lds
    s_cmp_eq_u32 s46, 0
    s_mov_b64 exec, 0
    s_cbranch_scc1 ahead_k7_0
    s_cmp_eq_u32 s46, 1
    s_cbranch_scc1 ahead_k7_1
    s_branch return_k7
return_k7:
    s_mov_b64 exec, -1
    s_waitcnt vmcnt(19)
    s_waitcnt lgkmcnt(0)
    s_barrier
    v_readfirstlane_b32 s95, v24
    v_mfma_f32_16x16x32_bf16 v[172:175], a[160:163], v[100:103], v[172:175]
    ds_read_b64_tr_b16 v[108:109], v32 offset:16384
    ds_read_b64_tr_b16 v[110:111], v32 offset:24576
    v_mfma_f32_16x16x32_bf16 v[176:179], a[164:167], v[100:103], v[176:179]
    ds_read_b64_tr_b16 v[112:113], v32 offset:17408
    ds_read_b64_tr_b16 v[114:115], v32 offset:25600
    v_mfma_f32_16x16x32_bf16 v[180:183], a[168:171], v[100:103], v[180:183]
    ds_read_b64_tr_b16 v[116:117], v32 offset:18432
    ds_read_b64_tr_b16 v[118:119], v32 offset:26624
    buffer_load_dwordx4 v16, s[12:15], s53 offen offset:1024 lds
    v_mfma_f32_16x16x32_bf16 v[184:187], a[172:175], v[100:103], v[184:187]
    ds_read_b64_tr_b16 v[120:121], v32 offset:19456
    ds_read_b64_tr_b16 v[122:123], v32 offset:27648
    v_mfma_f32_16x16x32_bf16 v[192:195], v[28:31], v[100:103], v[192:195]
    v_mfma_f32_16x16x32_bf16 v[172:175], a[176:179], v[104:107], v[172:175]
    v_mfma_f32_16x16x32_bf16 v[176:179], a[180:183], v[104:107], v[176:179]
    v_mfma_f32_16x16x32_bf16 v[180:183], a[184:187], v[104:107], v[180:183]
    buffer_load_dwordx4 v16, s[12:15], s54 offen offset:2048 lds
    v_mfma_f32_16x16x32_bf16 v[184:187], a[188:191], v[104:107], v[184:187]
    v_mfma_f32_16x16x32_bf16 v[192:195], v[28:31], v[104:107], v[192:195]
    s_waitcnt lgkmcnt(6)
    v_mfma_f32_16x16x32_bf16 v[172:175], a[192:195], v[108:111], v[172:175]
    v_mfma_f32_16x16x32_bf16 v[176:179], a[196:199], v[108:111], v[176:179]
    v_mfma_f32_16x16x32_bf16 v[180:183], a[200:203], v[108:111], v[180:183]
    buffer_load_dwordx4 v16, s[12:15], s55 offen offset:3072 lds
    v_mfma_f32_16x16x32_bf16 v[184:187], a[204:207], v[108:111], v[184:187]
    v_mfma_f32_16x16x32_bf16 v[192:195], v[28:31], v[108:111], v[192:195]
    s_waitcnt lgkmcnt(4)
    v_mfma_f32_16x16x32_bf16 v[172:175], a[208:211], v[112:115], v[172:175]
    v_mfma_f32_16x16x32_bf16 v[176:179], a[212:215], v[112:115], v[176:179]
    v_mfma_f32_16x16x32_bf16 v[180:183], a[216:219], v[112:115], v[180:183]
    v_mfma_f32_16x16x32_bf16 v[184:187], a[220:223], v[112:115], v[184:187]
    v_mfma_f32_16x16x32_bf16 v[192:195], v[28:31], v[112:115], v[192:195]
    s_waitcnt vmcnt(18)
    s_waitcnt lgkmcnt(0)
    s_barrier
    s_waitcnt vmcnt(5)
    buffer_store_dwordx2 v[24:25], v2, s[40:43], s56 offen offset:0 sc1
    v_mfma_f32_16x16x32_bf16 v[172:175], a[224:227], v[116:119], v[172:175]
    ds_read_b64_tr_b16 v[92:93], v33 offset:0
    ds_read_b64_tr_b16 v[94:95], v33 offset:8192
    v_mfma_f32_16x16x32_bf16 v[176:179], a[228:231], v[116:119], v[176:179]
    ds_read_b64_tr_b16 v[96:97], v33 offset:1024
    ds_read_b64_tr_b16 v[98:99], v33 offset:9216
    v_mfma_f32_16x16x32_bf16 v[180:183], a[232:235], v[116:119], v[180:183]
    ds_read_b64_tr_b16 v[100:101], v33 offset:2048
    ds_read_b64_tr_b16 v[102:103], v33 offset:10240
    v_mfma_f32_16x16x32_bf16 v[184:187], a[236:239], v[116:119], v[184:187]
    ds_read_b64_tr_b16 v[104:105], v33 offset:3072
    ds_read_b64_tr_b16 v[106:107], v33 offset:11264
    v_mfma_f32_16x16x32_bf16 v[192:195], v[28:31], v[116:119], v[192:195]
    v_mfma_f32_16x16x32_bf16 v[172:175], a[240:243], v[120:123], v[172:175]
    v_mfma_f32_16x16x32_bf16 v[176:179], a[244:247], v[120:123], v[176:179]
    v_mfma_f32_16x16x32_bf16 v[180:183], a[248:251], v[120:123], v[180:183]
    v_mfma_f32_16x16x32_bf16 v[184:187], a[252:255], v[120:123], v[184:187]
    v_mfma_f32_16x16x32_bf16 v[192:195], v[28:31], v[120:123], v[192:195]
    s_waitcnt lgkmcnt(6)
    v_mfma_f32_16x16x32_bf16 v[156:159], v[92:95], a[0:3], 0
    v_mov_b32 v222, v42
    v_mov_b32 v223, v42
    s_nop 1
    v_mul_f32 v236, v125, v192
    v_mul_f32 v237, v127, v192
    v_mfma_f32_16x16x32_bf16 v[160:163], v[92:95], a[4:7], 0
    v_mul_f32 v238, v129, v192
    v_mul_f32 v239, v131, v192
    v_fma_f32 v236, v172, v124, -v236
    v_fma_f32 v237, v173, v126, -v237
    v_mfma_f32_16x16x32_bf16 v[164:167], v[92:95], a[8:11], 0
    v_fma_f32 v238, v174, v128, -v238
    v_fma_f32 v239, v175, v130, -v239
    v_cvt_pk_bf16_f32 v220, v236, v237
    v_cvt_pk_bf16_f32 v221, v238, v239
    v_mfma_f32_16x16x32_bf16 v[168:171], v[92:95], a[12:15], 0
    v_permlane16_swap_b32 v220, v222
    v_permlane16_swap_b32 v221, v223
    v_mfma_f32_16x16x32_bf16 v[188:191], v[92:95], v[28:31], 0
    v_permlane32_swap_b32 v220, v222
    v_permlane32_swap_b32 v221, v223
    buffer_store_dwordx4 v[220:223], v27, s[40:43], s94 offen offset:0 sc1
    v_mov_b32 v226, v42
    s_waitcnt lgkmcnt(4)
    v_mfma_f32_16x16x32_bf16 v[156:159], v[96:99], a[16:19], v[156:159]
    v_mov_b32 v227, v42
    v_mul_f32 v240, v133, v192
    v_mul_f32 v241, v135, v192
    v_mul_f32 v242, v137, v192
    v_mfma_f32_16x16x32_bf16 v[160:163], v[96:99], a[20:23], v[160:163]
    v_mul_f32 v243, v139, v192
    v_fma_f32 v240, v176, v132, -v240
    v_fma_f32 v241, v177, v134, -v241
    v_fma_f32 v242, v178, v136, -v242
    v_mfma_f32_16x16x32_bf16 v[164:167], v[96:99], a[24:27], v[164:167]
    v_fma_f32 v243, v179, v138, -v243
    v_cvt_pk_bf16_f32 v224, v240, v241
    v_cvt_pk_bf16_f32 v225, v242, v243
    v_mfma_f32_16x16x32_bf16 v[168:171], v[96:99], a[28:31], v[168:171]
    v_permlane16_swap_b32 v224, v226
    v_permlane16_swap_b32 v225, v227
    s_nop 0
    v_permlane32_swap_b32 v224, v226
    v_mfma_f32_16x16x32_bf16 v[188:191], v[96:99], v[28:31], v[188:191]
    v_permlane32_swap_b32 v225, v227
    buffer_store_dwordx4 v[224:227], v27, s[40:43], s94 offen offset:512 sc1
    v_mov_b32 v230, v42
    v_mov_b32 v231, v42
    s_waitcnt lgkmcnt(0)
    s_barrier
    v_mfma_f32_16x16x32_bf16 v[156:159], v[100:103], a[32:35], v[156:159]
    ds_read_b64_tr_b16 v[108:109], v33 offset:16384
    ds_read_b64_tr_b16 v[110:111], v33 offset:24576
    v_mul_f32 v236, v141, v192
    v_mul_f32 v237, v143, v192
    v_mfma_f32_16x16x32_bf16 v[160:163], v[100:103], a[36:39], v[160:163]
    ds_read_b64_tr_b16 v[112:113], v33 offset:17408
    ds_read_b64_tr_b16 v[114:115], v33 offset:25600
    v_mul_f32 v238, v145, v192
    v_mul_f32 v239, v147, v192
    v_mfma_f32_16x16x32_bf16 v[164:167], v[100:103], a[40:43], v[164:167]
    ds_read_b64_tr_b16 v[116:117], v33 offset:18432
    ds_read_b64_tr_b16 v[118:119], v33 offset:26624
    s_add_u32 m0, s49, 0x20000
    v_add_u32 v16, s85, v77
    buffer_load_dwordx4 v16, s[12:15], 0 offen offset:0 lds
    v_mfma_f32_16x16x32_bf16 v[168:171], v[100:103], a[44:47], v[168:171]
    ds_read_b64_tr_b16 v[120:121], v33 offset:19456
    ds_read_b64_tr_b16 v[122:123], v33 offset:27648
    v_fma_f32 v236, v180, v140, -v236
    v_fma_f32 v237, v181, v142, -v237
    v_mfma_f32_16x16x32_bf16 v[188:191], v[100:103], v[28:31], v[188:191]
    v_fma_f32 v238, v182, v144, -v238
    v_fma_f32 v239, v183, v146, -v239
    v_cvt_pk_bf16_f32 v228, v236, v237
    v_cvt_pk_bf16_f32 v229, v238, v239
    v_mfma_f32_16x16x32_bf16 v[156:159], v[104:107], a[48:51], v[156:159]
    v_permlane16_swap_b32 v228, v230
    v_permlane16_swap_b32 v229, v231
    v_mfma_f32_16x16x32_bf16 v[160:163], v[104:107], a[52:55], v[160:163]
    buffer_load_dwordx4 v16, s[12:15], s53 offen offset:1024 lds
    v_permlane32_swap_b32 v228, v230
    v_permlane32_swap_b32 v229, v231
    buffer_store_dwordx4 v[228:231], v27, s[40:43], s94 offen offset:1024 sc1
    v_mfma_f32_16x16x32_bf16 v[164:167], v[104:107], a[56:59], v[164:167]
    v_mov_b32 v234, v42
    v_mov_b32 v235, v42
    v_mul_f32 v240, v149, v192
    v_mul_f32 v241, v151, v192
    v_mfma_f32_16x16x32_bf16 v[168:171], v[104:107], a[60:63], v[168:171]
    v_mul_f32 v242, v153, v192
    v_mul_f32 v243, v155, v192
    v_fma_f32 v240, v184, v148, -v240
    v_fma_f32 v241, v185, v150, -v241
    v_mfma_f32_16x16x32_bf16 v[188:191], v[104:107], v[28:31], v[188:191]
    v_fma_f32 v242, v186, v152, -v242
    v_fma_f32 v243, v187, v154, -v243
    v_cvt_pk_bf16_f32 v232, v240, v241
    v_cvt_pk_bf16_f32 v233, v242, v243
    s_waitcnt lgkmcnt(6)
    v_mfma_f32_16x16x32_bf16 v[156:159], v[108:111], a[64:67], v[156:159]
    buffer_load_dwordx4 v16, s[12:15], s54 offen offset:2048 lds
    v_permlane16_swap_b32 v232, v234
    v_permlane16_swap_b32 v233, v235
    v_mfma_f32_16x16x32_bf16 v[160:163], v[108:111], a[68:71], v[160:163]
    v_permlane32_swap_b32 v232, v234
    v_permlane32_swap_b32 v233, v235
    buffer_store_dwordx4 v[232:235], v27, s[40:43], s94 offen offset:1536 sc1
    v_mfma_f32_16x16x32_bf16 v[164:167], v[108:111], a[72:75], v[164:167]
    v_mfma_f32_16x16x32_bf16 v[168:171], v[108:111], a[76:79], v[168:171]
    v_mfma_f32_16x16x32_bf16 v[188:191], v[108:111], v[28:31], v[188:191]
    s_waitcnt lgkmcnt(4)
    v_mfma_f32_16x16x32_bf16 v[156:159], v[112:115], a[80:83], v[156:159]
    v_mfma_f32_16x16x32_bf16 v[160:163], v[112:115], a[84:87], v[160:163]
    buffer_load_dwordx4 v16, s[12:15], s55 offen offset:3072 lds
    v_mfma_f32_16x16x32_bf16 v[164:167], v[112:115], a[88:91], v[164:167]
    v_mfma_f32_16x16x32_bf16 v[168:171], v[112:115], a[92:95], v[168:171]
    v_mfma_f32_16x16x32_bf16 v[188:191], v[112:115], v[28:31], v[188:191]
    s_waitcnt lgkmcnt(0)
    s_barrier
    v_mfma_f32_16x16x32_bf16 v[156:159], v[116:119], a[96:99], v[156:159]
    ds_read_b64_tr_b16 v[92:93], v33 offset:32768
    ds_read_b64_tr_b16 v[94:95], v33 offset:40960
    s_add_u32 m0, s49, 0x24000
    v_add_u32 v16, s86, v77
    buffer_load_dwordx4 v16, s[12:15], 0 offen offset:0 lds
    v_mfma_f32_16x16x32_bf16 v[160:163], v[116:119], a[100:103], v[160:163]
    ds_read_b64_tr_b16 v[96:97], v33 offset:33792
    ds_read_b64_tr_b16 v[98:99], v33 offset:41984
    v_mfma_f32_16x16x32_bf16 v[164:167], v[116:119], a[104:107], v[164:167]
    ds_read_b64_tr_b16 v[100:101], v33 offset:34816
    ds_read_b64_tr_b16 v[102:103], v33 offset:43008
    v_mfma_f32_16x16x32_bf16 v[168:171], v[116:119], a[108:111], v[168:171]
    ds_read_b64_tr_b16 v[104:105], v33 offset:35840
    ds_read_b64_tr_b16 v[106:107], v33 offset:44032
    v_mfma_f32_16x16x32_bf16 v[188:191], v[116:119], v[28:31], v[188:191]
    v_mfma_f32_16x16x32_bf16 v[156:159], v[120:123], a[112:115], v[156:159]
    buffer_load_dwordx4 v16, s[12:15], s53 offen offset:1024 lds
    v_mfma_f32_16x16x32_bf16 v[160:163], v[120:123], a[116:119], v[160:163]
    v_mfma_f32_16x16x32_bf16 v[164:167], v[120:123], a[120:123], v[164:167]
    v_mfma_f32_16x16x32_bf16 v[168:171], v[120:123], a[124:127], v[168:171]
    v_mfma_f32_16x16x32_bf16 v[188:191], v[120:123], v[28:31], v[188:191]
    buffer_load_dword v90, v17, s[40:43], 0 offen offset:0 sc1
    s_waitcnt lgkmcnt(6)
    v_mfma_f32_16x16x32_bf16 v[156:159], v[92:95], a[128:131], v[156:159]
    v_mfma_f32_16x16x32_bf16 v[160:163], v[92:95], a[132:135], v[160:163]
    v_mfma_f32_16x16x32_bf16 v[164:167], v[92:95], a[136:139], v[164:167]
    v_mfma_f32_16x16x32_bf16 v[168:171], v[92:95], a[140:143], v[168:171]
    v_mfma_f32_16x16x32_bf16 v[188:191], v[92:95], v[28:31], v[188:191]
    buffer_load_dwordx4 v16, s[12:15], s54 offen offset:2048 lds
    s_waitcnt lgkmcnt(4)
    v_mfma_f32_16x16x32_bf16 v[156:159], v[96:99], a[144:147], v[156:159]
    v_mfma_f32_16x16x32_bf16 v[160:163], v[96:99], a[148:151], v[160:163]
    v_mfma_f32_16x16x32_bf16 v[164:167], v[96:99], a[152:155], v[164:167]
    v_mfma_f32_16x16x32_bf16 v[168:171], v[96:99], a[156:159], v[168:171]
    v_mfma_f32_16x16x32_bf16 v[188:191], v[96:99], v[28:31], v[188:191]
    buffer_load_dwordx4 v16, s[12:15], s55 offen offset:3072 lds
    s_waitcnt vmcnt(18)
    s_waitcnt lgkmcnt(0)
    s_barrier
    v_mfma_f32_16x16x32_bf16 v[156:159], v[100:103], a[160:163], v[156:159]
    ds_read_b64_tr_b16 v[108:109], v33 offset:49152
    ds_read_b64_tr_b16 v[110:111], v33 offset:57344
    v_mfma_f32_16x16x32_bf16 v[160:163], v[100:103], a[164:167], v[160:163]
    ds_read_b64_tr_b16 v[112:113], v33 offset:50176
    ds_read_b64_tr_b16 v[114:115], v33 offset:58368
    v_mfma_f32_16x16x32_bf16 v[164:167], v[100:103], a[168:171], v[164:167]
    ds_read_b64_tr_b16 v[116:117], v33 offset:51200
    ds_read_b64_tr_b16 v[118:119], v33 offset:59392
    v_mfma_f32_16x16x32_bf16 v[168:171], v[100:103], a[172:175], v[168:171]
    ds_read_b64_tr_b16 v[120:121], v33 offset:52224
    ds_read_b64_tr_b16 v[122:123], v33 offset:60416
    s_add_u32 m0, s49, 0x0
    v_add_u32 v16, s87, v77
    buffer_load_dwordx4 v16, s[12:15], 0 offen offset:0 lds
    v_mfma_f32_16x16x32_bf16 v[188:191], v[100:103], v[28:31], v[188:191]
    v_mfma_f32_16x16x32_bf16 v[156:159], v[104:107], a[176:179], v[156:159]
    v_mfma_f32_16x16x32_bf16 v[160:163], v[104:107], a[180:183], v[160:163]
    v_mfma_f32_16x16x32_bf16 v[164:167], v[104:107], a[184:187], v[164:167]
    v_mfma_f32_16x16x32_bf16 v[168:171], v[104:107], a[188:191], v[168:171]
    buffer_load_dwordx4 v16, s[12:15], s53 offen offset:1024 lds
    v_mfma_f32_16x16x32_bf16 v[188:191], v[104:107], v[28:31], v[188:191]
    s_min_u32 s70, s44, 4
    s_bfm_b64 s[50:51], s70, 0
    s_waitcnt vmcnt(4)
    v_cmp_ne_u32 vcc, s95, v90
    s_and_b64 vcc, vcc, s[50:51]
    s_cbranch_vccz polled_10
    s_mov_b32 s57, 0x40000
poll_9:
    buffer_load_dword v90, v17, s[40:43], 0 offen offset:0 sc1
    s_waitcnt vmcnt(0)
    v_cmp_ne_u32 vcc, s95, v90
    s_and_b64 vcc, vcc, s[50:51]
    s_cbranch_vccz polled_10
    s_sub_u32 s57, s57, 1
    s_cbranch_scc0 poll_9
polled_10:
    v_or_b32 v14, s80, v1
    buffer_load_dwordx4 v[144:147], v14, s[40:43], s58 offen offset:1024 sc1
    buffer_load_dwordx4 v[140:143], v14, s[40:43], s58 offen offset:0 sc1
    s_waitcnt lgkmcnt(6)
    v_mfma_f32_16x16x32_bf16 v[156:159], v[108:111], a[192:195], v[156:159]
    v_mfma_f32_16x16x32_bf16 v[160:163], v[108:111], a[196:199], v[160:163]
    v_mfma_f32_16x16x32_bf16 v[164:167], v[108:111], a[200:203], v[164:167]
    v_mfma_f32_16x16x32_bf16 v[168:171], v[108:111], a[204:207], v[168:171]
ahead_k7_0:
    s_cbranch_execz return_k7
    v_mfma_f32_16x16x32_bf16 v[188:191], v[108:111], v[28:31], v[188:191]
    v_or_b32 v14, s81, v1
    buffer_load_dwordx4 v[152:155], v14, s[40:43], s59 offen offset:1024 sc1
    s_waitcnt lgkmcnt(4)
    v_mfma_f32_16x16x32_bf16 v[156:159], v[112:115], a[208:211], v[156:159]
    v_mfma_f32_16x16x32_bf16 v[160:163], v[112:115], a[212:215], v[160:163]
    v_mfma_f32_16x16x32_bf16 v[164:167], v[112:115], a[216:219], v[164:167]
    v_mfma_f32_16x16x32_bf16 v[168:171], v[112:115], a[220:223], v[168:171]
    v_mfma_f32_16x16x32_bf16 v[188:191], v[112:115], v[28:31], v[188:191]
    buffer_load_dwordx4 v[148:151], v14, s[40:43], s59 offen offset:0 sc1
    s_waitcnt lgkmcnt(2)
    v_mfma_f32_16x16x32_bf16 v[188:191], v[116:119], v[28:31], v[188:191]
    s_waitcnt lgkmcnt(0)
    v_mfma_f32_16x16x32_bf16 v[188:191], v[120:123], v[28:31], v[188:191]
    v_mfma_f32_16x16x32_bf16 v[156:159], v[116:119], a[224:227], v[156:159]
    v_mfma_f32_16x16x32_bf16 v[156:159], v[120:123], a[240:243], v[156:159]
    v_mul_f32 v124, v205, v188
    v_mul_f32 v125, v205, v189
    v_mfma_f32_16x16x32_bf16 v[160:163], v[116:119], a[228:231], v[160:163]
    v_or_b32 v14, s82, v1
    buffer_load_dwordx4 v[176:179], v14, s[40:43], s60 offen offset:1024 sc1
    v_mfma_f32_16x16x32_bf16 v[160:163], v[120:123], a[244:247], v[160:163]
    v_mul_f32 v126, v205, v190
    v_mul_f32 v127, v205, v191
    v_mfma_f32_16x16x32_bf16 v[164:167], v[116:119], a[232:235], v[164:167]
    v_mul_f32 v128, v207, v188
    v_mul_f32 v129, v207, v189
    v_mfma_f32_16x16x32_bf16 v[164:167], v[120:123], a[248:251], v[164:167]
    v_mul_f32 v130, v207, v190
    v_mul_f32 v131, v207, v191
    v_mfma_f32_16x16x32_bf16 v[168:171], v[116:119], a[236:239], v[168:171]
    v_mul_f32 v132, v209, v188
    v_mul_f32 v133, v209, v189
    v_mfma_f32_16x16x32_bf16 v[168:171], v[120:123], a[252:255], v[168:171]
    buffer_load_dwordx4 v[172:175], v14, s[40:43], s60 offen offset:0 sc1
    v_mul_f32 v134, v209, v190
    v_mul_f32 v135, v209, v191
    v_mul_f32 v136, v211, v188
    v_mul_f32 v137, v211, v189
    v_mul_f32 v138, v211, v190
    v_mul_f32 v139, v211, v191
    buffer_store_dword v24, v2, s[40:43], s56 offen offset:8 sc1
    v_fma_f32 v124, v156, v204, -v124
    v_fma_f32 v125, v157, v204, -v125
    v_fma_f32 v126, v158, v204, -v126
    v_fma_f32 v127, v159, v204, -v127
    v_cvt_pk_bf16_f32 v92, v124, v125
    v_cvt_pk_bf16_f32 v93, v126, v127
    v_fma_f32 v128, v160, v206, -v128
    v_fma_f32 v129, v161, v206, -v129
    v_fma_f32 v130, v162, v206, -v130
    v_fma_f32 v131, v163, v206, -v131
    v_cvt_pk_bf16_f32 v94, v128, v129
    v_cvt_pk_bf16_f32 v95, v130, v131
    v_fma_f32 v132, v164, v208, -v132
    v_fma_f32 v133, v165, v208, -v133
    v_fma_f32 v134, v166, v208, -v134
    v_or_b32 v14, s83, v1
    buffer_load_dwordx4 v[184:187], v14, s[40:43], s61 offen offset:1024 sc1
    v_fma_f32 v135, v167, v208, -v135
    v_cvt_pk_bf16_f32 v96, v132, v133
    v_cvt_pk_bf16_f32 v97, v134, v135
    v_fma_f32 v136, v168, v210, -v136
    v_fma_f32 v137, v169, v210, -v137
    v_fma_f32 v138, v170, v210, -v138
    v_fma_f32 v139, v171, v210, -v139
    v_cvt_pk_bf16_f32 v98, v136, v137
    v_cvt_pk_bf16_f32 v99, v138, v139
    v_permlane16_swap_b32 v92, v94
    v_permlane16_swap_b32 v93, v95
    v_permlane16_swap_b32 v96, v98
    v_permlane16_swap_b32 v97, v99
    v_mfma_f32_32x32x16_bf16 v[100:115], v[212:215], v[92:95], v[44:59]
    buffer_load_dwordx4 v[180:183], v14, s[40:43], s61 offen offset:0 sc1
    v_and_b32 v8, 7, v0
    v_lshlrev_b32 v8, 12, v8
    s_lshl_b32 s70, s46, 10
    s_add_u32 s70, s70, s78
    s_add_u32 s70, s70, 0x28000
    s_sub_u32 s71, s70, 0xff400
    s_cmp_eq_u32 s46, 0
    s_cselect_b32 s72, s44, 0
    s_cmp_lg_u32 s72, 0
    s_cselect_b32 s71, s71, s70
    s_add_u32 s72, s70, 0xff400
    s_cmp_eq_u32 s46, 3
    s_cselect_b32 s73, s44, 31
    s_cmp_lg_u32 s73, 31
    s_cselect_b32 s71, s72, s71
    v_mov_b32 v9, s70
    buffer_load_dwordx4 v16, s[12:15], s54 offen offset:2048 lds
    v_mov_b32 v10, s71
    v_cmp_gt_u32 vcc, 8, v0
    s_nop 1
    v_cndmask_b32 v9, v10, v9, vcc
    v_add_u32 v7, v8, v9
    v_exp_f32 v100, v100
    v_exp_f32 v101, v101
    v_mfma_f32_32x32x16_bf16 v[116:131], v[212:215], v[96:99], 0
    v_exp_f32 v102, v102
    v_exp_f32 v103, v103
    v_exp_f32 v104, v104
    buffer_load_dwordx4 v16, s[12:15], s55 offen offset:3072 lds
    v_exp_f32 v105, v105
    v_exp_f32 v106, v106
    v_exp_f32 v107, v107
    v_cvt_pk_bf16_f32 v32, v100, v101
    v_cvt_pk_bf16_f32 v33, v102, v103
    v_cvt_pk_bf16_f32 v34, v104, v105
    v_cvt_pk_bf16_f32 v35, v106, v107
    v_exp_f32 v108, v108
    v_exp_f32 v109, v109
    v_mfma_f32_32x32x16_bf16 v[156:171], v[220:223], v[32:35], 0
    v_exp_f32 v110, v110
    v_exp_f32 v111, v111
    v_exp_f32 v112, v112
    v_exp_f32 v113, v113
    v_exp_f32 v114, v114
    v_exp_f32 v115, v115
    v_cvt_pk_bf16_f32 v36, v108, v109
    v_cvt_pk_bf16_f32 v37, v110, v111
    v_cvt_pk_bf16_f32 v38, v112, v113
    v_cvt_pk_bf16_f32 v39, v114, v115
    v_exp_f32 v116, v116
    v_exp_f32 v117, v117
    v_mfma_f32_32x32x16_bf16 v[100:115], v[216:219], v[96:99], v[44:59]
    v_exp_f32 v118, v118
    v_exp_f32 v119, v119
    v_exp_f32 v120, v120
    v_exp_f32 v121, v121
    v_mfma_f32_32x32x16_bf16 v[156:171], v[224:227], v[36:39], v[156:171]
    v_exp_f32 v122, v122
    v_exp_f32 v123, v123
    v_cvt_pk_bf16_f32 v132, v116, v117
    v_cvt_pk_bf16_f32 v133, v118, v119
    v_cvt_pk_bf16_f32 v134, v120, v121
    v_cvt_pk_bf16_f32 v135, v122, v123
    v_exp_f32 v124, v124
    v_exp_f32 v125, v125
    v_mfma_f32_32x32x16_bf16 v[188:203], v[220:223], v[132:135], 0
    v_exp_f32 v126, v126
    v_exp_f32 v127, v127
    v_exp_f32 v128, v128
    v_exp_f32 v129, v129
    v_exp_f32 v130, v130
    v_exp_f32 v131, v131
    v_cvt_pk_bf16_f32 v136, v124, v125
    v_cvt_pk_bf16_f32 v137, v126, v127
    v_cvt_pk_bf16_f32 v138, v128, v129
    v_cvt_pk_bf16_f32 v139, v130, v131
    buffer_load_dword v91, v17, s[40:43], 0 offen offset:8 sc1
    v_exp_f32 v100, v100
    v_exp_f32 v101, v101
    s_waitcnt vmcnt(11)
    v_mfma_f32_32x32x16_bf16 v[116:131], v[144:147], v[92:95], 0
    v_exp_f32 v102, v102
    v_exp_f32 v103, v103
    v_exp_f32 v104, v104
    v_exp_f32 v105, v105
    v_mfma_f32_32x32x16_bf16 v[188:203], v[224:227], v[136:139], v[188:203]
    v_exp_f32 v106, v106
    v_exp_f32 v107, v107
    v_cvt_pk_bf16_f32 v32, v100, v101
    v_cvt_pk_bf16_f32 v33, v102, v103
    v_cvt_pk_bf16_f32 v34, v104, v105
    v_cvt_pk_bf16_f32 v35, v106, v107
    v_exp_f32 v108, v108
    v_exp_f32 v109, v109
    v_mfma_f32_32x32x16_bf16 v[188:203], v[228:231], v[32:35], v[188:203]
    v_exp_f32 v110, v110
    v_exp_f32 v111, v111
    v_exp_f32 v112, v112
    v_exp_f32 v113, v113
    v_exp_f32 v114, v114
    v_exp_f32 v115, v115
    v_cvt_pk_bf16_f32 v36, v108, v109
    v_cvt_pk_bf16_f32 v37, v110, v111
    v_cvt_pk_bf16_f32 v38, v112, v113
    v_cvt_pk_bf16_f32 v39, v114, v115
    s_nop 1
    v_mfma_f32_32x32x16_bf16 v[188:203], v[232:235], v[36:39], v[188:203]
    v_exp_f32 v116, v116
    v_exp_f32 v117, v117
    v_mfma_f32_32x32x16_bf16 v[100:115], v[144:147], v[96:99], 0
    v_exp_f32 v118, v118
    v_exp_f32 v119, v119
    v_exp_f32 v120, v120
    v_exp_f32 v121, v121
    v_exp_f32 v122, v122
    v_exp_f32 v123, v123
    v_cvt_pk_bf16_f32 v132, v116, v117
    v_cvt_pk_bf16_f32 v133, v118, v119
    v_cvt_pk_bf16_f32 v134, v120, v121
    v_cvt_pk_bf16_f32 v135, v122, v123
    v_exp_f32 v124, v124
    v_exp_f32 v125, v125
    v_exp_f32 v126, v126
    v_exp_f32 v127, v127
    v_exp_f32 v128, v128
    v_exp_f32 v129, v129
    v_exp_f32 v130, v130
    v_exp_f32 v131, v131
    v_cvt_pk_bf16_f32 v136, v124, v125
    v_cvt_pk_bf16_f32 v137, v126, v127
    v_cvt_pk_bf16_f32 v138, v128, v129
    v_cvt_pk_bf16_f32 v139, v130, v131
    s_waitcnt vmcnt(0)
    v_cmp_ne_u32 vcc, s95, v91
    s_and_b64 vcc, vcc, s[50:51]
    s_cbranch_vccz polled_12
    s_mov_b32 s57, 0x40000
poll_11:
    buffer_load_dword v91, v17, s[40:43], 0 offen offset:8 sc1
    s_waitcnt vmcnt(0)
    v_cmp_ne_u32 vcc, s95, v91
    s_and_b64 vcc, vcc, s[50:51]
    s_cbranch_vccz polled_12
    s_sub_u32 s57, s57, 1
    s_cbranch_scc0 poll_11
polled_12:
    s_barrier
    v_or_b32 v14, s80, v27
    buffer_load_dwordx4 a[8:11], v14, s[40:43], s58 offen offset:1024 sc1
    v_exp_f32 v100, v100
    v_exp_f32 v101, v101
    v_mfma_f32_32x32x16_bf16 v[116:131], v[140:143], v[92:95], 0
    v_exp_f32 v102, v102
    v_exp_f32 v103, v103
    v_exp_f32 v104, v104
    v_exp_f32 v105, v105
    v_exp_f32 v106, v106
    buffer_load_dwordx4 a[12:15], v14, s[40:43], s58 offen offset:1536 sc1
    v_exp_f32 v107, v107
    v_cvt_pk_bf16_f32 v32, v100, v101
    v_cvt_pk_bf16_f32 v33, v102, v103
    v_cvt_pk_bf16_f32 v34, v104, v105
    v_cvt_pk_bf16_f32 v35, v106, v107
    v_exp_f32 v108, v108
    v_exp_f32 v109, v109
    v_exp_f32 v110, v110
    v_exp_f32 v111, v111
    v_exp_f32 v112, v112
    buffer_load_dwordx4 a[0:3], v14, s[40:43], s58 offen offset:0 sc1
    v_exp_f32 v113, v113
    v_exp_f32 v114, v114
    v_exp_f32 v115, v115
    v_cvt_pk_bf16_f32 v36, v108, v109
    v_cvt_pk_bf16_f32 v37, v110, v111
    v_cvt_pk_bf16_f32 v38, v112, v113
    v_cvt_pk_bf16_f32 v39, v114, v115
    v_exp_f32 v116, v116
    v_exp_f32 v117, v117
    v_mfma_f32_32x32x16_bf16 v[100:115], v[140:143], v[96:99], 0
    buffer_load_dwordx4 a[4:7], v14, s[40:43], s58 offen offset:512 sc1
    v_exp_f32 v118, v118
    v_exp_f32 v119, v119
    v_exp_f32 v120, v120
    v_exp_f32 v121, v121
    v_exp_f32 v122, v122
    v_exp_f32 v123, v123
    v_cvt_pk_bf16_f32 v212, v116, v117
    v_cvt_pk_bf16_f32 v213, v118, v119
    v_cvt_pk_bf16_f32 v214, v120, v121
    v_cvt_pk_bf16_f32 v215, v122, v123
    v_or_b32 v14, s81, v27
    buffer_load_dwordx4 a[24:27], v14, s[40:43], s59 offen offset:1024 sc1
    v_exp_f32 v124, v124
    v_exp_f32 v125, v125
    v_exp_f32 v126, v126
    v_exp_f32 v127, v127
    v_exp_f32 v128, v128
    v_exp_f32 v129, v129
    v_exp_f32 v130, v130
    v_exp_f32 v131, v131
    buffer_load_dwordx4 a[28:31], v14, s[40:43], s59 offen offset:1536 sc1
    v_cvt_pk_bf16_f32 v216, v124, v125
    v_cvt_pk_bf16_f32 v217, v126, v127
    v_cvt_pk_bf16_f32 v218, v128, v129
    v_cvt_pk_bf16_f32 v219, v130, v131
    v_exp_f32 v100, v100
    v_exp_f32 v101, v101
    v_mfma_f32_32x32x16_bf16 v[116:131], v[152:155], v[92:95], 0
    v_exp_f32 v102, v102
    v_exp_f32 v103, v103
    v_exp_f32 v104, v104
    buffer_load_dwordx4 a[16:19], v14, s[40:43], s59 offen offset:0 sc1
    v_exp_f32 v105, v105
    v_exp_f32 v106, v106
    v_exp_f32 v107, v107
    v_cvt_pk_bf16_f32 v220, v100, v101
    v_cvt_pk_bf16_f32 v221, v102, v103
    v_cvt_pk_bf16_f32 v222, v104, v105
    v_cvt_pk_bf16_f32 v223, v106, v107
    v_exp_f32 v108, v108
    v_exp_f32 v109, v109
    v_exp_f32 v110, v110
    buffer_load_dwordx4 a[20:23], v14, s[40:43], s59 offen offset:512 sc1
    v_exp_f32 v111, v111
    v_exp_f32 v112, v112
    v_exp_f32 v113, v113
    v_exp_f32 v114, v114
    v_exp_f32 v115, v115
    v_cvt_pk_bf16_f32 v224, v108, v109
    v_cvt_pk_bf16_f32 v225, v110, v111
    v_cvt_pk_bf16_f32 v226, v112, v113
    v_cvt_pk_bf16_f32 v227, v114, v115
    v_exp_f32 v116, v116
    v_or_b32 v14, s82, v27
    buffer_load_dwordx4 a[40:43], v14, s[40:43], s60 offen offset:1024 sc1
    v_exp_f32 v117, v117
    v_mfma_f32_32x32x16_bf16 v[100:115], v[152:155], v[96:99], 0
    v_exp_f32 v118, v118
    v_exp_f32 v119, v119
    v_exp_f32 v120, v120
    v_exp_f32 v121, v121
    v_exp_f32 v122, v122
    v_exp_f32 v123, v123
    buffer_load_dwordx4 a[44:47], v14, s[40:43], s60 offen offset:1536 sc1
    v_cvt_pk_bf16_f32 v228, v116, v117
    v_cvt_pk_bf16_f32 v229, v118, v119
    v_cvt_pk_bf16_f32 v230, v120, v121
    v_cvt_pk_bf16_f32 v231, v122, v123
    v_exp_f32 v124, v124
    v_exp_f32 v125, v125
    v_exp_f32 v126, v126
    v_exp_f32 v127, v127
    v_exp_f32 v128, v128
    v_exp_f32 v129, v129
    buffer_load_dwordx4 a[32:35], v14, s[40:43], s60 offen offset:0 sc1
    v_exp_f32 v130, v130
    v_exp_f32 v131, v131
    v_cvt_pk_bf16_f32 v232, v124, v125
    v_cvt_pk_bf16_f32 v233, v126, v127
    v_cvt_pk_bf16_f32 v234, v128, v129
    v_cvt_pk_bf16_f32 v235, v130, v131
    v_exp_f32 v100, v100
    v_exp_f32 v101, v101
    v_mfma_f32_32x32x16_bf16 v[116:131], v[148:151], v[92:95], 0
    v_exp_f32 v102, v102
    buffer_load_dwordx4 a[36:39], v14, s[40:43], s60 offen offset:512 sc1
    v_exp_f32 v103, v103
    v_exp_f32 v104, v104
    v_exp_f32 v105, v105
    v_exp_f32 v106, v106
    v_exp_f32 v107, v107
    v_cvt_pk_bf16_f32 v44, v100, v101
    v_cvt_pk_bf16_f32 v45, v102, v103
    v_cvt_pk_bf16_f32 v46, v104, v105
    v_cvt_pk_bf16_f32 v47, v106, v107
    v_exp_f32 v108, v108
    v_or_b32 v14, s83, v27
    buffer_load_dwordx4 a[56:59], v14, s[40:43], s61 offen offset:1024 sc1
    v_exp_f32 v109, v109
    v_exp_f32 v110, v110
    v_exp_f32 v111, v111
    v_exp_f32 v112, v112
    v_exp_f32 v113, v113
    v_exp_f32 v114, v114
    v_exp_f32 v115, v115
    v_cvt_pk_bf16_f32 v48, v108, v109
    v_cvt_pk_bf16_f32 v49, v110, v111
    buffer_load_dwordx4 a[60:63], v14, s[40:43], s61 offen offset:1536 sc1
    v_cvt_pk_bf16_f32 v50, v112, v113
    v_cvt_pk_bf16_f32 v51, v114, v115
    v_exp_f32 v116, v116
    v_exp_f32 v117, v117
    v_mfma_f32_32x32x16_bf16 v[100:115], v[148:151], v[96:99], 0
    v_exp_f32 v118, v118
    v_exp_f32 v119, v119
    v_exp_f32 v120, v120
    v_exp_f32 v121, v121
    buffer_load_dwordx4 a[48:51], v14, s[40:43], s61 offen offset:0 sc1
    s_waitcnt vmcnt(14)
    v_mfma_f32_32x32x16_bf16 v[156:171], a[8:11], v[132:135], v[156:171]
    v_exp_f32 v122, v122
    v_exp_f32 v123, v123
    v_cvt_pk_bf16_f32 v52, v116, v117
    v_cvt_pk_bf16_f32 v53, v118, v119
    v_cvt_pk_bf16_f32 v54, v120, v121
    v_cvt_pk_bf16_f32 v55, v122, v123
    v_exp_f32 v124, v124
    v_exp_f32 v125, v125
    s_waitcnt vmcnt(13)
    v_mfma_f32_32x32x16_bf16 v[156:171], a[12:15], v[136:139], v[156:171]
    buffer_load_dwordx4 a[52:55], v14, s[40:43], s61 offen offset:512 sc1
    v_exp_f32 v126, v126
    v_exp_f32 v127, v127
    v_exp_f32 v128, v128
    v_exp_f32 v129, v129
    v_mfma_f32_32x32x16_bf16 v[188:203], a[8:11], v[32:35], v[188:203]
    v_exp_f32 v130, v130
    v_exp_f32 v131, v131
    v_cvt_pk_bf16_f32 v56, v124, v125
    v_cvt_pk_bf16_f32 v57, v126, v127
    s_add_u32 m0, s49, 0x10000
    v_add_u32 v16, s84, v76
    buffer_load_dwordx4 v16, s[16:19], 0 offen offset:0 lds
    v_cvt_pk_bf16_f32 v58, v128, v129
    v_cvt_pk_bf16_f32 v59, v130, v131
    v_mfma_f32_32x32x16_bf16 v[188:203], a[12:15], v[36:39], v[188:203]
    v_exp_f32 v100, v100
    v_exp_f32 v101, v101
    v_mfma_f32_32x32x16_bf16 v[116:131], v[176:179], v[92:95], 0
    v_exp_f32 v102, v102
    v_exp_f32 v103, v103
    buffer_load_dwordx4 v16, s[16:19], s53 offen offset:1024 lds
    v_exp_f32 v104, v104
    v_exp_f32 v105, v105
    s_waitcnt vmcnt(15)
    v_mfma_f32_32x32x16_bf16 v[156:171], a[0:3], v[212:215], v[156:171]
    v_exp_f32 v106, v106
    v_exp_f32 v107, v107
    v_cvt_pk_bf16_f32 v132, v100, v101
    v_cvt_pk_bf16_f32 v133, v102, v103
    v_cvt_pk_bf16_f32 v134, v104, v105
    v_cvt_pk_bf16_f32 v135, v106, v107
    v_exp_f32 v108, v108
    buffer_load_dwordx4 v16, s[16:19], s54 offen offset:2048 lds
    v_exp_f32 v109, v109
    s_waitcnt vmcnt(15)
    v_mfma_f32_32x32x16_bf16 v[156:171], a[4:7], v[216:219], v[156:171]
    v_exp_f32 v110, v110
    v_exp_f32 v111, v111
    v_exp_f32 v112, v112
    v_exp_f32 v113, v113
    v_mfma_f32_32x32x16_bf16 v[188:203], a[0:3], v[220:223], v[188:203]
    v_exp_f32 v114, v114
    buffer_load_dwordx4 v16, s[16:19], s55 offen offset:3072 lds
    v_exp_f32 v115, v115
    v_cvt_pk_bf16_f32 v136, v108, v109
    v_cvt_pk_bf16_f32 v137, v110, v111
    v_cvt_pk_bf16_f32 v138, v112, v113
    v_cvt_pk_bf16_f32 v139, v114, v115
    v_mfma_f32_32x32x16_bf16 v[188:203], a[4:7], v[224:227], v[188:203]
    v_exp_f32 v116, v116
    v_exp_f32 v117, v117
    v_mfma_f32_32x32x16_bf16 v[100:115], v[176:179], v[96:99], 0
    buffer_load_dwordx2 v[12:13], v7, s[40:43], 0 offen sc1
    v_exp_f32 v118, v118
    v_exp_f32 v119, v119
    v_exp_f32 v120, v120
    v_exp_f32 v121, v121
    s_waitcnt vmcnt(16)
    v_mfma_f32_32x32x16_bf16 v[156:171], a[24:27], v[228:231], v[156:171]
    v_exp_f32 v122, v122
    v_exp_f32 v123, v123
    v_cvt_pk_bf16_f32 v32, v116, v117
    v_cvt_pk_bf16_f32 v33, v118, v119
    s_add_u32 s3, s94, 0x30000
    buffer_load_dword v6, v79, s[40:43], s3 offen
    v_cvt_pk_bf16_f32 v34, v120, v121
    v_cvt_pk_bf16_f32 v35, v122, v123
    v_exp_f32 v124, v124
    v_exp_f32 v125, v125
    s_waitcnt vmcnt(16)
    v_mfma_f32_32x32x16_bf16 v[156:171], a[28:31], v[232:235], v[156:171]
    v_exp_f32 v126, v126
    v_exp_f32 v127, v127
    v_exp_f32 v128, v128
    v_exp_f32 v129, v129
    s_add_u32 s3, s96, 0x0
    buffer_load_dword v6, v79, s[40:43], s3 offen
    v_mfma_f32_32x32x16_bf16 v[188:203], a[24:27], v[44:47], v[188:203]
    v_exp_f32 v130, v130
    v_exp_f32 v131, v131
    v_cvt_pk_bf16_f32 v36, v124, v125
    v_cvt_pk_bf16_f32 v37, v126, v127
    v_cvt_pk_bf16_f32 v38, v128, v129
    v_cvt_pk_bf16_f32 v39, v130, v131
    v_mfma_f32_32x32x16_bf16 v[188:203], a[28:31], v[48:51], v[188:203]
    v_exp_f32 v100, v100
    v_exp_f32 v101, v101
    s_xor_b32 s3, s45, 4
    s_lshl2_add_u32 s3, s3, s46
    s_lshl_b32 s3, s3, 9
    s_add_u32 s3, s3, s78
    s_add_u32 s3, s3, 0x30000
    v_and_b32 v90, 1, v4
    v_mul_u32_u24 v90, 0x3f80, v90
    v_lshl_add_u32 v90, v4, 7, v90
    v_lshl_add_u32 v90, v5, 4, v90
    buffer_store_dword v20, v90, s[40:43], s3 offen
    s_add_u32 s3, s3, 0x8000
    buffer_store_dword v20, v90, s[40:43], s3 offen
    v_mfma_f32_32x32x16_bf16 v[116:131], v[172:175], v[92:95], 0
    v_exp_f32 v102, v102
    v_exp_f32 v103, v103
    v_exp_f32 v104, v104
    v_exp_f32 v105, v105
    s_waitcnt vmcnt(18)
    v_mfma_f32_32x32x16_bf16 v[156:171], a[16:19], v[52:55], v[156:171]
    v_exp_f32 v106, v106
    v_exp_f32 v107, v107
    s_add_u32 s3, s96, 0x10000
    buffer_load_dword v6, v79, s[40:43], s3 offen
    v_cvt_pk_bf16_f32 v212, v100, v101
    v_cvt_pk_bf16_f32 v213, v102, v103
    v_cvt_pk_bf16_f32 v214, v104, v105
    v_cvt_pk_bf16_f32 v215, v106, v107
    v_exp_f32 v108, v108
    v_exp_f32 v109, v109
    s_waitcnt vmcnt(18)
    v_mfma_f32_32x32x16_bf16 v[156:171], a[20:23], v[56:59], v[156:171]
    v_exp_f32 v110, v110
    v_exp_f32 v111, v111
    v_exp_f32 v112, v112
    s_add_u32 s3, s94, 0x80000
    buffer_load_dword v6, v88, s[40:43], s3 offen
    v_exp_f32 v113, v113
    v_mfma_f32_32x32x16_bf16 v[188:203], a[16:19], v[132:135], v[188:203]
    v_exp_f32 v114, v114
    v_exp_f32 v115, v115
    v_cvt_pk_bf16_f32 v216, v108, v109
    v_cvt_pk_bf16_f32 v217, v110, v111
    v_cvt_pk_bf16_f32 v218, v112, v113
    v_cvt_pk_bf16_f32 v219, v114, v115
    v_mfma_f32_32x32x16_bf16 v[188:203], a[20:23], v[136:139], v[188:203]
    v_exp_f32 v116, v116
    s_lshl2_add_u32 s3, s2, s46
    s_and_b32 s3, s3, 0x1ff
    s_lshl_b32 s3, s3, 10
    buffer_load_dword v6, v88, s[20:23], s3 offen
    v_exp_f32 v117, v117
    v_mfma_f32_32x32x16_bf16 v[100:115], v[172:175], v[96:99], 0
    v_exp_f32 v118, v118
    v_exp_f32 v119, v119
    v_exp_f32 v120, v120
    v_exp_f32 v121, v121
    s_waitcnt vmcnt(19)
    v_mfma_f32_32x32x16_bf16 v[156:171], a[40:43], v[32:35], v[156:171]
    v_exp_f32 v122, v122
    s_lshl2_add_u32 s3, s2, s46
    s_mul_i32 s3, s3, 1792
    buffer_load_dword v6, v89, s[24:27], s3 offen
    v_exp_f32 v123, v123
    v_cvt_pk_bf16_f32 v220, v116, v117
    v_cvt_pk_bf16_f32 v221, v118, v119
    v_cvt_pk_bf16_f32 v222, v120, v121
    v_cvt_pk_bf16_f32 v223, v122, v123
    v_exp_f32 v124, v124
    v_exp_f32 v125, v125
    s_waitcnt vmcnt(19)
    v_mfma_f32_32x32x16_bf16 v[156:171], a[44:47], v[36:39], v[156:171]
    v_exp_f32 v126, v126
    v_exp_f32 v127, v127
    v_exp_f32 v128, v128
    v_exp_f32 v129, v129
    v_mfma_f32_32x32x16_bf16 v[188:203], a[40:43], v[212:215], v[188:203]
    v_exp_f32 v130, v130
    v_exp_f32 v131, v131
    v_cvt_pk_bf16_f32 v224, v124, v125
    v_cvt_pk_bf16_f32 v225, v126, v127
    v_cvt_pk_bf16_f32 v226, v128, v129
    v_cvt_pk_bf16_f32 v227, v130, v131
    v_mfma_f32_32x32x16_bf16 v[188:203], a[44:47], v[216:219], v[188:203]
    v_exp_f32 v100, v100
    v_exp_f32 v101, v101
    v_mfma_f32_32x32x16_bf16 v[116:131], v[184:187], v[92:95], 0
    v_exp_f32 v102, v102
    v_exp_f32 v103, v103
    v_exp_f32 v104, v104
    v_exp_f32 v105, v105
    s_waitcnt vmcnt(18)
    v_mfma_f32_32x32x16_bf16 v[156:171], a[32:35], v[220:223], v[156:171]
    v_exp_f32 v106, v106
    v_exp_f32 v107, v107
    v_cvt_pk_bf16_f32 v228, v100, v101
    v_cvt_pk_bf16_f32 v229, v102, v103
    v_cvt_pk_bf16_f32 v230, v104, v105
    v_cvt_pk_bf16_f32 v231, v106, v107
    v_exp_f32 v108, v108
    v_exp_f32 v109, v109
    s_waitcnt vmcnt(17)
    v_mfma_f32_32x32x16_bf16 v[156:171], a[36:39], v[224:227], v[156:171]
    v_exp_f32 v110, v110
    v_exp_f32 v111, v111
    v_exp_f32 v112, v112
    v_exp_f32 v113, v113
    v_mfma_f32_32x32x16_bf16 v[188:203], a[32:35], v[228:231], v[188:203]
    v_exp_f32 v114, v114
    v_exp_f32 v115, v115
    v_cvt_pk_bf16_f32 v232, v108, v109
    v_cvt_pk_bf16_f32 v233, v110, v111
    v_cvt_pk_bf16_f32 v234, v112, v113
    v_cvt_pk_bf16_f32 v235, v114, v115
    v_exp_f32 v116, v116
    v_exp_f32 v117, v117
    v_mfma_f32_32x32x16_bf16 v[100:115], v[184:187], v[96:99], v[60:75]
    v_exp_f32 v118, v118
    v_exp_f32 v119, v119
    v_exp_f32 v120, v120
    v_exp_f32 v121, v121
    v_mfma_f32_32x32x16_bf16 v[188:203], a[36:39], v[232:235], v[188:203]
    v_exp_f32 v122, v122
    v_exp_f32 v123, v123
    v_cvt_pk_bf16_f32 v44, v116, v117
    v_cvt_pk_bf16_f32 v45, v118, v119
    v_cvt_pk_bf16_f32 v46, v120, v121
    v_cvt_pk_bf16_f32 v47, v122, v123
    v_exp_f32 v124, v124
    v_exp_f32 v125, v125
    s_waitcnt vmcnt(16)
    v_mfma_f32_32x32x16_bf16 v[156:171], a[56:59], v[44:47], v[156:171]
    v_exp_f32 v126, v126
    v_exp_f32 v127, v127
    v_exp_f32 v128, v128
    v_exp_f32 v129, v129
    v_exp_f32 v130, v130
    v_exp_f32 v131, v131
    v_cvt_pk_bf16_f32 v48, v124, v125
    v_cvt_pk_bf16_f32 v49, v126, v127
    v_cvt_pk_bf16_f32 v50, v128, v129
    v_cvt_pk_bf16_f32 v51, v130, v131
    v_exp_f32 v100, v100
    v_exp_f32 v101, v101
    v_mfma_f32_32x32x16_bf16 v[116:131], v[180:183], v[92:95], v[60:75]
    v_exp_f32 v102, v102
    v_exp_f32 v103, v103
    v_exp_f32 v104, v104
    v_exp_f32 v105, v105
    s_waitcnt vmcnt(15)
    v_mfma_f32_32x32x16_bf16 v[156:171], a[60:63], v[48:51], v[156:171]
    v_exp_f32 v106, v106
    v_exp_f32 v107, v107
    v_cvt_pk_bf16_f32 v52, v100, v101
    v_cvt_pk_bf16_f32 v53, v102, v103
    v_cvt_pk_bf16_f32 v54, v104, v105
    v_cvt_pk_bf16_f32 v55, v106, v107
    v_exp_f32 v108, v108
    v_exp_f32 v109, v109
    v_mfma_f32_32x32x16_bf16 v[188:203], a[56:59], v[52:55], v[188:203]
    v_exp_f32 v110, v110
    v_exp_f32 v111, v111
    v_exp_f32 v112, v112
    v_exp_f32 v113, v113
    v_exp_f32 v114, v114
    v_exp_f32 v115, v115
    v_cvt_pk_bf16_f32 v56, v108, v109
    v_cvt_pk_bf16_f32 v57, v110, v111
    v_cvt_pk_bf16_f32 v58, v112, v113
    v_cvt_pk_bf16_f32 v59, v114, v115
    v_exp_f32 v116, v116
    v_exp_f32 v117, v117
    v_exp_f32 v118, v118
    v_exp_f32 v119, v119
    v_exp_f32 v120, v120
    v_exp_f32 v121, v121
    v_mfma_f32_32x32x16_bf16 v[188:203], a[60:63], v[56:59], v[188:203]
    v_exp_f32 v122, v122
    v_exp_f32 v123, v123
    v_cvt_pk_bf16_f32 v132, v116, v117
    v_cvt_pk_bf16_f32 v133, v118, v119
    v_cvt_pk_bf16_f32 v134, v120, v121
    v_cvt_pk_bf16_f32 v135, v122, v123
    v_exp_f32 v124, v124
    v_exp_f32 v125, v125
    s_waitcnt vmcnt(14)
    v_mfma_f32_32x32x16_bf16 v[156:171], a[48:51], v[132:135], v[156:171]
    v_exp_f32 v126, v126
    v_exp_f32 v127, v127
    v_exp_f32 v128, v128
    v_exp_f32 v129, v129
    v_exp_f32 v130, v130
    v_exp_f32 v131, v131
    v_cvt_pk_bf16_f32 v136, v124, v125
    v_cvt_pk_bf16_f32 v137, v126, v127
    v_cvt_pk_bf16_f32 v138, v128, v129
    v_cvt_pk_bf16_f32 v139, v130, v131
    s_waitcnt vmcnt(8)
    v_cmp_ne_u32 vcc, s95, v12
    s_nop 0
    s_cbranch_vccz polled_14
    s_mov_b32 s57, 0x40000
poll_13:
    buffer_load_dwordx2 v[12:13], v7, s[40:43], 0 offen sc1
    s_waitcnt vmcnt(0)
    v_cmp_ne_u32 vcc, s95, v12
    s_nop 0
    s_cbranch_vccz polled_14
    s_sub_u32 s57, s57, 1
    s_cbranch_scc0 poll_13
polled_14:
    v_cmp_ne_u32 vcc, s48, v13
    s_and_b32 s70, vcc_lo, 0xff
    s_cselect_b32 s47, 0, 1
    s_xor_b32 s70, s45, 4
    s_lshl_b32 s70, s70, 11
    s_add_u32 s70, s70, s78
    s_lshr_b32 s71, s46, 1
    s_lshl_b32 s71, s71, 10
    s_add_u32 s70, s70, s71
    v_mfma_f32_32x32x16_bf16 v[156:171], a[52:55], v[136:139], v[156:171]
    s_and_b32 s71, s46, 1
    s_lshl_b32 s71, s71, 9
    s_add_u32 s70, s70, s71
    s_add_u32 s58, s70, 0x30000
    s_add_u32 s59, s58, 0x8000
    s_mov_b32 s70, 0x1f800000
    s_mov_b32 s71, 0x5f800000
    v_cmp_nle_f32 s[74:75], s70, v196
    v_cmp_nge_f32 s[72:73], s71, v196
    v_rcp_f32 v196, v196
    s_nop 0
    v_pk_mul_f32 v[188:189], v[188:189], v[196:197] op_sel_hi:[1,0]
    v_pk_mul_f32 v[190:191], v[190:191], v[196:197] op_sel_hi:[1,0]
    v_pk_mul_f32 v[192:193], v[192:193], v[196:197] op_sel_hi:[1,0]
    v_pk_mul_f32 v[194:195], v[194:195], v[196:197] op_sel_hi:[1,0]
    v_cvt_pk_bf16_f32 v216, v188, v189
    v_cvt_pk_bf16_f32 v217, v190, v191
    v_cvt_pk_bf16_f32 v218, v192, v193
    v_cvt_pk_bf16_f32 v219, v194, v195
    s_or_b64 s[74:75], s[74:75], s[72:73]
    v_cmp_nle_f32 vcc, s70, v164
    v_cmp_nge_f32 s[72:73], s71, v164
    s_or_b64 vcc, vcc, s[74:75]
    s_or_b64 vcc, vcc, s[72:73]
ahead_k7_1:
    s_cbranch_execz return_k7
    s_cbranch_vccnz SAFE_SOFTMAX
    v_rcp_f32 v164, v164
    s_nop 0
    v_pk_mul_f32 v[156:157], v[156:157], v[164:165] op_sel_hi:[1,0]
    v_pk_mul_f32 v[158:159], v[158:159], v[164:165] op_sel_hi:[1,0]
    v_pk_mul_f32 v[160:161], v[160:161], v[164:165] op_sel_hi:[1,0]
    v_pk_mul_f32 v[162:163], v[162:163], v[164:165] op_sel_hi:[1,0]
    v_cvt_pk_bf16_f32 v212, v156, v157
    v_cvt_pk_bf16_f32 v213, v158, v159
    v_cvt_pk_bf16_f32 v214, v160, v161
    v_cvt_pk_bf16_f32 v215, v162, v163
SOFTMAX_DONE:
    s_cmp_eq_u32 s47, 0
    s_cbranch_scc1 SLOW_TAIL
    buffer_store_dword v24, v2, s[40:43], s56 offen offset:12 sc1
    buffer_store_dwordx4 v[212:215], v90, s[40:43], s58 offen
    buffer_store_dwordx4 v[216:219], v90, s[40:43], s59 offen
    v_xor_b32 v32, 0, v19
    v_xor_b32 v33, 32, v19
    v_xor_b32 v34, 64, v19
    v_xor_b32 v35, 96, v19
    ds_read_b64_tr_b16 a[0:1], v32 offset:32768
    ds_read_b64_tr_b16 a[2:3], v32 offset:40960
    ds_read_b64_tr_b16 a[4:5], v33 offset:32768
    ds_read_b64_tr_b16 a[6:7], v33 offset:40960
    ds_read_b64_tr_b16 a[8:9], v34 offset:32768
    ds_read_b64_tr_b16 a[10:11], v34 offset:40960
    s_add_u32 m0, s49, 0x14000
    v_add_u32 v16, s85, v76
    buffer_load_dwordx4 v16, s[16:19], 0 offen offset:0 lds
    ds_read_b64_tr_b16 a[12:13], v35 offset:32768
    ds_read_b64_tr_b16 a[14:15], v35 offset:40960
    ds_read_b64_tr_b16 a[16:17], v32 offset:33792
    v_add_u32 v36, 0x20000, v32
    ds_read_b64_tr_b16 a[18:19], v32 offset:41984
    v_add_u32 v37, 0x20000, v33
    ds_read_b64_tr_b16 a[20:21], v33 offset:33792
    v_add_u32 v38, 0x20000, v34
    ds_read_b64_tr_b16 a[22:23], v33 offset:41984
    buffer_load_dwordx4 v16, s[16:19], s53 offen offset:1024 lds
    ds_read_b64_tr_b16 a[24:25], v34 offset:33792
    v_add_u32 v39, 0x20000, v35
    ds_read_b64_tr_b16 a[26:27], v34 offset:41984
    s_add_u32 s70, s78, 0x28080
    ds_read_b64_tr_b16 a[28:29], v35 offset:33792
    v_and_b32 v192, 31, v0
    ds_read_b64_tr_b16 a[30:31], v35 offset:41984
    v_lshlrev_b32 v27, 10, v192
    ds_read_b64_tr_b16 a[32:33], v32 offset:34816
    v_mov_b32 v193, 0x40000000
    ds_read_b64_tr_b16 a[34:35], v32 offset:43008
    buffer_load_dwordx4 v16, s[16:19], s54 offen offset:2048 lds
    ds_read_b64_tr_b16 a[36:37], v33 offset:34816
    v_lshlrev_b32 v40, 16, v80
    ds_read_b64_tr_b16 a[38:39], v33 offset:43008
    v_and_b32 v41, 0xffff0000, v80
    ds_read_b64_tr_b16 a[40:41], v34 offset:34816
    v_lshlrev_b32 v42, 16, v81
    ds_read_b64_tr_b16 a[42:43], v34 offset:43008
    v_and_b32 v43, 0xffff0000, v81
    ds_read_b64_tr_b16 a[44:45], v35 offset:34816
    v_lshlrev_b32 v44, 16, v82
    ds_read_b64_tr_b16 a[46:47], v35 offset:43008
    buffer_load_dwordx4 v16, s[16:19], s55 offen offset:3072 lds
    s_waitcnt vmcnt(11)
    buffer_store_dword v24, v2, s[40:43], s56 offen offset:128
    ds_read_b64_tr_b16 a[48:49], v32 offset:35840
    v_and_b32 v45, 0xffff0000, v82
    ds_read_b64_tr_b16 a[50:51], v32 offset:44032
    v_lshlrev_b32 v46, 16, v83
    ds_read_b64_tr_b16 a[52:53], v33 offset:35840
    v_and_b32 v47, 0xffff0000, v83
    ds_read_b64_tr_b16 a[54:55], v33 offset:44032
    v_lshlrev_b32 v48, 16, v84
    ds_read_b64_tr_b16 a[56:57], v34 offset:35840
    v_and_b32 v49, 0xffff0000, v84
    ds_read_b64_tr_b16 a[58:59], v34 offset:44032
    s_add_u32 m0, s49, 0x18000
    v_add_u32 v16, s86, v76
    buffer_load_dwordx4 v16, s[16:19], 0 offen offset:0 lds
    ds_read_b64_tr_b16 a[60:61], v35 offset:35840
    v_lshlrev_b32 v50, 16, v85
    ds_read_b64_tr_b16 a[62:63], v35 offset:44032
    v_and_b32 v51, 0xffff0000, v85
    ds_read_b64_tr_b16 a[64:65], v36 offset:0
    v_lshlrev_b32 v52, 16, v86
    ds_read_b64_tr_b16 a[66:67], v36 offset:8192
    v_and_b32 v53, 0xffff0000, v86
    ds_read_b64_tr_b16 a[68:69], v37 offset:0
    v_lshlrev_b32 v54, 16, v87
    ds_read_b64_tr_b16 a[70:71], v37 offset:8192
    buffer_load_dwordx4 v16, s[16:19], s53 offen offset:1024 lds
    ds_read_b64_tr_b16 a[72:73], v38 offset:0
    v_and_b32 v55, 0xffff0000, v87
    ds_read_b64_tr_b16 a[74:75], v38 offset:8192
    v_lshlrev_b32 v13, 12, v4
    ds_read_b64_tr_b16 a[76:77], v39 offset:0
    v_lshl_add_u32 v13, v5, 4, v13
    ds_read_b64_tr_b16 a[78:79], v39 offset:8192
    s_mul_i32 s48, s46, 7168
    ds_read_b64_tr_b16 a[80:81], v36 offset:1024
    s_bfe_u32 s71, s44, 0x10001
    ds_read_b64_tr_b16 a[82:83], v36 offset:9216
    buffer_load_dwordx4 v16, s[16:19], s54 offen offset:2048 lds
    ds_read_b64_tr_b16 a[84:85], v37 offset:1024
    s_lshl1_add_u32 s71, s46, s71
    ds_read_b64_tr_b16 a[86:87], v37 offset:9216
    s_mul_i32 s71, s71, 28672
    ds_read_b64_tr_b16 a[88:89], v38 offset:1024
    s_mul_i32 s72, s45, 448
    ds_read_b64_tr_b16 a[90:91], v38 offset:9216
    s_andn2_b32 s72, s72, 127
    ds_read_b64_tr_b16 a[92:93], v39 offset:1024
    s_add_u32 s71, s71, s72
    ds_read_b64_tr_b16 a[94:95], v39 offset:9216
    buffer_load_dwordx4 v16, s[16:19], s55 offen offset:3072 lds
    ds_read_b64_tr_b16 a[96:97], v36 offset:2048
    v_lshrrev_b32 v194, 2, v0
    ds_read_b64_tr_b16 a[98:99], v36 offset:10240
    v_mul_u32_u24 v194, 0xe00, v194
    ds_read_b64_tr_b16 a[100:101], v37 offset:2048
    v_and_b32 v195, 3, v0
    ds_read_b64_tr_b16 a[102:103], v37 offset:10240
    v_lshl_add_u32 v194, v195, 7, v194
    ds_read_b64_tr_b16 a[104:105], v38 offset:2048
    v_add_u32 v194, s71, v194
    ds_read_b64_tr_b16 a[106:107], v38 offset:10240
    s_add_u32 m0, s49, 0x1c000
    v_add_u32 v16, s87, v76
    buffer_load_dwordx4 v16, s[16:19], 0 offen offset:0 lds
    ds_read_b64_tr_b16 a[108:109], v39 offset:2048
    v_cmp_gt_u32 vcc, 32, v0
    ds_read_b64_tr_b16 a[110:111], v39 offset:10240
    s_nop 0
    v_cndmask_b32 v21, v193, v194, vcc
    ds_read_b64_tr_b16 a[112:113], v36 offset:3072
    s_and_b32 s77, s44, 1
    ds_read_b64_tr_b16 a[114:115], v36 offset:11264
    s_mul_i32 s77, s77, 917504
    ds_read_b64_tr_b16 a[116:117], v37 offset:3072
    s_lshl_b32 s58, s88, 4
    ds_read_b64_tr_b16 a[118:119], v37 offset:11264
    buffer_load_dwordx4 v16, s[16:19], s53 offen offset:1024 lds
    ds_read_b64_tr_b16 a[120:121], v38 offset:3072
    s_add_u32 s58, s58, s63
    ds_read_b64_tr_b16 a[122:123], v38 offset:11264
    s_add_u32 s58, s58, 0x30000
    ds_read_b64_tr_b16 a[124:125], v39 offset:3072
    s_lshl_b32 s59, s89, 4
    ds_read_b64_tr_b16 a[126:127], v39 offset:11264
    s_add_u32 s59, s59, s63
    ds_read_b64_tr_b16 a[128:129], v36 offset:16384
    s_add_u32 s59, s59, 0x30000
    ds_read_b64_tr_b16 a[130:131], v36 offset:24576
    buffer_load_dwordx4 v16, s[16:19], s54 offen offset:2048 lds
    ds_read_b64_tr_b16 a[132:133], v37 offset:16384
    s_lshl_b32 s60, s90, 4
    ds_read_b64_tr_b16 a[134:135], v37 offset:24576
    s_add_u32 s60, s60, s63
    ds_read_b64_tr_b16 a[136:137], v38 offset:16384
    s_add_u32 s60, s60, 0x30000
    ds_read_b64_tr_b16 a[138:139], v38 offset:24576
    s_lshl_b32 s61, s91, 4
    ds_read_b64_tr_b16 a[140:141], v39 offset:16384
    s_add_u32 s61, s61, s63
    ds_read_b64_tr_b16 a[142:143], v39 offset:24576
    buffer_load_dwordx4 v16, s[16:19], s55 offen offset:3072 lds
    s_add_u32 s61, s61, 0x30000
    buffer_load_dword v8, v27, s[40:43], s70 offen sc1
    buffer_load_dword v74, v17, s[40:43], 0 offen offset:12 sc1
    ds_read_b64_tr_b16 a[144:145], v36 offset:17408
    ds_read_b64_tr_b16 a[146:147], v36 offset:25600
    ds_read_b64_tr_b16 a[148:149], v37 offset:17408
    ds_read_b64_tr_b16 a[150:151], v37 offset:25600
    ds_read_b64_tr_b16 a[152:153], v38 offset:17408
    ds_read_b64_tr_b16 a[154:155], v38 offset:25600
    ds_read_b64_tr_b16 a[156:157], v39 offset:17408
    ds_read_b64_tr_b16 a[158:159], v39 offset:25600
    ds_read_b64_tr_b16 a[160:161], v36 offset:18432
    ds_read_b64_tr_b16 a[162:163], v36 offset:26624
    ds_read_b64_tr_b16 a[164:165], v37 offset:18432
    ds_read_b64_tr_b16 a[166:167], v37 offset:26624
    ds_read_b64_tr_b16 a[168:169], v38 offset:18432
    ds_read_b64_tr_b16 a[170:171], v38 offset:26624
    ds_read_b64_tr_b16 a[172:173], v39 offset:18432
    ds_read_b64_tr_b16 a[174:175], v39 offset:26624
    ds_read_b64_tr_b16 a[176:177], v36 offset:19456
    ds_read_b64_tr_b16 a[178:179], v36 offset:27648
    ds_read_b64_tr_b16 a[180:181], v37 offset:19456
    ds_read_b64_tr_b16 a[182:183], v37 offset:27648
    ds_read_b64_tr_b16 a[184:185], v38 offset:19456
    ds_read_b64_tr_b16 a[186:187], v38 offset:27648
    ds_read_b64_tr_b16 a[188:189], v39 offset:19456
    ds_read_b64_tr_b16 a[190:191], v39 offset:27648
    ds_read_b64_tr_b16 a[192:193], v32 offset:0
    ds_read_b64_tr_b16 a[194:195], v32 offset:8192
    ds_read_b64_tr_b16 a[196:197], v33 offset:0
    ds_read_b64_tr_b16 a[198:199], v33 offset:8192
    ds_read_b64_tr_b16 a[200:201], v34 offset:0
    ds_read_b64_tr_b16 a[202:203], v34 offset:8192
    ds_read_b64_tr_b16 a[204:205], v35 offset:0
    ds_read_b64_tr_b16 a[206:207], v35 offset:8192
    ds_read_b64_tr_b16 a[208:209], v32 offset:1024
    ds_read_b64_tr_b16 a[210:211], v32 offset:9216
    ds_read_b64_tr_b16 a[212:213], v33 offset:1024
    ds_read_b64_tr_b16 a[214:215], v33 offset:9216
    ds_read_b64_tr_b16 a[216:217], v34 offset:1024
    ds_read_b64_tr_b16 a[218:219], v34 offset:9216
    ds_read_b64_tr_b16 a[220:221], v35 offset:1024
    ds_read_b64_tr_b16 a[222:223], v35 offset:9216
    ds_read_b64_tr_b16 a[224:225], v32 offset:2048
    ds_read_b64_tr_b16 a[226:227], v32 offset:10240
    ds_read_b64_tr_b16 a[228:229], v33 offset:2048
    ds_read_b64_tr_b16 a[230:231], v33 offset:10240
    ds_read_b64_tr_b16 a[232:233], v34 offset:2048
    ds_read_b64_tr_b16 a[234:235], v34 offset:10240
    ds_read_b64_tr_b16 a[236:237], v35 offset:2048
    ds_read_b64_tr_b16 a[238:239], v35 offset:10240
    ds_read_b64_tr_b16 a[240:241], v32 offset:3072
    ds_read_b64_tr_b16 a[242:243], v32 offset:11264
    ds_read_b64_tr_b16 a[244:245], v33 offset:3072
    ds_read_b64_tr_b16 a[246:247], v33 offset:11264
    ds_read_b64_tr_b16 a[248:249], v34 offset:3072
    ds_read_b64_tr_b16 a[250:251], v34 offset:11264
    ds_read_b64_tr_b16 a[252:253], v35 offset:3072
    ds_read_b64_tr_b16 a[254:255], v35 offset:11264
    s_cmp_eq_u32 s46, 0
    s_mov_b64 exec, 0
    s_cbranch_scc1 ahead_p3_0
    s_cmp_eq_u32 s46, 1
    s_cbranch_scc1 ahead_p3_1
    s_cmp_eq_u32 s46, 2
    s_cbranch_scc1 ahead_p3_2
    s_branch ahead_p3_3
return_p3:
    s_mov_b64 exec, -1
    s_waitcnt vmcnt(1)
    v_cmp_ne_u32 vcc, s95, v8
    s_nop 0
    s_cbranch_vccz polled_16
    s_mov_b32 s57, 0x40000
poll_15:
    buffer_load_dword v8, v27, s[40:43], s70 offen sc1
    s_waitcnt vmcnt(0)
    v_cmp_ne_u32 vcc, s95, v8
    s_nop 0
    s_cbranch_vccz polled_16
    s_sub_u32 s57, s57, 1
    s_cbranch_scc0 poll_15
polled_16:
    s_waitcnt vmcnt(0)
    v_cmp_ne_u32 vcc, s95, v74
    s_and_b64 vcc, vcc, s[50:51]
    s_cbranch_vccz polled_18
    s_mov_b32 s57, 0x40000
poll_17:
    buffer_load_dword v74, v17, s[40:43], 0 offen offset:12 sc1
    s_waitcnt vmcnt(0)
    v_cmp_ne_u32 vcc, s95, v74
    s_and_b64 vcc, vcc, s[50:51]
    s_cbranch_vccz polled_18
    s_sub_u32 s57, s57, 1
    s_cbranch_scc0 poll_17
polled_18:
    s_add_u32 s72, s96, 0x0
    buffer_store_dword v20, v1, s[40:43], s72 offen offset:0
    buffer_store_dword v20, v1, s[40:43], s72 offen offset:1024
    buffer_load_dwordx4 v[92:95], v1, s[40:43], s58 offen offset:0 sc1
    s_lshr_b32 s70, s46, 1
    s_lshl_b32 s70, s70, 5
    s_and_b32 s71, s46, 1
    s_lshl_b32 s71, s71, 4
    s_add_u32 s70, s70, s71
    s_mul_i32 s71, s45, 448
    v_mov_b32 v192, v0
    v_mul_u32_u24 v193, 0x925, v192
    v_lshrrev_b32 v193, 16, v193
    v_mul_u32_u24 v194, 28, v193
    v_sub_u32 v192, v192, v194
    v_lshrrev_b32 v194, 1, v193
    buffer_load_dwordx4 v[96:99], v1, s[40:43], s58 offen offset:1024 sc1
    v_and_b32 v194, 2, v194
    v_xor_b32 v192, v192, v194
    v_add_u32 v193, s70, v193
    v_mul_u32_u24 v193, 0xe00, v193
    v_lshl_add_u32 v192, v192, 4, v193
    v_add_u32 v192, s71, v192
    v_subrev_u32 v196, 0, v192
    v_add_u32 v192, 64, v0
    v_mul_u32_u24 v193, 0x925, v192
    v_lshrrev_b32 v193, 16, v193
    v_mul_u32_u24 v194, 28, v193
    v_sub_u32 v192, v192, v194
    buffer_load_dwordx4 v[100:103], v1, s[40:43], s58 offen offset:2048 sc1
    v_lshrrev_b32 v194, 1, v193
    v_and_b32 v194, 2, v194
    v_xor_b32 v192, v192, v194
    v_add_u32 v193, s70, v193
    v_mul_u32_u24 v193, 0xe00, v193
    v_lshl_add_u32 v192, v192, 4, v193
    v_add_u32 v192, s71, v192
    v_subrev_u32 v197, 1024, v192
    v_add_u32 v192, 128, v0
    v_mul_u32_u24 v193, 0x925, v192
    v_lshrrev_b32 v193, 16, v193
    v_mul_u32_u24 v194, 28, v193
    buffer_load_dwordx4 v[104:107], v1, s[40:43], s58 offen offset:3072 sc1
    s_waitcnt lgkmcnt(0)
    s_barrier
    v_sub_u32 v192, v192, v194
    v_lshrrev_b32 v194, 1, v193
    v_and_b32 v194, 2, v194
    v_xor_b32 v192, v192, v194
    v_add_u32 v193, s70, v193
    v_mul_u32_u24 v193, 0xe00, v193
    v_lshl_add_u32 v192, v192, 4, v193
    v_add_u32 v192, s71, v192
    v_subrev_u32 v198, 2048, v192
    v_add_u32 v192, 192, v0
    v_mul_u32_u24 v193, 0x925, v192
    v_lshrrev_b32 v193, 16, v193
    buffer_load_dwordx4 v[108:111], v1, s[40:43], s59 offen offset:0 sc1
    v_mul_u32_u24 v194, 28, v193
    v_sub_u32 v192, v192, v194
    v_lshrrev_b32 v194, 1, v193
    v_and_b32 v194, 2, v194
    v_xor_b32 v192, v192, v194
    v_add_u32 v193, s70, v193
    v_mul_u32_u24 v193, 0xe00, v193
    v_lshl_add_u32 v192, v192, 4, v193
    v_add_u32 v192, s71, v192
    v_subrev_u32 v199, 3072, v192
    v_add_u32 v192, 256, v0
    v_mul_u32_u24 v193, 0x925, v192
    buffer_load_dwordx4 v[112:115], v1, s[40:43], s59 offen offset:1024 sc1
    v_lshrrev_b32 v193, 16, v193
    v_mul_u32_u24 v194, 28, v193
    v_sub_u32 v192, v192, v194
    v_lshrrev_b32 v194, 1, v193
    v_and_b32 v194, 2, v194
    v_xor_b32 v192, v192, v194
    v_add_u32 v193, s70, v193
    v_mul_u32_u24 v193, 0xe00, v193
    v_lshl_add_u32 v192, v192, 4, v193
    v_add_u32 v192, s71, v192
    v_subrev_u32 v200, 0, v192
    v_add_u32 v192, 320, v0
    buffer_load_dwordx4 v[116:119], v1, s[40:43], s59 offen offset:2048 sc1
    v_mul_u32_u24 v193, 0x925, v192
    v_lshrrev_b32 v193, 16, v193
    v_mul_u32_u24 v194, 28, v193
    v_sub_u32 v192, v192, v194
    v_lshrrev_b32 v194, 1, v193
    v_and_b32 v194, 2, v194
    v_xor_b32 v192, v192, v194
    v_add_u32 v193, s70, v193
    v_mul_u32_u24 v193, 0xe00, v193
    v_lshl_add_u32 v192, v192, 4, v193
    v_add_u32 v192, s71, v192
    v_subrev_u32 v201, 1024, v192
    buffer_load_dwordx4 v[120:123], v1, s[40:43], s59 offen offset:3072 sc1
    v_add_u32 v192, 384, v0
    v_mul_u32_u24 v193, 0x925, v192
    v_lshrrev_b32 v193, 16, v193
    v_mul_u32_u24 v194, 28, v193
    v_sub_u32 v192, v192, v194
    v_lshrrev_b32 v194, 1, v193
    v_and_b32 v194, 2, v194
    v_xor_b32 v192, v192, v194
    v_add_u32 v193, s70, v193
    v_mul_u32_u24 v193, 0xe00, v193
    v_lshl_add_u32 v192, v192, 4, v193
    v_add_u32 v192, s71, v192
    buffer_load_dwordx4 v[124:127], v1, s[40:43], s60 offen offset:0 sc1
    v_subrev_u32 v202, 2048, v192
    s_waitcnt vmcnt(8)
    v_mfma_f32_16x16x32_bf16 v[40:43], a[0:3], v[92:95], v[40:43]
    s_lshr_b32 s72, s88, 5
    buffer_load_dwordx4 v[128:131], v1, s[40:43], s60 offen offset:1024 sc1
    v_mfma_f32_16x16x32_bf16 v[44:47], a[4:7], v[92:95], v[44:47]
    s_lshr_b32 s72, 0x02fe01ff, s72
    v_mfma_f32_16x16x32_bf16 v[48:51], a[8:11], v[92:95], v[48:51]
    s_sext_i32_i8 s72, s72
    v_mfma_f32_16x16x32_bf16 v[52:55], a[12:15], v[92:95], v[52:55]
    s_add_u32 s72, s72, s79
    s_waitcnt vmcnt(8)
    v_mfma_f32_16x16x32_bf16 v[40:43], a[16:19], v[96:99], v[40:43]
    v_add_u32 v192, s72, v5
    buffer_load_dwordx4 v[132:135], v1, s[40:43], s60 offen offset:2048 sc1
    v_mfma_f32_16x16x32_bf16 v[44:47], a[20:23], v[96:99], v[44:47]
    v_lshrrev_b32 v193, 6, v192
    v_mfma_f32_16x16x32_bf16 v[48:51], a[24:27], v[96:99], v[48:51]
    v_cmp_eq_u32 vcc, s44, v193
    v_mfma_f32_16x16x32_bf16 v[52:55], a[28:31], v[96:99], v[52:55]
    v_mov_b32 v194, 0x70000
    s_waitcnt vmcnt(8)
    v_mfma_f32_16x16x32_bf16 v[40:43], a[32:35], v[100:103], v[40:43]
    v_mov_b32 v195, 0x30000
    buffer_load_dwordx4 v[136:139], v1, s[40:43], s60 offen offset:3072 sc1
    v_mfma_f32_16x16x32_bf16 v[44:47], a[36:39], v[100:103], v[44:47]
    v_cndmask_b32 v194, v194, v195, vcc
    v_mfma_f32_16x16x32_bf16 v[48:51], a[40:43], v[100:103], v[48:51]
    v_lshl_add_u32 v194, v193, 20, v194
    v_mfma_f32_16x16x32_bf16 v[52:55], a[44:47], v[100:103], v[52:55]
    v_bfe_u32 v193, v192, 4, 2
    s_waitcnt vmcnt(8)
    v_mfma_f32_16x16x32_bf16 v[40:43], a[48:51], v[104:107], v[40:43]
    v_lshl_add_u32 v194, v193, 14, v194
    buffer_load_dwordx4 v[140:143], v1, s[40:43], s61 offen offset:0 sc1
    v_mfma_f32_16x16x32_bf16 v[44:47], a[52:55], v[104:107], v[44:47]
    v_and_b32 v193, 15, v192
    v_mfma_f32_16x16x32_bf16 v[48:51], a[56:59], v[104:107], v[48:51]
    v_lshl_add_u32 v193, v4, 4, v193
    v_mfma_f32_16x16x32_bf16 v[52:55], a[60:63], v[104:107], v[52:55]
    v_and_b32 v195, 1, v192
    s_waitcnt vmcnt(8)
    v_mfma_f32_16x16x32_bf16 v[40:43], a[64:67], v[108:111], v[40:43]
    v_lshl_add_u32 v195, v4, 1, v195
    buffer_load_dwordx4 v[144:147], v1, s[40:43], s61 offen offset:1024 sc1
    v_mfma_f32_16x16x32_bf16 v[44:47], a[68:71], v[108:111], v[44:47]
    v_cndmask_b32 v193, v195, v193, vcc
    v_mfma_f32_16x16x32_bf16 v[48:51], a[72:75], v[108:111], v[48:51]
    v_lshl_add_u32 v194, v193, 4, v194
    v_mfma_f32_16x16x32_bf16 v[52:55], a[76:79], v[108:111], v[52:55]
    v_mov_b32 v193, 0x40000000
    s_waitcnt vmcnt(8)
    v_mfma_f32_16x16x32_bf16 v[40:43], a[80:83], v[112:115], v[40:43]
    v_cmp_gt_u32 vcc, 0x800, v192
    buffer_load_dwordx4 v[148:151], v1, s[40:43], s61 offen offset:2048 sc1
    v_mfma_f32_16x16x32_bf16 v[44:47], a[84:87], v[112:115], v[44:47]
    v_cndmask_b32 v203, v193, v194, vcc
    v_mfma_f32_16x16x32_bf16 v[48:51], a[88:91], v[112:115], v[48:51]
    s_lshr_b32 s72, s89, 5
    v_mfma_f32_16x16x32_bf16 v[52:55], a[92:95], v[112:115], v[52:55]
    s_lshr_b32 s72, 0x02fe01ff, s72
    s_waitcnt vmcnt(8)
    v_mfma_f32_16x16x32_bf16 v[40:43], a[96:99], v[116:119], v[40:43]
    s_sext_i32_i8 s72, s72
    buffer_load_dwordx4 v[152:155], v1, s[40:43], s61 offen offset:3072 sc1
    v_mfma_f32_16x16x32_bf16 v[44:47], a[100:103], v[116:119], v[44:47]
    s_add_u32 s72, s72, s79
    v_mfma_f32_16x16x32_bf16 v[48:51], a[104:107], v[116:119], v[48:51]
    v_add_u32 v192, s72, v5
    v_mfma_f32_16x16x32_bf16 v[52:55], a[108:111], v[116:119], v[52:55]
    v_lshrrev_b32 v193, 6, v192
    s_waitcnt vmcnt(8)
    v_mfma_f32_16x16x32_bf16 v[40:43], a[112:115], v[120:123], v[40:43]
    v_cmp_eq_u32 vcc, s44, v193
    v_mfma_f32_16x16x32_bf16 v[44:47], a[116:119], v[120:123], v[44:47]
    s_add_u32 m0, s49, 0x0
    v_add_u32 v16, s84, v76
    buffer_load_dwordx4 v16, s[20:23], 0 offen offset:0 lds
    v_mfma_f32_16x16x32_bf16 v[48:51], a[120:123], v[120:123], v[48:51]
    v_mov_b32 v194, 0x70000
    v_mfma_f32_16x16x32_bf16 v[52:55], a[124:127], v[120:123], v[52:55]
    v_mov_b32 v195, 0x30000
    s_waitcnt vmcnt(8)
    v_mfma_f32_16x16x32_bf16 v[40:43], a[128:131], v[124:127], v[40:43]
    v_cndmask_b32 v194, v194, v195, vcc
    v_mfma_f32_16x16x32_bf16 v[44:47], a[132:135], v[124:127], v[44:47]
    v_lshl_add_u32 v194, v193, 20, v194
    v_mfma_f32_16x16x32_bf16 v[48:51], a[136:139], v[124:127], v[48:51]
    buffer_load_dwordx4 v16, s[20:23], s53 offen offset:1024 lds
    v_mfma_f32_16x16x32_bf16 v[52:55], a[140:143], v[124:127], v[52:55]
    v_bfe_u32 v193, v192, 4, 2
    s_waitcnt vmcnt(8)
    v_mfma_f32_16x16x32_bf16 v[40:43], a[144:147], v[128:131], v[40:43]
    v_lshl_add_u32 v194, v193, 14, v194
    v_mfma_f32_16x16x32_bf16 v[44:47], a[148:151], v[128:131], v[44:47]
    v_and_b32 v193, 15, v192
    v_mfma_f32_16x16x32_bf16 v[48:51], a[152:155], v[128:131], v[48:51]
    v_lshl_add_u32 v193, v4, 4, v193
    v_mfma_f32_16x16x32_bf16 v[52:55], a[156:159], v[128:131], v[52:55]
    buffer_load_dwordx4 v16, s[20:23], s54 offen offset:2048 lds
    s_waitcnt vmcnt(8)
    v_mfma_f32_16x16x32_bf16 v[40:43], a[160:163], v[132:135], v[40:43]
    v_and_b32 v195, 1, v192
    v_mfma_f32_16x16x32_bf16 v[44:47], a[164:167], v[132:135], v[44:47]
    v_lshl_add_u32 v195, v4, 1, v195
    v_mfma_f32_16x16x32_bf16 v[48:51], a[168:171], v[132:135], v[48:51]
    v_cndmask_b32 v193, v195, v193, vcc
    v_mfma_f32_16x16x32_bf16 v[52:55], a[172:175], v[132:135], v[52:55]
    v_lshl_add_u32 v194, v193, 4, v194
    s_waitcnt vmcnt(7)
    v_mfma_f32_16x16x32_bf16 v[40:43], a[176:179], v[136:139], v[40:43]
    buffer_load_dwordx4 v16, s[20:23], s55 offen offset:3072 lds
    v_mfma_f32_16x16x32_bf16 v[44:47], a[180:183], v[136:139], v[44:47]
    v_mov_b32 v193, 0x40000000
    v_mfma_f32_16x16x32_bf16 v[48:51], a[184:187], v[136:139], v[48:51]
    v_cmp_gt_u32 vcc, 0x800, v192
    v_mfma_f32_16x16x32_bf16 v[52:55], a[188:191], v[136:139], v[52:55]
    v_cndmask_b32 v204, v193, v194, vcc
    s_waitcnt vmcnt(7)
    v_mfma_f32_16x16x32_bf16 v[40:43], a[192:195], v[140:143], v[40:43]
    v_mfma_f32_16x16x32_bf16 v[44:47], a[196:199], v[140:143], v[44:47]
    s_add_u32 m0, s49, 0x4000
    v_add_u32 v16, s85, v76
    buffer_load_dwordx4 v16, s[20:23], 0 offen offset:0 lds
    v_mfma_f32_16x16x32_bf16 v[48:51], a[200:203], v[140:143], v[48:51]
    v_mfma_f32_16x16x32_bf16 v[52:55], a[204:207], v[140:143], v[52:55]
    s_waitcnt vmcnt(7)
    v_mfma_f32_16x16x32_bf16 v[40:43], a[208:211], v[144:147], v[40:43]
    v_mfma_f32_16x16x32_bf16 v[44:47], a[212:215], v[144:147], v[44:47]
    v_mfma_f32_16x16x32_bf16 v[48:51], a[216:219], v[144:147], v[48:51]
    buffer_load_dwordx4 v16, s[20:23], s53 offen offset:1024 lds
    v_mfma_f32_16x16x32_bf16 v[52:55], a[220:223], v[144:147], v[52:55]
    s_waitcnt vmcnt(7)
    v_mfma_f32_16x16x32_bf16 v[40:43], a[224:227], v[148:151], v[40:43]
    v_mfma_f32_16x16x32_bf16 v[44:47], a[228:231], v[148:151], v[44:47]
    v_mfma_f32_16x16x32_bf16 v[48:51], a[232:235], v[148:151], v[48:51]
    v_mfma_f32_16x16x32_bf16 v[52:55], a[236:239], v[148:151], v[52:55]
    buffer_load_dwordx4 v16, s[20:23], s54 offen offset:2048 lds
    s_waitcnt vmcnt(7)
    v_mfma_f32_16x16x32_bf16 v[40:43], a[240:243], v[152:155], v[40:43]
    v_mfma_f32_16x16x32_bf16 v[44:47], a[244:247], v[152:155], v[44:47]
    v_mfma_f32_16x16x32_bf16 v[48:51], a[248:251], v[152:155], v[48:51]
    v_mfma_f32_16x16x32_bf16 v[52:55], a[252:255], v[152:155], v[52:55]
    v_cmp_u_f32 vcc, v40, v40
    s_nop 0
    s_cbranch_vccnz retry_19
back_20:
    s_add_u32 s71, s96, 0x0
    v_cvt_pk_bf16_f32 v172, v40, v41
    buffer_load_dwordx4 v16, s[20:23], s55 offen offset:3072 lds
    v_cvt_pk_bf16_f32 v173, v42, v43
    v_cvt_pk_bf16_f32 v174, v44, v45
    v_cvt_pk_bf16_f32 v175, v46, v47
    buffer_store_dwordx4 v[172:175], v1, s[40:43], s71 offen offset:0
    v_cvt_pk_bf16_f32 v176, v48, v49
    v_cvt_pk_bf16_f32 v177, v50, v51
    v_cvt_pk_bf16_f32 v178, v52, v53
    v_cvt_pk_bf16_f32 v179, v54, v55
    buffer_store_dwordx4 v[176:179], v1, s[40:43], s71 offen offset:1024
    v_mfma_f32_16x16x32_bf16 v[184:187], v[172:175], v[172:175], 0
    v_mfma_f32_16x16x32_bf16 v[180:183], v[28:31], v[172:175], 0
    v_mfma_f32_16x16x32_bf16 v[184:187], v[176:179], v[176:179], v[184:187]
    v_mfma_f32_16x16x32_bf16 v[180:183], v[28:31], v[176:179], v[180:183]
    v_add_u32 v36, 0x10000, v32
    s_add_u32 m0, s49, 0xc000
    v_add_u32 v16, s87, v76
    buffer_load_dwordx4 v16, s[20:23], 0 offen offset:0 lds
    v_add_u32 v37, 0x10000, v33
    v_add_u32 v38, 0x10000, v34
    v_add_u32 v39, 0x10000, v35
    s_barrier
    ds_read_b64_tr_b16 a[0:1], v36 offset:0
    ds_read_b64_tr_b16 a[2:3], v36 offset:8192
    ds_read_b64_tr_b16 a[4:5], v37 offset:0
    ds_read_b64_tr_b16 a[6:7], v37 offset:8192
    ds_read_b64_tr_b16 a[8:9], v38 offset:0
    ds_read_b64_tr_b16 a[10:11], v38 offset:8192
    buffer_load_dwordx4 v16, s[20:23], s53 offen offset:1024 lds
    ds_read_b64_tr_b16 a[12:13], v39 offset:0
    ds_read_b64_tr_b16 a[14:15], v39 offset:8192
    ds_read_b64_tr_b16 a[16:17], v36 offset:1024
    ds_read_b64_tr_b16 a[18:19], v36 offset:9216
    ds_read_b64_tr_b16 a[20:21], v37 offset:1024
    ds_read_b64_tr_b16 a[22:23], v37 offset:9216
    ds_read_b64_tr_b16 a[24:25], v38 offset:1024
    v_cndmask_b32 v181, v184, v185, s[64:65]
    ds_read_b64_tr_b16 a[26:27], v38 offset:9216
    buffer_load_dwordx4 v16, s[20:23], s54 offen offset:2048 lds
    ds_read_b64_tr_b16 a[28:29], v39 offset:1024
    v_cndmask_b32 v181, v181, v186, s[66:67]
    ds_read_b64_tr_b16 a[30:31], v39 offset:9216
    v_cndmask_b32 v181, v181, v187, s[68:69]
    s_waitcnt lgkmcnt(14)
    v_mfma_f32_16x16x32_bf16 v[156:159], a[0:3], v[28:31], 0
    v_mov_b32 v182, s95
    s_lshl_b32 s70, s46, 10
    s_waitcnt lgkmcnt(12)
    v_mfma_f32_16x16x32_bf16 v[160:163], a[4:7], v[28:31], 0
    s_add_u32 s70, s70, s78
    s_add_u32 s70, s70, 0x28000
    s_waitcnt lgkmcnt(10)
    v_mfma_f32_16x16x32_bf16 v[164:167], a[8:11], v[28:31], 0
    buffer_load_dwordx4 v16, s[20:23], s55 offen offset:3072 lds
    s_add_u32 s71, s70, 0x4000
    s_waitcnt lgkmcnt(8)
    v_mfma_f32_16x16x32_bf16 v[168:171], a[12:15], v[28:31], 0
    s_lshl_b32 s58, s88, 4
    s_add_u32 s58, s58, s97
    ds_read_b64_tr_b16 a[32:33], v36 offset:2048
    s_lshl_b32 s59, s89, 4
    ds_read_b64_tr_b16 a[34:35], v36 offset:10240
    s_add_u32 s59, s59, s97
    ds_read_b64_tr_b16 a[36:37], v37 offset:2048
    s_lshl_b32 s60, s90, 4
    ds_read_b64_tr_b16 a[38:39], v37 offset:10240
    s_add_u32 m0, s49, 0x8000
    v_add_u32 v16, s86, v76
    buffer_load_dwordx4 v16, s[20:23], 0 offen offset:0 lds
    ds_read_b64_tr_b16 a[40:41], v38 offset:2048
    s_add_u32 s60, s60, s97
    ds_read_b64_tr_b16 a[42:43], v38 offset:10240
    s_lshl_b32 s61, s91, 4
    ds_read_b64_tr_b16 a[44:45], v39 offset:2048
    s_add_u32 s61, s61, s97
    ds_read_b64_tr_b16 a[46:47], v39 offset:10240
    s_waitcnt lgkmcnt(14)
    v_mfma_f32_16x16x32_bf16 v[156:159], a[16:19], v[28:31], v[156:159]
    s_waitcnt lgkmcnt(12)
    v_mfma_f32_16x16x32_bf16 v[160:163], a[20:23], v[28:31], v[160:163]
    buffer_load_dwordx4 v16, s[20:23], s53 offen offset:1024 lds
    s_waitcnt lgkmcnt(10)
    v_mfma_f32_16x16x32_bf16 v[164:167], a[24:27], v[28:31], v[164:167]
    s_waitcnt lgkmcnt(8)
    v_mfma_f32_16x16x32_bf16 v[168:171], a[28:31], v[28:31], v[168:171]
    ds_read_b64_tr_b16 a[48:49], v36 offset:3072
    ds_read_b64_tr_b16 a[50:51], v36 offset:11264
    ds_read_b64_tr_b16 a[52:53], v37 offset:3072
    ds_read_b64_tr_b16 a[54:55], v37 offset:11264
    ds_read_b64_tr_b16 a[56:57], v38 offset:3072
    buffer_load_dwordx4 v16, s[20:23], s54 offen offset:2048 lds
    ds_read_b64_tr_b16 a[58:59], v38 offset:11264
    ds_read_b64_tr_b16 a[60:61], v39 offset:3072
    ds_read_b64_tr_b16 a[62:63], v39 offset:11264
    s_waitcnt lgkmcnt(14)
    v_mfma_f32_16x16x32_bf16 v[156:159], a[32:35], v[28:31], v[156:159]
    s_waitcnt lgkmcnt(12)
    v_mfma_f32_16x16x32_bf16 v[160:163], a[36:39], v[28:31], v[160:163]
    s_waitcnt lgkmcnt(10)
    v_mfma_f32_16x16x32_bf16 v[164:167], a[40:43], v[28:31], v[164:167]
    buffer_load_dwordx4 v16, s[20:23], s55 offen offset:3072 lds
ahead_p3_0:
    s_cbranch_execz ahead_p3_4
    s_waitcnt lgkmcnt(8)
    v_mfma_f32_16x16x32_bf16 v[168:171], a[44:47], v[28:31], v[168:171]
    buffer_store_dwordx3 v[180:182], v26, s[40:43], s56 offen offset:256
    ds_read_b64_tr_b16 a[64:65], v36 offset:16384
    ds_read_b64_tr_b16 a[66:67], v36 offset:24576
    ds_read_b64_tr_b16 a[68:69], v37 offset:16384
    ds_read_b64_tr_b16 a[70:71], v37 offset:24576
    ds_read_b64_tr_b16 a[72:73], v38 offset:16384
    ds_read_b64_tr_b16 a[74:75], v38 offset:24576
    ds_read_b64_tr_b16 a[76:77], v39 offset:16384
    ds_read_b64_tr_b16 a[78:79], v39 offset:24576
    s_add_u32 m0, s48, 0x20000
    s_add_u32 s3, s77, 0x0
    buffer_load_dwordx4 v196, s[24:27], s3 offen offset:0 lds
    s_waitcnt lgkmcnt(14)
    v_mfma_f32_16x16x32_bf16 v[156:159], a[48:51], v[28:31], v[156:159]
    s_waitcnt lgkmcnt(12)
    v_mfma_f32_16x16x32_bf16 v[160:163], a[52:55], v[28:31], v[160:163]
    s_waitcnt lgkmcnt(10)
    v_mfma_f32_16x16x32_bf16 v[164:167], a[56:59], v[28:31], v[164:167]
    s_waitcnt lgkmcnt(8)
    v_mfma_f32_16x16x32_bf16 v[168:171], a[60:63], v[28:31], v[168:171]
    ds_read_b64_tr_b16 a[80:81], v36 offset:17408
    buffer_load_dwordx4 v197, s[24:27], s3 offen offset:1024 lds
    ds_read_b64_tr_b16 a[82:83], v36 offset:25600
    ds_read_b64_tr_b16 a[84:85], v37 offset:17408
    ds_read_b64_tr_b16 a[86:87], v37 offset:25600
    ds_read_b64_tr_b16 a[88:89], v38 offset:17408
    ds_read_b64_tr_b16 a[90:91], v38 offset:25600
    ds_read_b64_tr_b16 a[92:93], v39 offset:17408
    ds_read_b64_tr_b16 a[94:95], v39 offset:25600
    s_waitcnt lgkmcnt(14)
    v_mfma_f32_16x16x32_bf16 v[156:159], a[64:67], v[28:31], v[156:159]
    buffer_load_dwordx4 v198, s[24:27], s3 offen offset:2048 lds
    s_waitcnt lgkmcnt(12)
    v_mfma_f32_16x16x32_bf16 v[160:163], a[68:71], v[28:31], v[160:163]
    s_waitcnt lgkmcnt(10)
    v_mfma_f32_16x16x32_bf16 v[164:167], a[72:75], v[28:31], v[164:167]
    s_waitcnt lgkmcnt(8)
    v_mfma_f32_16x16x32_bf16 v[168:171], a[76:79], v[28:31], v[168:171]
    ds_read_b64_tr_b16 a[96:97], v36 offset:18432
    ds_read_b64_tr_b16 a[98:99], v36 offset:26624
    ds_read_b64_tr_b16 a[100:101], v37 offset:18432
    buffer_load_dwordx4 v199, s[24:27], s3 offen offset:3072 lds
    ds_read_b64_tr_b16 a[102:103], v37 offset:26624
    ds_read_b64_tr_b16 a[104:105], v38 offset:18432
    ds_read_b64_tr_b16 a[106:107], v38 offset:26624
    ds_read_b64_tr_b16 a[108:109], v39 offset:18432
    ds_read_b64_tr_b16 a[110:111], v39 offset:26624
    s_waitcnt lgkmcnt(14)
    v_mfma_f32_16x16x32_bf16 v[156:159], a[80:83], v[28:31], v[156:159]
    s_waitcnt lgkmcnt(12)
    v_mfma_f32_16x16x32_bf16 v[160:163], a[84:87], v[28:31], v[160:163]
    s_add_u32 m0, s48, 0x21000
    s_nop 0
    buffer_load_dwordx4 v200, s[24:27], s3 offen offset:0 lds
    s_waitcnt lgkmcnt(10)
    v_mfma_f32_16x16x32_bf16 v[164:167], a[88:91], v[28:31], v[164:167]
    s_waitcnt lgkmcnt(8)
    v_mfma_f32_16x16x32_bf16 v[168:171], a[92:95], v[28:31], v[168:171]
    ds_read_b64_tr_b16 a[112:113], v36 offset:19456
    ds_read_b64_tr_b16 a[114:115], v36 offset:27648
    ds_read_b64_tr_b16 a[116:117], v37 offset:19456
    ds_read_b64_tr_b16 a[118:119], v37 offset:27648
    ds_read_b64_tr_b16 a[120:121], v38 offset:19456
    buffer_load_dwordx4 v201, s[24:27], s3 offen offset:1024 lds
    ds_read_b64_tr_b16 a[122:123], v38 offset:27648
    ds_read_b64_tr_b16 a[124:125], v39 offset:19456
    ds_read_b64_tr_b16 a[126:127], v39 offset:27648
    s_waitcnt lgkmcnt(14)
    v_mfma_f32_16x16x32_bf16 v[156:159], a[96:99], v[28:31], v[156:159]
    s_waitcnt lgkmcnt(12)
    v_mfma_f32_16x16x32_bf16 v[160:163], a[100:103], v[28:31], v[160:163]
    s_waitcnt lgkmcnt(10)
    v_mfma_f32_16x16x32_bf16 v[164:167], a[104:107], v[28:31], v[164:167]
    buffer_load_dwordx4 v202, s[24:27], s3 offen offset:2048 lds
    s_waitcnt lgkmcnt(8)
    v_mfma_f32_16x16x32_bf16 v[168:171], a[108:111], v[28:31], v[168:171]
    ds_read_b64_tr_b16 a[128:129], v36 offset:32768
    ds_read_b64_tr_b16 a[130:131], v36 offset:40960
    ds_read_b64_tr_b16 a[132:133], v37 offset:32768
    ds_read_b64_tr_b16 a[134:135], v37 offset:40960
    ds_read_b64_tr_b16 a[136:137], v38 offset:32768
    ds_read_b64_tr_b16 a[138:139], v38 offset:40960
    ds_read_b64_tr_b16 a[140:141], v39 offset:32768
    ds_read_b64_tr_b16 a[142:143], v39 offset:40960
    s_waitcnt lgkmcnt(14)
    v_mfma_f32_16x16x32_bf16 v[156:159], a[112:115], v[28:31], v[156:159]
    s_waitcnt lgkmcnt(12)
    v_mfma_f32_16x16x32_bf16 v[160:163], a[116:119], v[28:31], v[160:163]
    s_waitcnt lgkmcnt(10)
    v_mfma_f32_16x16x32_bf16 v[164:167], a[120:123], v[28:31], v[164:167]
    s_waitcnt lgkmcnt(8)
    v_mfma_f32_16x16x32_bf16 v[168:171], a[124:127], v[28:31], v[168:171]
    ds_read_b64_tr_b16 a[144:145], v36 offset:33792
    ds_read_b64_tr_b16 a[146:147], v36 offset:41984
    ds_read_b64_tr_b16 a[148:149], v37 offset:33792
    ds_read_b64_tr_b16 a[150:151], v37 offset:41984
    ds_read_b64_tr_b16 a[152:153], v38 offset:33792
    ds_read_b64_tr_b16 a[154:155], v38 offset:41984
    ds_read_b64_tr_b16 a[156:157], v39 offset:33792
    ds_read_b64_tr_b16 a[158:159], v39 offset:41984
    s_waitcnt lgkmcnt(14)
    v_mfma_f32_16x16x32_bf16 v[156:159], a[128:131], v[28:31], v[156:159]
    s_waitcnt lgkmcnt(12)
    v_mfma_f32_16x16x32_bf16 v[160:163], a[132:135], v[28:31], v[160:163]
    s_waitcnt lgkmcnt(10)
    v_mfma_f32_16x16x32_bf16 v[164:167], a[136:139], v[28:31], v[164:167]
    s_waitcnt lgkmcnt(8)
    v_mfma_f32_16x16x32_bf16 v[168:171], a[140:143], v[28:31], v[168:171]
    buffer_load_dwordx3 v[172:174], v13, s[40:43], s70 offen offset:256 sc1
    buffer_load_dwordx3 v[176:178], v13, s[40:43], s71 offen offset:256 sc1
    ds_read_b64_tr_b16 a[160:161], v36 offset:34816
    ds_read_b64_tr_b16 a[162:163], v36 offset:43008
    ds_read_b64_tr_b16 a[164:165], v37 offset:34816
    ds_read_b64_tr_b16 a[166:167], v37 offset:43008
    ds_read_b64_tr_b16 a[168:169], v38 offset:34816
    ds_read_b64_tr_b16 a[170:171], v38 offset:43008
    ds_read_b64_tr_b16 a[172:173], v39 offset:34816
    ds_read_b64_tr_b16 a[174:175], v39 offset:43008
    ds_read_b64_tr_b16 a[176:177], v36 offset:35840
    ds_read_b64_tr_b16 a[178:179], v36 offset:44032
    ds_read_b64_tr_b16 a[180:181], v37 offset:35840
    ds_read_b64_tr_b16 a[182:183], v37 offset:44032
    ds_read_b64_tr_b16 a[184:185], v38 offset:35840
    ds_read_b64_tr_b16 a[186:187], v38 offset:44032
    ds_read_b64_tr_b16 a[188:189], v39 offset:35840
    ds_read_b64_tr_b16 a[190:191], v39 offset:44032
    ds_read_b64_tr_b16 a[192:193], v36 offset:49152
    ds_read_b64_tr_b16 a[194:195], v36 offset:57344
    ds_read_b64_tr_b16 a[196:197], v37 offset:49152
    ds_read_b64_tr_b16 a[198:199], v37 offset:57344
    ds_read_b64_tr_b16 a[200:201], v38 offset:49152
    ds_read_b64_tr_b16 a[202:203], v38 offset:57344
    ds_read_b64_tr_b16 a[204:205], v39 offset:49152
    ds_read_b64_tr_b16 a[206:207], v39 offset:57344
    ds_read_b64_tr_b16 a[208:209], v36 offset:50176
    ds_read_b64_tr_b16 a[210:211], v36 offset:58368
    ds_read_b64_tr_b16 a[212:213], v37 offset:50176
    ds_read_b64_tr_b16 a[214:215], v37 offset:58368
    ds_read_b64_tr_b16 a[216:217], v38 offset:50176
    ds_read_b64_tr_b16 a[218:219], v38 offset:58368
    ds_read_b64_tr_b16 a[220:221], v39 offset:50176
    ds_read_b64_tr_b16 a[222:223], v39 offset:58368
    ds_read_b64_tr_b16 a[224:225], v36 offset:51200
    ds_read_b64_tr_b16 a[226:227], v36 offset:59392
    ds_read_b64_tr_b16 a[228:229], v37 offset:51200
    ds_read_b64_tr_b16 a[230:231], v37 offset:59392
    ds_read_b64_tr_b16 a[232:233], v38 offset:51200
    ds_read_b64_tr_b16 a[234:235], v38 offset:59392
    ds_read_b64_tr_b16 a[236:237], v39 offset:51200
    ds_read_b64_tr_b16 a[238:239], v39 offset:59392
    ds_read_b64_tr_b16 a[240:241], v36 offset:52224
    ds_read_b64_tr_b16 a[242:243], v36 offset:60416
    ds_read_b64_tr_b16 a[244:245], v37 offset:52224
    ds_read_b64_tr_b16 a[246:247], v37 offset:60416
    ds_read_b64_tr_b16 a[248:249], v38 offset:52224
    ds_read_b64_tr_b16 a[250:251], v38 offset:60416
    ds_read_b64_tr_b16 a[252:253], v39 offset:52224
    ds_read_b64_tr_b16 a[254:255], v39 offset:60416
    s_waitcnt vmcnt(1)
    v_cmp_ne_u32 vcc, s95, v174
    s_waitcnt vmcnt(0)
    v_cmp_ne_u32 s[74:75], s95, v178
    s_or_b64 vcc, vcc, s[74:75]
    s_cbranch_vccz polled_22
    s_mov_b32 s57, 0x40000
poll_21:
    buffer_load_dwordx3 v[172:174], v13, s[40:43], s70 offen offset:256 sc1
    buffer_load_dwordx3 v[176:178], v13, s[40:43], s71 offen offset:256 sc1
    s_waitcnt vmcnt(1)
    v_cmp_ne_u32 vcc, s95, v174
    s_waitcnt vmcnt(0)
    v_cmp_ne_u32 s[74:75], s95, v178
    s_or_b64 vcc, vcc, s[74:75]
    s_cbranch_vccz polled_22
    s_sub_u32 s57, s57, 1
    s_cbranch_scc0 poll_21
polled_22:
    s_add_u32 s72, s94, 0x30000
    buffer_store_dword v20, v1, s[40:43], s72 offen offset:0
    buffer_store_dword v20, v1, s[40:43], s72 offen offset:1024
    buffer_load_dwordx4 v[92:95], v1, s[40:43], s58 offen offset:0 sc1
    s_waitcnt lgkmcnt(15)
    v_mfma_f32_16x16x32_bf16 v[156:159], a[144:147], v[28:31], v[156:159]
    v_add_f32 v172, v172, v176
    v_add_f32 v173, v173, v177
    v_mfma_f32_16x16x32_bf16 v[160:163], a[148:151], v[28:31], v[160:163]
    v_permlane32_swap_b32 v172, v173
    v_add_f32 v172, v172, v173
    v_mfma_f32_16x16x32_bf16 v[164:167], a[152:155], v[28:31], v[164:167]
    v_mov_b32 v173, v172
    s_nop 1
    v_permlane16_swap_b32 v172, v173
    v_mfma_f32_16x16x32_bf16 v[168:171], a[156:159], v[28:31], v[168:171]
    v_add_f32 v172, v172, v173
    v_mov_b32 v173, v172
    buffer_load_dwordx4 v[96:99], v1, s[40:43], s58 offen offset:1024 sc1
    v_mfma_f32_16x16x32_bf16 v[156:159], a[160:163], v[28:31], v[156:159]
    v_permlane32_swap_b32 v172, v173
    v_mul_f32 v7, 0x3b000000, v172
    v_mfma_f32_16x16x32_bf16 v[160:163], a[164:167], v[28:31], v[160:163]
    v_mul_f32 v173, 0x3b000000, v173
    v_fma_f32 v173, -v7, v7, v173
    v_mfma_f32_16x16x32_bf16 v[164:167], a[168:171], v[28:31], v[164:167]
    v_max_f32 v173, 0, v173
    v_add_f32 v12, 0x3727c5ac, v173
    v_mfma_f32_16x16x32_bf16 v[168:171], a[172:175], v[28:31], v[168:171]
    v_rsq_f32 v12, v12
    s_nop 0
    v_mul_f32 v192, v12, v12
    buffer_load_dwordx4 v[100:103], v1, s[40:43], s58 offen offset:2048 sc1
    v_mfma_f32_16x16x32_bf16 v[156:159], a[176:179], v[28:31], v[156:159]
    v_mul_f32 v192, v192, v173
    v_add_f32 v192, 0x3727c5ac, v192
    v_mfma_f32_16x16x32_bf16 v[160:163], a[180:183], v[28:31], v[160:163]
    v_rsq_f32 v192, v192
    s_nop 0
    v_mul_f32 v192, v192, v12
    v_mfma_f32_16x16x32_bf16 v[164:167], a[184:187], v[28:31], v[164:167]
    v_mul_f32 v22, 0xc0135761, v192
    v_mul_f32 v23, v192, v192
    v_mfma_f32_16x16x32_bf16 v[168:171], a[188:191], v[28:31], v[168:171]
    v_mul_f32 v23, v23, v22
    v_mul_f32 v23, 0x3d372713, v23
    buffer_load_dwordx4 v[104:107], v1, s[40:43], s58 offen offset:3072 sc1
    s_waitcnt lgkmcnt(0)
    s_barrier
    v_mfma_f32_16x16x32_bf16 v[156:159], a[192:195], v[28:31], v[156:159]
    v_rcp_f32 v72, v192
    v_mfma_f32_16x16x32_bf16 v[160:163], a[196:199], v[28:31], v[160:163]
    v_mfma_f32_16x16x32_bf16 v[164:167], a[200:203], v[28:31], v[164:167]
    v_mfma_f32_16x16x32_bf16 v[168:171], a[204:207], v[28:31], v[168:171]
    buffer_load_dwordx4 v[108:111], v1, s[40:43], s59 offen offset:0 sc1
    v_mfma_f32_16x16x32_bf16 v[156:159], a[208:211], v[28:31], v[156:159]
    v_mfma_f32_16x16x32_bf16 v[160:163], a[212:215], v[28:31], v[160:163]
    v_mfma_f32_16x16x32_bf16 v[164:167], a[216:219], v[28:31], v[164:167]
    v_mfma_f32_16x16x32_bf16 v[168:171], a[220:223], v[28:31], v[168:171]
    buffer_load_dwordx4 v[112:115], v1, s[40:43], s59 offen offset:1024 sc1
    v_mfma_f32_16x16x32_bf16 v[156:159], a[224:227], v[28:31], v[156:159]
    v_mfma_f32_16x16x32_bf16 v[160:163], a[228:231], v[28:31], v[160:163]
    v_mfma_f32_16x16x32_bf16 v[164:167], a[232:235], v[28:31], v[164:167]
    v_mfma_f32_16x16x32_bf16 v[168:171], a[236:239], v[28:31], v[168:171]
    buffer_load_dwordx4 v[116:119], v1, s[40:43], s59 offen offset:2048 sc1
    v_mfma_f32_16x16x32_bf16 v[156:159], a[240:243], v[28:31], v[156:159]
    v_mfma_f32_16x16x32_bf16 v[160:163], a[244:247], v[28:31], v[160:163]
    v_mfma_f32_16x16x32_bf16 v[164:167], a[248:251], v[28:31], v[164:167]
    v_mfma_f32_16x16x32_bf16 v[168:171], a[252:255], v[28:31], v[168:171]
    buffer_load_dwordx4 v[120:123], v1, s[40:43], s59 offen offset:3072 sc1
    v_mul_f32 v56, -v7, v156
    v_mul_f32 v57, -v7, v157
    v_mul_f32 v58, -v7, v158
    v_mul_f32 v59, -v7, v159
    v_mul_f32 v60, -v7, v160
    v_mul_f32 v61, -v7, v161
    v_mul_f32 v62, -v7, v162
    v_mul_f32 v63, -v7, v163
    v_mul_f32 v64, -v7, v164
    v_mul_f32 v65, -v7, v165
    v_mul_f32 v66, -v7, v166
    v_mul_f32 v67, -v7, v167
    v_mul_f32 v68, -v7, v168
    v_mul_f32 v69, -v7, v169
    v_mul_f32 v70, -v7, v170
    v_mul_f32 v71, -v7, v171
    buffer_load_dwordx4 v[124:127], v1, s[40:43], s60 offen offset:0 sc1
    s_waitcnt vmcnt(8)
    v_mfma_f32_16x16x32_bf16 v[56:59], a[0:3], v[92:95], v[56:59]
    s_lshr_b32 s72, s90, 5
    buffer_load_dwordx4 v[128:131], v1, s[40:43], s60 offen offset:1024 sc1
    v_mfma_f32_16x16x32_bf16 v[60:63], a[4:7], v[92:95], v[60:63]
    s_lshr_b32 s72, 0x02fe01ff, s72
    v_mfma_f32_16x16x32_bf16 v[64:67], a[8:11], v[92:95], v[64:67]
    s_sext_i32_i8 s72, s72
    v_mfma_f32_16x16x32_bf16 v[68:71], a[12:15], v[92:95], v[68:71]
    s_add_u32 s72, s72, s79
    s_waitcnt vmcnt(8)
    v_mfma_f32_16x16x32_bf16 v[56:59], a[16:19], v[96:99], v[56:59]
    v_add_u32 v192, s72, v5
    buffer_load_dwordx4 v[132:135], v1, s[40:43], s60 offen offset:2048 sc1
    v_mfma_f32_16x16x32_bf16 v[60:63], a[20:23], v[96:99], v[60:63]
    v_lshrrev_b32 v193, 6, v192
    v_mfma_f32_16x16x32_bf16 v[64:67], a[24:27], v[96:99], v[64:67]
    v_cmp_eq_u32 vcc, s44, v193
    v_mfma_f32_16x16x32_bf16 v[68:71], a[28:31], v[96:99], v[68:71]
    v_mov_b32 v194, 0x70000
    s_waitcnt vmcnt(8)
    v_mfma_f32_16x16x32_bf16 v[56:59], a[32:35], v[100:103], v[56:59]
    v_mov_b32 v195, 0x30000
    buffer_load_dwordx4 v[136:139], v1, s[40:43], s60 offen offset:3072 sc1
    v_mfma_f32_16x16x32_bf16 v[60:63], a[36:39], v[100:103], v[60:63]
    v_cndmask_b32 v194, v194, v195, vcc
    v_mfma_f32_16x16x32_bf16 v[64:67], a[40:43], v[100:103], v[64:67]
    v_lshl_add_u32 v194, v193, 20, v194
    v_mfma_f32_16x16x32_bf16 v[68:71], a[44:47], v[100:103], v[68:71]
    v_bfe_u32 v193, v192, 4, 2
    s_waitcnt vmcnt(8)
    v_mfma_f32_16x16x32_bf16 v[56:59], a[48:51], v[104:107], v[56:59]
    v_lshl_add_u32 v194, v193, 14, v194
    buffer_load_dwordx4 v[140:143], v1, s[40:43], s61 offen offset:0 sc1
    v_mfma_f32_16x16x32_bf16 v[60:63], a[52:55], v[104:107], v[60:63]
    v_and_b32 v193, 15, v192
    v_mfma_f32_16x16x32_bf16 v[64:67], a[56:59], v[104:107], v[64:67]
    v_lshl_add_u32 v193, v4, 4, v193
    v_mfma_f32_16x16x32_bf16 v[68:71], a[60:63], v[104:107], v[68:71]
    v_and_b32 v195, 1, v192
    s_waitcnt vmcnt(8)
    v_mfma_f32_16x16x32_bf16 v[56:59], a[64:67], v[108:111], v[56:59]
    v_lshl_add_u32 v195, v4, 1, v195
    buffer_load_dwordx4 v[144:147], v1, s[40:43], s61 offen offset:1024 sc1
    v_mfma_f32_16x16x32_bf16 v[60:63], a[68:71], v[108:111], v[60:63]
    v_cndmask_b32 v193, v195, v193, vcc
    v_mfma_f32_16x16x32_bf16 v[64:67], a[72:75], v[108:111], v[64:67]
    v_lshl_add_u32 v194, v193, 4, v194
    v_mfma_f32_16x16x32_bf16 v[68:71], a[76:79], v[108:111], v[68:71]
    v_mov_b32 v193, 0x40000000
    s_waitcnt vmcnt(8)
    v_mfma_f32_16x16x32_bf16 v[56:59], a[80:83], v[112:115], v[56:59]
    v_cmp_gt_u32 vcc, 0x800, v192
    buffer_load_dwordx4 v[148:151], v1, s[40:43], s61 offen offset:2048 sc1
    v_mfma_f32_16x16x32_bf16 v[60:63], a[84:87], v[112:115], v[60:63]
    v_cndmask_b32 v205, v193, v194, vcc
    v_mfma_f32_16x16x32_bf16 v[64:67], a[88:91], v[112:115], v[64:67]
    s_lshr_b32 s72, s91, 5
    v_mfma_f32_16x16x32_bf16 v[68:71], a[92:95], v[112:115], v[68:71]
    s_lshr_b32 s72, 0x02fe01ff, s72
    s_waitcnt vmcnt(8)
    v_mfma_f32_16x16x32_bf16 v[56:59], a[96:99], v[116:119], v[56:59]
    s_sext_i32_i8 s72, s72
    buffer_load_dwordx4 v[152:155], v1, s[40:43], s61 offen offset:3072 sc1
    v_mfma_f32_16x16x32_bf16 v[60:63], a[100:103], v[116:119], v[60:63]
    s_add_u32 s72, s72, s79
    v_mfma_f32_16x16x32_bf16 v[64:67], a[104:107], v[116:119], v[64:67]
    v_add_u32 v192, s72, v5
    v_mfma_f32_16x16x32_bf16 v[68:71], a[108:111], v[116:119], v[68:71]
    v_lshrrev_b32 v193, 6, v192
    s_waitcnt vmcnt(8)
    v_mfma_f32_16x16x32_bf16 v[56:59], a[112:115], v[120:123], v[56:59]
    v_cmp_eq_u32 vcc, s44, v193
    v_mfma_f32_16x16x32_bf16 v[60:63], a[116:119], v[120:123], v[60:63]
    s_add_u32 m0, s48, 0x10000
    s_add_u32 s3, s77, 0x38000
    buffer_load_dwordx4 v196, s[24:27], s3 offen offset:0 lds
    v_mfma_f32_16x16x32_bf16 v[64:67], a[120:123], v[120:123], v[64:67]
    v_mov_b32 v194, 0x70000
    v_mfma_f32_16x16x32_bf16 v[68:71], a[124:127], v[120:123], v[68:71]
    v_mov_b32 v195, 0x30000
    s_waitcnt vmcnt(8)
    v_mfma_f32_16x16x32_bf16 v[56:59], a[128:131], v[124:127], v[56:59]
    v_cndmask_b32 v194, v194, v195, vcc
    v_mfma_f32_16x16x32_bf16 v[60:63], a[132:135], v[124:127], v[60:63]
    v_lshl_add_u32 v194, v193, 20, v194
    v_mfma_f32_16x16x32_bf16 v[64:67], a[136:139], v[124:127], v[64:67]
    buffer_load_dwordx4 v197, s[24:27], s3 offen offset:1024 lds
    v_mfma_f32_16x16x32_bf16 v[68:71], a[140:143], v[124:127], v[68:71]
    v_bfe_u32 v193, v192, 4, 2
    s_waitcnt vmcnt(8)
    v_mfma_f32_16x16x32_bf16 v[56:59], a[144:147], v[128:131], v[56:59]
    v_lshl_add_u32 v194, v193, 14, v194
    v_mfma_f32_16x16x32_bf16 v[60:63], a[148:151], v[128:131], v[60:63]
    v_and_b32 v193, 15, v192
    v_mfma_f32_16x16x32_bf16 v[64:67], a[152:155], v[128:131], v[64:67]
    v_lshl_add_u32 v193, v4, 4, v193
    v_mfma_f32_16x16x32_bf16 v[68:71], a[156:159], v[128:131], v[68:71]
    buffer_load_dwordx4 v198, s[24:27], s3 offen offset:2048 lds
    s_waitcnt vmcnt(8)
    v_mfma_f32_16x16x32_bf16 v[56:59], a[160:163], v[132:135], v[56:59]
    v_and_b32 v195, 1, v192
    v_mfma_f32_16x16x32_bf16 v[60:63], a[164:167], v[132:135], v[60:63]
    v_lshl_add_u32 v195, v4, 1, v195
    v_mfma_f32_16x16x32_bf16 v[64:67], a[168:171], v[132:135], v[64:67]
    v_cndmask_b32 v193, v195, v193, vcc
    v_mfma_f32_16x16x32_bf16 v[68:71], a[172:175], v[132:135], v[68:71]
    v_lshl_add_u32 v194, v193, 4, v194
    s_waitcnt vmcnt(7)
    v_mfma_f32_16x16x32_bf16 v[56:59], a[176:179], v[136:139], v[56:59]
    buffer_load_dwordx4 v199, s[24:27], s3 offen offset:3072 lds
    v_mfma_f32_16x16x32_bf16 v[60:63], a[180:183], v[136:139], v[60:63]
    v_mov_b32 v193, 0x40000000
    v_mfma_f32_16x16x32_bf16 v[64:67], a[184:187], v[136:139], v[64:67]
    v_cmp_gt_u32 vcc, 0x800, v192
    v_mfma_f32_16x16x32_bf16 v[68:71], a[188:191], v[136:139], v[68:71]
    v_cndmask_b32 v206, v193, v194, vcc
    s_waitcnt vmcnt(7)
    v_mfma_f32_16x16x32_bf16 v[56:59], a[192:195], v[140:143], v[56:59]
    v_mfma_f32_16x16x32_bf16 v[60:63], a[196:199], v[140:143], v[60:63]
    s_add_u32 m0, s48, 0x11000
    s_nop 0
    buffer_load_dwordx4 v200, s[24:27], s3 offen offset:0 lds
    v_mfma_f32_16x16x32_bf16 v[64:67], a[200:203], v[140:143], v[64:67]
    v_mfma_f32_16x16x32_bf16 v[68:71], a[204:207], v[140:143], v[68:71]
    s_waitcnt vmcnt(7)
    v_mfma_f32_16x16x32_bf16 v[56:59], a[208:211], v[144:147], v[56:59]
    v_mfma_f32_16x16x32_bf16 v[60:63], a[212:215], v[144:147], v[60:63]
    v_mfma_f32_16x16x32_bf16 v[64:67], a[216:219], v[144:147], v[64:67]
    buffer_load_dwordx4 v201, s[24:27], s3 offen offset:1024 lds
    v_mfma_f32_16x16x32_bf16 v[68:71], a[220:223], v[144:147], v[68:71]
    s_waitcnt vmcnt(7)
    v_mfma_f32_16x16x32_bf16 v[56:59], a[224:227], v[148:151], v[56:59]
    v_mfma_f32_16x16x32_bf16 v[60:63], a[228:231], v[148:151], v[60:63]
    v_mfma_f32_16x16x32_bf16 v[64:67], a[232:235], v[148:151], v[64:67]
    v_mfma_f32_16x16x32_bf16 v[68:71], a[236:239], v[148:151], v[68:71]
    buffer_load_dwordx4 v202, s[24:27], s3 offen offset:2048 lds
    s_waitcnt vmcnt(7)
    v_mfma_f32_16x16x32_bf16 v[56:59], a[240:243], v[152:155], v[56:59]
    v_mfma_f32_16x16x32_bf16 v[60:63], a[244:247], v[152:155], v[60:63]
    v_mfma_f32_16x16x32_bf16 v[64:67], a[248:251], v[152:155], v[64:67]
    v_mfma_f32_16x16x32_bf16 v[68:71], a[252:255], v[152:155], v[68:71]
    v_cmp_u_f32 vcc, v56, v56
    s_nop 0
    s_cbranch_vccnz retry_23
back_24:
    s_add_u32 s71, s94, 0x30000
    v_pk_mul_f32 v[188:189], v[56:57], v[56:57]
    s_lshl2_add_u32 s3, s2, s46
    s_mul_i32 s3, s3, 1792
    buffer_load_dword v6, v89, s[28:31], s3 offen
    v_pk_mul_f32 v[190:191], v[58:59], v[58:59]
    v_pk_fma_f32 v[188:189], v[188:189], v[22:23], v[22:23] op_sel:[0,1,0] op_sel_hi:[1,1,0]
    v_pk_fma_f32 v[190:191], v[190:191], v[22:23], v[22:23] op_sel:[0,1,0] op_sel_hi:[1,1,0]
    v_pk_mul_f32 v[188:189], v[188:189], v[56:57]
    v_pk_mul_f32 v[190:191], v[190:191], v[58:59]
    v_exp_f32 v188, v188
    v_exp_f32 v189, v189
    v_exp_f32 v190, v190
    v_exp_f32 v191, v191
    v_pk_fma_f32 v[188:189], v[188:189], v[72:73], v[72:73] op_sel_hi:[1,0,0]
    v_pk_fma_f32 v[190:191], v[190:191], v[72:73], v[72:73] op_sel_hi:[1,0,0]
    v_rcp_f32 v188, v188
    v_rcp_f32 v189, v189
    v_rcp_f32 v190, v190
    v_rcp_f32 v191, v191
    v_pk_mul_f32 v[56:57], v[56:57], v[188:189]
    v_pk_mul_f32 v[58:59], v[58:59], v[190:191]
    v_cvt_pk_bf16_f32 v172, v56, v57
    v_cvt_pk_bf16_f32 v173, v58, v59
    v_pk_mul_f32 v[188:189], v[60:61], v[60:61]
    v_pk_mul_f32 v[190:191], v[62:63], v[62:63]
    v_pk_fma_f32 v[188:189], v[188:189], v[22:23], v[22:23] op_sel:[0,1,0] op_sel_hi:[1,1,0]
    v_pk_fma_f32 v[190:191], v[190:191], v[22:23], v[22:23] op_sel:[0,1,0] op_sel_hi:[1,1,0]
    v_pk_mul_f32 v[188:189], v[188:189], v[60:61]
    v_pk_mul_f32 v[190:191], v[190:191], v[62:63]
    v_exp_f32 v188, v188
    v_exp_f32 v189, v189
    v_exp_f32 v190, v190
    v_exp_f32 v191, v191
    v_pk_fma_f32 v[188:189], v[188:189], v[72:73], v[72:73] op_sel_hi:[1,0,0]
    v_pk_fma_f32 v[190:191], v[190:191], v[72:73], v[72:73] op_sel_hi:[1,0,0]
    v_rcp_f32 v188, v188
    v_rcp_f32 v189, v189
    v_rcp_f32 v190, v190
    v_rcp_f32 v191, v191
    v_pk_mul_f32 v[60:61], v[60:61], v[188:189]
    v_pk_mul_f32 v[62:63], v[62:63], v[190:191]
    v_cvt_pk_bf16_f32 v174, v60, v61
    v_cvt_pk_bf16_f32 v175, v62, v63
    buffer_store_dwordx4 v[172:175], v1, s[40:43], s71 offen offset:0
    v_pk_mul_f32 v[188:189], v[64:65], v[64:65]
    v_pk_mul_f32 v[190:191], v[66:67], v[66:67]
    v_pk_fma_f32 v[188:189], v[188:189], v[22:23], v[22:23] op_sel:[0,1,0] op_sel_hi:[1,1,0]
    v_pk_fma_f32 v[190:191], v[190:191], v[22:23], v[22:23] op_sel:[0,1,0] op_sel_hi:[1,1,0]
    v_pk_mul_f32 v[188:189], v[188:189], v[64:65]
    v_pk_mul_f32 v[190:191], v[190:191], v[66:67]
    v_exp_f32 v188, v188
    v_exp_f32 v189, v189
    v_exp_f32 v190, v190
    v_exp_f32 v191, v191
    v_pk_fma_f32 v[188:189], v[188:189], v[72:73], v[72:73] op_sel_hi:[1,0,0]
    v_pk_fma_f32 v[190:191], v[190:191], v[72:73], v[72:73] op_sel_hi:[1,0,0]
    v_rcp_f32 v188, v188
    v_rcp_f32 v189, v189
    v_rcp_f32 v190, v190
    v_rcp_f32 v191, v191
    v_pk_mul_f32 v[64:65], v[64:65], v[188:189]
    v_pk_mul_f32 v[66:67], v[66:67], v[190:191]
    v_cvt_pk_bf16_f32 v176, v64, v65
    v_cvt_pk_bf16_f32 v177, v66, v67
    v_pk_mul_f32 v[188:189], v[68:69], v[68:69]
    v_pk_mul_f32 v[190:191], v[70:71], v[70:71]
    v_pk_fma_f32 v[188:189], v[188:189], v[22:23], v[22:23] op_sel:[0,1,0] op_sel_hi:[1,1,0]
    v_pk_fma_f32 v[190:191], v[190:191], v[22:23], v[22:23] op_sel:[0,1,0] op_sel_hi:[1,1,0]
    v_pk_mul_f32 v[188:189], v[188:189], v[68:69]
    v_pk_mul_f32 v[190:191], v[190:191], v[70:71]
    v_exp_f32 v188, v188
    v_exp_f32 v189, v189
    v_exp_f32 v190, v190
    v_exp_f32 v191, v191
    v_pk_fma_f32 v[188:189], v[188:189], v[72:73], v[72:73] op_sel_hi:[1,0,0]
    v_pk_fma_f32 v[190:191], v[190:191], v[72:73], v[72:73] op_sel_hi:[1,0,0]
    v_rcp_f32 v188, v188
    v_rcp_f32 v189, v189
    v_rcp_f32 v190, v190
    v_rcp_f32 v191, v191
    v_pk_mul_f32 v[68:69], v[68:69], v[188:189]
    v_pk_mul_f32 v[70:71], v[70:71], v[190:191]
    v_cvt_pk_bf16_f32 v178, v68, v69
    v_cvt_pk_bf16_f32 v179, v70, v71
    buffer_store_dwordx4 v[176:179], v1, s[40:43], s71 offen offset:1024
    buffer_store_dwordx4 v[172:175], v18, s[40:43], s76 offen offset:0 sc1
    buffer_store_dwordx4 v[176:179], v18, s[40:43], s76 offen offset:1024 sc1
    s_barrier
    s_add_u32 s71, s78, 0xfff7c000
    s_add_u32 s72, s78, 0x171000
    s_cmp_eq_u32 s44, 0
    s_cselect_b32 s71, 0x40000000, s71
    s_cmp_eq_u32 s44, 31
    s_cselect_b32 s72, 0x40000000, s72
    s_cmp_eq_u32 s46, 0
    s_cselect_b32 s71, s71, 0x40000000
    s_cmp_eq_u32 s46, 3
    s_cselect_b32 s71, s72, s71
    ds_read_b64_tr_b16 a[0:1], v32 offset:0
    ds_read_b64_tr_b16 a[2:3], v32 offset:8192
    ds_read_b64_tr_b16 a[4:5], v33 offset:0
    ds_read_b64_tr_b16 a[6:7], v33 offset:8192
    ds_read_b64_tr_b16 a[8:9], v34 offset:0
    ds_read_b64_tr_b16 a[10:11], v34 offset:8192
    ds_read_b64_tr_b16 a[12:13], v35 offset:0
    ds_read_b64_tr_b16 a[14:15], v35 offset:8192
    ds_read_b64_tr_b16 a[16:17], v32 offset:1024
    v_mul_f32 v192, -v7, v12
    ds_read_b64_tr_b16 a[18:19], v32 offset:9216
    v_fma_f32 v56, v40, v12, v192
    ds_read_b64_tr_b16 a[20:21], v33 offset:1024
    v_fma_f32 v57, v41, v12, v192
    ds_read_b64_tr_b16 a[22:23], v33 offset:9216
    v_fma_f32 v58, v42, v12, v192
    ds_read_b64_tr_b16 a[24:25], v34 offset:1024
    v_fma_f32 v59, v43, v12, v192
    ds_read_b64_tr_b16 a[26:27], v34 offset:9216
    v_fma_f32 v60, v44, v12, v192
    ds_read_b64_tr_b16 a[28:29], v35 offset:1024
    v_fma_f32 v61, v45, v12, v192
    ds_read_b64_tr_b16 a[30:31], v35 offset:9216
    v_fma_f32 v62, v46, v12, v192
    ds_read_b64_tr_b16 a[32:33], v32 offset:2048
    v_fma_f32 v63, v47, v12, v192
    ds_read_b64_tr_b16 a[34:35], v32 offset:10240
    v_fma_f32 v64, v48, v12, v192
    ds_read_b64_tr_b16 a[36:37], v33 offset:2048
    v_fma_f32 v65, v49, v12, v192
    ds_read_b64_tr_b16 a[38:39], v33 offset:10240
    v_fma_f32 v66, v50, v12, v192
    ds_read_b64_tr_b16 a[40:41], v34 offset:2048
    v_fma_f32 v67, v51, v12, v192
    ds_read_b64_tr_b16 a[42:43], v34 offset:10240
    v_fma_f32 v68, v52, v12, v192
    ds_read_b64_tr_b16 a[44:45], v35 offset:2048
    v_fma_f32 v69, v53, v12, v192
    ds_read_b64_tr_b16 a[46:47], v35 offset:10240
    v_fma_f32 v70, v54, v12, v192
    ds_read_b64_tr_b16 a[48:49], v32 offset:3072
    v_fma_f32 v71, v55, v12, v192
    ds_read_b64_tr_b16 a[50:51], v32 offset:11264
    v_and_b32 v192, 2, v0
    ds_read_b64_tr_b16 a[52:53], v33 offset:3072
    v_subrev_u32 v192, 1, v192
    ds_read_b64_tr_b16 a[54:55], v33 offset:11264
    v_cmp_gt_u32 vcc, 8, v0
    ds_read_b64_tr_b16 a[56:57], v34 offset:3072
    s_nop 0
    v_cndmask_b32 v192, v192, v3, vcc
    ds_read_b64_tr_b16 a[58:59], v34 offset:11264
    v_add_u32 v192, s46, v192
    ds_read_b64_tr_b16 a[60:61], v35 offset:3072
    v_med3_i32 v192, v192, 0, 3
    ds_read_b64_tr_b16 a[62:63], v35 offset:11264
    v_and_b32 v193, 7, v0
    ds_read_b64_tr_b16 a[64:65], v32 offset:16384
    v_lshlrev_b32 v193, 12, v193
    ds_read_b64_tr_b16 a[66:67], v32 offset:24576
    v_lshl_add_u32 v17, v192, 10, v193
    ds_read_b64_tr_b16 a[68:69], v33 offset:16384
    s_add_u32 s70, s78, 0x28084
    ds_read_b64_tr_b16 a[70:71], v33 offset:24576
    s_lshl_b32 s58, s88, 4
    ds_read_b64_tr_b16 a[72:73], v34 offset:16384
    s_lshl_b32 s59, s89, 4
    ds_read_b64_tr_b16 a[74:75], v34 offset:24576
    s_lshl_b32 s60, s90, 4
    ds_read_b64_tr_b16 a[76:77], v35 offset:16384
    s_lshl_b32 s61, s91, 4
    ds_read_b64_tr_b16 a[78:79], v35 offset:24576
    v_and_b32 v194, 3, v0
    ds_read_b64_tr_b16 a[80:81], v32 offset:17408
    v_lshl_add_u32 v20, v194, 10, s71
    ds_read_b64_tr_b16 a[82:83], v32 offset:25600
    v_and_b32 v194, 4, v0
    ds_read_b64_tr_b16 a[84:85], v33 offset:17408
    v_lshl_add_u32 v20, v194, 11, v20
    ds_read_b64_tr_b16 a[86:87], v33 offset:25600
    v_and_b32 v194, 56, v0
    ds_read_b64_tr_b16 a[88:89], v34 offset:17408
    v_lshl_add_u32 v20, v194, 1, v20
    ds_read_b64_tr_b16 a[90:91], v34 offset:25600
    ds_read_b64_tr_b16 a[92:93], v35 offset:17408
ahead_p3_1:
    s_cbranch_execz return_p3
    ds_read_b64_tr_b16 a[94:95], v35 offset:25600
    buffer_store_dword v24, v2, s[40:43], s56 offen offset:132
    ds_read_b64_tr_b16 a[96:97], v32 offset:18432
    ds_read_b64_tr_b16 a[98:99], v32 offset:26624
    ds_read_b64_tr_b16 a[100:101], v33 offset:18432
    ds_read_b64_tr_b16 a[102:103], v33 offset:26624
    ds_read_b64_tr_b16 a[104:105], v34 offset:18432
    ds_read_b64_tr_b16 a[106:107], v34 offset:26624
    ds_read_b64_tr_b16 a[108:109], v35 offset:18432
    ds_read_b64_tr_b16 a[110:111], v35 offset:26624
    ds_read_b64_tr_b16 a[112:113], v32 offset:19456
    ds_read_b64_tr_b16 a[114:115], v32 offset:27648
    ds_read_b64_tr_b16 a[116:117], v33 offset:19456
    ds_read_b64_tr_b16 a[118:119], v33 offset:27648
    ds_read_b64_tr_b16 a[120:121], v34 offset:19456
    ds_read_b64_tr_b16 a[122:123], v34 offset:27648
    ds_read_b64_tr_b16 a[124:125], v35 offset:19456
    ds_read_b64_tr_b16 a[126:127], v35 offset:27648
    ds_read_b64_tr_b16 a[128:129], v32 offset:32768
    ds_read_b64_tr_b16 a[130:131], v32 offset:40960
    ds_read_b64_tr_b16 a[132:133], v33 offset:32768
    ds_read_b64_tr_b16 a[134:135], v33 offset:40960
    ds_read_b64_tr_b16 a[136:137], v34 offset:32768
    ds_read_b64_tr_b16 a[138:139], v34 offset:40960
    ds_read_b64_tr_b16 a[140:141], v35 offset:32768
    ds_read_b64_tr_b16 a[142:143], v35 offset:40960
    ds_read_b64_tr_b16 a[144:145], v32 offset:33792
    ds_read_b64_tr_b16 a[146:147], v32 offset:41984
    ds_read_b64_tr_b16 a[148:149], v33 offset:33792
    ds_read_b64_tr_b16 a[150:151], v33 offset:41984
    ds_read_b64_tr_b16 a[152:153], v34 offset:33792
    ds_read_b64_tr_b16 a[154:155], v34 offset:41984
    ds_read_b64_tr_b16 a[156:157], v35 offset:33792
    ds_read_b64_tr_b16 a[158:159], v35 offset:41984
    ds_read_b64_tr_b16 a[160:161], v32 offset:34816
    ds_read_b64_tr_b16 a[162:163], v32 offset:43008
    ds_read_b64_tr_b16 a[164:165], v33 offset:34816
    ds_read_b64_tr_b16 a[166:167], v33 offset:43008
    ds_read_b64_tr_b16 a[168:169], v34 offset:34816
    ds_read_b64_tr_b16 a[170:171], v34 offset:43008
    ds_read_b64_tr_b16 a[172:173], v35 offset:34816
    ds_read_b64_tr_b16 a[174:175], v35 offset:43008
    buffer_load_dword v8, v17, s[40:43], s70 offen sc1
    buffer_load_dword v9, v20, s[40:43], 0 offen sc1
    s_add_u32 s3, s77, 0xa8000
    buffer_load_dword v6, v21, s[24:27], s3 offen
    ds_read_b64_tr_b16 a[176:177], v32 offset:35840
    ds_read_b64_tr_b16 a[178:179], v32 offset:44032
    ds_read_b64_tr_b16 a[180:181], v33 offset:35840
    ds_read_b64_tr_b16 a[182:183], v33 offset:44032
    ds_read_b64_tr_b16 a[184:185], v34 offset:35840
    ds_read_b64_tr_b16 a[186:187], v34 offset:44032
    ds_read_b64_tr_b16 a[188:189], v35 offset:35840
    ds_read_b64_tr_b16 a[190:191], v35 offset:44032
    ds_read_b64_tr_b16 a[192:193], v32 offset:49152
    ds_read_b64_tr_b16 a[194:195], v32 offset:57344
    ds_read_b64_tr_b16 a[196:197], v33 offset:49152
    ds_read_b64_tr_b16 a[198:199], v33 offset:57344
    ds_read_b64_tr_b16 a[200:201], v34 offset:49152
    ds_read_b64_tr_b16 a[202:203], v34 offset:57344
    ds_read_b64_tr_b16 a[204:205], v35 offset:49152
    ds_read_b64_tr_b16 a[206:207], v35 offset:57344
    ds_read_b64_tr_b16 a[208:209], v32 offset:50176
    ds_read_b64_tr_b16 a[210:211], v32 offset:58368
    ds_read_b64_tr_b16 a[212:213], v33 offset:50176
    ds_read_b64_tr_b16 a[214:215], v33 offset:58368
    ds_read_b64_tr_b16 a[216:217], v34 offset:50176
    ds_read_b64_tr_b16 a[218:219], v34 offset:58368
    ds_read_b64_tr_b16 a[220:221], v35 offset:50176
    ds_read_b64_tr_b16 a[222:223], v35 offset:58368
    ds_read_b64_tr_b16 a[224:225], v32 offset:51200
    ds_read_b64_tr_b16 a[226:227], v32 offset:59392
    ds_read_b64_tr_b16 a[228:229], v33 offset:51200
    ds_read_b64_tr_b16 a[230:231], v33 offset:59392
    ds_read_b64_tr_b16 a[232:233], v34 offset:51200
    ds_read_b64_tr_b16 a[234:235], v34 offset:59392
    ds_read_b64_tr_b16 a[236:237], v35 offset:51200
    ds_read_b64_tr_b16 a[238:239], v35 offset:59392
    ds_read_b64_tr_b16 a[240:241], v32 offset:52224
    ds_read_b64_tr_b16 a[242:243], v32 offset:60416
    ds_read_b64_tr_b16 a[244:245], v33 offset:52224
    ds_read_b64_tr_b16 a[246:247], v33 offset:60416
    ds_read_b64_tr_b16 a[248:249], v34 offset:52224
    ds_read_b64_tr_b16 a[250:251], v34 offset:60416
    ds_read_b64_tr_b16 a[252:253], v35 offset:52224
    ds_read_b64_tr_b16 a[254:255], v35 offset:60416
    s_waitcnt vmcnt(2)
    v_cmp_ne_u32 vcc, s95, v8
    s_nop 0
    s_cbranch_vccz polled_26
    s_mov_b32 s57, 0x40000
poll_25:
    buffer_load_dword v8, v17, s[40:43], s70 offen sc1
    s_waitcnt vmcnt(0)
    v_cmp_ne_u32 vcc, s95, v8
    s_nop 0
    s_cbranch_vccz polled_26
    s_sub_u32 s57, s57, 1
    s_cbranch_scc0 poll_25
polled_26:
    s_waitcnt vmcnt(1)
    v_cmp_eq_u32 vcc, -1, v9
    s_nop 0
    s_cbranch_vccz polled_28
    s_mov_b32 s57, 0x40000
poll_27:
    buffer_load_dword v9, v20, s[40:43], 0 offen sc1
    s_waitcnt vmcnt(0)
    v_cmp_eq_u32 vcc, -1, v9
    s_nop 0
    s_cbranch_vccz polled_28
    s_sub_u32 s57, s57, 1
    s_cbranch_scc0 poll_27
polled_28:
    buffer_load_dwordx4 v[92:95], v203, s[40:43], s58 offen offset:0 sc1
    s_and_b32 s70, s46, 1
    s_lshr_b32 s72, s46, 1
    v_lshrrev_b32 v192, 2, v0
    v_mul_u32_u24 v192, 0x1c0, v192
    v_and_b32 v193, 3, v0
    v_lshl_add_u32 v192, v193, 3, v192
    s_mul_i32 s71, s70, 224
    v_add_u32 v192, s71, v192
    v_and_b32 v193, 16, v0
    v_lshlrev_b32 v193, 1, v193
    s_lshl_b32 s71, s70, 1
    s_sub_u32 s71, 1, s71
    buffer_load_dwordx4 v[96:99], v203, s[40:43], s58 offen offset:1024 sc1
    v_mul_i32_i24 v193, s71, v193
    s_mul_i32 s71, s72, 14336
    s_sub_u32 s73, 14336, s71
    v_add_u32 v194, v192, v193
    v_sub_u32 v195, v192, v193
    v_add_u32 v32, s71, v194
    v_add_u32 v33, s71, v195
    v_add_u32 v34, s73, v194
    v_add_u32 v35, s73, v195
    s_mul_i32 s71, s72, 74752
    s_add_u32 s71, s71, 57344
    v_add_u32 v74, s71, v1
    buffer_load_dwordx4 v[100:103], v203, s[40:43], s58 offen offset:2048 sc1
    s_lshl_b32 s73, s72, 11
    s_sub_u32 s71, s71, s73
    v_add_u32 v75, s71, v1
    s_lshl_b32 s71, s46, 10
    s_add_u32 s71, s71, 0x27000
    v_add_u32 v80, s71, v1
    v_xor_b32 v81, 0x800, v80
    s_add_u32 s71, s93, 0
    s_and_b32 s71, s71, 3
    s_mul_i32 s84, s71, 114688
    s_and_b32 s70, s71, 1
    s_and_b32 s73, s46, 2
    buffer_load_dwordx4 v[104:107], v203, s[40:43], s58 offen offset:3072 sc1
    s_waitcnt lgkmcnt(0)
    s_barrier
    s_or_b32 s70, s70, s73
    s_lshl_b32 s70, s70, 14
    s_lshr_b32 s71, s71, 1
    s_lshl1_add_u32 s71, s46, s71
    s_lshl_b32 s71, s71, 11
    s_add_u32 s80, s70, s71
    s_add_u32 s71, s93, 1
    s_and_b32 s71, s71, 3
    s_mul_i32 s85, s71, 114688
    s_and_b32 s70, s71, 1
    s_and_b32 s73, s46, 2
    s_or_b32 s70, s70, s73
    buffer_load_dwordx4 v[108:111], v204, s[40:43], s59 offen offset:0 sc1
    s_lshl_b32 s70, s70, 14
    s_lshr_b32 s71, s71, 1
    s_lshl1_add_u32 s71, s46, s71
    s_lshl_b32 s71, s71, 11
    s_add_u32 s81, s70, s71
    s_add_u32 s71, s93, 2
    s_and_b32 s71, s71, 3
    s_mul_i32 s86, s71, 114688
    s_and_b32 s70, s71, 1
    s_and_b32 s73, s46, 2
    s_or_b32 s70, s70, s73
    s_lshl_b32 s70, s70, 14
    buffer_load_dwordx4 v[112:115], v204, s[40:43], s59 offen offset:1024 sc1
    s_lshr_b32 s71, s71, 1
    s_lshl1_add_u32 s71, s46, s71
    s_lshl_b32 s71, s71, 11
    s_add_u32 s82, s70, s71
    s_add_u32 s71, s93, 3
    s_and_b32 s71, s71, 3
    s_mul_i32 s87, s71, 114688
    s_and_b32 s70, s71, 1
    s_and_b32 s73, s46, 2
    s_or_b32 s70, s70, s73
    s_lshl_b32 s70, s70, 14
    s_lshr_b32 s71, s71, 1
    buffer_load_dwordx4 v[116:119], v204, s[40:43], s59 offen offset:2048 sc1
    s_lshl1_add_u32 s71, s46, s71
    s_lshl_b32 s71, s71, 11
    s_add_u32 s83, s70, s71
    s_mul_i32 s70, s46, 458752
    s_lshl_b32 s71, s45, 7
    s_add_u32 s70, s70, s71
    v_lshl_add_u32 v192, v0, 10, s70
    v_mov_b32 v193, 0x40000000
    v_cmp_gt_u32 vcc, 16, v0
    s_nop 1
    v_cndmask_b32 v27, v193, v192, vcc
    v_lshlrev_b32 v193, 1, v15
    v_and_b32 v193, 4, v193
    buffer_load_dwordx4 v[120:123], v204, s[40:43], s59 offen offset:3072 sc1
    v_and_b32 v194, 7, v0
    v_xor_b32 v193, v193, v194
    v_lshl_add_u32 v193, v193, 4, s70
    v_add_u32 v192, 0x60, v15
    v_lshl_add_u32 v78, v192, 10, v193
    v_lshrrev_b32 v192, 5, v0
    v_and_b32 v194, 3, v15
    v_lshl_add_u32 v192, v192, 4, v194
    v_lshl_add_u32 v77, v192, 10, v193
    s_mov_b32 s50, 3072
    s_mov_b32 s51, 6144
    s_mov_b32 s52, 9216
    buffer_load_dwordx4 v[124:127], v205, s[40:43], s60 offen offset:0 sc1
    s_mov_b32 s53, 7168
    s_waitcnt vmcnt(8)
    v_mfma_f32_16x16x32_bf16 v[56:59], a[0:3], v[92:95], v[56:59]
    buffer_load_dwordx4 v[128:131], v205, s[40:43], s60 offen offset:1024 sc1
    v_mfma_f32_16x16x32_bf16 v[60:63], a[4:7], v[92:95], v[60:63]
    v_mfma_f32_16x16x32_bf16 v[64:67], a[8:11], v[92:95], v[64:67]
    v_mfma_f32_16x16x32_bf16 v[68:71], a[12:15], v[92:95], v[68:71]
    s_waitcnt vmcnt(8)
    v_mfma_f32_16x16x32_bf16 v[56:59], a[16:19], v[96:99], v[56:59]
    buffer_load_dwordx4 v[132:135], v205, s[40:43], s60 offen offset:2048 sc1
    v_mfma_f32_16x16x32_bf16 v[60:63], a[20:23], v[96:99], v[60:63]
    v_mfma_f32_16x16x32_bf16 v[64:67], a[24:27], v[96:99], v[64:67]
    v_mfma_f32_16x16x32_bf16 v[68:71], a[28:31], v[96:99], v[68:71]
    s_waitcnt vmcnt(8)
    v_mfma_f32_16x16x32_bf16 v[56:59], a[32:35], v[100:103], v[56:59]
    buffer_load_dwordx4 v[136:139], v205, s[40:43], s60 offen offset:3072 sc1
    v_mfma_f32_16x16x32_bf16 v[60:63], a[36:39], v[100:103], v[60:63]
    v_mfma_f32_16x16x32_bf16 v[64:67], a[40:43], v[100:103], v[64:67]
    v_mfma_f32_16x16x32_bf16 v[68:71], a[44:47], v[100:103], v[68:71]
    s_waitcnt vmcnt(8)
    v_mfma_f32_16x16x32_bf16 v[56:59], a[48:51], v[104:107], v[56:59]
    buffer_load_dwordx4 v[140:143], v206, s[40:43], s61 offen offset:0 sc1
    v_mfma_f32_16x16x32_bf16 v[60:63], a[52:55], v[104:107], v[60:63]
    v_mfma_f32_16x16x32_bf16 v[64:67], a[56:59], v[104:107], v[64:67]
    v_mfma_f32_16x16x32_bf16 v[68:71], a[60:63], v[104:107], v[68:71]
    s_waitcnt vmcnt(8)
    v_mfma_f32_16x16x32_bf16 v[56:59], a[64:67], v[108:111], v[56:59]
    buffer_load_dwordx4 v[144:147], v206, s[40:43], s61 offen offset:1024 sc1
    v_mfma_f32_16x16x32_bf16 v[60:63], a[68:71], v[108:111], v[60:63]
    v_mfma_f32_16x16x32_bf16 v[64:67], a[72:75], v[108:111], v[64:67]
    v_mfma_f32_16x16x32_bf16 v[68:71], a[76:79], v[108:111], v[68:71]
    s_waitcnt vmcnt(8)
    v_mfma_f32_16x16x32_bf16 v[56:59], a[80:83], v[112:115], v[56:59]
    buffer_load_dwordx4 v[148:151], v206, s[40:43], s61 offen offset:2048 sc1
    v_mfma_f32_16x16x32_bf16 v[60:63], a[84:87], v[112:115], v[60:63]
    v_mfma_f32_16x16x32_bf16 v[64:67], a[88:91], v[112:115], v[64:67]
    v_mfma_f32_16x16x32_bf16 v[68:71], a[92:95], v[112:115], v[68:71]
    s_waitcnt vmcnt(8)
    v_mfma_f32_16x16x32_bf16 v[56:59], a[96:99], v[116:119], v[56:59]
    buffer_load_dwordx4 v[152:155], v206, s[40:43], s61 offen offset:3072 sc1
    v_mfma_f32_16x16x32_bf16 v[60:63], a[100:103], v[116:119], v[60:63]
    v_mfma_f32_16x16x32_bf16 v[64:67], a[104:107], v[116:119], v[64:67]
    v_mfma_f32_16x16x32_bf16 v[68:71], a[108:111], v[116:119], v[68:71]
    s_waitcnt vmcnt(8)
    v_mfma_f32_16x16x32_bf16 v[56:59], a[112:115], v[120:123], v[56:59]
    v_mfma_f32_16x16x32_bf16 v[60:63], a[116:119], v[120:123], v[60:63]
    s_add_u32 m0, s48, 0x17000
    s_add_u32 s3, s77, 0x70000
    buffer_load_dwordx4 v196, s[24:27], s3 offen offset:0 lds
    v_mfma_f32_16x16x32_bf16 v[64:67], a[120:123], v[120:123], v[64:67]
    v_mfma_f32_16x16x32_bf16 v[68:71], a[124:127], v[120:123], v[68:71]
    s_waitcnt vmcnt(8)
    v_mfma_f32_16x16x32_bf16 v[56:59], a[128:131], v[124:127], v[56:59]
    v_mfma_f32_16x16x32_bf16 v[60:63], a[132:135], v[124:127], v[60:63]
    v_mfma_f32_16x16x32_bf16 v[64:67], a[136:139], v[124:127], v[64:67]
    buffer_load_dwordx4 v197, s[24:27], s3 offen offset:1024 lds
    v_mfma_f32_16x16x32_bf16 v[68:71], a[140:143], v[124:127], v[68:71]
    s_waitcnt vmcnt(8)
    v_mfma_f32_16x16x32_bf16 v[56:59], a[144:147], v[128:131], v[56:59]
    v_mfma_f32_16x16x32_bf16 v[60:63], a[148:151], v[128:131], v[60:63]
    v_mfma_f32_16x16x32_bf16 v[64:67], a[152:155], v[128:131], v[64:67]
    v_mfma_f32_16x16x32_bf16 v[68:71], a[156:159], v[128:131], v[68:71]
    buffer_load_dwordx4 v198, s[24:27], s3 offen offset:2048 lds
    s_waitcnt vmcnt(8)
    v_mfma_f32_16x16x32_bf16 v[56:59], a[160:163], v[132:135], v[56:59]
    v_mfma_f32_16x16x32_bf16 v[60:63], a[164:167], v[132:135], v[60:63]
    v_mfma_f32_16x16x32_bf16 v[64:67], a[168:171], v[132:135], v[64:67]
    v_mfma_f32_16x16x32_bf16 v[68:71], a[172:175], v[132:135], v[68:71]
    s_waitcnt vmcnt(7)
    v_mfma_f32_16x16x32_bf16 v[56:59], a[176:179], v[136:139], v[56:59]
    buffer_load_dwordx4 v199, s[24:27], s3 offen offset:3072 lds
    v_mfma_f32_16x16x32_bf16 v[60:63], a[180:183], v[136:139], v[60:63]
    v_mfma_f32_16x16x32_bf16 v[64:67], a[184:187], v[136:139], v[64:67]
    v_mfma_f32_16x16x32_bf16 v[68:71], a[188:191], v[136:139], v[68:71]
    s_waitcnt vmcnt(7)
    v_mfma_f32_16x16x32_bf16 v[56:59], a[192:195], v[140:143], v[56:59]
    v_mfma_f32_16x16x32_bf16 v[60:63], a[196:199], v[140:143], v[60:63]
    s_add_u32 m0, s48, 0x18000
    s_nop 0
    buffer_load_dwordx4 v200, s[24:27], s3 offen offset:0 lds
    v_mfma_f32_16x16x32_bf16 v[64:67], a[200:203], v[140:143], v[64:67]
    v_mfma_f32_16x16x32_bf16 v[68:71], a[204:207], v[140:143], v[68:71]
    s_waitcnt vmcnt(7)
    v_mfma_f32_16x16x32_bf16 v[56:59], a[208:211], v[144:147], v[56:59]
    v_mfma_f32_16x16x32_bf16 v[60:63], a[212:215], v[144:147], v[60:63]
    v_mfma_f32_16x16x32_bf16 v[64:67], a[216:219], v[144:147], v[64:67]
    buffer_load_dwordx4 v201, s[24:27], s3 offen offset:1024 lds
    v_mfma_f32_16x16x32_bf16 v[68:71], a[220:223], v[144:147], v[68:71]
    s_waitcnt vmcnt(7)
    v_mfma_f32_16x16x32_bf16 v[56:59], a[224:227], v[148:151], v[56:59]
    v_mfma_f32_16x16x32_bf16 v[60:63], a[228:231], v[148:151], v[60:63]
    v_mfma_f32_16x16x32_bf16 v[64:67], a[232:235], v[148:151], v[64:67]
    v_mfma_f32_16x16x32_bf16 v[68:71], a[236:239], v[148:151], v[68:71]
    buffer_load_dwordx4 v202, s[24:27], s3 offen offset:2048 lds
    s_waitcnt vmcnt(7)
    v_mfma_f32_16x16x32_bf16 v[56:59], a[240:243], v[152:155], v[56:59]
    v_mfma_f32_16x16x32_bf16 v[60:63], a[244:247], v[152:155], v[60:63]
    v_mfma_f32_16x16x32_bf16 v[64:67], a[248:251], v[152:155], v[64:67]
    v_mfma_f32_16x16x32_bf16 v[68:71], a[252:255], v[152:155], v[68:71]
    v_cmp_u_f32 vcc, v56, v56
    s_nop 0
    s_cbranch_vccnz retry_29
back_30:
    s_add_u32 s71, s96, 0x10000
    v_cvt_pk_bf16_f32 v172, v56, v57
    s_add_u32 m0, s48, 0x0
    s_add_u32 s3, s77, 0xa8000
    buffer_load_dwordx4 v196, s[24:27], s3 offen offset:0 lds
    v_cvt_pk_bf16_f32 v173, v58, v59
    v_cvt_pk_bf16_f32 v174, v60, v61
    v_cvt_pk_bf16_f32 v175, v62, v63
    buffer_store_dwordx4 v[172:175], v1, s[40:43], s71 offen offset:0
    v_cvt_pk_bf16_f32 v176, v64, v65
    v_cvt_pk_bf16_f32 v177, v66, v67
    v_cvt_pk_bf16_f32 v178, v68, v69
    v_cvt_pk_bf16_f32 v179, v70, v71
    buffer_store_dwordx4 v[176:179], v1, s[40:43], s71 offen offset:1024
    v_mfma_f32_16x16x32_bf16 v[184:187], v[172:175], v[172:175], 0
    v_mfma_f32_16x16x32_bf16 v[180:183], v[28:31], v[172:175], 0
    v_mfma_f32_16x16x32_bf16 v[184:187], v[176:179], v[176:179], v[184:187]
    v_mfma_f32_16x16x32_bf16 v[180:183], v[28:31], v[176:179], v[180:183]
    s_barrier
    v_add_u32 v36, 0x20000, v32
    buffer_load_dwordx4 v197, s[24:27], s3 offen offset:1024 lds
    v_add_u32 v37, 0x20000, v33
    v_add_u32 v38, 0x20000, v34
    v_add_u32 v39, 0x20000, v35
    ds_read_b64_tr_b16 a[128:129], v36 offset:0
    ds_read_b64_tr_b16 a[130:131], v36 offset:7168
    ds_read_b64_tr_b16 a[132:133], v37 offset:32
    ds_read_b64_tr_b16 a[134:135], v37 offset:7200
    ds_read_b64_tr_b16 a[136:137], v36 offset:64
    v_cndmask_b32 v181, v184, v185, s[64:65]
    ds_read_b64_tr_b16 a[138:139], v36 offset:7232
    buffer_load_dwordx4 v198, s[24:27], s3 offen offset:2048 lds
    ds_read_b64_tr_b16 a[140:141], v37 offset:96
    v_cndmask_b32 v181, v181, v186, s[66:67]
    ds_read_b64_tr_b16 a[142:143], v37 offset:7264
    v_cndmask_b32 v181, v181, v187, s[68:69]
    ds_read_b64_tr_b16 a[144:145], v36 offset:128
    v_mov_b32 v182, s95
    ds_read_b64_tr_b16 a[146:147], v36 offset:7296
    v_add_f32 v40, v40, v56
    ds_read_b64_tr_b16 a[148:149], v37 offset:160
    v_add_f32 v41, v41, v57
    ds_read_b64_tr_b16 a[150:151], v37 offset:7328
    buffer_load_dwordx4 v199, s[24:27], s3 offen offset:3072 lds
    ds_read_b64_tr_b16 a[152:153], v36 offset:192
    v_add_f32 v42, v42, v58
    ds_read_b64_tr_b16 a[154:155], v36 offset:7360
    v_add_f32 v43, v43, v59
    ds_read_b64_tr_b16 a[156:157], v38 offset:0
    v_add_f32 v44, v44, v60
    ds_read_b64_tr_b16 a[158:159], v38 offset:7168
    v_add_f32 v45, v45, v61
    ds_read_b64_tr_b16 a[160:161], v39 offset:32
    v_add_f32 v46, v46, v62
    ds_read_b64_tr_b16 a[162:163], v39 offset:7200
    s_add_u32 m0, s48, 0x1000
    s_nop 0
    buffer_load_dwordx4 v200, s[24:27], s3 offen offset:0 lds
    ds_read_b64_tr_b16 a[164:165], v38 offset:64
    v_add_f32 v47, v47, v63
    ds_read_b64_tr_b16 a[166:167], v38 offset:7232
    v_add_f32 v48, v48, v64
    ds_read_b64_tr_b16 a[168:169], v39 offset:96
    v_add_f32 v49, v49, v65
    ds_read_b64_tr_b16 a[170:171], v39 offset:7264
    v_add_f32 v50, v50, v66
    ds_read_b64_tr_b16 a[172:173], v38 offset:128
    v_add_f32 v51, v51, v67
    ds_read_b64_tr_b16 a[174:175], v38 offset:7296
    buffer_load_dwordx4 v201, s[24:27], s3 offen offset:1024 lds
    ds_read_b64_tr_b16 a[176:177], v39 offset:160
    v_add_f32 v52, v52, v68
    ds_read_b64_tr_b16 a[178:179], v39 offset:7328
    v_add_f32 v53, v53, v69
    ds_read_b64_tr_b16 a[180:181], v38 offset:192
    v_add_f32 v54, v54, v70
    ds_read_b64_tr_b16 a[182:183], v38 offset:7360
    v_add_f32 v55, v55, v71
    v_add_u32 v36, 0x10000, v32
    v_add_u32 v37, 0x10000, v33
    v_add_u32 v38, 0x10000, v34
    buffer_load_dwordx4 v202, s[24:27], s3 offen offset:2048 lds
    v_add_u32 v39, 0x10000, v35
    ds_read_b64_tr_b16 a[184:185], v36 offset:0
    v_cmp_eq_u32 vcc, 0, v5
    ds_read_b64_tr_b16 a[186:187], v36 offset:7168
    s_nop 0
    v_cndmask_b32 v204, v3, v28, vcc
    ds_read_b64_tr_b16 a[188:189], v37 offset:32
    v_cndmask_b32 v205, v3, v28, vcc
    ds_read_b64_tr_b16 a[190:191], v37 offset:7200
    v_cndmask_b32 v206, v3, v28, vcc
    ds_read_b64_tr_b16 a[192:193], v36 offset:64
    s_add_u32 m0, s48, 0x7000
    s_sub_u32 s3, 0xe0000, s77
    buffer_load_dwordx4 v196, s[24:27], s3 offen offset:0 lds
    ds_read_b64_tr_b16 a[194:195], v36 offset:7232
    v_cndmask_b32 v207, v3, v28, vcc
    ds_read_b64_tr_b16 a[196:197], v37 offset:96
    v_cmp_eq_u32 vcc, 1, v5
    ds_read_b64_tr_b16 a[198:199], v37 offset:7264
    s_nop 0
    v_cndmask_b32 v208, v3, v28, vcc
    ds_read_b64_tr_b16 a[200:201], v36 offset:128
    v_cndmask_b32 v209, v3, v28, vcc
    ds_read_b64_tr_b16 a[202:203], v36 offset:7296
    v_cndmask_b32 v210, v3, v28, vcc
    ds_read_b64_tr_b16 a[204:205], v37 offset:160
    buffer_load_dwordx4 v197, s[24:27], s3 offen offset:1024 lds
    ds_read_b64_tr_b16 a[206:207], v37 offset:7328
    v_cndmask_b32 v211, v3, v28, vcc
    ds_read_b64_tr_b16 a[208:209], v36 offset:192
    v_cmp_eq_u32 vcc, 2, v5
    ds_read_b64_tr_b16 a[210:211], v36 offset:7360
    s_nop 0
    v_cndmask_b32 v212, v3, v28, vcc
    ds_read_b64_tr_b16 a[212:213], v38 offset:0
    v_cndmask_b32 v213, v3, v28, vcc
    ds_read_b64_tr_b16 a[214:215], v38 offset:7168
    v_cndmask_b32 v214, v3, v28, vcc
    ds_read_b64_tr_b16 a[216:217], v39 offset:32
    buffer_load_dwordx4 v198, s[24:27], s3 offen offset:2048 lds
    ds_read_b64_tr_b16 a[218:219], v39 offset:7200
    v_cndmask_b32 v215, v3, v28, vcc
    ds_read_b64_tr_b16 a[220:221], v38 offset:64
    v_cmp_eq_u32 vcc, 3, v5
    ds_read_b64_tr_b16 a[222:223], v38 offset:7232
    s_nop 0
    v_cndmask_b32 v216, v3, v28, vcc
    ds_read_b64_tr_b16 a[224:225], v39 offset:96
    v_cndmask_b32 v217, v3, v28, vcc
    ds_read_b64_tr_b16 a[226:227], v39 offset:7264
    v_cndmask_b32 v218, v3, v28, vcc
    ds_read_b64_tr_b16 a[228:229], v38 offset:128
    buffer_load_dwordx4 v199, s[24:27], s3 offen offset:3072 lds
    ds_read_b64_tr_b16 a[230:231], v38 offset:7296
    v_cndmask_b32 v219, v3, v28, vcc
    ds_read_b64_tr_b16 a[232:233], v39 offset:160
    v_cmp_eq_u32 vcc, 4, v5
    ds_read_b64_tr_b16 a[234:235], v39 offset:7328
    s_nop 0
    v_cndmask_b32 v220, v3, v28, vcc
    ds_read_b64_tr_b16 a[236:237], v38 offset:192
    v_cndmask_b32 v221, v3, v28, vcc
    ds_read_b64_tr_b16 a[238:239], v38 offset:7360
    v_cndmask_b32 v222, v3, v28, vcc
    v_cndmask_b32 v223, v3, v28, vcc
    s_add_u32 m0, s48, 0x8000
    s_nop 0
    buffer_load_dwordx4 v200, s[24:27], s3 offen offset:0 lds
    v_cmp_eq_u32 vcc, 5, v5
    s_nop 1
    v_cndmask_b32 v224, v3, v28, vcc
    v_cndmask_b32 v225, v3, v28, vcc
    v_cndmask_b32 v226, v3, v28, vcc
    v_cndmask_b32 v227, v3, v28, vcc
    v_cmp_eq_u32 vcc, 6, v5
    s_nop 1
    v_cndmask_b32 v228, v3, v28, vcc
    v_cndmask_b32 v229, v3, v28, vcc
    v_cndmask_b32 v230, v3, v28, vcc
    v_cndmask_b32 v231, v3, v28, vcc
    s_lshr_b32 s72, s46, 1
    s_lshl_b32 s71, s72, 11
    s_add_u32 s70, s78, s71
    s_add_u32 s70, s70, 0x28000
    s_add_u32 s71, s70, 0x4000
    s_mul_i32 s72, s72, 40960
    s_lshl_b32 s73, s46, 14
    s_add_u32 s72, s72, s73
    s_and_b32 s73, s44, 1
    s_lshl_b32 s73, s73, 13
    s_xor_b32 s58, s73, 0x0
    s_add_u32 s58, s58, s97
    s_add_u32 s58, s58, 0x10000
    s_xor_b32 s59, s73, 0x1000
    s_add_u32 s59, s59, s97
    s_add_u32 s59, s59, 0x10000
    s_xor_b32 s60, s73, 0x2000
    s_add_u32 s60, s60, s97
    s_add_u32 s60, s60, 0x10000
    s_xor_b32 s61, s73, 0x3000
    s_add_u32 s61, s61, s97
    s_add_u32 s61, s61, 0x10000
    s_waitcnt lgkmcnt(15)
    v_mfma_f32_16x16x32_bf16 v[84:87], a[128:131], v[204:207], 0
    buffer_load_dwordx4 v201, s[24:27], s3 offen offset:1024 lds
    v_mfma_f32_16x16x32_bf16 v[84:87], a[132:135], v[208:211], v[84:87]
    v_mfma_f32_16x16x32_bf16 v[84:87], a[136:139], v[212:215], v[84:87]
    v_mfma_f32_16x16x32_bf16 v[84:87], a[140:143], v[216:219], v[84:87]
    v_mfma_f32_16x16x32_bf16 v[84:87], a[144:147], v[220:223], v[84:87]
    v_mfma_f32_16x16x32_bf16 v[84:87], a[148:151], v[224:227], v[84:87]
    buffer_load_dwordx4 v202, s[24:27], s3 offen offset:2048 lds
    v_mfma_f32_16x16x32_bf16 v[84:87], a[152:155], v[228:231], v[84:87]
    s_waitcnt vmcnt(13)
    buffer_store_dwordx3 v[180:182], v26, s[40:43], s56 offen offset:512
    s_waitcnt lgkmcnt(0)
    s_barrier
    v_mfma_f32_16x16x32_bf16 v[84:87], a[184:187], v[204:207], v[84:87]
    v_mfma_f32_16x16x32_bf16 v[84:87], a[188:191], v[208:211], v[84:87]
    v_mfma_f32_16x16x32_bf16 v[84:87], a[192:195], v[212:215], v[84:87]
    v_mfma_f32_16x16x32_bf16 v[84:87], a[196:199], v[216:219], v[84:87]
    v_mfma_f32_16x16x32_bf16 v[84:87], a[200:203], v[220:223], v[84:87]
    v_mfma_f32_16x16x32_bf16 v[84:87], a[204:207], v[224:227], v[84:87]
    v_mfma_f32_16x16x32_bf16 v[84:87], a[208:211], v[228:231], v[84:87]
    buffer_load_dwordx3 v[56:58], v13, s[40:43], s70 offen offset:512 sc1
    buffer_load_dwordx3 v[60:62], v13, s[40:43], s71 offen offset:512 sc1
    buffer_load_dwordx3 v[64:66], v13, s[40:43], s70 offen offset:1536 sc1
    buffer_load_dwordx3 v[68:70], v13, s[40:43], s71 offen offset:1536 sc1
    v_add_u32 v36, 0x17000, v32
    v_add_u32 v37, 0x17000, v33
    v_add_u32 v38, 0x17000, v34
    v_add_u32 v39, 0x17000, v35
    ds_read_b64_tr_b16 v[152:153], v36 offset:0
    ds_read_b64_tr_b16 v[154:155], v36 offset:7168
    ds_read_b64_tr_b16 v[156:157], v37 offset:32
    ds_read_b64_tr_b16 v[158:159], v37 offset:7200
    ds_read_b64_tr_b16 v[160:161], v36 offset:64
    ds_read_b64_tr_b16 v[162:163], v36 offset:7232
    ds_read_b64_tr_b16 v[164:165], v37 offset:96
    ds_read_b64_tr_b16 v[166:167], v37 offset:7264
    ds_read_b64_tr_b16 v[168:169], v36 offset:128
    ds_read_b64_tr_b16 v[170:171], v36 offset:7296
    ds_read_b64_tr_b16 v[172:173], v37 offset:160
    ds_read_b64_tr_b16 v[174:175], v37 offset:7328
    ds_read_b64_tr_b16 v[176:177], v36 offset:192
    ds_read_b64_tr_b16 v[178:179], v36 offset:7360
    ds_read_b64_tr_b16 v[180:181], v38 offset:0
    ds_read_b64_tr_b16 v[182:183], v38 offset:7168
    ds_read_b64_tr_b16 v[184:185], v39 offset:32
    ds_read_b64_tr_b16 v[186:187], v39 offset:7200
    ds_read_b64_tr_b16 v[232:233], v38 offset:64
    ds_read_b64_tr_b16 v[234:235], v38 offset:7232
    ds_read_b64_tr_b16 v[236:237], v39 offset:96
    ds_read_b64_tr_b16 v[238:239], v39 offset:7264
    ds_read_b64_tr_b16 v[240:241], v38 offset:128
    ds_read_b64_tr_b16 v[242:243], v38 offset:7296
    ds_read_b64_tr_b16 v[244:245], v39 offset:160
    ds_read_b64_tr_b16 v[246:247], v39 offset:7328
    ds_read_b64_tr_b16 v[248:249], v38 offset:192
    ds_read_b64_tr_b16 v[250:251], v38 offset:7360
    s_waitcnt lgkmcnt(15)
    v_mfma_f32_16x16x32_bf16 v[84:87], v[152:155], v[204:207], v[84:87]
    v_mfma_f32_16x16x32_bf16 v[84:87], v[156:159], v[208:211], v[84:87]
    v_mfma_f32_16x16x32_bf16 v[84:87], v[160:163], v[212:215], v[84:87]
    v_mfma_f32_16x16x32_bf16 v[84:87], v[164:167], v[216:219], v[84:87]
    v_mfma_f32_16x16x32_bf16 v[84:87], v[168:171], v[220:223], v[84:87]
    v_mfma_f32_16x16x32_bf16 v[84:87], v[172:175], v[224:227], v[84:87]
    s_waitcnt lgkmcnt(14)
    v_mfma_f32_16x16x32_bf16 v[84:87], v[176:179], v[228:231], v[84:87]
    s_waitcnt vmcnt(3)
    v_cmp_ne_u32 vcc, s95, v58
    s_waitcnt vmcnt(2)
    v_cmp_ne_u32 s[74:75], s95, v62
    s_or_b64 vcc, vcc, s[74:75]
    s_waitcnt vmcnt(1)
    v_cmp_ne_u32 s[74:75], s95, v66
    s_or_b64 vcc, vcc, s[74:75]
    s_waitcnt vmcnt(0)
    v_cmp_ne_u32 s[74:75], s95, v70
    s_or_b64 vcc, vcc, s[74:75]
    s_cbranch_vccz polled_32
    s_mov_b32 s57, 0x40000
poll_31:
    buffer_load_dwordx3 v[56:58], v13, s[40:43], s70 offen offset:512 sc1
    buffer_load_dwordx3 v[60:62], v13, s[40:43], s71 offen offset:512 sc1
    buffer_load_dwordx3 v[64:66], v13, s[40:43], s70 offen offset:1536 sc1
    buffer_load_dwordx3 v[68:70], v13, s[40:43], s71 offen offset:1536 sc1
    s_waitcnt vmcnt(3)
    v_cmp_ne_u32 vcc, s95, v58
    s_waitcnt vmcnt(2)
    v_cmp_ne_u32 s[74:75], s95, v62
    s_or_b64 vcc, vcc, s[74:75]
    s_waitcnt vmcnt(1)
    v_cmp_ne_u32 s[74:75], s95, v66
    s_or_b64 vcc, vcc, s[74:75]
    s_waitcnt vmcnt(0)
    v_cmp_ne_u32 s[74:75], s95, v70
    s_or_b64 vcc, vcc, s[74:75]
    s_cbranch_vccz polled_32
    s_sub_u32 s57, s57, 1
    s_cbranch_scc0 poll_31
polled_32:
    s_add_u32 m0, s72, 0xe000
    s_nop 0
    buffer_load_dwordx4 v1, s[40:43], s58 offen offset:0 sc1 lds
    buffer_load_dwordx4 v1, s[40:43], s58 offen offset:1024 sc1 lds
    buffer_load_dwordx4 v1, s[40:43], s58 offen offset:2048 sc1 lds
    buffer_load_dwordx4 v1, s[40:43], s58 offen offset:3072 sc1 lds
    v_add_f32 v56, v56, v60
    v_add_f32 v64, v64, v68
    v_add_f32 v57, v57, v61
    v_add_f32 v65, v65, v69
    s_nop 0
    v_permlane32_swap_b32 v56, v57
    v_permlane32_swap_b32 v64, v65
    v_add_f32 v56, v56, v57
    v_add_f32 v64, v64, v65
    v_mov_b32 v57, v56
    v_mov_b32 v65, v64
    s_nop 0
    v_permlane16_swap_b32 v56, v57
    v_permlane16_swap_b32 v64, v65
    v_add_f32 v56, v56, v57
    s_add_u32 m0, s72, 0xf000
    s_nop 0
    buffer_load_dwordx4 v1, s[40:43], s59 offen offset:0 sc1 lds
    v_add_f32 v64, v64, v65
    v_mov_b32 v57, v56
    v_mov_b32 v65, v64
    s_nop 0
    v_permlane32_swap_b32 v56, v57
    v_permlane32_swap_b32 v64, v65
    v_mul_f32 v7, 0x3b000000, v56
ahead_p3_2:
    s_cbranch_execz return_p3
    v_mul_f32 v148, 0x3b000000, v64
    v_mul_f32 v57, 0x3b000000, v57
    v_mul_f32 v65, 0x3b000000, v65
    v_fma_f32 v57, -v7, v7, v57
    v_fma_f32 v65, -v148, v148, v65
    v_max_f32 v57, 0, v57
    v_max_f32 v65, 0, v65
    buffer_load_dwordx4 v1, s[40:43], s59 offen offset:1024 sc1 lds
    v_add_f32 v192, 0x3727c5ac, v57
    v_add_f32 v193, 0x3727c5ac, v65
    v_rsq_f32 v192, v192
    v_rsq_f32 v193, v193
    v_mul_f32 v22, 0xc0135761, v192
    v_mul_f32 v82, 0xc0135761, v193
    v_mul_f32 v23, v192, v192
    v_mul_f32 v83, v193, v193
    v_mul_f32 v23, v23, v22
    v_mul_f32 v83, v83, v82
    v_mul_f32 v23, 0x3d372713, v23
    buffer_load_dwordx4 v1, s[40:43], s59 offen offset:2048 sc1 lds
    v_mul_f32 v83, 0x3d372713, v83
    v_rcp_f32 v72, v192
    v_rcp_f32 v90, v193
    v_mov_b32 v149, v7
    s_lshl_b32 s70, s46, 8
    v_lshl_add_u32 v56, v5, 4, s70
    v_lshl_add_u32 v56, v4, 10, v56
    v_add_u32 v57, 0x1e000, v56
    s_lshr_b32 s70, s46, 1
    s_lshl_b32 s70, s70, 9
    s_bitcmp1_b32 s46, 0
    s_cselect_b32 s73, 0x10000, 0
    s_add_u32 s70, s70, s73
    s_add_u32 s70, s70, 0xe000
    v_and_b32 v9, 31, v0
    buffer_load_dwordx4 v1, s[40:43], s59 offen offset:3072 sc1 lds
    v_lshl_add_u32 v9, v9, 4, s70
    v_lshrrev_b32 v10, 5, v0
    v_lshl_add_u32 v21, v10, 10, v9
    s_and_b32 s70, s46, 1
    v_bfe_u32 v8, v0, 2, 2
    v_lshl_add_u32 v9, v10, 3, v8
    v_lshlrev_b32 v9, 7, v9
    v_lshlrev_b32 v8, 5, v8
    v_and_b32 v8, 64, v8
    s_lshl_b32 s70, s70, 6
    v_xor_b32 v8, s70, v8
    v_add3_u32 v9, v9, v8, s49
    v_and_b32 v8, 16, v0
    s_add_u32 m0, s72, 0x10000
    s_nop 0
    buffer_load_dwordx4 v1, s[40:43], s60 offen offset:0 sc1 lds
    v_lshl_add_u32 v9, v8, 1, v9
    v_and_b32 v8, 3, v0
    v_lshl_add_u32 v58, v8, 3, v9
    v_xor_b32 v59, 64, v58
    buffer_load_dwordx4 v1, s[40:43], s60 offen offset:1024 sc1 lds
    buffer_load_dwordx4 v1, s[40:43], s60 offen offset:2048 sc1 lds
    buffer_load_dwordx4 v1, s[40:43], s60 offen offset:3072 sc1 lds
    s_add_u32 m0, s72, 0x11000
    s_nop 0
    buffer_load_dwordx4 v1, s[40:43], s61 offen offset:0 sc1 lds
    s_waitcnt vmcnt(7)
    s_waitcnt lgkmcnt(0)
    s_barrier
    ds_read_b128 a[0:3], v74 offset:0
    ds_read_b128 a[4:7], v74 offset:16384
    ds_read_b128 a[8:11], v75 offset:1024
    ds_read_b128 a[12:15], v75 offset:17408
    s_waitcnt lgkmcnt(3)
    v_mfma_f32_16x16x32_bf16 v[92:95], a[128:131], a[0:3], 0
    ds_read_b128 a[16:19], v74 offset:2048
    s_waitcnt lgkmcnt(3)
    v_mfma_f32_16x16x32_bf16 v[96:99], a[128:131], a[4:7], 0
    ds_read_b128 a[20:23], v74 offset:18432
    ds_read_b128 a[24:27], v75 offset:3072
    buffer_load_dwordx4 v1, s[40:43], s61 offen offset:1024 sc1 lds
    v_mfma_f32_16x16x32_bf16 v[100:103], a[132:135], a[0:3], 0
    ds_read_b128 a[28:31], v75 offset:19456
    v_mfma_f32_16x16x32_bf16 v[104:107], a[132:135], a[4:7], 0
    ds_read_b128 a[32:35], v74 offset:4096
    ds_read_b128 a[36:39], v74 offset:20480
    v_mfma_f32_16x16x32_bf16 v[108:111], a[136:139], a[0:3], 0
    ds_read_b128 a[40:43], v75 offset:5120
    v_mfma_f32_16x16x32_bf16 v[112:115], a[136:139], a[4:7], 0
    ds_read_b128 a[44:47], v75 offset:21504
    buffer_load_dwordx4 v1, s[40:43], s61 offen offset:2048 sc1 lds
    v_mfma_f32_16x16x32_bf16 v[116:119], a[140:143], a[0:3], 0
    v_mfma_f32_16x16x32_bf16 v[120:123], a[140:143], a[4:7], 0
    v_mfma_f32_16x16x32_bf16 v[124:127], a[144:147], a[0:3], 0
    v_mfma_f32_16x16x32_bf16 v[128:131], a[144:147], a[4:7], 0
    v_mfma_f32_16x16x32_bf16 v[132:135], a[148:151], a[0:3], 0
    buffer_load_dwordx4 v1, s[40:43], s61 offen offset:3072 sc1 lds
    v_mfma_f32_16x16x32_bf16 v[136:139], a[148:151], a[4:7], 0
    v_mfma_f32_16x16x32_bf16 v[140:143], a[152:155], a[0:3], 0
    v_mfma_f32_16x16x32_bf16 v[144:147], a[152:155], a[4:7], 0
    s_waitcnt lgkmcnt(9)
    v_mfma_f32_16x16x32_bf16 v[92:95], a[156:159], a[8:11], v[92:95]
    s_waitcnt lgkmcnt(8)
    v_mfma_f32_16x16x32_bf16 v[96:99], a[156:159], a[12:15], v[96:99]
    buffer_load_dword v6, v27, s[28:31], s84 offen
    v_mfma_f32_16x16x32_bf16 v[100:103], a[160:163], a[8:11], v[100:103]
    v_mfma_f32_16x16x32_bf16 v[104:107], a[160:163], a[12:15], v[104:107]
    v_mfma_f32_16x16x32_bf16 v[108:111], a[164:167], a[8:11], v[108:111]
    v_mfma_f32_16x16x32_bf16 v[112:115], a[164:167], a[12:15], v[112:115]
    v_mfma_f32_16x16x32_bf16 v[116:119], a[168:171], a[8:11], v[116:119]
    s_add_u32 m0, s48, 0x17000
    s_sub_u32 s3, 0x118000, s77
    buffer_load_dwordx4 v196, s[24:27], s3 offen offset:0 lds
    v_mfma_f32_16x16x32_bf16 v[120:123], a[168:171], a[12:15], v[120:123]
    v_mfma_f32_16x16x32_bf16 v[124:127], a[172:175], a[8:11], v[124:127]
    v_mfma_f32_16x16x32_bf16 v[128:131], a[172:175], a[12:15], v[128:131]
    v_mfma_f32_16x16x32_bf16 v[132:135], a[176:179], a[8:11], v[132:135]
    v_mfma_f32_16x16x32_bf16 v[136:139], a[176:179], a[12:15], v[136:139]
    buffer_load_dwordx4 v197, s[24:27], s3 offen offset:1024 lds
    v_mfma_f32_16x16x32_bf16 v[140:143], a[180:183], a[8:11], v[140:143]
    v_mfma_f32_16x16x32_bf16 v[144:147], a[180:183], a[12:15], v[144:147]
    s_waitcnt vmcnt(3)
    s_waitcnt lgkmcnt(0)
    s_barrier
    v_mfma_f32_16x16x32_bf16 v[92:95], a[184:187], a[16:19], v[92:95]
    ds_read_b128 a[48:51], v74 offset:6144
    v_mfma_f32_16x16x32_bf16 v[96:99], a[184:187], a[20:23], v[96:99]
    ds_read_b128 a[52:55], v74 offset:22528
    ds_read_b128 a[56:59], v75 offset:7168
    buffer_load_dwordx4 v198, s[24:27], s3 offen offset:2048 lds
    v_mfma_f32_16x16x32_bf16 v[100:103], a[188:191], a[16:19], v[100:103]
    ds_read_b128 a[60:63], v75 offset:23552
    v_mfma_f32_16x16x32_bf16 v[104:107], a[188:191], a[20:23], v[104:107]
    ds_read_b128 a[64:67], v74 offset:8192
    ds_read_b128 a[68:71], v74 offset:24576
    v_mfma_f32_16x16x32_bf16 v[108:111], a[192:195], a[16:19], v[108:111]
    ds_read_b128 a[72:75], v75 offset:9216
    v_mfma_f32_16x16x32_bf16 v[112:115], a[192:195], a[20:23], v[112:115]
    ds_read_b128 a[76:79], v75 offset:25600
    ds_read_b128 a[80:83], v74 offset:10240
    buffer_load_dwordx4 v199, s[24:27], s3 offen offset:3072 lds
    v_mfma_f32_16x16x32_bf16 v[116:119], a[196:199], a[16:19], v[116:119]
    ds_read_b128 a[84:87], v74 offset:26624
    v_mfma_f32_16x16x32_bf16 v[120:123], a[196:199], a[20:23], v[120:123]
    ds_read_b128 a[88:91], v75 offset:11264
    ds_read_b128 a[92:95], v75 offset:27648
    v_mfma_f32_16x16x32_bf16 v[124:127], a[200:203], a[16:19], v[124:127]
    ds_read_b128 a[96:99], v74 offset:12288
    v_mfma_f32_16x16x32_bf16 v[128:131], a[200:203], a[20:23], v[128:131]
    ds_read_b128 a[100:103], v74 offset:28672
    ds_read_b128 a[104:107], v75 offset:13312
    s_add_u32 m0, s48, 0x18000
    s_nop 0
    buffer_load_dwordx4 v200, s[24:27], s3 offen offset:0 lds
    v_mfma_f32_16x16x32_bf16 v[132:135], a[204:207], a[16:19], v[132:135]
    ds_read_b128 a[108:111], v75 offset:29696
    v_mfma_f32_16x16x32_bf16 v[136:139], a[204:207], a[20:23], v[136:139]
    ds_read_b128 a[112:115], v74 offset:14336
    ds_read_b128 a[116:119], v74 offset:30720
    v_mfma_f32_16x16x32_bf16 v[140:143], a[208:211], a[16:19], v[140:143]
    ds_read_b128 a[120:123], v75 offset:15360
    v_mfma_f32_16x16x32_bf16 v[144:147], a[208:211], a[20:23], v[144:147]
    ds_read_b128 a[124:127], v75 offset:31744
    buffer_load_dwordx4 v201, s[24:27], s3 offen offset:1024 lds
    v_mfma_f32_16x16x32_bf16 v[92:95], a[212:215], a[24:27], v[92:95]
    v_mfma_f32_16x16x32_bf16 v[96:99], a[212:215], a[28:31], v[96:99]
    v_mfma_f32_16x16x32_bf16 v[100:103], a[216:219], a[24:27], v[100:103]
    v_mfma_f32_16x16x32_bf16 v[104:107], a[216:219], a[28:31], v[104:107]
    v_mfma_f32_16x16x32_bf16 v[108:111], a[220:223], a[24:27], v[108:111]
    buffer_load_dwordx4 v202, s[24:27], s3 offen offset:2048 lds
    v_mfma_f32_16x16x32_bf16 v[112:115], a[220:223], a[28:31], v[112:115]
    v_mfma_f32_16x16x32_bf16 v[116:119], a[224:227], a[24:27], v[116:119]
    v_mfma_f32_16x16x32_bf16 v[120:123], a[224:227], a[28:31], v[120:123]
    v_mfma_f32_16x16x32_bf16 v[124:127], a[228:231], a[24:27], v[124:127]
    v_mfma_f32_16x16x32_bf16 v[128:131], a[228:231], a[28:31], v[128:131]
    s_add_u32 s3, s84, 0x4000
    buffer_load_dword v6, v27, s[28:31], s3 offen
    v_mfma_f32_16x16x32_bf16 v[132:135], a[232:235], a[24:27], v[132:135]
    v_mfma_f32_16x16x32_bf16 v[136:139], a[232:235], a[28:31], v[136:139]
    v_mfma_f32_16x16x32_bf16 v[140:143], a[236:239], a[24:27], v[140:143]
    v_mfma_f32_16x16x32_bf16 v[144:147], a[236:239], a[28:31], v[144:147]
    s_waitcnt lgkmcnt(0)
    s_barrier
    v_mfma_f32_16x16x32_bf16 v[92:95], v[152:155], a[32:35], v[92:95]
    v_add_u32 v36, 0x0, v32
    s_add_u32 s3, s84, 0x18000
    buffer_load_dword v6, v27, s[28:31], s3 offen
    v_mfma_f32_16x16x32_bf16 v[96:99], v[152:155], a[36:39], v[96:99]
    v_add_u32 v37, 0x0, v33
    v_add_u32 v38, 0x0, v34
    v_mfma_f32_16x16x32_bf16 v[100:103], v[156:159], a[32:35], v[100:103]
    v_add_u32 v39, 0x0, v35
    v_mfma_f32_16x16x32_bf16 v[104:107], v[156:159], a[36:39], v[104:107]
    ds_read_b64_tr_b16 a[184:185], v36 offset:0
    ds_read_b64_tr_b16 a[186:187], v36 offset:7168
    v_mfma_f32_16x16x32_bf16 v[108:111], v[160:163], a[32:35], v[108:111]
    ds_read_b64_tr_b16 a[188:189], v37 offset:32
    buffer_store_dword v24, v2, s[40:43], s56 offen offset:148
    v_mfma_f32_16x16x32_bf16 v[112:115], v[160:163], a[36:39], v[112:115]
    ds_read_b64_tr_b16 a[190:191], v37 offset:7200
    ds_read_b64_tr_b16 a[192:193], v36 offset:64
    v_mfma_f32_16x16x32_bf16 v[116:119], v[164:167], a[32:35], v[116:119]
    ds_read_b64_tr_b16 a[194:195], v36 offset:7232
    v_mfma_f32_16x16x32_bf16 v[120:123], v[164:167], a[36:39], v[120:123]
    ds_read_b64_tr_b16 a[196:197], v37 offset:96
    ds_read_b64_tr_b16 a[198:199], v37 offset:7264
    v_mfma_f32_16x16x32_bf16 v[124:127], v[168:171], a[32:35], v[124:127]
    ds_read_b64_tr_b16 a[200:201], v36 offset:128
    s_add_u32 m0, s48, 0x10000
    s_sub_u32 s3, 0x150000, s77
    buffer_load_dwordx4 v196, s[24:27], s3 offen offset:0 lds
    v_mfma_f32_16x16x32_bf16 v[128:131], v[168:171], a[36:39], v[128:131]
    ds_read_b64_tr_b16 a[202:203], v36 offset:7296
    ds_read_b64_tr_b16 a[204:205], v37 offset:160
    v_mfma_f32_16x16x32_bf16 v[132:135], v[172:175], a[32:35], v[132:135]
    ds_read_b64_tr_b16 a[206:207], v37 offset:7328
    v_mfma_f32_16x16x32_bf16 v[136:139], v[172:175], a[36:39], v[136:139]
    ds_read_b64_tr_b16 a[208:209], v36 offset:192
    ds_read_b64_tr_b16 a[210:211], v36 offset:7360
    v_mfma_f32_16x16x32_bf16 v[140:143], v[176:179], a[32:35], v[140:143]
    ds_read_b64_tr_b16 a[212:213], v38 offset:0
    buffer_load_dwordx4 v197, s[24:27], s3 offen offset:1024 lds
    v_mfma_f32_16x16x32_bf16 v[144:147], v[176:179], a[36:39], v[144:147]
    ds_read_b64_tr_b16 a[214:215], v38 offset:7168
    ds_read_b64_tr_b16 a[216:217], v39 offset:32
    v_mfma_f32_16x16x32_bf16 v[92:95], v[180:183], a[40:43], v[92:95]
    ds_read_b64_tr_b16 a[218:219], v39 offset:7200
    v_mfma_f32_16x16x32_bf16 v[96:99], v[180:183], a[44:47], v[96:99]
    ds_read_b64_tr_b16 a[220:221], v38 offset:64
    ds_read_b64_tr_b16 a[222:223], v38 offset:7232
    v_mfma_f32_16x16x32_bf16 v[100:103], v[184:187], a[40:43], v[100:103]
    ds_read_b64_tr_b16 a[224:225], v39 offset:96
    buffer_load_dwordx4 v198, s[24:27], s3 offen offset:2048 lds
    v_mfma_f32_16x16x32_bf16 v[104:107], v[184:187], a[44:47], v[104:107]
    ds_read_b64_tr_b16 a[226:227], v39 offset:7264
    ds_read_b64_tr_b16 a[228:229], v38 offset:128
    v_mfma_f32_16x16x32_bf16 v[108:111], v[232:235], a[40:43], v[108:111]
    ds_read_b64_tr_b16 a[230:231], v38 offset:7296
    v_mfma_f32_16x16x32_bf16 v[112:115], v[232:235], a[44:47], v[112:115]
    ds_read_b64_tr_b16 a[232:233], v39 offset:160
    ds_read_b64_tr_b16 a[234:235], v39 offset:7328
    v_mfma_f32_16x16x32_bf16 v[116:119], v[236:239], a[40:43], v[116:119]
    ds_read_b64_tr_b16 a[236:237], v38 offset:192
    buffer_load_dwordx4 v199, s[24:27], s3 offen offset:3072 lds
    v_mfma_f32_16x16x32_bf16 v[120:123], v[236:239], a[44:47], v[120:123]
    ds_read_b64_tr_b16 a[238:239], v38 offset:7360
    ds_write_b128 v56, v[40:43] offset:57344
    v_mfma_f32_16x16x32_bf16 v[124:127], v[240:243], a[40:43], v[124:127]
    ds_write_b128 v56, v[44:47] offset:61440
    v_mfma_f32_16x16x32_bf16 v[128:131], v[240:243], a[44:47], v[128:131]
    ds_write_b128 v57, v[48:51] offset:0
    ds_write_b128 v57, v[52:55] offset:4096
    s_add_u32 m0, s48, 0x11000
    s_nop 0
    buffer_load_dwordx4 v200, s[24:27], s3 offen offset:0 lds
    v_mfma_f32_16x16x32_bf16 v[132:135], v[244:247], a[40:43], v[132:135]
    v_mfma_f32_16x16x32_bf16 v[136:139], v[244:247], a[44:47], v[136:139]
    v_mfma_f32_16x16x32_bf16 v[140:143], v[248:251], a[40:43], v[140:143]
    v_mfma_f32_16x16x32_bf16 v[144:147], v[248:251], a[44:47], v[144:147]
    s_waitcnt lgkmcnt(0)
    s_barrier
    v_mfma_f32_16x16x32_bf16 v[92:95], a[184:187], a[48:51], v[92:95]
    v_add_u32 v36, 0x7000, v32
    buffer_load_dwordx4 v201, s[24:27], s3 offen offset:1024 lds
    v_mfma_f32_16x16x32_bf16 v[96:99], a[184:187], a[52:55], v[96:99]
    v_add_u32 v37, 0x7000, v33
    v_add_u32 v38, 0x7000, v34
    v_mfma_f32_16x16x32_bf16 v[84:87], a[184:187], v[204:207], v[84:87]
    v_add_u32 v39, 0x7000, v35
    v_mfma_f32_16x16x32_bf16 v[100:103], a[188:191], a[48:51], v[100:103]
    ds_read_b64_tr_b16 a[128:129], v36 offset:0
    ds_read_b64_tr_b16 a[130:131], v36 offset:7168
    v_mfma_f32_16x16x32_bf16 v[104:107], a[188:191], a[52:55], v[104:107]
    ds_read_b64_tr_b16 a[132:133], v37 offset:32
    buffer_load_dwordx4 v202, s[24:27], s3 offen offset:2048 lds
    v_mfma_f32_16x16x32_bf16 v[84:87], a[188:191], v[208:211], v[84:87]
    ds_read_b64_tr_b16 a[134:135], v37 offset:7200
    ds_read_b64_tr_b16 a[136:137], v36 offset:64
    v_mfma_f32_16x16x32_bf16 v[108:111], a[192:195], a[48:51], v[108:111]
    ds_read_b64_tr_b16 a[138:139], v36 offset:7232
    v_mfma_f32_16x16x32_bf16 v[112:115], a[192:195], a[52:55], v[112:115]
    ds_read_b64_tr_b16 a[140:141], v37 offset:96
    ds_read_b64_tr_b16 a[142:143], v37 offset:7264
    v_mfma_f32_16x16x32_bf16 v[84:87], a[192:195], v[212:215], v[84:87]
    ds_read_b64_tr_b16 a[144:145], v36 offset:128
    s_add_u32 m0, s48, 0x20000
    s_sub_u32 s3, 0x188000, s77
    buffer_load_dwordx4 v196, s[24:27], s3 offen offset:0 lds
    v_mfma_f32_16x16x32_bf16 v[116:119], a[196:199], a[48:51], v[116:119]
    ds_read_b64_tr_b16 a[146:147], v36 offset:7296
    ds_read_b64_tr_b16 a[148:149], v37 offset:160
    v_mfma_f32_16x16x32_bf16 v[120:123], a[196:199], a[52:55], v[120:123]
    ds_read_b64_tr_b16 a[150:151], v37 offset:7328
    v_mfma_f32_16x16x32_bf16 v[84:87], a[196:199], v[216:219], v[84:87]
    ds_read_b64_tr_b16 a[152:153], v36 offset:192
    ds_read_b64_tr_b16 a[154:155], v36 offset:7360
    v_mfma_f32_16x16x32_bf16 v[124:127], a[200:203], a[48:51], v[124:127]
    ds_read_b64_tr_b16 a[156:157], v38 offset:0
    buffer_load_dwordx4 v197, s[24:27], s3 offen offset:1024 lds
    v_mfma_f32_16x16x32_bf16 v[128:131], a[200:203], a[52:55], v[128:131]
    ds_read_b64_tr_b16 a[158:159], v38 offset:7168
    ds_read_b64_tr_b16 a[160:161], v39 offset:32
    v_mfma_f32_16x16x32_bf16 v[84:87], a[200:203], v[220:223], v[84:87]
    ds_read_b64_tr_b16 a[162:163], v39 offset:7200
    v_mfma_f32_16x16x32_bf16 v[132:135], a[204:207], a[48:51], v[132:135]
    ds_read_b64_tr_b16 a[164:165], v38 offset:64
    ds_read_b64_tr_b16 a[166:167], v38 offset:7232
    v_mfma_f32_16x16x32_bf16 v[136:139], a[204:207], a[52:55], v[136:139]
    ds_read_b64_tr_b16 a[168:169], v39 offset:96
    buffer_load_dwordx4 v198, s[24:27], s3 offen offset:2048 lds
    v_mfma_f32_16x16x32_bf16 v[84:87], a[204:207], v[224:227], v[84:87]
    ds_read_b64_tr_b16 a[170:171], v39 offset:7264
    ds_read_b64_tr_b16 a[172:173], v38 offset:128
    v_mfma_f32_16x16x32_bf16 v[140:143], a[208:211], a[48:51], v[140:143]
    ds_read_b64_tr_b16 a[174:175], v38 offset:7296
    v_mfma_f32_16x16x32_bf16 v[144:147], a[208:211], a[52:55], v[144:147]
    ds_read_b64_tr_b16 a[176:177], v39 offset:160
    ds_read_b64_tr_b16 a[178:179], v39 offset:7328
    v_mfma_f32_16x16x32_bf16 v[84:87], a[208:211], v[228:231], v[84:87]
    ds_read_b64_tr_b16 a[180:181], v38 offset:192
    buffer_load_dwordx4 v199, s[24:27], s3 offen offset:3072 lds
    v_mfma_f32_16x16x32_bf16 v[92:95], a[212:215], a[56:59], v[92:95]
    ds_read_b64_tr_b16 a[182:183], v38 offset:7360
    ds_read_b128 v[40:43], v21 offset:0
    v_mfma_f32_16x16x32_bf16 v[96:99], a[212:215], a[60:63], v[96:99]
    ds_read_b128 v[44:47], v21 offset:2048
    v_mfma_f32_16x16x32_bf16 v[100:103], a[216:219], a[56:59], v[100:103]
    ds_read_b128 v[48:51], v21 offset:4096
    ds_read_b128 v[52:55], v21 offset:6144
    s_add_u32 m0, s48, 0x21000
    s_nop 0
    buffer_load_dwordx4 v200, s[24:27], s3 offen offset:0 lds
    v_mfma_f32_16x16x32_bf16 v[104:107], a[216:219], a[60:63], v[104:107]
    v_mfma_f32_16x16x32_bf16 v[108:111], a[220:223], a[56:59], v[108:111]
    v_mfma_f32_16x16x32_bf16 v[112:115], a[220:223], a[60:63], v[112:115]
    v_mfma_f32_16x16x32_bf16 v[116:119], a[224:227], a[56:59], v[116:119]
    v_mfma_f32_16x16x32_bf16 v[120:123], a[224:227], a[60:63], v[120:123]
    buffer_load_dwordx4 v201, s[24:27], s3 offen offset:1024 lds
    v_mfma_f32_16x16x32_bf16 v[124:127], a[228:231], a[56:59], v[124:127]
    v_mfma_f32_16x16x32_bf16 v[128:131], a[228:231], a[60:63], v[128:131]
    v_mfma_f32_16x16x32_bf16 v[132:135], a[232:235], a[56:59], v[132:135]
    v_mfma_f32_16x16x32_bf16 v[136:139], a[232:235], a[60:63], v[136:139]
    v_mfma_f32_16x16x32_bf16 v[140:143], a[236:239], a[56:59], v[140:143]
    buffer_load_dwordx4 v202, s[24:27], s3 offen offset:2048 lds
    v_mfma_f32_16x16x32_bf16 v[144:147], a[236:239], a[60:63], v[144:147]
    s_waitcnt vmcnt(17)
    s_waitcnt lgkmcnt(0)
    s_barrier
    v_mfma_f32_16x16x32_bf16 v[92:95], a[128:131], a[64:67], v[92:95]
    v_add_u32 v36, 0x17000, v32
    v_mfma_f32_16x16x32_bf16 v[96:99], a[128:131], a[68:71], v[96:99]
    v_add_u32 v37, 0x17000, v33
    v_add_u32 v38, 0x17000, v34
    v_mfma_f32_16x16x32_bf16 v[84:87], a[128:131], v[204:207], v[84:87]
    v_add_u32 v39, 0x17000, v35
    s_add_u32 m0, s49, 0x0
    s_add_u32 s3, s84, 0x8000
    v_add_u32 v20, s3, v77
    buffer_load_dwordx4 v20, s[28:31], 0 offen offset:0 lds
    v_mfma_f32_16x16x32_bf16 v[100:103], a[132:135], a[64:67], v[100:103]
    ds_read_b64_tr_b16 a[184:185], v36 offset:0
    ds_read_b64_tr_b16 a[186:187], v36 offset:7168
    v_mfma_f32_16x16x32_bf16 v[104:107], a[132:135], a[68:71], v[104:107]
    ds_read_b64_tr_b16 a[188:189], v37 offset:32
    v_mfma_f32_16x16x32_bf16 v[84:87], a[132:135], v[208:211], v[84:87]
    ds_read_b64_tr_b16 a[190:191], v37 offset:7200
    ds_read_b64_tr_b16 a[192:193], v36 offset:64
    v_mfma_f32_16x16x32_bf16 v[108:111], a[136:139], a[64:67], v[108:111]
    ds_read_b64_tr_b16 a[194:195], v36 offset:7232
    buffer_load_dwordx4 v20, s[28:31], s50 offen offset:1024 lds
    v_mfma_f32_16x16x32_bf16 v[112:115], a[136:139], a[68:71], v[112:115]
    ds_read_b64_tr_b16 a[196:197], v37 offset:96
    ds_read_b64_tr_b16 a[198:199], v37 offset:7264
    v_mfma_f32_16x16x32_bf16 v[84:87], a[136:139], v[212:215], v[84:87]
    ds_read_b64_tr_b16 a[200:201], v36 offset:128
    v_mfma_f32_16x16x32_bf16 v[116:119], a[140:143], a[64:67], v[116:119]
    ds_read_b64_tr_b16 a[202:203], v36 offset:7296
    ds_read_b64_tr_b16 a[204:205], v37 offset:160
    v_mfma_f32_16x16x32_bf16 v[120:123], a[140:143], a[68:71], v[120:123]
    ds_read_b64_tr_b16 a[206:207], v37 offset:7328
    buffer_load_dwordx4 v20, s[28:31], s51 offen offset:2048 lds
    v_mfma_f32_16x16x32_bf16 v[84:87], a[140:143], v[216:219], v[84:87]
    ds_read_b64_tr_b16 a[208:209], v36 offset:192
    ds_read_b64_tr_b16 a[210:211], v36 offset:7360
    v_mfma_f32_16x16x32_bf16 v[124:127], a[144:147], a[64:67], v[124:127]
    ds_read_b64_tr_b16 a[212:213], v38 offset:0
    v_mfma_f32_16x16x32_bf16 v[128:131], a[144:147], a[68:71], v[128:131]
    ds_read_b64_tr_b16 a[214:215], v38 offset:7168
    ds_read_b64_tr_b16 a[216:217], v39 offset:32
    v_mfma_f32_16x16x32_bf16 v[84:87], a[144:147], v[220:223], v[84:87]
    ds_read_b64_tr_b16 a[218:219], v39 offset:7200
    buffer_load_dwordx4 v20, s[28:31], s52 offen offset:3072 lds
    v_mfma_f32_16x16x32_bf16 v[132:135], a[148:151], a[64:67], v[132:135]
    ds_read_b64_tr_b16 a[220:221], v38 offset:64
    ds_read_b64_tr_b16 a[222:223], v38 offset:7232
    v_mfma_f32_16x16x32_bf16 v[136:139], a[148:151], a[68:71], v[136:139]
    ds_read_b64_tr_b16 a[224:225], v39 offset:96
    v_mfma_f32_16x16x32_bf16 v[84:87], a[148:151], v[224:227], v[84:87]
    ds_read_b64_tr_b16 a[226:227], v39 offset:7264
    ds_read_b64_tr_b16 a[228:229], v38 offset:128
    v_mfma_f32_16x16x32_bf16 v[140:143], a[152:155], a[64:67], v[140:143]
    ds_read_b64_tr_b16 a[230:231], v38 offset:7296
    s_add_u32 m0, s49, 0x4000
    v_add_u32 v20, s84, v77
    buffer_load_dwordx4 v20, s[28:31], 0 offen offset:0 lds
    v_mfma_f32_16x16x32_bf16 v[144:147], a[152:155], a[68:71], v[144:147]
    ds_read_b64_tr_b16 a[232:233], v39 offset:160
    ds_read_b64_tr_b16 a[234:235], v39 offset:7328
    v_mfma_f32_16x16x32_bf16 v[84:87], a[152:155], v[228:231], v[84:87]
    ds_read_b64_tr_b16 a[236:237], v38 offset:192
    v_mfma_f32_16x16x32_bf16 v[92:95], a[156:159], a[72:75], v[92:95]
    ds_read_b64_tr_b16 a[238:239], v38 offset:7360
    v_mfma_f32_16x16x32_bf16 v[96:99], a[156:159], a[76:79], v[96:99]
    v_mfma_f32_16x16x32_bf16 v[100:103], a[160:163], a[72:75], v[100:103]
    buffer_load_dwordx4 v20, s[28:31], s50 offen offset:1024 lds
    v_mfma_f32_16x16x32_bf16 v[104:107], a[160:163], a[76:79], v[104:107]
    v_mfma_f32_16x16x32_bf16 v[108:111], a[164:167], a[72:75], v[108:111]
    v_mfma_f32_16x16x32_bf16 v[112:115], a[164:167], a[76:79], v[112:115]
    v_mfma_f32_16x16x32_bf16 v[116:119], a[168:171], a[72:75], v[116:119]
    v_mfma_f32_16x16x32_bf16 v[120:123], a[168:171], a[76:79], v[120:123]
    buffer_load_dwordx4 v20, s[28:31], s51 offen offset:2048 lds
    v_mfma_f32_16x16x32_bf16 v[124:127], a[172:175], a[72:75], v[124:127]
    v_mfma_f32_16x16x32_bf16 v[128:131], a[172:175], a[76:79], v[128:131]
    v_mfma_f32_16x16x32_bf16 v[132:135], a[176:179], a[72:75], v[132:135]
    v_mfma_f32_16x16x32_bf16 v[136:139], a[176:179], a[76:79], v[136:139]
    v_mfma_f32_16x16x32_bf16 v[140:143], a[180:183], a[72:75], v[140:143]
    buffer_load_dwordx4 v20, s[28:31], s52 offen offset:3072 lds
    v_mfma_f32_16x16x32_bf16 v[144:147], a[180:183], a[76:79], v[144:147]
    s_waitcnt vmcnt(15)
    s_waitcnt lgkmcnt(0)
    s_barrier
    v_mfma_f32_16x16x32_bf16 v[92:95], a[184:187], a[80:83], v[92:95]
    v_add_u32 v36, 0x10000, v32
    v_lshrrev_b32 v192, 5, v0
    v_mfma_f32_16x16x32_bf16 v[96:99], a[184:187], a[84:87], v[96:99]
    v_add_u32 v37, 0x10000, v33
    v_add_u32 v38, 0x10000, v34
    v_mfma_f32_16x16x32_bf16 v[84:87], a[184:187], v[204:207], v[84:87]
    v_add_u32 v39, 0x10000, v35
    s_add_u32 m0, s49, 0x8000
    v_add_u32 v20, s85, v77
    buffer_load_dwordx4 v20, s[28:31], 0 offen offset:0 lds
    v_mfma_f32_16x16x32_bf16 v[100:103], a[188:191], a[80:83], v[100:103]
    ds_read_b64_tr_b16 a[128:129], v36 offset:0
    ds_read_b64_tr_b16 a[130:131], v36 offset:7168
    v_mfma_f32_16x16x32_bf16 v[104:107], a[188:191], a[84:87], v[104:107]
    ds_read_b64_tr_b16 a[132:133], v37 offset:32
    v_bfe_u32 v193, v0, 4, 1
    v_mfma_f32_16x16x32_bf16 v[84:87], a[188:191], v[208:211], v[84:87]
    ds_read_b64_tr_b16 a[134:135], v37 offset:7200
    ds_read_b64_tr_b16 a[136:137], v36 offset:64
    v_mfma_f32_16x16x32_bf16 v[108:111], a[192:195], a[80:83], v[108:111]
    ds_read_b64_tr_b16 a[138:139], v36 offset:7232
    buffer_load_dwordx4 v20, s[28:31], s50 offen offset:1024 lds
    v_mfma_f32_16x16x32_bf16 v[112:115], a[192:195], a[84:87], v[112:115]
    ds_read_b64_tr_b16 a[140:141], v37 offset:96
    ds_read_b64_tr_b16 a[142:143], v37 offset:7264
    v_mfma_f32_16x16x32_bf16 v[84:87], a[192:195], v[212:215], v[84:87]
    ds_read_b64_tr_b16 a[144:145], v36 offset:128
    v_lshlrev_b32 v194, 4, v5
    v_mfma_f32_16x16x32_bf16 v[116:119], a[196:199], a[80:83], v[116:119]
    ds_read_b64_tr_b16 a[146:147], v36 offset:7296
    ds_read_b64_tr_b16 a[148:149], v37 offset:160
    v_mfma_f32_16x16x32_bf16 v[120:123], a[196:199], a[84:87], v[120:123]
    ds_read_b64_tr_b16 a[150:151], v37 offset:7328
    buffer_load_dwordx4 v20, s[28:31], s51 offen offset:2048 lds
    v_mfma_f32_16x16x32_bf16 v[84:87], a[196:199], v[216:219], v[84:87]
    ds_read_b64_tr_b16 a[152:153], v36 offset:192
    ds_read_b64_tr_b16 a[154:155], v36 offset:7360
    v_mfma_f32_16x16x32_bf16 v[124:127], a[200:203], a[80:83], v[124:127]
    ds_read_b64_tr_b16 a[156:157], v38 offset:0
    v_lshl_add_u32 v195, v192, 10, v194
    v_mfma_f32_16x16x32_bf16 v[128:131], a[200:203], a[84:87], v[128:131]
    ds_read_b64_tr_b16 a[158:159], v38 offset:7168
    ds_read_b64_tr_b16 a[160:161], v39 offset:32
    v_mfma_f32_16x16x32_bf16 v[84:87], a[200:203], v[220:223], v[84:87]
    ds_read_b64_tr_b16 a[162:163], v39 offset:7200
    buffer_load_dwordx4 v20, s[28:31], s52 offen offset:3072 lds
    v_mfma_f32_16x16x32_bf16 v[132:135], a[204:207], a[80:83], v[132:135]
    ds_read_b64_tr_b16 a[164:165], v38 offset:64
    ds_read_b64_tr_b16 a[166:167], v38 offset:7232
    v_mfma_f32_16x16x32_bf16 v[136:139], a[204:207], a[84:87], v[136:139]
    ds_read_b64_tr_b16 a[168:169], v39 offset:96
    v_lshl_add_u32 v60, v193, 9, v195
    v_mfma_f32_16x16x32_bf16 v[84:87], a[204:207], v[224:227], v[84:87]
    ds_read_b64_tr_b16 a[170:171], v39 offset:7264
    ds_read_b64_tr_b16 a[172:173], v38 offset:128
    v_mfma_f32_16x16x32_bf16 v[140:143], a[208:211], a[80:83], v[140:143]
    ds_read_b64_tr_b16 a[174:175], v38 offset:7296
    s_add_u32 m0, s49, 0xc000
    v_add_u32 v20, s86, v77
    buffer_load_dwordx4 v20, s[28:31], 0 offen offset:0 lds
    v_mfma_f32_16x16x32_bf16 v[144:147], a[208:211], a[84:87], v[144:147]
    ds_read_b64_tr_b16 a[176:177], v39 offset:160
    ds_read_b64_tr_b16 a[178:179], v39 offset:7328
    v_mfma_f32_16x16x32_bf16 v[84:87], a[208:211], v[228:231], v[84:87]
    ds_read_b64_tr_b16 a[180:181], v38 offset:192
    v_lshl_add_u32 v195, v192, 9, v194
    v_mfma_f32_16x16x32_bf16 v[92:95], a[212:215], a[88:91], v[92:95]
    ds_read_b64_tr_b16 a[182:183], v38 offset:7360
    v_lshl_add_u32 v61, v193, 3, v195
    v_mfma_f32_16x16x32_bf16 v[96:99], a[212:215], a[92:95], v[96:99]
    s_add_u32 s62, s78, 0x28000
    v_and_b32 v192, 7, v0
    v_mfma_f32_16x16x32_bf16 v[100:103], a[216:219], a[88:91], v[100:103]
    buffer_load_dwordx4 v20, s[28:31], s50 offen offset:1024 lds
    s_lshl_b32 s70, s46, 13
    v_mfma_f32_16x16x32_bf16 v[104:107], a[216:219], a[92:95], v[104:107]
    v_lshl_add_u32 v17, v192, 10, s70
    s_lshl_b32 s70, s46, 10
    v_mfma_f32_16x16x32_bf16 v[108:111], a[220:223], a[88:91], v[108:111]
    v_lshl_add_u32 v13, v192, 12, s70
    s_lshl_b32 s73, s46, 14
    v_mfma_f32_16x16x32_bf16 v[112:115], a[220:223], a[92:95], v[112:115]
    s_sub_u32 s70, s63, s73
    s_add_u32 s70, s70, 0x30000
    v_mfma_f32_16x16x32_bf16 v[116:119], a[224:227], a[88:91], v[116:119]
    buffer_load_dwordx4 v20, s[28:31], s51 offen offset:2048 lds
    v_add_u32 v62, s70, v1
    v_mfma_f32_16x16x32_bf16 v[120:123], a[224:227], a[92:95], v[120:123]
    s_sub_u32 s70, s97, s73
    s_add_u32 s70, s70, 0x0
    v_mfma_f32_16x16x32_bf16 v[124:127], a[228:231], a[88:91], v[124:127]
    v_add_u32 v63, s70, v1
    s_sub_u32 s70, s97, s73
    v_mfma_f32_16x16x32_bf16 v[128:131], a[228:231], a[92:95], v[128:131]
    s_add_u32 s70, s70, 0x10000
    v_add_u32 v64, s70, v1
    v_mfma_f32_16x16x32_bf16 v[132:135], a[232:235], a[88:91], v[132:135]
    buffer_load_dwordx4 v20, s[28:31], s52 offen offset:3072 lds
    s_sub_u32 s70, s63, s73
    v_mfma_f32_16x16x32_bf16 v[136:139], a[232:235], a[92:95], v[136:139]
    s_add_u32 s70, s70, 0x80000
    v_add_u32 v65, s70, v1
    v_mfma_f32_16x16x32_bf16 v[140:143], a[236:239], a[88:91], v[140:143]
    s_xor_b32 s58, s80, 0x8000
    s_xor_b32 s59, s81, 0x8000
    v_mfma_f32_16x16x32_bf16 v[144:147], a[236:239], a[92:95], v[144:147]
    s_xor_b32 s60, s82, 0x8000
    s_xor_b32 s61, s83, 0x8000
    s_waitcnt vmcnt(16)
    s_waitcnt lgkmcnt(0)
    s_barrier
    v_mfma_f32_16x16x32_bf16 v[92:95], a[128:131], a[96:99], v[92:95]
    v_add_u32 v36, 0x20000, v32
    s_add_u32 m0, s49, 0x18000
    v_add_u32 v20, s87, v77
    buffer_load_dwordx4 v20, s[28:31], 0 offen offset:0 lds
    v_mfma_f32_16x16x32_bf16 v[96:99], a[128:131], a[100:103], v[96:99]
    v_add_u32 v37, 0x20000, v33
    v_add_u32 v38, 0x20000, v34
    v_mfma_f32_16x16x32_bf16 v[84:87], a[128:131], v[204:207], v[84:87]
    v_add_u32 v39, 0x20000, v35
    v_mfma_f32_16x16x32_bf16 v[100:103], a[132:135], a[96:99], v[100:103]
    ds_read_b64_tr_b16 a[184:185], v36 offset:0
ahead_p3_3:
    s_cbranch_execz return_p3
    ds_read_b64_tr_b16 a[186:187], v36 offset:7168
    v_mfma_f32_16x16x32_bf16 v[104:107], a[132:135], a[100:103], v[104:107]
    ds_read_b64_tr_b16 a[188:189], v37 offset:32
    buffer_load_dwordx4 v20, s[28:31], s50 offen offset:1024 lds
    v_mfma_f32_16x16x32_bf16 v[84:87], a[132:135], v[208:211], v[84:87]
    ds_read_b64_tr_b16 a[190:191], v37 offset:7200
    ds_read_b64_tr_b16 a[192:193], v36 offset:64
    v_mfma_f32_16x16x32_bf16 v[108:111], a[136:139], a[96:99], v[108:111]
    ds_read_b64_tr_b16 a[194:195], v36 offset:7232
    v_mfma_f32_16x16x32_bf16 v[112:115], a[136:139], a[100:103], v[112:115]
    ds_read_b64_tr_b16 a[196:197], v37 offset:96
    ds_read_b64_tr_b16 a[198:199], v37 offset:7264
    v_mfma_f32_16x16x32_bf16 v[84:87], a[136:139], v[212:215], v[84:87]
    ds_read_b64_tr_b16 a[200:201], v36 offset:128
    buffer_load_dwordx4 v20, s[28:31], s51 offen offset:2048 lds
    v_mfma_f32_16x16x32_bf16 v[116:119], a[140:143], a[96:99], v[116:119]
    ds_read_b64_tr_b16 a[202:203], v36 offset:7296
    ds_read_b64_tr_b16 a[204:205], v37 offset:160
    v_mfma_f32_16x16x32_bf16 v[120:123], a[140:143], a[100:103], v[120:123]
    ds_read_b64_tr_b16 a[206:207], v37 offset:7328
    v_mfma_f32_16x16x32_bf16 v[84:87], a[140:143], v[216:219], v[84:87]
    ds_read_b64_tr_b16 a[208:209], v36 offset:192
    ds_read_b64_tr_b16 a[210:211], v36 offset:7360
    v_mfma_f32_16x16x32_bf16 v[124:127], a[144:147], a[96:99], v[124:127]
    ds_read_b64_tr_b16 a[212:213], v38 offset:0
    buffer_load_dwordx4 v20, s[28:31], s52 offen offset:3072 lds
    v_mfma_f32_16x16x32_bf16 v[128:131], a[144:147], a[100:103], v[128:131]
    ds_read_b64_tr_b16 a[214:215], v38 offset:7168
    ds_read_b64_tr_b16 a[216:217], v39 offset:32
    v_mfma_f32_16x16x32_bf16 v[84:87], a[144:147], v[220:223], v[84:87]
    ds_read_b64_tr_b16 a[218:219], v39 offset:7200
    v_mfma_f32_16x16x32_bf16 v[132:135], a[148:151], a[96:99], v[132:135]
    ds_read_b64_tr_b16 a[220:221], v38 offset:64
    ds_read_b64_tr_b16 a[222:223], v38 offset:7232
    v_mfma_f32_16x16x32_bf16 v[136:139], a[148:151], a[100:103], v[136:139]
    ds_read_b64_tr_b16 a[224:225], v39 offset:96
    s_add_u32 m0, s49, 0x1c000
    s_add_u32 s3, s84, 0x10000
    v_add_u32 v20, s3, v77
    buffer_load_dwordx4 v20, s[28:31], 0 offen offset:0 lds
    v_mfma_f32_16x16x32_bf16 v[84:87], a[148:151], v[224:227], v[84:87]
    ds_read_b64_tr_b16 a[226:227], v39 offset:7264
    ds_read_b64_tr_b16 a[228:229], v38 offset:128
    v_mfma_f32_16x16x32_bf16 v[140:143], a[152:155], a[96:99], v[140:143]
    ds_read_b64_tr_b16 a[230:231], v38 offset:7296
    v_mfma_f32_16x16x32_bf16 v[144:147], a[152:155], a[100:103], v[144:147]
    ds_read_b64_tr_b16 a[232:233], v39 offset:160
    ds_read_b64_tr_b16 a[234:235], v39 offset:7328
    v_mfma_f32_16x16x32_bf16 v[84:87], a[152:155], v[228:231], v[84:87]
    ds_read_b64_tr_b16 a[236:237], v38 offset:192
    buffer_load_dwordx4 v20, s[28:31], s50 offen offset:1024 lds
    v_mfma_f32_16x16x32_bf16 v[92:95], a[156:159], a[104:107], v[92:95]
    ds_read_b64_tr_b16 a[238:239], v38 offset:7360
    v_mfma_f32_16x16x32_bf16 v[96:99], a[156:159], a[108:111], v[96:99]
    s_waitcnt lgkmcnt(15)
    v_mfma_f32_16x16x32_bf16 v[84:87], a[184:187], v[204:207], v[84:87]
    v_mfma_f32_16x16x32_bf16 v[84:87], a[188:191], v[208:211], v[84:87]
    v_mfma_f32_16x16x32_bf16 v[100:103], a[160:163], a[104:107], v[100:103]
    buffer_load_dwordx4 v20, s[28:31], s51 offen offset:2048 lds
    v_mfma_f32_16x16x32_bf16 v[104:107], a[160:163], a[108:111], v[104:107]
    v_mfma_f32_16x16x32_bf16 v[84:87], a[192:195], v[212:215], v[84:87]
    v_mfma_f32_16x16x32_bf16 v[84:87], a[196:199], v[216:219], v[84:87]
    v_mfma_f32_16x16x32_bf16 v[108:111], a[164:167], a[104:107], v[108:111]
    v_mfma_f32_16x16x32_bf16 v[112:115], a[164:167], a[108:111], v[112:115]
    buffer_load_dwordx4 v20, s[28:31], s52 offen offset:3072 lds
    v_mfma_f32_16x16x32_bf16 v[84:87], a[200:203], v[220:223], v[84:87]
    v_mfma_f32_16x16x32_bf16 v[84:87], a[204:207], v[224:227], v[84:87]
    v_mfma_f32_16x16x32_bf16 v[116:119], a[168:171], a[104:107], v[116:119]
    v_mfma_f32_16x16x32_bf16 v[120:123], a[168:171], a[108:111], v[120:123]
    s_waitcnt lgkmcnt(14)
    v_mfma_f32_16x16x32_bf16 v[84:87], a[208:211], v[228:231], v[84:87]
    s_add_u32 m0, s49, 0x10000
    s_add_u32 s3, s85, 0x8000
    v_add_u32 v20, s3, v77
    buffer_load_dwordx4 v20, s[28:31], 0 offen offset:0 lds
    v_mfma_f32_16x16x32_bf16 v[124:127], a[172:175], a[104:107], v[124:127]
    v_mfma_f32_16x16x32_bf16 v[128:131], a[172:175], a[108:111], v[128:131]
    v_mfma_f32_16x16x32_bf16 v[132:135], a[176:179], a[104:107], v[132:135]
    v_mfma_f32_16x16x32_bf16 v[136:139], a[176:179], a[108:111], v[136:139]
    ds_write_b128 v80, v[84:87]
    buffer_load_dwordx4 v20, s[28:31], s50 offen offset:1024 lds
    v_mfma_f32_16x16x32_bf16 v[140:143], a[180:183], a[104:107], v[140:143]
    v_mfma_f32_16x16x32_bf16 v[144:147], a[180:183], a[108:111], v[144:147]
    s_waitcnt lgkmcnt(0)
    s_barrier
    ds_read_b128 v[68:71], v81
    v_mfma_f32_16x16x32_bf16 v[92:95], a[184:187], a[112:115], v[92:95]
    v_mfma_f32_16x16x32_bf16 v[96:99], a[184:187], a[116:119], v[96:99]
    buffer_load_dwordx4 v20, s[28:31], s51 offen offset:2048 lds
    v_mfma_f32_16x16x32_bf16 v[100:103], a[188:191], a[112:115], v[100:103]
    v_mfma_f32_16x16x32_bf16 v[104:107], a[188:191], a[116:119], v[104:107]
    v_mfma_f32_16x16x32_bf16 v[108:111], a[192:195], a[112:115], v[108:111]
    v_mfma_f32_16x16x32_bf16 v[112:115], a[192:195], a[116:119], v[112:115]
    s_waitcnt lgkmcnt(0)
    v_pk_add_f32 v[84:85], v[84:85], v[68:69]
    v_mfma_f32_16x16x32_bf16 v[116:119], a[196:199], a[112:115], v[116:119]
    buffer_load_dwordx4 v20, s[28:31], s52 offen offset:3072 lds
    v_pk_add_f32 v[86:87], v[86:87], v[70:71]
    v_mfma_f32_16x16x32_bf16 v[120:123], a[196:199], a[116:119], v[120:123]
    v_mfma_f32_16x16x32_bf16 v[124:127], a[200:203], a[112:115], v[124:127]
    v_mov_b32_dpp v204, v84 row_newbcast:0 row_mask:0xf bank_mask:0xf
    v_mov_b32_dpp v205, v85 row_newbcast:0 row_mask:0xf bank_mask:0xf
    v_mfma_f32_16x16x32_bf16 v[128:131], a[200:203], a[116:119], v[128:131]
    v_mov_b32_dpp v206, v86 row_newbcast:0 row_mask:0xf bank_mask:0xf
    v_mov_b32_dpp v207, v87 row_newbcast:0 row_mask:0xf bank_mask:0xf
    s_waitcnt vmcnt(24)
    s_waitcnt vmcnt(20)
    s_waitcnt vmcnt(16)
    v_mfma_f32_16x16x32_bf16 v[132:135], a[204:207], a[112:115], v[132:135]
    v_add_u32 v38, 0x0, v58
    s_add_u32 m0, s49, 0x14000
    s_add_u32 s3, s86, 0x8000
    v_add_u32 v20, s3, v77
    buffer_load_dwordx4 v20, s[28:31], 0 offen offset:0 lds
    v_mfma_f32_16x16x32_bf16 v[136:139], a[204:207], a[116:119], v[136:139]
    v_add_u32 v39, 0x0, v59
    ds_read_b64_tr_b16 a[64:65], v38 offset:0
    v_mfma_f32_16x16x32_bf16 v[140:143], a[208:211], a[112:115], v[140:143]
    ds_read_b64_tr_b16 a[66:67], v38 offset:512
    v_mov_b32_dpp v208, v84 row_newbcast:1 row_mask:0xf bank_mask:0xf
    v_mfma_f32_16x16x32_bf16 v[144:147], a[208:211], a[116:119], v[144:147]
    ds_read_b64_tr_b16 a[68:69], v39 offset:0
    ds_read_b64_tr_b16 a[70:71], v39 offset:512
    v_mfma_f32_16x16x32_bf16 v[92:95], a[212:215], a[120:123], v[92:95]
    ds_read_b64_tr_b16 a[72:73], v38 offset:2048
    buffer_load_dwordx4 v20, s[28:31], s50 offen offset:1024 lds
    v_mfma_f32_16x16x32_bf16 v[96:99], a[212:215], a[124:127], v[96:99]
    ds_read_b64_tr_b16 a[74:75], v38 offset:2560
    ds_read_b64_tr_b16 a[76:77], v39 offset:2048
    v_mfma_f32_16x16x32_bf16 v[100:103], a[216:219], a[120:123], v[100:103]
    ds_read_b64_tr_b16 a[78:79], v39 offset:2560
    v_mov_b32_dpp v209, v85 row_newbcast:1 row_mask:0xf bank_mask:0xf
    v_mfma_f32_16x16x32_bf16 v[104:107], a[216:219], a[124:127], v[104:107]
    v_add_u32 v36, 0x4000, v58
    v_add_u32 v37, 0x4000, v59
    v_mfma_f32_16x16x32_bf16 v[108:111], a[220:223], a[120:123], v[108:111]
    ds_read_b64_tr_b16 a[0:1], v36 offset:0
    buffer_load_dwordx4 v20, s[28:31], s51 offen offset:2048 lds
    v_mfma_f32_16x16x32_bf16 v[112:115], a[220:223], a[124:127], v[112:115]
    ds_read_b64_tr_b16 a[2:3], v36 offset:512
    ds_read_b64_tr_b16 a[4:5], v37 offset:0
    v_mfma_f32_16x16x32_bf16 v[116:119], a[224:227], a[120:123], v[116:119]
    ds_read_b64_tr_b16 a[6:7], v37 offset:512
    v_mov_b32_dpp v210, v86 row_newbcast:1 row_mask:0xf bank_mask:0xf
    v_mfma_f32_16x16x32_bf16 v[120:123], a[224:227], a[124:127], v[120:123]
    ds_read_b64_tr_b16 a[8:9], v36 offset:2048
    ds_read_b64_tr_b16 a[10:11], v36 offset:2560
    v_mfma_f32_16x16x32_bf16 v[124:127], a[228:231], a[120:123], v[124:127]
    ds_read_b64_tr_b16 a[12:13], v37 offset:2048
    buffer_load_dwordx4 v20, s[28:31], s52 offen offset:3072 lds
    v_mfma_f32_16x16x32_bf16 v[128:131], a[228:231], a[124:127], v[128:131]
    ds_read_b64_tr_b16 a[14:15], v37 offset:2560
    v_add_u32 v38, 0x8000, v58
    v_mfma_f32_16x16x32_bf16 v[132:135], a[232:235], a[120:123], v[132:135]
    v_add_u32 v39, 0x8000, v59
    v_mov_b32_dpp v211, v87 row_newbcast:1 row_mask:0xf bank_mask:0xf
    v_mfma_f32_16x16x32_bf16 v[136:139], a[232:235], a[124:127], v[136:139]
    ds_read_b64_tr_b16 a[16:17], v38 offset:0
    ds_read_b64_tr_b16 a[18:19], v38 offset:512
    v_mfma_f32_16x16x32_bf16 v[140:143], a[236:239], a[120:123], v[140:143]
    ds_read_b64_tr_b16 a[20:21], v39 offset:0
    s_add_u32 m0, s49, 0x20000
    s_add_u32 s3, s87, 0x8000
    v_add_u32 v20, s3, v77
    buffer_load_dwordx4 v20, s[28:31], 0 offen offset:0 lds
    v_mfma_f32_16x16x32_bf16 v[144:147], a[236:239], a[124:127], v[144:147]
    ds_read_b64_tr_b16 a[22:23], v39 offset:512
    ds_read_b64_tr_b16 a[24:25], v38 offset:2048
    v_mov_b32_dpp v212, v84 row_newbcast:2 row_mask:0xf bank_mask:0xf
    v_mov_b32_dpp v213, v85 row_newbcast:2 row_mask:0xf bank_mask:0xf
    v_mov_b32_dpp v214, v86 row_newbcast:2 row_mask:0xf bank_mask:0xf
    v_mov_b32_dpp v215, v87 row_newbcast:2 row_mask:0xf bank_mask:0xf
    v_mov_b32_dpp v216, v84 row_newbcast:3 row_mask:0xf bank_mask:0xf
    v_mov_b32_dpp v217, v85 row_newbcast:3 row_mask:0xf bank_mask:0xf
    v_mov_b32_dpp v218, v86 row_newbcast:3 row_mask:0xf bank_mask:0xf
    v_mov_b32_dpp v219, v87 row_newbcast:3 row_mask:0xf bank_mask:0xf
    v_mov_b32_dpp v220, v84 row_newbcast:4 row_mask:0xf bank_mask:0xf
    v_mov_b32_dpp v221, v85 row_newbcast:4 row_mask:0xf bank_mask:0xf
    v_mov_b32_dpp v222, v86 row_newbcast:4 row_mask:0xf bank_mask:0xf
    buffer_load_dwordx4 v20, s[28:31], s50 offen offset:1024 lds
    v_mov_b32_dpp v223, v87 row_newbcast:4 row_mask:0xf bank_mask:0xf
    v_mov_b32_dpp v224, v84 row_newbcast:5 row_mask:0xf bank_mask:0xf
    v_mov_b32_dpp v225, v85 row_newbcast:5 row_mask:0xf bank_mask:0xf
    v_mov_b32_dpp v226, v86 row_newbcast:5 row_mask:0xf bank_mask:0xf
    v_mov_b32_dpp v227, v87 row_newbcast:5 row_mask:0xf bank_mask:0xf
    v_mov_b32_dpp v228, v84 row_newbcast:6 row_mask:0xf bank_mask:0xf
    v_mov_b32_dpp v229, v85 row_newbcast:6 row_mask:0xf bank_mask:0xf
    v_mov_b32_dpp v230, v86 row_newbcast:6 row_mask:0xf bank_mask:0xf
    v_mov_b32_dpp v231, v87 row_newbcast:6 row_mask:0xf bank_mask:0xf
    buffer_load_dword v69, v13, s[40:43], s62 offen offset:148 sc1
    v_pk_fma_f32 v[92:93], v[204:205], v[148:149], v[92:93] op_sel:[0,1,0] op_sel_hi:[1,1,1] neg_lo:[0,1,0] neg_hi:[0,1,0]
    v_pk_fma_f32 v[94:95], v[206:207], v[148:149], v[94:95] op_sel:[0,1,0] op_sel_hi:[1,1,1] neg_lo:[0,1,0] neg_hi:[0,1,0]
    v_pk_mul_f32 v[188:189], v[92:93], v[92:93]
    v_pk_mul_f32 v[190:191], v[94:95], v[94:95]
    ds_read_b64_tr_b16 a[26:27], v38 offset:2560
    v_pk_fma_f32 v[188:189], v[188:189], v[22:23], v[22:23] op_sel:[0,1,0] op_sel_hi:[1,1,0]
    buffer_load_dwordx4 v20, s[28:31], s51 offen offset:2048 lds
    v_pk_fma_f32 v[190:191], v[190:191], v[22:23], v[22:23] op_sel:[0,1,0] op_sel_hi:[1,1,0]
    v_pk_mul_f32 v[188:189], v[188:189], v[92:93]
    v_pk_mul_f32 v[190:191], v[190:191], v[94:95]
    ds_read_b64_tr_b16 a[28:29], v39 offset:2048
    v_exp_f32 v188, v188
    buffer_load_dwordx4 v20, s[28:31], s52 offen offset:3072 lds
    v_exp_f32 v189, v189
    v_exp_f32 v190, v190
    v_exp_f32 v191, v191
    ds_read_b64_tr_b16 a[30:31], v39 offset:2560
    v_pk_fma_f32 v[188:189], v[188:189], v[72:73], v[72:73] op_sel_hi:[1,0,0]
    v_pk_fma_f32 v[190:191], v[190:191], v[72:73], v[72:73] op_sel_hi:[1,0,0]
    v_rcp_f32 v188, v188
    v_rcp_f32 v189, v189
    v_rcp_f32 v190, v190
    v_rcp_f32 v191, v191
    v_pk_mul_f32 v[92:93], v[92:93], v[188:189]
    v_pk_mul_f32 v[94:95], v[94:95], v[190:191]
    v_cvt_pk_bf16_f32 v92, v92, v93
    v_cvt_pk_bf16_f32 v93, v94, v95
    s_waitcnt vmcnt(21)
    v_pk_fma_f32 v[100:101], v[208:209], v[148:149], v[100:101] op_sel:[0,1,0] op_sel_hi:[1,1,1] neg_lo:[0,1,0] neg_hi:[0,1,0]
    v_add_u32 v36, 0xc000, v58
    v_pk_fma_f32 v[102:103], v[210:211], v[148:149], v[102:103] op_sel:[0,1,0] op_sel_hi:[1,1,1] neg_lo:[0,1,0] neg_hi:[0,1,0]
    v_pk_mul_f32 v[188:189], v[100:101], v[100:101]
    v_pk_mul_f32 v[190:191], v[102:103], v[102:103]
    v_pk_fma_f32 v[188:189], v[188:189], v[22:23], v[22:23] op_sel:[0,1,0] op_sel_hi:[1,1,0]
    v_add_u32 v37, 0xc000, v59
    v_pk_fma_f32 v[190:191], v[190:191], v[22:23], v[22:23] op_sel:[0,1,0] op_sel_hi:[1,1,0]
    v_pk_mul_f32 v[188:189], v[188:189], v[100:101]
    v_pk_mul_f32 v[190:191], v[190:191], v[102:103]
    v_exp_f32 v188, v188
    ds_read_b64_tr_b16 a[32:33], v36 offset:0
    v_exp_f32 v189, v189
    v_exp_f32 v190, v190
    v_exp_f32 v191, v191
    v_pk_fma_f32 v[188:189], v[188:189], v[72:73], v[72:73] op_sel_hi:[1,0,0]
    ds_read_b64_tr_b16 a[34:35], v36 offset:512
    v_pk_fma_f32 v[190:191], v[190:191], v[72:73], v[72:73] op_sel_hi:[1,0,0]
    v_rcp_f32 v188, v188
    v_rcp_f32 v189, v189
    v_rcp_f32 v190, v190
    ds_read_b64_tr_b16 a[36:37], v37 offset:0
    v_rcp_f32 v191, v191
    v_pk_mul_f32 v[100:101], v[100:101], v[188:189]
    v_pk_mul_f32 v[102:103], v[102:103], v[190:191]
    v_cvt_pk_bf16_f32 v94, v100, v101
    ds_read_b64_tr_b16 a[38:39], v37 offset:512
    v_cvt_pk_bf16_f32 v95, v102, v103
    s_add_u32 s71, s94, 0x30000
    buffer_store_dwordx4 v[92:95], v60, s[40:43], s71 offen offset:0
    s_waitcnt vmcnt(18)
    v_pk_fma_f32 v[96:97], v[204:205], v[148:149], v[96:97] op_sel_hi:[1,0,1] neg_lo:[0,1,0] neg_hi:[0,1,0]
    v_pk_fma_f32 v[98:99], v[206:207], v[148:149], v[98:99] op_sel_hi:[1,0,1] neg_lo:[0,1,0] neg_hi:[0,1,0]
    v_pk_mul_f32 v[188:189], v[96:97], v[96:97]
    ds_read_b64_tr_b16 a[40:41], v36 offset:2048
    v_pk_mul_f32 v[190:191], v[98:99], v[98:99]
    v_pk_fma_f32 v[188:189], v[188:189], v[82:83], v[82:83] op_sel:[0,1,0] op_sel_hi:[1,1,0]
    s_waitcnt lgkmcnt(15)
    s_add_u32 m0, s49, 0x0
    s_add_u32 s3, s85, 0x10000
    v_add_u32 v20, s3, v77
    buffer_load_dwordx4 v20, s[28:31], 0 offen offset:0 lds
    v_pk_fma_f32 v[190:191], v[190:191], v[82:83], v[82:83] op_sel:[0,1,0] op_sel_hi:[1,1,0]
    v_pk_mul_f32 v[188:189], v[188:189], v[96:97]
    ds_read_b64_tr_b16 a[42:43], v36 offset:2560
    v_pk_mul_f32 v[190:191], v[190:191], v[98:99]
    v_exp_f32 v188, v188
    buffer_load_dwordx4 v20, s[28:31], s50 offen offset:1024 lds
    v_exp_f32 v189, v189
    v_exp_f32 v190, v190
    ds_read_b64_tr_b16 a[44:45], v37 offset:2048
    v_exp_f32 v191, v191
    buffer_load_dwordx4 v20, s[28:31], s51 offen offset:2048 lds
    v_pk_fma_f32 v[188:189], v[188:189], v[90:91], v[90:91] op_sel_hi:[1,0,0]
    v_pk_fma_f32 v[190:191], v[190:191], v[90:91], v[90:91] op_sel_hi:[1,0,0]
    v_rcp_f32 v188, v188
    ds_read_b64_tr_b16 a[46:47], v37 offset:2560
    v_rcp_f32 v189, v189
    buffer_load_dwordx4 v20, s[28:31], s52 offen offset:3072 lds
    v_rcp_f32 v190, v190
    v_rcp_f32 v191, v191
    v_pk_mul_f32 v[96:97], v[96:97], v[188:189]
    v_add_u32 v38, 0x18000, v58
    v_pk_mul_f32 v[98:99], v[98:99], v[190:191]
    v_cvt_pk_bf16_f32 v96, v96, v97
    v_cvt_pk_bf16_f32 v97, v98, v99
    v_pk_fma_f32 v[104:105], v[208:209], v[148:149], v[104:105] op_sel_hi:[1,0,1] neg_lo:[0,1,0] neg_hi:[0,1,0]
    v_add_u32 v39, 0x18000, v59
    s_waitcnt lgkmcnt(15)
    s_add_u32 m0, s49, 0x4000
    s_add_u32 s3, s86, 0x10000
    v_add_u32 v20, s3, v77
    buffer_load_dwordx4 v20, s[28:31], 0 offen offset:0 lds
    v_pk_fma_f32 v[106:107], v[210:211], v[148:149], v[106:107] op_sel_hi:[1,0,1] neg_lo:[0,1,0] neg_hi:[0,1,0]
    v_pk_mul_f32 v[188:189], v[104:105], v[104:105]
    v_pk_mul_f32 v[190:191], v[106:107], v[106:107]
    v_pk_fma_f32 v[188:189], v[188:189], v[82:83], v[82:83] op_sel:[0,1,0] op_sel_hi:[1,1,0]
    ds_read_b64_tr_b16 a[48:49], v38 offset:0
    v_pk_fma_f32 v[190:191], v[190:191], v[82:83], v[82:83] op_sel:[0,1,0] op_sel_hi:[1,1,0]
    buffer_load_dwordx4 v20, s[28:31], s50 offen offset:1024 lds
    v_pk_mul_f32 v[188:189], v[188:189], v[104:105]
    v_pk_mul_f32 v[190:191], v[190:191], v[106:107]
    v_exp_f32 v188, v188
    ds_read_b64_tr_b16 a[50:51], v38 offset:512
    v_exp_f32 v189, v189
    buffer_load_dwordx4 v20, s[28:31], s51 offen offset:2048 lds
    v_exp_f32 v190, v190
    v_exp_f32 v191, v191
    v_pk_fma_f32 v[188:189], v[188:189], v[90:91], v[90:91] op_sel_hi:[1,0,0]
    ds_read_b64_tr_b16 a[52:53], v39 offset:0
    buffer_load_dwordx4 v20, s[28:31], s52 offen offset:3072 lds
    v_pk_fma_f32 v[190:191], v[190:191], v[90:91], v[90:91] op_sel_hi:[1,0,0]
    v_rcp_f32 v188, v188
    v_rcp_f32 v189, v189
    v_rcp_f32 v190, v190
    ds_read_b64_tr_b16 a[54:55], v39 offset:512
    v_rcp_f32 v191, v191
    v_pk_mul_f32 v[104:105], v[104:105], v[188:189]
    v_pk_mul_f32 v[106:107], v[106:107], v[190:191]
    v_cvt_pk_bf16_f32 v98, v104, v105
    ds_read_b64_tr_b16 a[56:57], v38 offset:2048
    v_cvt_pk_bf16_f32 v99, v106, v107
    buffer_store_dwordx4 v[96:99], v60, s[40:43], s71 offen offset:256
    v_pk_fma_f32 v[108:109], v[212:213], v[148:149], v[108:109] op_sel:[0,1,0] op_sel_hi:[1,1,1] neg_lo:[0,1,0] neg_hi:[0,1,0]
    v_pk_fma_f32 v[110:111], v[214:215], v[148:149], v[110:111] op_sel:[0,1,0] op_sel_hi:[1,1,1] neg_lo:[0,1,0] neg_hi:[0,1,0]
    v_pk_mul_f32 v[188:189], v[108:109], v[108:109]
    ds_read_b64_tr_b16 a[58:59], v38 offset:2560
    v_pk_mul_f32 v[190:191], v[110:111], v[110:111]
    v_pk_fma_f32 v[188:189], v[188:189], v[22:23], v[22:23] op_sel:[0,1,0] op_sel_hi:[1,1,0]
    s_waitcnt lgkmcnt(14)
    s_add_u32 m0, s49, 0x8000
    s_add_u32 s3, s87, 0x10000
    v_add_u32 v20, s3, v77
    buffer_load_dwordx4 v20, s[28:31], 0 offen offset:0 lds
    v_pk_fma_f32 v[190:191], v[190:191], v[22:23], v[22:23] op_sel:[0,1,0] op_sel_hi:[1,1,0]
    v_pk_mul_f32 v[188:189], v[188:189], v[108:109]
    ds_read_b64_tr_b16 a[60:61], v39 offset:2048
    v_pk_mul_f32 v[190:191], v[190:191], v[110:111]
    v_exp_f32 v188, v188
    buffer_load_dwordx4 v20, s[28:31], s50 offen offset:1024 lds
    v_exp_f32 v189, v189
    v_exp_f32 v190, v190
    ds_read_b64_tr_b16 a[62:63], v39 offset:2560
    v_exp_f32 v191, v191
    buffer_load_dwordx4 v20, s[28:31], s51 offen offset:2048 lds
    v_pk_fma_f32 v[188:189], v[188:189], v[72:73], v[72:73] op_sel_hi:[1,0,0]
    v_pk_fma_f32 v[190:191], v[190:191], v[72:73], v[72:73] op_sel_hi:[1,0,0]
    v_rcp_f32 v188, v188
    v_rcp_f32 v189, v189
    buffer_load_dwordx4 v20, s[28:31], s52 offen offset:3072 lds
    v_rcp_f32 v190, v190
    v_rcp_f32 v191, v191
    v_pk_mul_f32 v[108:109], v[108:109], v[188:189]
    v_pk_mul_f32 v[110:111], v[110:111], v[190:191]
    v_cvt_pk_bf16_f32 v108, v108, v109
    v_cvt_pk_bf16_f32 v109, v110, v111
    v_pk_fma_f32 v[116:117], v[216:217], v[148:149], v[116:117] op_sel:[0,1,0] op_sel_hi:[1,1,1] neg_lo:[0,1,0] neg_hi:[0,1,0]
    s_waitcnt lgkmcnt(8)
    s_add_u32 m0, s49, 0xc000
    v_add_u32 v20, s84, v78
    buffer_load_dwordx4 v20, s[28:31], 0 offen offset:0 lds
    v_pk_fma_f32 v[118:119], v[218:219], v[148:149], v[118:119] op_sel:[0,1,0] op_sel_hi:[1,1,1] neg_lo:[0,1,0] neg_hi:[0,1,0]
    v_pk_mul_f32 v[188:189], v[116:117], v[116:117]
    v_pk_mul_f32 v[190:191], v[118:119], v[118:119]
    v_pk_fma_f32 v[188:189], v[188:189], v[22:23], v[22:23] op_sel:[0,1,0] op_sel_hi:[1,1,0]
    v_pk_fma_f32 v[190:191], v[190:191], v[22:23], v[22:23] op_sel:[0,1,0] op_sel_hi:[1,1,0]
    v_pk_mul_f32 v[188:189], v[188:189], v[116:117]
    buffer_load_dwordx4 v20, s[28:31], s53 offen offset:1024 lds
    v_pk_mul_f32 v[190:191], v[190:191], v[118:119]
    v_exp_f32 v188, v188
    v_exp_f32 v189, v189
    v_exp_f32 v190, v190
    s_add_u32 m0, s49, 0xc800
    v_add_u32 v20, s85, v78
    buffer_load_dwordx4 v20, s[28:31], 0 offen offset:0 lds
    v_exp_f32 v191, v191
    v_pk_fma_f32 v[188:189], v[188:189], v[72:73], v[72:73] op_sel_hi:[1,0,0]
    v_pk_fma_f32 v[190:191], v[190:191], v[72:73], v[72:73] op_sel_hi:[1,0,0]
    v_rcp_f32 v188, v188
    buffer_load_dwordx4 v20, s[28:31], s53 offen offset:1024 lds
    v_rcp_f32 v189, v189
    v_rcp_f32 v190, v190
    v_rcp_f32 v191, v191
    v_pk_mul_f32 v[116:117], v[116:117], v[188:189]
    v_pk_mul_f32 v[118:119], v[118:119], v[190:191]
    v_cvt_pk_bf16_f32 v110, v116, v117
    v_cvt_pk_bf16_f32 v111, v118, v119
    s_add_u32 s71, s96, 0x0
    buffer_store_dwordx4 v[108:111], v60, s[40:43], s71 offen offset:0
    s_waitcnt vmcnt(9)
    buffer_store_dword v24, v2, s[40:43], s56 offen offset:136
    v_pk_fma_f32 v[112:113], v[212:213], v[148:149], v[112:113] op_sel_hi:[1,0,1] neg_lo:[0,1,0] neg_hi:[0,1,0]
    v_pk_fma_f32 v[114:115], v[214:215], v[148:149], v[114:115] op_sel_hi:[1,0,1] neg_lo:[0,1,0] neg_hi:[0,1,0]
    v_pk_mul_f32 v[188:189], v[112:113], v[112:113]
    v_pk_mul_f32 v[190:191], v[114:115], v[114:115]
    v_pk_fma_f32 v[188:189], v[188:189], v[82:83], v[82:83] op_sel:[0,1,0] op_sel_hi:[1,1,0]
    v_pk_fma_f32 v[190:191], v[190:191], v[82:83], v[82:83] op_sel:[0,1,0] op_sel_hi:[1,1,0]
    s_waitcnt lgkmcnt(0)
    s_add_u32 m0, s49, 0x18000
    v_add_u32 v20, s86, v78
    buffer_load_dwordx4 v20, s[28:31], 0 offen offset:0 lds
    v_pk_mul_f32 v[188:189], v[188:189], v[112:113]
    v_pk_mul_f32 v[190:191], v[190:191], v[114:115]
    v_exp_f32 v188, v188
    v_exp_f32 v189, v189
    buffer_load_dwordx4 v20, s[28:31], s53 offen offset:1024 lds
    v_exp_f32 v190, v190
    v_exp_f32 v191, v191
    v_pk_fma_f32 v[188:189], v[188:189], v[90:91], v[90:91] op_sel_hi:[1,0,0]
    v_pk_fma_f32 v[190:191], v[190:191], v[90:91], v[90:91] op_sel_hi:[1,0,0]
    s_add_u32 m0, s49, 0x18800
    v_add_u32 v20, s87, v78
    buffer_load_dwordx4 v20, s[28:31], 0 offen offset:0 lds
    v_rcp_f32 v188, v188
    v_rcp_f32 v189, v189
    v_rcp_f32 v190, v190
    buffer_load_dwordx4 v20, s[28:31], s53 offen offset:1024 lds
    v_rcp_f32 v191, v191
    v_pk_mul_f32 v[112:113], v[112:113], v[188:189]
    v_pk_mul_f32 v[114:115], v[114:115], v[190:191]
    v_cvt_pk_bf16_f32 v112, v112, v113
    v_cvt_pk_bf16_f32 v113, v114, v115
    v_pk_fma_f32 v[120:121], v[216:217], v[148:149], v[120:121] op_sel_hi:[1,0,1] neg_lo:[0,1,0] neg_hi:[0,1,0]
    v_pk_fma_f32 v[122:123], v[218:219], v[148:149], v[122:123] op_sel_hi:[1,0,1] neg_lo:[0,1,0] neg_hi:[0,1,0]
    v_pk_mul_f32 v[188:189], v[120:121], v[120:121]
    v_pk_mul_f32 v[190:191], v[122:123], v[122:123]
    v_pk_fma_f32 v[188:189], v[188:189], v[82:83], v[82:83] op_sel:[0,1,0] op_sel_hi:[1,1,0]
    v_pk_fma_f32 v[190:191], v[190:191], v[82:83], v[82:83] op_sel:[0,1,0] op_sel_hi:[1,1,0]
    v_pk_mul_f32 v[188:189], v[188:189], v[120:121]
    v_pk_mul_f32 v[190:191], v[190:191], v[122:123]
    v_exp_f32 v188, v188
    v_exp_f32 v189, v189
    v_exp_f32 v190, v190
    v_exp_f32 v191, v191
    v_pk_fma_f32 v[188:189], v[188:189], v[90:91], v[90:91] op_sel_hi:[1,0,0]
    v_pk_fma_f32 v[190:191], v[190:191], v[90:91], v[90:91] op_sel_hi:[1,0,0]
    v_rcp_f32 v188, v188
    v_rcp_f32 v189, v189
    v_rcp_f32 v190, v190
    v_rcp_f32 v191, v191
    v_pk_mul_f32 v[120:121], v[120:121], v[188:189]
    v_pk_mul_f32 v[122:123], v[122:123], v[190:191]
    v_cvt_pk_bf16_f32 v114, v120, v121
    v_cvt_pk_bf16_f32 v115, v122, v123
    buffer_store_dwordx4 v[112:115], v60, s[40:43], s71 offen offset:256
    v_cmp_ne_u32 vcc, s95, v69
    s_nop 0
    s_cbranch_vccz polled_34
    s_mov_b32 s57, 0x40000
poll_33:
    buffer_load_dword v69, v13, s[40:43], s62 offen offset:148 sc1
    s_waitcnt vmcnt(0)
    v_cmp_ne_u32 vcc, s95, v69
    s_nop 0
    s_cbranch_vccz polled_34
    s_sub_u32 s57, s57, 1
    s_cbranch_scc0 poll_33
polled_34:
    buffer_load_dword v66, v17, s[40:43], s62 offen offset:136 sc1
    v_pk_fma_f32 v[124:125], v[220:221], v[148:149], v[124:125] op_sel:[0,1,0] op_sel_hi:[1,1,1] neg_lo:[0,1,0] neg_hi:[0,1,0]
    v_pk_fma_f32 v[126:127], v[222:223], v[148:149], v[126:127] op_sel:[0,1,0] op_sel_hi:[1,1,1] neg_lo:[0,1,0] neg_hi:[0,1,0]
    v_pk_mul_f32 v[188:189], v[124:125], v[124:125]
    v_pk_mul_f32 v[190:191], v[126:127], v[126:127]
    v_pk_fma_f32 v[188:189], v[188:189], v[22:23], v[22:23] op_sel:[0,1,0] op_sel_hi:[1,1,0]
    v_pk_fma_f32 v[190:191], v[190:191], v[22:23], v[22:23] op_sel:[0,1,0] op_sel_hi:[1,1,0]
    v_pk_mul_f32 v[188:189], v[188:189], v[124:125]
    v_pk_mul_f32 v[190:191], v[190:191], v[126:127]
    v_exp_f32 v188, v188
    v_exp_f32 v189, v189
    v_exp_f32 v190, v190
    v_exp_f32 v191, v191
    v_pk_fma_f32 v[188:189], v[188:189], v[72:73], v[72:73] op_sel_hi:[1,0,0]
    v_pk_fma_f32 v[190:191], v[190:191], v[72:73], v[72:73] op_sel_hi:[1,0,0]
    v_rcp_f32 v188, v188
    v_rcp_f32 v189, v189
    v_rcp_f32 v190, v190
    v_rcp_f32 v191, v191
    v_pk_mul_f32 v[124:125], v[124:125], v[188:189]
    v_pk_mul_f32 v[126:127], v[126:127], v[190:191]
    v_cvt_pk_bf16_f32 v124, v124, v125
    v_cvt_pk_bf16_f32 v125, v126, v127
    v_pk_fma_f32 v[132:133], v[224:225], v[148:149], v[132:133] op_sel:[0,1,0] op_sel_hi:[1,1,1] neg_lo:[0,1,0] neg_hi:[0,1,0]
    v_add_u32 v36, 0x1c000, v58
    v_pk_fma_f32 v[134:135], v[226:227], v[148:149], v[134:135] op_sel:[0,1,0] op_sel_hi:[1,1,1] neg_lo:[0,1,0] neg_hi:[0,1,0]
    v_pk_mul_f32 v[188:189], v[132:133], v[132:133]
    v_pk_mul_f32 v[190:191], v[134:135], v[134:135]
    v_pk_fma_f32 v[188:189], v[188:189], v[22:23], v[22:23] op_sel:[0,1,0] op_sel_hi:[1,1,0]
    v_add_u32 v37, 0x1c000, v59
    v_pk_fma_f32 v[190:191], v[190:191], v[22:23], v[22:23] op_sel:[0,1,0] op_sel_hi:[1,1,0]
    v_pk_mul_f32 v[188:189], v[188:189], v[132:133]
    v_pk_mul_f32 v[190:191], v[190:191], v[134:135]
    v_exp_f32 v188, v188
    ds_read_b64_tr_b16 a[128:129], v36 offset:0
    v_exp_f32 v189, v189
    v_exp_f32 v190, v190
    v_exp_f32 v191, v191
    v_pk_fma_f32 v[188:189], v[188:189], v[72:73], v[72:73] op_sel_hi:[1,0,0]
    ds_read_b64_tr_b16 a[130:131], v36 offset:512
    v_pk_fma_f32 v[190:191], v[190:191], v[72:73], v[72:73] op_sel_hi:[1,0,0]
    v_rcp_f32 v188, v188
    v_rcp_f32 v189, v189
    v_rcp_f32 v190, v190
    ds_read_b64_tr_b16 a[132:133], v37 offset:0
    v_rcp_f32 v191, v191
    v_pk_mul_f32 v[132:133], v[132:133], v[188:189]
    v_pk_mul_f32 v[134:135], v[134:135], v[190:191]
    v_cvt_pk_bf16_f32 v126, v132, v133
    ds_read_b64_tr_b16 a[134:135], v37 offset:512
    v_cvt_pk_bf16_f32 v127, v134, v135
    s_add_u32 s71, s96, 0x10000
    buffer_store_dwordx4 v[124:127], v60, s[40:43], s71 offen offset:0 sc1
    s_waitcnt vmcnt(1)
    v_cmp_ne_u32 vcc, s95, v66
    s_nop 0
    s_cbranch_vccz polled_36
    s_mov_b32 s57, 0x40000
poll_35:
    buffer_load_dword v66, v17, s[40:43], s62 offen offset:136 sc1
    s_waitcnt vmcnt(0)
    v_cmp_ne_u32 vcc, s95, v66
    s_nop 0
    s_cbranch_vccz polled_36
    s_sub_u32 s57, s57, 1
    s_cbranch_scc0 poll_35
polled_36:
    buffer_store_dword v24, v2, s[40:43], s56 offen offset:140
    v_pk_fma_f32 v[128:129], v[220:221], v[148:149], v[128:129] op_sel_hi:[1,0,1] neg_lo:[0,1,0] neg_hi:[0,1,0]
    v_pk_fma_f32 v[130:131], v[222:223], v[148:149], v[130:131] op_sel_hi:[1,0,1] neg_lo:[0,1,0] neg_hi:[0,1,0]
    v_pk_mul_f32 v[188:189], v[128:129], v[128:129]
    ds_read_b64_tr_b16 a[136:137], v36 offset:2048
    v_pk_mul_f32 v[190:191], v[130:131], v[130:131]
    v_pk_fma_f32 v[188:189], v[188:189], v[82:83], v[82:83] op_sel:[0,1,0] op_sel_hi:[1,1,0]
    buffer_load_dwordx4 a[224:227], v62, s[40:43], s80 offen offset:0 sc1
    v_pk_fma_f32 v[190:191], v[190:191], v[82:83], v[82:83] op_sel:[0,1,0] op_sel_hi:[1,1,0]
    v_pk_mul_f32 v[188:189], v[188:189], v[128:129]
    ds_read_b64_tr_b16 a[138:139], v36 offset:2560
    v_pk_mul_f32 v[190:191], v[190:191], v[130:131]
    v_exp_f32 v188, v188
    buffer_load_dwordx4 a[228:231], v62, s[40:43], s58 offen offset:0 sc1
    v_exp_f32 v189, v189
    v_exp_f32 v190, v190
    ds_read_b64_tr_b16 a[140:141], v37 offset:2048
    v_exp_f32 v191, v191
    buffer_load_dwordx4 a[232:235], v62, s[40:43], s80 offen offset:1024 sc1
    v_pk_fma_f32 v[188:189], v[188:189], v[90:91], v[90:91] op_sel_hi:[1,0,0]
    v_pk_fma_f32 v[190:191], v[190:191], v[90:91], v[90:91] op_sel_hi:[1,0,0]
    v_rcp_f32 v188, v188
    ds_read_b64_tr_b16 a[142:143], v37 offset:2560
    v_rcp_f32 v189, v189
    buffer_load_dwordx4 a[236:239], v62, s[40:43], s58 offen offset:1024 sc1
    v_rcp_f32 v190, v190
    v_rcp_f32 v191, v191
    v_pk_mul_f32 v[128:129], v[128:129], v[188:189]
    v_pk_mul_f32 v[130:131], v[130:131], v[190:191]
    buffer_load_dwordx4 a[240:243], v62, s[40:43], s81 offen offset:0 sc1
    v_cvt_pk_bf16_f32 v128, v128, v129
    v_cvt_pk_bf16_f32 v129, v130, v131
    v_pk_fma_f32 v[136:137], v[224:225], v[148:149], v[136:137] op_sel_hi:[1,0,1] neg_lo:[0,1,0] neg_hi:[0,1,0]
    v_add_u32 v38, 0x10000, v58
    v_pk_fma_f32 v[138:139], v[226:227], v[148:149], v[138:139] op_sel_hi:[1,0,1] neg_lo:[0,1,0] neg_hi:[0,1,0]
    v_pk_mul_f32 v[188:189], v[136:137], v[136:137]
    buffer_load_dwordx4 a[244:247], v62, s[40:43], s59 offen offset:0 sc1
    v_pk_mul_f32 v[190:191], v[138:139], v[138:139]
    v_pk_fma_f32 v[188:189], v[188:189], v[82:83], v[82:83] op_sel:[0,1,0] op_sel_hi:[1,1,0]
    v_add_u32 v39, 0x10000, v59
    v_pk_fma_f32 v[190:191], v[190:191], v[82:83], v[82:83] op_sel:[0,1,0] op_sel_hi:[1,1,0]
    v_pk_mul_f32 v[188:189], v[188:189], v[136:137]
    v_pk_mul_f32 v[190:191], v[190:191], v[138:139]
    buffer_load_dwordx4 a[248:251], v62, s[40:43], s81 offen offset:1024 sc1
    v_exp_f32 v188, v188
    ds_read_b64_tr_b16 a[80:81], v38 offset:0
    v_exp_f32 v189, v189
    v_exp_f32 v190, v190
    buffer_load_dwordx4 a[252:255], v62, s[40:43], s59 offen offset:1024 sc1
    v_exp_f32 v191, v191
    v_pk_fma_f32 v[188:189], v[188:189], v[90:91], v[90:91] op_sel_hi:[1,0,0]
    ds_read_b64_tr_b16 a[82:83], v38 offset:512
    v_pk_fma_f32 v[190:191], v[190:191], v[90:91], v[90:91] op_sel_hi:[1,0,0]
    v_rcp_f32 v188, v188
    buffer_load_dwordx4 v[84:87], v62, s[40:43], s82 offen offset:0 sc1
    v_rcp_f32 v189, v189
    v_rcp_f32 v190, v190
    ds_read_b64_tr_b16 a[84:85], v39 offset:0
    v_rcp_f32 v191, v191
    buffer_load_dwordx4 v[152:155], v62, s[40:43], s60 offen offset:0 sc1
    v_pk_mul_f32 v[136:137], v[136:137], v[188:189]
    v_pk_mul_f32 v[138:139], v[138:139], v[190:191]
    v_cvt_pk_bf16_f32 v130, v136, v137
    ds_read_b64_tr_b16 a[86:87], v39 offset:512
    v_cvt_pk_bf16_f32 v131, v138, v139
    buffer_store_dwordx4 v[128:131], v60, s[40:43], s71 offen offset:256 sc1
ahead_p3_4:
    s_cbranch_execz return_p3
    buffer_load_dword v67, v17, s[40:43], s62 offen offset:140 sc1
    v_pk_fma_f32 v[140:141], v[228:229], v[148:149], v[140:141] op_sel:[0,1,0] op_sel_hi:[1,1,1] neg_lo:[0,1,0] neg_hi:[0,1,0]
    v_pk_fma_f32 v[142:143], v[230:231], v[148:149], v[142:143] op_sel:[0,1,0] op_sel_hi:[1,1,1] neg_lo:[0,1,0] neg_hi:[0,1,0]
    v_pk_mul_f32 v[188:189], v[140:141], v[140:141]
    ds_read_b64_tr_b16 a[88:89], v38 offset:2048
    v_pk_mul_f32 v[190:191], v[142:143], v[142:143]
    v_pk_fma_f32 v[188:189], v[188:189], v[22:23], v[22:23] op_sel:[0,1,0] op_sel_hi:[1,1,0]
    buffer_load_dwordx4 v[156:159], v62, s[40:43], s82 offen offset:1024 sc1
    v_pk_fma_f32 v[190:191], v[190:191], v[22:23], v[22:23] op_sel:[0,1,0] op_sel_hi:[1,1,0]
    v_pk_mul_f32 v[188:189], v[188:189], v[140:141]
    ds_read_b64_tr_b16 a[90:91], v38 offset:2560
    v_pk_mul_f32 v[190:191], v[190:191], v[142:143]
    v_exp_f32 v188, v188
    buffer_load_dwordx4 v[160:163], v62, s[40:43], s60 offen offset:1024 sc1
    v_exp_f32 v189, v189
    v_exp_f32 v190, v190
    ds_read_b64_tr_b16 a[92:93], v39 offset:2048
    v_exp_f32 v191, v191
    buffer_load_dwordx4 v[164:167], v62, s[40:43], s83 offen offset:0 sc1
    v_pk_fma_f32 v[188:189], v[188:189], v[72:73], v[72:73] op_sel_hi:[1,0,0]
    v_pk_fma_f32 v[190:191], v[190:191], v[72:73], v[72:73] op_sel_hi:[1,0,0]
    v_rcp_f32 v188, v188
    ds_read_b64_tr_b16 a[94:95], v39 offset:2560
    v_rcp_f32 v189, v189
    buffer_load_dwordx4 v[168:171], v62, s[40:43], s61 offen offset:0 sc1
    v_rcp_f32 v190, v190
    v_rcp_f32 v191, v191
    v_pk_mul_f32 v[140:141], v[140:141], v[188:189]
    v_add_u32 v36, 0x14000, v58
    buffer_load_dwordx4 v[172:175], v62, s[40:43], s83 offen offset:1024 sc1
    v_pk_mul_f32 v[142:143], v[142:143], v[190:191]
    v_cvt_pk_bf16_f32 v140, v140, v141
    v_cvt_pk_bf16_f32 v141, v142, v143
    s_add_u32 s71, s94, 0x80000
    buffer_store_dwordx2 v[140:141], v61, s[40:43], s71 offen offset:0 sc1
    v_pk_fma_f32 v[144:145], v[228:229], v[148:149], v[144:145] op_sel_hi:[1,0,1] neg_lo:[0,1,0] neg_hi:[0,1,0]
    v_add_u32 v37, 0x14000, v59
    v_pk_fma_f32 v[146:147], v[230:231], v[148:149], v[146:147] op_sel_hi:[1,0,1] neg_lo:[0,1,0] neg_hi:[0,1,0]
    v_pk_mul_f32 v[188:189], v[144:145], v[144:145]
    v_pk_mul_f32 v[190:191], v[146:147], v[146:147]
    v_pk_fma_f32 v[188:189], v[188:189], v[82:83], v[82:83] op_sel:[0,1,0] op_sel_hi:[1,1,0]
    ds_read_b64_tr_b16 a[96:97], v36 offset:0
    buffer_load_dwordx4 v[176:179], v62, s[40:43], s61 offen offset:1024 sc1
    v_pk_fma_f32 v[190:191], v[190:191], v[82:83], v[82:83] op_sel:[0,1,0] op_sel_hi:[1,1,0]
    v_pk_mul_f32 v[188:189], v[188:189], v[144:145]
    v_pk_mul_f32 v[190:191], v[190:191], v[146:147]
    v_exp_f32 v188, v188
    ds_read_b64_tr_b16 a[98:99], v36 offset:512
    v_exp_f32 v189, v189
    v_exp_f32 v190, v190
    v_exp_f32 v191, v191
    v_pk_fma_f32 v[188:189], v[188:189], v[90:91], v[90:91] op_sel_hi:[1,0,0]
    ds_read_b64_tr_b16 a[100:101], v37 offset:0
    v_pk_fma_f32 v[190:191], v[190:191], v[90:91], v[90:91] op_sel_hi:[1,0,0]
    v_rcp_f32 v188, v188
    v_rcp_f32 v189, v189
    v_rcp_f32 v190, v190
    ds_read_b64_tr_b16 a[102:103], v37 offset:512
    v_rcp_f32 v191, v191
    v_pk_mul_f32 v[144:145], v[144:145], v[188:189]
    v_pk_mul_f32 v[146:147], v[146:147], v[190:191]
    v_cvt_pk_bf16_f32 v144, v144, v145
    ds_read_b64_tr_b16 a[104:105], v36 offset:2048
    v_cvt_pk_bf16_f32 v145, v146, v147
    buffer_store_dwordx2 v[144:145], v61, s[40:43], s71 offen offset:256 sc1
    s_waitcnt vmcnt(8)
    v_cmp_ne_u32 vcc, s95, v67
    s_nop 0
    s_cbranch_vccz polled_38
    s_mov_b32 s57, 0x40000
poll_37:
    buffer_load_dword v67, v17, s[40:43], s62 offen offset:140 sc1
    s_waitcnt vmcnt(0)
    v_cmp_ne_u32 vcc, s95, v67
    s_nop 0
    s_cbranch_vccz polled_38
    s_sub_u32 s57, s57, 1
    s_cbranch_scc0 poll_37
polled_38:
    v_mfma_f32_32x32x16_bf16 v[40:55], a[0:3], a[224:227], v[40:55]
    ds_read_b64_tr_b16 a[106:107], v36 offset:2560
    ds_read_b64_tr_b16 a[108:109], v37 offset:2048
    buffer_load_dwordx4 v[180:183], v63, s[40:43], s80 offen offset:0 sc1
    v_mfma_f32_32x32x16_bf16 v[204:219], a[4:7], a[224:227], 0
    ds_read_b64_tr_b16 a[110:111], v37 offset:2560
    v_add_u32 v38, 0x20000, v58
    v_add_u32 v39, 0x20000, v59
    buffer_load_dwordx4 v[184:187], v63, s[40:43], s58 offen offset:0 sc1
    v_mfma_f32_32x32x16_bf16 v[92:107], a[0:3], a[228:231], 0
    ds_read_b64_tr_b16 a[112:113], v38 offset:0
    ds_read_b64_tr_b16 a[114:115], v38 offset:512
    v_mfma_f32_32x32x16_bf16 v[108:123], a[4:7], a[228:231], 0
    ds_read_b64_tr_b16 a[116:117], v39 offset:0
    ds_read_b64_tr_b16 a[118:119], v39 offset:512
    ds_read_b64_tr_b16 a[120:121], v38 offset:2048
    buffer_load_dwordx4 v[232:235], v63, s[40:43], s80 offen offset:1024 sc1
    v_mfma_f32_32x32x16_bf16 v[92:107], a[8:11], a[236:239], v[92:107]
    ds_read_b64_tr_b16 a[122:123], v38 offset:2560
    ds_read_b64_tr_b16 a[124:125], v39 offset:2048
    buffer_load_dwordx4 v[236:239], v63, s[40:43], s58 offen offset:1024 sc1
    v_mfma_f32_32x32x16_bf16 v[108:123], a[12:15], a[236:239], v[108:123]
    ds_read_b64_tr_b16 a[126:127], v39 offset:2560
    buffer_load_dwordx4 v[240:243], v63, s[40:43], s81 offen offset:0 sc1
    v_mfma_f32_32x32x16_bf16 v[204:219], a[12:15], a[232:235], v[204:219]
    buffer_load_dwordx4 v[244:247], v63, s[40:43], s59 offen offset:0 sc1
    v_mfma_f32_32x32x16_bf16 v[40:55], a[8:11], a[232:235], v[40:55]
    buffer_load_dwordx4 v[248:251], v63, s[40:43], s81 offen offset:1024 sc1
    s_waitcnt vmcnt(7)
    buffer_store_dword v24, v2, s[40:43], s56 offen offset:144
    v_mfma_f32_32x32x16_bf16 v[92:107], a[16:19], a[244:247], v[92:107]
    v_mfma_f32_32x32x16_bf16 v[108:123], a[20:23], a[244:247], v[108:123]
    buffer_load_dwordx4 v[252:255], v63, s[40:43], s59 offen offset:1024 sc1
    v_mfma_f32_32x32x16_bf16 v[204:219], a[20:23], a[240:243], v[204:219]
    buffer_load_dwordx4 v[124:127], v63, s[40:43], s82 offen offset:0 sc1
    v_mfma_f32_32x32x16_bf16 v[40:55], a[16:19], a[240:243], v[40:55]
    buffer_load_dwordx4 v[128:131], v63, s[40:43], s60 offen offset:0 sc1
    v_mfma_f32_32x32x16_bf16 v[92:107], a[24:27], a[252:255], v[92:107]
    buffer_load_dwordx4 v[132:135], v63, s[40:43], s82 offen offset:1024 sc1
    v_mfma_f32_32x32x16_bf16 v[108:123], a[28:31], a[252:255], v[108:123]
    buffer_load_dwordx4 v[136:139], v63, s[40:43], s60 offen offset:1024 sc1
    v_mfma_f32_32x32x16_bf16 v[204:219], a[28:31], a[248:251], v[204:219]
    buffer_load_dwordx4 v[140:143], v63, s[40:43], s83 offen offset:0 sc1
    v_mfma_f32_32x32x16_bf16 v[40:55], a[24:27], a[248:251], v[40:55]
    buffer_load_dwordx4 v[144:147], v63, s[40:43], s61 offen offset:0 sc1
    v_mfma_f32_32x32x16_bf16 v[92:107], a[32:35], v[152:155], v[92:107]
    buffer_load_dwordx4 v[220:223], v63, s[40:43], s83 offen offset:1024 sc1
    v_mfma_f32_32x32x16_bf16 v[108:123], a[36:39], v[152:155], v[108:123]
    buffer_load_dwordx4 v[224:227], v63, s[40:43], s61 offen offset:1024 sc1
    v_mfma_f32_32x32x16_bf16 v[204:219], a[36:39], v[84:87], v[204:219]
    v_mfma_f32_32x32x16_bf16 v[40:55], a[32:35], v[84:87], v[40:55]
    v_mfma_f32_32x32x16_bf16 v[92:107], a[40:43], v[160:163], v[92:107]
    s_lshl_b32 s70, s44, 6
    s_lshr_b32 s73, s46, 1
    s_lshl_b32 s73, s73, 5
    s_add_u32 s70, s70, s73
    v_and_b32 v192, 15, v0
    v_mfma_f32_32x32x16_bf16 v[108:123], a[44:47], v[160:163], v[108:123]
    v_add_u32 v192, s70, v192
    v_lshlrev_b32 v192, 10, v192
    v_and_b32 v9, 16, v0
    v_lshl_add_u32 v192, v9, 1, v192
    v_lshrrev_b32 v9, 5, v0
    v_mfma_f32_32x32x16_bf16 v[204:219], a[44:47], v[156:159], v[204:219]
    v_lshl_add_u32 v192, v9, 4, v192
    s_lshl_b32 s70, s45, 7
    s_and_b32 s73, s46, 1
    s_lshl_b32 s73, s73, 6
    s_add_u32 s73, s70, s73
    v_mfma_f32_32x32x16_bf16 v[40:55], a[40:43], v[156:159], v[40:55]
    s_add_u32 s72, s73, 0x4000
    v_add_u32 v60, s49, v1
    v_xor_b32 v193, 4096, v60
    v_xor_b32 v194, 8192, v60
    v_xor_b32 v195, 12288, v60
    v_mfma_f32_32x32x16_bf16 v[92:107], a[48:51], v[168:171], v[92:107]
    v_mfma_f32_32x32x16_bf16 v[108:123], a[52:55], v[168:171], v[108:123]
    v_mfma_f32_32x32x16_bf16 v[204:219], a[52:55], v[164:167], v[204:219]
    v_mfma_f32_32x32x16_bf16 v[40:55], a[48:51], v[164:167], v[40:55]
    v_mfma_f32_32x32x16_bf16 v[92:107], a[56:59], v[176:179], v[92:107]
    v_mfma_f32_32x32x16_bf16 v[108:123], a[60:63], v[176:179], v[108:123]
    v_mfma_f32_32x32x16_bf16 v[204:219], a[60:63], v[172:175], v[204:219]
    v_mfma_f32_32x32x16_bf16 v[40:55], a[56:59], v[172:175], v[40:55]
    buffer_load_dword v68, v17, s[40:43], s62 offen offset:144 sc1
    s_waitcnt vmcnt(16)
    v_mfma_f32_32x32x16_bf16 v[92:107], a[64:67], v[184:187], v[92:107]
    v_mfma_f32_32x32x16_bf16 v[108:123], a[68:71], v[184:187], v[108:123]
    v_mfma_f32_32x32x16_bf16 v[204:219], a[68:71], v[180:183], v[204:219]
    v_mfma_f32_32x32x16_bf16 v[40:55], a[64:67], v[180:183], v[40:55]
    s_waitcnt vmcnt(14)
    v_mfma_f32_32x32x16_bf16 v[92:107], a[72:75], v[236:239], v[92:107]
    v_mfma_f32_32x32x16_bf16 v[108:123], a[76:79], v[236:239], v[108:123]
    v_mfma_f32_32x32x16_bf16 v[204:219], a[76:79], v[232:235], v[204:219]
    v_mfma_f32_32x32x16_bf16 v[40:55], a[72:75], v[232:235], v[40:55]
    s_waitcnt vmcnt(12) lgkmcnt(15)
    v_mfma_f32_32x32x16_bf16 v[92:107], a[80:83], v[244:247], v[92:107]
    v_mfma_f32_32x32x16_bf16 v[108:123], a[84:87], v[244:247], v[108:123]
    v_mfma_f32_32x32x16_bf16 v[204:219], a[84:87], v[240:243], v[204:219]
    v_mfma_f32_32x32x16_bf16 v[40:55], a[80:83], v[240:243], v[40:55]
    s_waitcnt vmcnt(0)
    v_cmp_ne_u32 vcc, s95, v68
    s_nop 0
    s_cbranch_vccz polled_40
    s_mov_b32 s57, 0x40000
poll_39:
    buffer_load_dword v68, v17, s[40:43], s62 offen offset:144 sc1
    s_waitcnt vmcnt(0)
    v_cmp_ne_u32 vcc, s95, v68
    s_nop 0
    s_cbranch_vccz polled_40
    s_sub_u32 s57, s57, 1
    s_cbranch_scc0 poll_39
polled_40:
    v_mfma_f32_32x32x16_bf16 v[92:107], a[88:91], v[252:255], v[92:107]
    buffer_load_dwordx4 v[228:231], v64, s[40:43], s80 offen offset:0 sc1
    v_mfma_f32_32x32x16_bf16 v[108:123], a[92:95], v[252:255], v[108:123]
    buffer_load_dwordx4 a[228:231], v64, s[40:43], s58 offen offset:0 sc1
    v_mfma_f32_32x32x16_bf16 v[204:219], a[92:95], v[248:251], v[204:219]
    buffer_load_dwordx4 a[224:227], v64, s[40:43], s80 offen offset:1024 sc1
    v_mfma_f32_32x32x16_bf16 v[40:55], a[88:91], v[248:251], v[40:55]
    buffer_load_dwordx4 a[236:239], v64, s[40:43], s58 offen offset:1024 sc1
    s_waitcnt lgkmcnt(14)
    v_mfma_f32_32x32x16_bf16 v[92:107], a[96:99], v[128:131], v[92:107]
    v_add_u32 v36, 0x0, v58
    v_add_u32 v37, 0x0, v59
    buffer_load_dwordx4 a[232:235], v64, s[40:43], s81 offen offset:0 sc1
    s_waitcnt lgkmcnt(12)
    v_mfma_f32_32x32x16_bf16 v[108:123], a[100:103], v[128:131], v[108:123]
    ds_read_b64_tr_b16 a[144:145], v36 offset:0
    ds_read_b64_tr_b16 a[146:147], v36 offset:512
    ds_read_b64_tr_b16 a[148:149], v37 offset:0
    buffer_load_dwordx4 a[244:247], v64, s[40:43], s59 offen offset:0 sc1
    v_mfma_f32_32x32x16_bf16 v[204:219], a[100:103], v[124:127], v[204:219]
    ds_read_b64_tr_b16 a[150:151], v37 offset:512
    ds_read_b64_tr_b16 a[152:153], v36 offset:2048
    buffer_load_dwordx4 a[240:243], v64, s[40:43], s81 offen offset:1024 sc1
    v_mfma_f32_32x32x16_bf16 v[40:55], a[96:99], v[124:127], v[40:55]
    ds_read_b64_tr_b16 a[154:155], v36 offset:2560
    ds_read_b64_tr_b16 a[156:157], v37 offset:2048
    ds_read_b64_tr_b16 a[158:159], v37 offset:2560
    buffer_load_dwordx4 a[252:255], v64, s[40:43], s59 offen offset:1024 sc1
    s_waitcnt lgkmcnt(15)
    v_mfma_f32_32x32x16_bf16 v[92:107], a[104:107], v[136:139], v[92:107]
    v_add_u32 v38, 0x4000, v58
    v_add_u32 v39, 0x4000, v59
    buffer_load_dwordx4 a[248:251], v64, s[40:43], s82 offen offset:0 sc1
    v_mfma_f32_32x32x16_bf16 v[108:123], a[108:111], v[136:139], v[108:123]
    ds_read_b64_tr_b16 a[160:161], v38 offset:0
    ds_read_b64_tr_b16 a[162:163], v38 offset:512
    ds_read_b64_tr_b16 a[164:165], v39 offset:0
    buffer_load_dwordx4 v[152:155], v64, s[40:43], s60 offen offset:0 sc1
    v_mfma_f32_32x32x16_bf16 v[204:219], a[108:111], v[132:135], v[204:219]
    ds_read_b64_tr_b16 a[166:167], v39 offset:512
    ds_read_b64_tr_b16 a[168:169], v38 offset:2048
    buffer_load_dwordx4 v[84:87], v64, s[40:43], s82 offen offset:1024 sc1
    v_mfma_f32_32x32x16_bf16 v[40:55], a[104:107], v[132:135], v[40:55]
    ds_read_b64_tr_b16 a[170:171], v38 offset:2560
    ds_read_b64_tr_b16 a[172:173], v39 offset:2048
    ds_read_b64_tr_b16 a[174:175], v39 offset:2560
    buffer_load_dwordx4 v[160:163], v64, s[40:43], s60 offen offset:1024 sc1
    s_waitcnt lgkmcnt(15)
    v_mfma_f32_32x32x16_bf16 v[92:107], a[112:115], v[144:147], v[92:107]
    v_mfma_f32_32x32x16_bf16 v[108:123], a[116:119], v[144:147], v[108:123]
    buffer_load_dwordx4 v[156:159], v64, s[40:43], s83 offen offset:0 sc1
    v_mfma_f32_32x32x16_bf16 v[204:219], a[116:119], v[140:143], v[204:219]
    buffer_load_dwordx4 v[168:171], v64, s[40:43], s61 offen offset:0 sc1
    v_mfma_f32_32x32x16_bf16 v[92:107], a[120:123], v[224:227], v[92:107]
    v_add_u32 v36, 0x8000, v58
    v_add_u32 v37, 0x8000, v59
    buffer_load_dwordx4 v[164:167], v64, s[40:43], s83 offen offset:1024 sc1
    v_mfma_f32_32x32x16_bf16 v[108:123], a[124:127], v[224:227], v[108:123]
    ds_read_b64_tr_b16 a[176:177], v36 offset:0
    ds_read_b64_tr_b16 a[178:179], v36 offset:512
    ds_read_b64_tr_b16 a[180:181], v37 offset:0
    buffer_load_dwordx4 v[176:179], v64, s[40:43], s61 offen offset:1024 sc1
    v_mfma_f32_32x32x16_bf16 v[204:219], a[124:127], v[220:223], v[204:219]
    ds_read_b64_tr_b16 a[182:183], v37 offset:512
    ds_read_b64_tr_b16 a[184:185], v36 offset:2048
    buffer_load_dwordx4 v[172:175], v65, s[40:43], s80 offen offset:0 sc1
    s_waitcnt vmcnt(15)
    v_mfma_f32_32x32x16_bf16 v[92:107], a[128:131], a[228:231], v[92:107]
    ds_read_b64_tr_b16 a[186:187], v36 offset:2560
    ds_read_b64_tr_b16 a[188:189], v37 offset:2048
    ds_read_b64_tr_b16 a[190:191], v37 offset:2560
    buffer_load_dwordx4 v[184:187], v65, s[40:43], s58 offen offset:0 sc1
    v_mfma_f32_32x32x16_bf16 v[108:123], a[132:135], a[228:231], v[108:123]
    v_mfma_f32_32x32x16_bf16 v[204:219], a[132:135], v[228:231], v[204:219]
    buffer_load_dwordx4 v[180:183], v65, s[40:43], s81 offen offset:0 sc1
    s_waitcnt vmcnt(15)
    v_mfma_f32_32x32x16_bf16 v[92:107], a[136:139], a[236:239], v[92:107]
    v_add_u32 v38, 0xc000, v58
    v_add_u32 v39, 0xc000, v59
    buffer_load_dwordx4 v[236:239], v65, s[40:43], s59 offen offset:0 sc1
    v_mfma_f32_32x32x16_bf16 v[108:123], a[140:143], a[236:239], v[108:123]
    ds_read_b64_tr_b16 a[192:193], v38 offset:0
    ds_read_b64_tr_b16 a[194:195], v38 offset:512
    ds_read_b64_tr_b16 a[196:197], v39 offset:0
    buffer_load_dwordx4 v[232:235], v65, s[40:43], s82 offen offset:0 sc1
    v_mfma_f32_32x32x16_bf16 v[204:219], a[140:143], a[224:227], v[204:219]
    ds_read_b64_tr_b16 a[198:199], v39 offset:512
    ds_read_b64_tr_b16 a[200:201], v38 offset:2048
    buffer_load_dwordx4 v[244:247], v65, s[40:43], s60 offen offset:0 sc1
    s_waitcnt vmcnt(16) lgkmcnt(15)
    v_mfma_f32_32x32x16_bf16 v[92:107], a[144:147], a[244:247], v[92:107]
    ds_read_b64_tr_b16 a[202:203], v38 offset:2560
    ds_read_b64_tr_b16 a[204:205], v39 offset:2048
    ds_read_b64_tr_b16 a[206:207], v39 offset:2560
    buffer_load_dwordx4 v[240:243], v65, s[40:43], s83 offen offset:0 sc1
    v_mfma_f32_32x32x16_bf16 v[108:123], a[148:151], a[244:247], v[108:123]
    v_mfma_f32_32x32x16_bf16 v[204:219], a[148:151], a[232:235], v[204:219]
    buffer_load_dwordx4 v[252:255], v65, s[40:43], s61 offen offset:0 sc1
    s_waitcnt vmcnt(16)
    v_mfma_f32_32x32x16_bf16 v[92:107], a[152:155], a[252:255], v[92:107]
    v_add_u32 v36, 0x18000, v58
    v_add_u32 v37, 0x18000, v59
    v_mfma_f32_32x32x16_bf16 v[108:123], a[156:159], a[252:255], v[108:123]
    ds_read_b64_tr_b16 a[208:209], v36 offset:0
    ds_read_b64_tr_b16 a[210:211], v36 offset:512
    ds_read_b64_tr_b16 a[212:213], v37 offset:0
    v_mfma_f32_32x32x16_bf16 v[204:219], a[156:159], a[240:243], v[204:219]
    ds_read_b64_tr_b16 a[214:215], v37 offset:512
    ds_read_b64_tr_b16 a[216:217], v36 offset:2048
    s_waitcnt vmcnt(14)
    v_mfma_f32_32x32x16_bf16 v[92:107], a[160:163], v[152:155], v[92:107]
    ds_read_b64_tr_b16 a[218:219], v36 offset:2560
    ds_read_b64_tr_b16 a[220:221], v37 offset:2048
    ds_read_b64_tr_b16 a[222:223], v37 offset:2560
    v_mfma_f32_32x32x16_bf16 v[108:123], a[164:167], v[152:155], v[108:123]
    s_waitcnt vmcnt(12)
    v_mfma_f32_32x32x16_bf16 v[92:107], a[168:171], v[160:163], v[92:107]
    s_waitcnt lgkmcnt(15)
    v_mfma_f32_32x32x16_bf16 v[108:123], a[172:175], v[160:163], v[108:123]
    s_waitcnt vmcnt(10)
    v_mfma_f32_32x32x16_bf16 v[92:107], a[176:179], v[168:171], v[92:107]
    v_mfma_f32_32x32x16_bf16 v[108:123], a[180:183], v[168:171], v[108:123]
    s_waitcnt vmcnt(8)
    v_mfma_f32_32x32x16_bf16 v[92:107], a[184:187], v[176:179], v[92:107]
    v_mfma_f32_32x32x16_bf16 v[108:123], a[188:191], v[176:179], v[108:123]
    s_waitcnt vmcnt(6) lgkmcnt(14)
    v_mfma_f32_32x32x16_bf16 v[92:107], a[192:195], v[184:187], v[92:107]
    s_waitcnt lgkmcnt(12)
    v_mfma_f32_32x32x16_bf16 v[108:123], a[196:199], v[184:187], v[108:123]
    s_waitcnt vmcnt(4) lgkmcnt(10)
    v_mfma_f32_32x32x16_bf16 v[92:107], a[200:203], v[236:239], v[92:107]
    s_waitcnt lgkmcnt(8)
    v_mfma_f32_32x32x16_bf16 v[108:123], a[204:207], v[236:239], v[108:123]
    s_waitcnt vmcnt(2) lgkmcnt(6)
    v_mfma_f32_32x32x16_bf16 v[92:107], a[208:211], v[244:247], v[92:107]
    s_waitcnt lgkmcnt(4)
    v_mfma_f32_32x32x16_bf16 v[108:123], a[212:215], v[244:247], v[108:123]
    s_waitcnt vmcnt(0) lgkmcnt(2)
    v_mfma_f32_32x32x16_bf16 v[92:107], a[216:219], v[252:255], v[92:107]
    s_waitcnt lgkmcnt(0)
    v_mfma_f32_32x32x16_bf16 v[108:123], a[220:223], v[252:255], v[108:123]
    v_mfma_f32_32x32x16_bf16 v[204:219], a[164:167], a[248:251], v[204:219]
    ds_write_b128 v60, v[92:95] offset:16384
    v_mfma_f32_32x32x16_bf16 v[204:219], a[172:175], v[84:87], v[204:219]
    ds_write_b128 v60, v[96:99] offset:17408
    v_mfma_f32_32x32x16_bf16 v[204:219], a[180:183], v[156:159], v[204:219]
    ds_write_b128 v60, v[100:103] offset:18432
    v_mfma_f32_32x32x16_bf16 v[204:219], a[188:191], v[164:167], v[204:219]
    ds_write_b128 v60, v[104:107] offset:19456
    v_mfma_f32_32x32x16_bf16 v[204:219], a[196:199], v[172:175], v[204:219]
    ds_write_b128 v60, v[108:111] offset:32768
    v_mfma_f32_32x32x16_bf16 v[204:219], a[204:207], v[180:183], v[204:219]
    ds_write_b128 v60, v[112:115] offset:33792
    v_mfma_f32_32x32x16_bf16 v[204:219], a[212:215], v[232:235], v[204:219]
    ds_write_b128 v60, v[116:119] offset:34816
    v_mfma_f32_32x32x16_bf16 v[204:219], a[220:223], v[240:243], v[204:219]
    ds_write_b128 v60, v[120:123] offset:35840
    v_mfma_f32_32x32x16_bf16 v[40:55], a[112:115], v[140:143], v[40:55]
    v_mfma_f32_32x32x16_bf16 v[40:55], a[120:123], v[220:223], v[40:55]
    v_mfma_f32_32x32x16_bf16 v[40:55], a[128:131], v[228:231], v[40:55]
    ds_write_b128 v60, v[204:207] offset:0
    v_mfma_f32_32x32x16_bf16 v[40:55], a[136:139], a[224:227], v[40:55]
    ds_write_b128 v60, v[208:211] offset:1024
    v_mfma_f32_32x32x16_bf16 v[40:55], a[144:147], a[232:235], v[40:55]
    ds_write_b128 v60, v[212:215] offset:2048
    v_mfma_f32_32x32x16_bf16 v[40:55], a[152:155], a[240:243], v[40:55]
    ds_write_b128 v60, v[216:219] offset:3072
    s_cmp_lg_u32 s46, 3
    s_cbranch_scc1 nowb_41
    s_and_b32 s70, s44, 3
    s_cmp_lg_u32 s70, 3
    s_cbranch_scc1 nowb_41
    s_cmp_lg_u32 s45, 0
    s_cbranch_scc1 nowb_41
    buffer_wbl2 sc1
    s_branch wbd_42
nowb_41:
    buffer_load_dword v69, v17, s[40:43], s62 offen offset:136
wbd_42:
    s_waitcnt lgkmcnt(0)
    s_barrier
    ds_read_b128 v[204:207], v193 offset:0
    ds_read_b128 v[208:211], v193 offset:1024
    ds_read_b128 v[212:215], v193 offset:2048
    ds_read_b128 v[216:219], v193 offset:3072
    ds_read_b128 v[92:95], v194 offset:16384
    ds_read_b128 v[96:99], v194 offset:17408
    ds_read_b128 v[100:103], v194 offset:18432
    ds_read_b128 v[104:107], v194 offset:19456
    ds_read_b128 v[108:111], v195 offset:32768
    ds_read_b128 v[112:115], v195 offset:33792
    ds_read_b128 v[116:119], v195 offset:34816
    ds_read_b128 v[120:123], v195 offset:35840
    v_mfma_f32_32x32x16_bf16 v[40:55], a[160:163], a[248:251], v[40:55]
    v_mfma_f32_32x32x16_bf16 v[40:55], a[168:171], v[84:87], v[40:55]
    v_mfma_f32_32x32x16_bf16 v[40:55], a[176:179], v[156:159], v[40:55]
    s_waitcnt lgkmcnt(7)
    v_pk_add_f32 v[204:205], v[204:205], v[92:93]
    v_pk_add_f32 v[206:207], v[206:207], v[94:95]
    s_waitcnt lgkmcnt(6)
    v_pk_add_f32 v[208:209], v[208:209], v[96:97]
    v_pk_add_f32 v[210:211], v[210:211], v[98:99]
    s_waitcnt lgkmcnt(5)
    v_pk_add_f32 v[212:213], v[212:213], v[100:101]
    v_mfma_f32_32x32x16_bf16 v[40:55], a[184:187], v[164:167], v[40:55]
    v_pk_add_f32 v[214:215], v[214:215], v[102:103]
    s_waitcnt lgkmcnt(4)
    v_pk_add_f32 v[216:217], v[216:217], v[104:105]
    v_pk_add_f32 v[218:219], v[218:219], v[106:107]
    s_waitcnt lgkmcnt(3)
    v_pk_add_f32 v[204:205], v[204:205], v[108:109]
    v_pk_add_f32 v[206:207], v[206:207], v[110:111]
    v_mfma_f32_32x32x16_bf16 v[40:55], a[192:195], v[172:175], v[40:55]
    s_waitcnt lgkmcnt(2)
    v_pk_add_f32 v[208:209], v[208:209], v[112:113]
    v_pk_add_f32 v[210:211], v[210:211], v[114:115]
    s_waitcnt lgkmcnt(1)
    v_pk_add_f32 v[212:213], v[212:213], v[116:117]
    v_pk_add_f32 v[214:215], v[214:215], v[118:119]
    s_waitcnt lgkmcnt(0)
    v_pk_add_f32 v[216:217], v[216:217], v[120:121]
    v_mfma_f32_32x32x16_bf16 v[40:55], a[200:203], v[180:183], v[40:55]
    v_pk_add_f32 v[218:219], v[218:219], v[122:123]
    v_mfma_f32_32x32x16_bf16 v[40:55], a[208:211], v[232:235], v[40:55]
    v_mfma_f32_32x32x16_bf16 v[40:55], a[216:219], v[240:243], v[40:55]
    s_nop 11
    v_pk_add_f32 v[40:41], v[40:41], v[204:205]
    v_pk_add_f32 v[42:43], v[42:43], v[206:207]
    v_pk_add_f32 v[44:45], v[44:45], v[208:209]
    v_pk_add_f32 v[46:47], v[46:47], v[210:211]
    v_cvt_pk_bf16_f32 v92, v40, v41
    v_cvt_pk_bf16_f32 v93, v42, v43
    v_cvt_pk_bf16_f32 v94, v44, v45
    v_cvt_pk_bf16_f32 v95, v46, v47
    s_nop 0
    v_permlane32_swap_b32 v92, v94
    v_permlane32_swap_b32 v93, v95
    v_pk_add_f32 v[48:49], v[48:49], v[212:213]
    v_pk_add_f32 v[50:51], v[50:51], v[214:215]
    v_pk_add_f32 v[52:53], v[52:53], v[216:217]
    v_pk_add_f32 v[54:55], v[54:55], v[218:219]
    v_cvt_pk_bf16_f32 v96, v48, v49
    v_cvt_pk_bf16_f32 v97, v50, v51
    v_cvt_pk_bf16_f32 v98, v52, v53
    v_cvt_pk_bf16_f32 v99, v54, v55
    s_nop 0
    v_permlane32_swap_b32 v96, v98
    v_permlane32_swap_b32 v97, v99
    s_nop 0
    v_permlane16_swap_b32 v92, v96
    v_permlane16_swap_b32 v93, v97
    v_permlane16_swap_b32 v94, v98
    v_permlane16_swap_b32 v95, v99
    buffer_store_dwordx4 v[92:95], v192, s[32:35], s73 offen sc1
    buffer_store_dwordx4 v[96:99], v192, s[32:35], s72 offen sc1
    s_endpgm
SLOW_TAIL:
    buffer_store_dword v24, v2, s[40:43], s56 offen offset:12 sc1
    buffer_store_dwordx4 v[212:215], v90, s[40:43], s58 offen sc1
    buffer_store_dwordx4 v[216:219], v90, s[40:43], s59 offen sc1
    v_xor_b32 v32, 0, v19
    v_xor_b32 v33, 32, v19
    v_xor_b32 v34, 64, v19
    v_xor_b32 v35, 96, v19
    ds_read_b64_tr_b16 a[0:1], v32 offset:32768
    ds_read_b64_tr_b16 a[2:3], v32 offset:40960
    ds_read_b64_tr_b16 a[4:5], v33 offset:32768
    ds_read_b64_tr_b16 a[6:7], v33 offset:40960
    ds_read_b64_tr_b16 a[8:9], v34 offset:32768
    ds_read_b64_tr_b16 a[10:11], v34 offset:40960
    s_add_u32 m0, s49, 0x14000
    v_add_u32 v16, s85, v76
    buffer_load_dwordx4 v16, s[16:19], 0 offen offset:0 lds
    ds_read_b64_tr_b16 a[12:13], v35 offset:32768
    ds_read_b64_tr_b16 a[14:15], v35 offset:40960
    ds_read_b64_tr_b16 a[16:17], v32 offset:33792
    v_add_u32 v36, 0x20000, v32
    ds_read_b64_tr_b16 a[18:19], v32 offset:41984
    v_add_u32 v37, 0x20000, v33
    ds_read_b64_tr_b16 a[20:21], v33 offset:33792
    v_add_u32 v38, 0x20000, v34
    ds_read_b64_tr_b16 a[22:23], v33 offset:41984
    buffer_load_dwordx4 v16, s[16:19], s53 offen offset:1024 lds
    ds_read_b64_tr_b16 a[24:25], v34 offset:33792
    v_add_u32 v39, 0x20000, v35
    ds_read_b64_tr_b16 a[26:27], v34 offset:41984
    s_add_u32 s70, s78, 0x28080
    ds_read_b64_tr_b16 a[28:29], v35 offset:33792
    v_and_b32 v192, 31, v0
    ds_read_b64_tr_b16 a[30:31], v35 offset:41984
    v_lshlrev_b32 v27, 10, v192
    ds_read_b64_tr_b16 a[32:33], v32 offset:34816
    v_mov_b32 v193, 0x40000000
    ds_read_b64_tr_b16 a[34:35], v32 offset:43008
    buffer_load_dwordx4 v16, s[16:19], s54 offen offset:2048 lds
    ds_read_b64_tr_b16 a[36:37], v33 offset:34816
    v_lshlrev_b32 v40, 16, v80
    ds_read_b64_tr_b16 a[38:39], v33 offset:43008
    v_and_b32 v41, 0xffff0000, v80
    ds_read_b64_tr_b16 a[40:41], v34 offset:34816
    v_lshlrev_b32 v42, 16, v81
    ds_read_b64_tr_b16 a[42:43], v34 offset:43008
    v_and_b32 v43, 0xffff0000, v81
    ds_read_b64_tr_b16 a[44:45], v35 offset:34816
    v_lshlrev_b32 v44, 16, v82
    ds_read_b64_tr_b16 a[46:47], v35 offset:43008
    buffer_load_dwordx4 v16, s[16:19], s55 offen offset:3072 lds
    ds_read_b64_tr_b16 a[48:49], v32 offset:35840
    v_and_b32 v45, 0xffff0000, v82
    ds_read_b64_tr_b16 a[50:51], v32 offset:44032
    v_lshlrev_b32 v46, 16, v83
    ds_read_b64_tr_b16 a[52:53], v33 offset:35840
    v_and_b32 v47, 0xffff0000, v83
    ds_read_b64_tr_b16 a[54:55], v33 offset:44032
    v_lshlrev_b32 v48, 16, v84
    ds_read_b64_tr_b16 a[56:57], v34 offset:35840
    v_and_b32 v49, 0xffff0000, v84
    ds_read_b64_tr_b16 a[58:59], v34 offset:44032
    s_add_u32 m0, s49, 0x18000
    v_add_u32 v16, s86, v76
    buffer_load_dwordx4 v16, s[16:19], 0 offen offset:0 lds
    ds_read_b64_tr_b16 a[60:61], v35 offset:35840
    v_lshlrev_b32 v50, 16, v85
    ds_read_b64_tr_b16 a[62:63], v35 offset:44032
    v_and_b32 v51, 0xffff0000, v85
    ds_read_b64_tr_b16 a[64:65], v36 offset:0
    v_lshlrev_b32 v52, 16, v86
    ds_read_b64_tr_b16 a[66:67], v36 offset:8192
    v_and_b32 v53, 0xffff0000, v86
    ds_read_b64_tr_b16 a[68:69], v37 offset:0
    v_lshlrev_b32 v54, 16, v87
    ds_read_b64_tr_b16 a[70:71], v37 offset:8192
    buffer_load_dwordx4 v16, s[16:19], s53 offen offset:1024 lds
    ds_read_b64_tr_b16 a[72:73], v38 offset:0
    v_and_b32 v55, 0xffff0000, v87
    ds_read_b64_tr_b16 a[74:75], v38 offset:8192
    v_lshlrev_b32 v13, 12, v4
    ds_read_b64_tr_b16 a[76:77], v39 offset:0
    v_lshl_add_u32 v13, v5, 4, v13
    ds_read_b64_tr_b16 a[78:79], v39 offset:8192
    s_mul_i32 s48, s46, 7168
    ds_read_b64_tr_b16 a[80:81], v36 offset:1024
    s_bfe_u32 s71, s44, 0x10001
    ds_read_b64_tr_b16 a[82:83], v36 offset:9216
    buffer_load_dwordx4 v16, s[16:19], s54 offen offset:2048 lds
    ds_read_b64_tr_b16 a[84:85], v37 offset:1024
    s_lshl1_add_u32 s71, s46, s71
    ds_read_b64_tr_b16 a[86:87], v37 offset:9216
    s_mul_i32 s71, s71, 28672
    ds_read_b64_tr_b16 a[88:89], v38 offset:1024
    s_mul_i32 s72, s45, 448
    ds_read_b64_tr_b16 a[90:91], v38 offset:9216
    s_andn2_b32 s72, s72, 127
    ds_read_b64_tr_b16 a[92:93], v39 offset:1024
    s_add_u32 s71, s71, s72
    ds_read_b64_tr_b16 a[94:95], v39 offset:9216
    buffer_load_dwordx4 v16, s[16:19], s55 offen offset:3072 lds
    ds_read_b64_tr_b16 a[96:97], v36 offset:2048
    v_lshrrev_b32 v194, 2, v0
    ds_read_b64_tr_b16 a[98:99], v36 offset:10240
    v_mul_u32_u24 v194, 0xe00, v194
    ds_read_b64_tr_b16 a[100:101], v37 offset:2048
    v_and_b32 v195, 3, v0
    ds_read_b64_tr_b16 a[102:103], v37 offset:10240
    v_lshl_add_u32 v194, v195, 7, v194
    ds_read_b64_tr_b16 a[104:105], v38 offset:2048
    v_add_u32 v194, s71, v194
    ds_read_b64_tr_b16 a[106:107], v38 offset:10240
    s_add_u32 m0, s49, 0x1c000
    v_add_u32 v16, s87, v76
    buffer_load_dwordx4 v16, s[16:19], 0 offen offset:0 lds
    ds_read_b64_tr_b16 a[108:109], v39 offset:2048
    v_cmp_gt_u32 vcc, 32, v0
    ds_read_b64_tr_b16 a[110:111], v39 offset:10240
    s_nop 0
    v_cndmask_b32 v21, v193, v194, vcc
    ds_read_b64_tr_b16 a[112:113], v36 offset:3072
    s_and_b32 s77, s44, 1
    ds_read_b64_tr_b16 a[114:115], v36 offset:11264
    s_mul_i32 s77, s77, 917504
    ds_read_b64_tr_b16 a[116:117], v37 offset:3072
    s_lshl_b32 s58, s88, 4
    ds_read_b64_tr_b16 a[118:119], v37 offset:11264
    buffer_load_dwordx4 v16, s[16:19], s53 offen offset:1024 lds
    ds_read_b64_tr_b16 a[120:121], v38 offset:3072
    s_add_u32 s58, s58, s63
    ds_read_b64_tr_b16 a[122:123], v38 offset:11264
    s_add_u32 s58, s58, 0x30000
    ds_read_b64_tr_b16 a[124:125], v39 offset:3072
    s_lshl_b32 s59, s89, 4
    ds_read_b64_tr_b16 a[126:127], v39 offset:11264
    s_add_u32 s59, s59, s63
    ds_read_b64_tr_b16 a[128:129], v36 offset:16384
    s_add_u32 s59, s59, 0x30000
    ds_read_b64_tr_b16 a[130:131], v36 offset:24576
    buffer_load_dwordx4 v16, s[16:19], s54 offen offset:2048 lds
    ds_read_b64_tr_b16 a[132:133], v37 offset:16384
    s_lshl_b32 s60, s90, 4
    ds_read_b64_tr_b16 a[134:135], v37 offset:24576
    s_add_u32 s60, s60, s63
    ds_read_b64_tr_b16 a[136:137], v38 offset:16384
    s_add_u32 s60, s60, 0x30000
    ds_read_b64_tr_b16 a[138:139], v38 offset:24576
    s_lshl_b32 s61, s91, 4
    ds_read_b64_tr_b16 a[140:141], v39 offset:16384
    s_add_u32 s61, s61, s63
    ds_read_b64_tr_b16 a[142:143], v39 offset:24576
    buffer_load_dwordx4 v16, s[16:19], s55 offen offset:3072 lds
    s_waitcnt vmcnt(12)
    buffer_store_dword v24, v2, s[40:43], s56 offen offset:128 sc1
    ds_read_b64_tr_b16 a[144:145], v36 offset:17408
    s_add_u32 s61, s61, 0x30000
    ds_read_b64_tr_b16 a[146:147], v36 offset:25600
    ds_read_b64_tr_b16 a[148:149], v37 offset:17408
    ds_read_b64_tr_b16 a[150:151], v37 offset:25600
    ds_read_b64_tr_b16 a[152:153], v38 offset:17408
    ds_read_b64_tr_b16 a[154:155], v38 offset:25600
    ds_read_b64_tr_b16 a[156:157], v39 offset:17408
    ds_read_b64_tr_b16 a[158:159], v39 offset:25600
    ds_read_b64_tr_b16 a[160:161], v36 offset:18432
    ds_read_b64_tr_b16 a[162:163], v36 offset:26624
    ds_read_b64_tr_b16 a[164:165], v37 offset:18432
    ds_read_b64_tr_b16 a[166:167], v37 offset:26624
    ds_read_b64_tr_b16 a[168:169], v38 offset:18432
    ds_read_b64_tr_b16 a[170:171], v38 offset:26624
    ds_read_b64_tr_b16 a[172:173], v39 offset:18432
    ds_read_b64_tr_b16 a[174:175], v39 offset:26624
    ds_read_b64_tr_b16 a[176:177], v36 offset:19456
    ds_read_b64_tr_b16 a[178:179], v36 offset:27648
    ds_read_b64_tr_b16 a[180:181], v37 offset:19456
    ds_read_b64_tr_b16 a[182:183], v37 offset:27648
    ds_read_b64_tr_b16 a[184:185], v38 offset:19456
    ds_read_b64_tr_b16 a[186:187], v38 offset:27648
    ds_read_b64_tr_b16 a[188:189], v39 offset:19456
    ds_read_b64_tr_b16 a[190:191], v39 offset:27648
    buffer_load_dword v8, v27, s[40:43], s70 offen sc1
    buffer_load_dword v74, v17, s[40:43], 0 offen offset:12 sc1
    ds_read_b64_tr_b16 a[192:193], v32 offset:0
    ds_read_b64_tr_b16 a[194:195], v32 offset:8192
    ds_read_b64_tr_b16 a[196:197], v33 offset:0
    ds_read_b64_tr_b16 a[198:199], v33 offset:8192
    ds_read_b64_tr_b16 a[200:201], v34 offset:0
    ds_read_b64_tr_b16 a[202:203], v34 offset:8192
    ds_read_b64_tr_b16 a[204:205], v35 offset:0
    ds_read_b64_tr_b16 a[206:207], v35 offset:8192
    ds_read_b64_tr_b16 a[208:209], v32 offset:1024
    ds_read_b64_tr_b16 a[210:211], v32 offset:9216
    ds_read_b64_tr_b16 a[212:213], v33 offset:1024
    ds_read_b64_tr_b16 a[214:215], v33 offset:9216
    ds_read_b64_tr_b16 a[216:217], v34 offset:1024
    ds_read_b64_tr_b16 a[218:219], v34 offset:9216
    ds_read_b64_tr_b16 a[220:221], v35 offset:1024
    ds_read_b64_tr_b16 a[222:223], v35 offset:9216
    ds_read_b64_tr_b16 a[224:225], v32 offset:2048
    ds_read_b64_tr_b16 a[226:227], v32 offset:10240
    ds_read_b64_tr_b16 a[228:229], v33 offset:2048
    ds_read_b64_tr_b16 a[230:231], v33 offset:10240
    ds_read_b64_tr_b16 a[232:233], v34 offset:2048
    ds_read_b64_tr_b16 a[234:235], v34 offset:10240
    ds_read_b64_tr_b16 a[236:237], v35 offset:2048
    ds_read_b64_tr_b16 a[238:239], v35 offset:10240
    ds_read_b64_tr_b16 a[240:241], v32 offset:3072
    ds_read_b64_tr_b16 a[242:243], v32 offset:11264
    ds_read_b64_tr_b16 a[244:245], v33 offset:3072
    ds_read_b64_tr_b16 a[246:247], v33 offset:11264
    ds_read_b64_tr_b16 a[248:249], v34 offset:3072
    ds_read_b64_tr_b16 a[250:251], v34 offset:11264
    ds_read_b64_tr_b16 a[252:253], v35 offset:3072
    ds_read_b64_tr_b16 a[254:255], v35 offset:11264
    s_waitcnt vmcnt(1)
    v_cmp_ne_u32 vcc, s95, v8
    s_nop 0
    s_cbranch_vccz polled_44
    s_mov_b32 s57, 0x40000
poll_43:
    buffer_load_dword v8, v27, s[40:43], s70 offen sc1
    s_waitcnt vmcnt(0)
    v_cmp_ne_u32 vcc, s95, v8
    s_nop 0
    s_cbranch_vccz polled_44
    s_sub_u32 s57, s57, 1
    s_cbranch_scc0 poll_43
polled_44:
    buffer_load_dwordx4 v[92:95], v1, s[40:43], s58 offen offset:0 sc1
    s_lshr_b32 s70, s46, 1
    s_lshl_b32 s70, s70, 5
    s_and_b32 s71, s46, 1
    s_lshl_b32 s71, s71, 4
    s_add_u32 s70, s70, s71
    s_mul_i32 s71, s45, 448
    v_mov_b32 v192, v0
    v_mul_u32_u24 v193, 0x925, v192
    v_lshrrev_b32 v193, 16, v193
    v_mul_u32_u24 v194, 28, v193
    v_sub_u32 v192, v192, v194
    v_lshrrev_b32 v194, 1, v193
    buffer_load_dwordx4 v[96:99], v1, s[40:43], s58 offen offset:1024 sc1
    v_and_b32 v194, 2, v194
    v_xor_b32 v192, v192, v194
    v_add_u32 v193, s70, v193
    v_mul_u32_u24 v193, 0xe00, v193
    v_lshl_add_u32 v192, v192, 4, v193
    v_add_u32 v192, s71, v192
    v_subrev_u32 v196, 0, v192
    v_add_u32 v192, 64, v0
    v_mul_u32_u24 v193, 0x925, v192
    v_lshrrev_b32 v193, 16, v193
    v_mul_u32_u24 v194, 28, v193
    v_sub_u32 v192, v192, v194
    buffer_load_dwordx4 v[100:103], v1, s[40:43], s58 offen offset:2048 sc1
    v_lshrrev_b32 v194, 1, v193
    v_and_b32 v194, 2, v194
    v_xor_b32 v192, v192, v194
    v_add_u32 v193, s70, v193
    v_mul_u32_u24 v193, 0xe00, v193
    v_lshl_add_u32 v192, v192, 4, v193
    v_add_u32 v192, s71, v192
    v_subrev_u32 v197, 1024, v192
    v_add_u32 v192, 128, v0
    v_mul_u32_u24 v193, 0x925, v192
    v_lshrrev_b32 v193, 16, v193
    v_mul_u32_u24 v194, 28, v193
    buffer_load_dwordx4 v[104:107], v1, s[40:43], s58 offen offset:3072 sc1
    s_waitcnt lgkmcnt(0)
    s_barrier
    v_sub_u32 v192, v192, v194
    v_lshrrev_b32 v194, 1, v193
    v_and_b32 v194, 2, v194
    v_xor_b32 v192, v192, v194
    v_add_u32 v193, s70, v193
    v_mul_u32_u24 v193, 0xe00, v193
    v_lshl_add_u32 v192, v192, 4, v193
    v_add_u32 v192, s71, v192
    v_subrev_u32 v198, 2048, v192
    v_add_u32 v192, 192, v0
    v_mul_u32_u24 v193, 0x925, v192
    v_lshrrev_b32 v193, 16, v193
    buffer_load_dwordx4 v[108:111], v1, s[40:43], s59 offen offset:0 sc1
    v_mul_u32_u24 v194, 28, v193
    v_sub_u32 v192, v192, v194
    v_lshrrev_b32 v194, 1, v193
    v_and_b32 v194, 2, v194
    v_xor_b32 v192, v192, v194
    v_add_u32 v193, s70, v193
    v_mul_u32_u24 v193, 0xe00, v193
    v_lshl_add_u32 v192, v192, 4, v193
    v_add_u32 v192, s71, v192
    v_subrev_u32 v199, 3072, v192
    v_add_u32 v192, 256, v0
    v_mul_u32_u24 v193, 0x925, v192
    buffer_load_dwordx4 v[112:115], v1, s[40:43], s59 offen offset:1024 sc1
    v_lshrrev_b32 v193, 16, v193
    v_mul_u32_u24 v194, 28, v193
    v_sub_u32 v192, v192, v194
    v_lshrrev_b32 v194, 1, v193
    v_and_b32 v194, 2, v194
    v_xor_b32 v192, v192, v194
    v_add_u32 v193, s70, v193
    v_mul_u32_u24 v193, 0xe00, v193
    v_lshl_add_u32 v192, v192, 4, v193
    v_add_u32 v192, s71, v192
    v_subrev_u32 v200, 0, v192
    v_add_u32 v192, 320, v0
    buffer_load_dwordx4 v[116:119], v1, s[40:43], s59 offen offset:2048 sc1
    v_mul_u32_u24 v193, 0x925, v192
    v_lshrrev_b32 v193, 16, v193
    v_mul_u32_u24 v194, 28, v193
    v_sub_u32 v192, v192, v194
    v_lshrrev_b32 v194, 1, v193
    v_and_b32 v194, 2, v194
    v_xor_b32 v192, v192, v194
    v_add_u32 v193, s70, v193
    v_mul_u32_u24 v193, 0xe00, v193
    v_lshl_add_u32 v192, v192, 4, v193
    v_add_u32 v192, s71, v192
    v_subrev_u32 v201, 1024, v192
    buffer_load_dwordx4 v[120:123], v1, s[40:43], s59 offen offset:3072 sc1
    v_add_u32 v192, 384, v0
    v_mul_u32_u24 v193, 0x925, v192
    v_lshrrev_b32 v193, 16, v193
    v_mul_u32_u24 v194, 28, v193
    v_sub_u32 v192, v192, v194
    v_lshrrev_b32 v194, 1, v193
    v_and_b32 v194, 2, v194
    v_xor_b32 v192, v192, v194
    v_add_u32 v193, s70, v193
    v_mul_u32_u24 v193, 0xe00, v193
    v_lshl_add_u32 v192, v192, 4, v193
    v_add_u32 v192, s71, v192
    buffer_load_dwordx4 v[124:127], v1, s[40:43], s60 offen offset:0 sc1
    v_subrev_u32 v202, 2048, v192
    s_waitcnt vmcnt(8)
    v_mfma_f32_16x16x32_bf16 v[40:43], a[0:3], v[92:95], v[40:43]
    s_lshr_b32 s72, s88, 5
    buffer_load_dwordx4 v[128:131], v1, s[40:43], s60 offen offset:1024 sc1
    v_mfma_f32_16x16x32_bf16 v[44:47], a[4:7], v[92:95], v[44:47]
    s_lshr_b32 s72, 0x02fe01ff, s72
    v_mfma_f32_16x16x32_bf16 v[48:51], a[8:11], v[92:95], v[48:51]
    s_sext_i32_i8 s72, s72
    v_mfma_f32_16x16x32_bf16 v[52:55], a[12:15], v[92:95], v[52:55]
    s_add_u32 s72, s72, s79
    s_waitcnt vmcnt(8)
    v_mfma_f32_16x16x32_bf16 v[40:43], a[16:19], v[96:99], v[40:43]
    v_add_u32 v192, s72, v5
    buffer_load_dwordx4 v[132:135], v1, s[40:43], s60 offen offset:2048 sc1
    v_mfma_f32_16x16x32_bf16 v[44:47], a[20:23], v[96:99], v[44:47]
    v_lshrrev_b32 v193, 6, v192
    v_mfma_f32_16x16x32_bf16 v[48:51], a[24:27], v[96:99], v[48:51]
    v_cmp_eq_u32 vcc, s44, v193
    v_mfma_f32_16x16x32_bf16 v[52:55], a[28:31], v[96:99], v[52:55]
    v_mov_b32 v194, 0x70000
    s_waitcnt vmcnt(8)
    v_mfma_f32_16x16x32_bf16 v[40:43], a[32:35], v[100:103], v[40:43]
    v_mov_b32 v195, 0x30000
    buffer_load_dwordx4 v[136:139], v1, s[40:43], s60 offen offset:3072 sc1
    v_mfma_f32_16x16x32_bf16 v[44:47], a[36:39], v[100:103], v[44:47]
    v_cndmask_b32 v194, v194, v195, vcc
    v_mfma_f32_16x16x32_bf16 v[48:51], a[40:43], v[100:103], v[48:51]
    v_lshl_add_u32 v194, v193, 20, v194
    v_mfma_f32_16x16x32_bf16 v[52:55], a[44:47], v[100:103], v[52:55]
    v_bfe_u32 v193, v192, 4, 2
    s_waitcnt vmcnt(8)
    v_mfma_f32_16x16x32_bf16 v[40:43], a[48:51], v[104:107], v[40:43]
    v_lshl_add_u32 v194, v193, 14, v194
    buffer_load_dwordx4 v[140:143], v1, s[40:43], s61 offen offset:0 sc1
    v_mfma_f32_16x16x32_bf16 v[44:47], a[52:55], v[104:107], v[44:47]
    v_and_b32 v193, 15, v192
    v_mfma_f32_16x16x32_bf16 v[48:51], a[56:59], v[104:107], v[48:51]
    v_lshl_add_u32 v193, v4, 4, v193
    v_mfma_f32_16x16x32_bf16 v[52:55], a[60:63], v[104:107], v[52:55]
    v_and_b32 v195, 1, v192
    s_waitcnt vmcnt(8)
    v_mfma_f32_16x16x32_bf16 v[40:43], a[64:67], v[108:111], v[40:43]
    v_lshl_add_u32 v195, v4, 1, v195
    buffer_load_dwordx4 v[144:147], v1, s[40:43], s61 offen offset:1024 sc1
    v_mfma_f32_16x16x32_bf16 v[44:47], a[68:71], v[108:111], v[44:47]
    v_cndmask_b32 v193, v195, v193, vcc
    v_mfma_f32_16x16x32_bf16 v[48:51], a[72:75], v[108:111], v[48:51]
    v_lshl_add_u32 v194, v193, 4, v194
    v_mfma_f32_16x16x32_bf16 v[52:55], a[76:79], v[108:111], v[52:55]
    v_mov_b32 v193, 0x40000000
    s_waitcnt vmcnt(8)
    v_mfma_f32_16x16x32_bf16 v[40:43], a[80:83], v[112:115], v[40:43]
    v_cmp_gt_u32 vcc, 0x800, v192
    buffer_load_dwordx4 v[148:151], v1, s[40:43], s61 offen offset:2048 sc1
    v_mfma_f32_16x16x32_bf16 v[44:47], a[84:87], v[112:115], v[44:47]
    v_cndmask_b32 v203, v193, v194, vcc
    v_mfma_f32_16x16x32_bf16 v[48:51], a[88:91], v[112:115], v[48:51]
    s_lshr_b32 s72, s89, 5
    v_mfma_f32_16x16x32_bf16 v[52:55], a[92:95], v[112:115], v[52:55]
    s_lshr_b32 s72, 0x02fe01ff, s72
    s_waitcnt vmcnt(8)
    v_mfma_f32_16x16x32_bf16 v[40:43], a[96:99], v[116:119], v[40:43]
    s_sext_i32_i8 s72, s72
    buffer_load_dwordx4 v[152:155], v1, s[40:43], s61 offen offset:3072 sc1
    v_mfma_f32_16x16x32_bf16 v[44:47], a[100:103], v[116:119], v[44:47]
    s_add_u32 s72, s72, s79
    v_mfma_f32_16x16x32_bf16 v[48:51], a[104:107], v[116:119], v[48:51]
    v_add_u32 v192, s72, v5
    v_mfma_f32_16x16x32_bf16 v[52:55], a[108:111], v[116:119], v[52:55]
    v_lshrrev_b32 v193, 6, v192
    s_waitcnt vmcnt(8)
    v_mfma_f32_16x16x32_bf16 v[40:43], a[112:115], v[120:123], v[40:43]
    v_cmp_eq_u32 vcc, s44, v193
    v_mfma_f32_16x16x32_bf16 v[44:47], a[116:119], v[120:123], v[44:47]
    s_add_u32 m0, s49, 0x0
    v_add_u32 v16, s84, v76
    buffer_load_dwordx4 v16, s[20:23], 0 offen offset:0 lds
    v_mfma_f32_16x16x32_bf16 v[48:51], a[120:123], v[120:123], v[48:51]
    v_mov_b32 v194, 0x70000
    v_mfma_f32_16x16x32_bf16 v[52:55], a[124:127], v[120:123], v[52:55]
    v_mov_b32 v195, 0x30000
    s_waitcnt vmcnt(8)
    v_mfma_f32_16x16x32_bf16 v[40:43], a[128:131], v[124:127], v[40:43]
    v_cndmask_b32 v194, v194, v195, vcc
    v_mfma_f32_16x16x32_bf16 v[44:47], a[132:135], v[124:127], v[44:47]
    v_lshl_add_u32 v194, v193, 20, v194
    v_mfma_f32_16x16x32_bf16 v[48:51], a[136:139], v[124:127], v[48:51]
    buffer_load_dwordx4 v16, s[20:23], s53 offen offset:1024 lds
    v_mfma_f32_16x16x32_bf16 v[52:55], a[140:143], v[124:127], v[52:55]
    v_bfe_u32 v193, v192, 4, 2
    s_waitcnt vmcnt(8)
    v_mfma_f32_16x16x32_bf16 v[40:43], a[144:147], v[128:131], v[40:43]
    v_lshl_add_u32 v194, v193, 14, v194
    v_mfma_f32_16x16x32_bf16 v[44:47], a[148:151], v[128:131], v[44:47]
    v_and_b32 v193, 15, v192
    v_mfma_f32_16x16x32_bf16 v[48:51], a[152:155], v[128:131], v[48:51]
    v_lshl_add_u32 v193, v4, 4, v193
    v_mfma_f32_16x16x32_bf16 v[52:55], a[156:159], v[128:131], v[52:55]
    buffer_load_dwordx4 v16, s[20:23], s54 offen offset:2048 lds
    s_waitcnt vmcnt(8)
    v_mfma_f32_16x16x32_bf16 v[40:43], a[160:163], v[132:135], v[40:43]
    v_and_b32 v195, 1, v192
    v_mfma_f32_16x16x32_bf16 v[44:47], a[164:167], v[132:135], v[44:47]
    v_lshl_add_u32 v195, v4, 1, v195
    v_mfma_f32_16x16x32_bf16 v[48:51], a[168:171], v[132:135], v[48:51]
    v_cndmask_b32 v193, v195, v193, vcc
    v_mfma_f32_16x16x32_bf16 v[52:55], a[172:175], v[132:135], v[52:55]
    v_lshl_add_u32 v194, v193, 4, v194
    s_waitcnt vmcnt(7)
    v_mfma_f32_16x16x32_bf16 v[40:43], a[176:179], v[136:139], v[40:43]
    buffer_load_dwordx4 v16, s[20:23], s55 offen offset:3072 lds
    v_mfma_f32_16x16x32_bf16 v[44:47], a[180:183], v[136:139], v[44:47]
    v_mov_b32 v193, 0x40000000
    v_mfma_f32_16x16x32_bf16 v[48:51], a[184:187], v[136:139], v[48:51]
    v_cmp_gt_u32 vcc, 0x800, v192
    v_mfma_f32_16x16x32_bf16 v[52:55], a[188:191], v[136:139], v[52:55]
    v_cndmask_b32 v204, v193, v194, vcc
    s_waitcnt vmcnt(7)
    v_mfma_f32_16x16x32_bf16 v[40:43], a[192:195], v[140:143], v[40:43]
    v_mfma_f32_16x16x32_bf16 v[44:47], a[196:199], v[140:143], v[44:47]
    s_add_u32 m0, s49, 0x4000
    v_add_u32 v16, s85, v76
    buffer_load_dwordx4 v16, s[20:23], 0 offen offset:0 lds
    v_mfma_f32_16x16x32_bf16 v[48:51], a[200:203], v[140:143], v[48:51]
    v_mfma_f32_16x16x32_bf16 v[52:55], a[204:207], v[140:143], v[52:55]
    s_waitcnt vmcnt(7)
    v_mfma_f32_16x16x32_bf16 v[40:43], a[208:211], v[144:147], v[40:43]
    v_mfma_f32_16x16x32_bf16 v[44:47], a[212:215], v[144:147], v[44:47]
    v_mfma_f32_16x16x32_bf16 v[48:51], a[216:219], v[144:147], v[48:51]
    buffer_load_dwordx4 v16, s[20:23], s53 offen offset:1024 lds
    v_mfma_f32_16x16x32_bf16 v[52:55], a[220:223], v[144:147], v[52:55]
    s_waitcnt vmcnt(7)
    v_mfma_f32_16x16x32_bf16 v[40:43], a[224:227], v[148:151], v[40:43]
    v_mfma_f32_16x16x32_bf16 v[44:47], a[228:231], v[148:151], v[44:47]
    v_mfma_f32_16x16x32_bf16 v[48:51], a[232:235], v[148:151], v[48:51]
    v_mfma_f32_16x16x32_bf16 v[52:55], a[236:239], v[148:151], v[52:55]
    buffer_load_dwordx4 v16, s[20:23], s54 offen offset:2048 lds
    s_waitcnt vmcnt(7)
    v_mfma_f32_16x16x32_bf16 v[40:43], a[240:243], v[152:155], v[40:43]
    v_mfma_f32_16x16x32_bf16 v[44:47], a[244:247], v[152:155], v[44:47]
    v_mfma_f32_16x16x32_bf16 v[48:51], a[248:251], v[152:155], v[48:51]
    v_mfma_f32_16x16x32_bf16 v[52:55], a[252:255], v[152:155], v[52:55]
    v_cmp_ne_u32 vcc, s95, v74
    s_and_b64 vcc, vcc, s[50:51]
    s_cbranch_vccz polled_46
    s_mov_b32 s57, 0x40000
poll_45:
    buffer_load_dword v74, v17, s[40:43], 0 offen offset:12 sc1
    s_waitcnt vmcnt(0)
    v_cmp_ne_u32 vcc, s95, v74
    s_and_b64 vcc, vcc, s[50:51]
    s_cbranch_vccz polled_46
    s_sub_u32 s57, s57, 1
    s_cbranch_scc0 poll_45
polled_46:
    s_add_u32 s71, s96, 0x0
    v_cvt_pk_bf16_f32 v172, v40, v41
    v_cvt_pk_bf16_f32 v173, v42, v43
    v_cvt_pk_bf16_f32 v174, v44, v45
    v_cvt_pk_bf16_f32 v175, v46, v47
    buffer_store_dwordx4 v[172:175], v1, s[40:43], s71 offen offset:0 sc1
    v_cvt_pk_bf16_f32 v176, v48, v49
    v_cvt_pk_bf16_f32 v177, v50, v51
    v_cvt_pk_bf16_f32 v178, v52, v53
    v_cvt_pk_bf16_f32 v179, v54, v55
    buffer_store_dwordx4 v[176:179], v1, s[40:43], s71 offen offset:1024 sc1
    v_mfma_f32_16x16x32_bf16 v[184:187], v[172:175], v[172:175], 0
    v_mfma_f32_16x16x32_bf16 v[180:183], v[28:31], v[172:175], 0
    v_mfma_f32_16x16x32_bf16 v[184:187], v[176:179], v[176:179], v[184:187]
    v_mfma_f32_16x16x32_bf16 v[180:183], v[28:31], v[176:179], v[180:183]
    v_add_u32 v36, 0x10000, v32
    buffer_load_dwordx4 v16, s[20:23], s55 offen offset:3072 lds
    v_add_u32 v37, 0x10000, v33
    v_add_u32 v38, 0x10000, v34
    v_add_u32 v39, 0x10000, v35
    s_barrier
    ds_read_b64_tr_b16 a[0:1], v36 offset:0
    ds_read_b64_tr_b16 a[2:3], v36 offset:8192
    ds_read_b64_tr_b16 a[4:5], v37 offset:0
    ds_read_b64_tr_b16 a[6:7], v37 offset:8192
    ds_read_b64_tr_b16 a[8:9], v38 offset:0
    ds_read_b64_tr_b16 a[10:11], v38 offset:8192
    s_add_u32 m0, s49, 0xc000
    v_add_u32 v16, s87, v76
    buffer_load_dwordx4 v16, s[20:23], 0 offen offset:0 lds
    ds_read_b64_tr_b16 a[12:13], v39 offset:0
    ds_read_b64_tr_b16 a[14:15], v39 offset:8192
    ds_read_b64_tr_b16 a[16:17], v36 offset:1024
    ds_read_b64_tr_b16 a[18:19], v36 offset:9216
    ds_read_b64_tr_b16 a[20:21], v37 offset:1024
    ds_read_b64_tr_b16 a[22:23], v37 offset:9216
    ds_read_b64_tr_b16 a[24:25], v38 offset:1024
    v_cndmask_b32 v181, v184, v185, s[64:65]
    ds_read_b64_tr_b16 a[26:27], v38 offset:9216
    buffer_load_dwordx4 v16, s[20:23], s53 offen offset:1024 lds
    ds_read_b64_tr_b16 a[28:29], v39 offset:1024
    v_cndmask_b32 v181, v181, v186, s[66:67]
    ds_read_b64_tr_b16 a[30:31], v39 offset:9216
    v_cndmask_b32 v181, v181, v187, s[68:69]
    s_waitcnt lgkmcnt(14)
    v_mfma_f32_16x16x32_bf16 v[156:159], a[0:3], v[28:31], 0
    v_mov_b32 v182, s95
    s_lshl_b32 s70, s46, 10
    s_waitcnt lgkmcnt(12)
    v_mfma_f32_16x16x32_bf16 v[160:163], a[4:7], v[28:31], 0
    s_add_u32 s70, s70, s78
    s_add_u32 s70, s70, 0x28000
    s_waitcnt lgkmcnt(10)
    v_mfma_f32_16x16x32_bf16 v[164:167], a[8:11], v[28:31], 0
    buffer_load_dwordx4 v16, s[20:23], s54 offen offset:2048 lds
    s_add_u32 s71, s70, 0x4000
    s_waitcnt lgkmcnt(8)
    v_mfma_f32_16x16x32_bf16 v[168:171], a[12:15], v[28:31], 0
    s_lshl_b32 s58, s88, 4
    s_add_u32 s58, s58, s97
    ds_read_b64_tr_b16 a[32:33], v36 offset:2048
    s_lshl_b32 s59, s89, 4
    ds_read_b64_tr_b16 a[34:35], v36 offset:10240
    s_add_u32 s59, s59, s97
    ds_read_b64_tr_b16 a[36:37], v37 offset:2048
    s_lshl_b32 s60, s90, 4
    ds_read_b64_tr_b16 a[38:39], v37 offset:10240
    buffer_load_dwordx4 v16, s[20:23], s55 offen offset:3072 lds
    ds_read_b64_tr_b16 a[40:41], v38 offset:2048
    s_add_u32 s60, s60, s97
    ds_read_b64_tr_b16 a[42:43], v38 offset:10240
    s_lshl_b32 s61, s91, 4
    ds_read_b64_tr_b16 a[44:45], v39 offset:2048
    s_add_u32 s61, s61, s97
    ds_read_b64_tr_b16 a[46:47], v39 offset:10240
    s_waitcnt lgkmcnt(14)
    v_mfma_f32_16x16x32_bf16 v[156:159], a[16:19], v[28:31], v[156:159]
    s_waitcnt lgkmcnt(12)
    v_mfma_f32_16x16x32_bf16 v[160:163], a[20:23], v[28:31], v[160:163]
    s_add_u32 m0, s49, 0x8000
    v_add_u32 v16, s86, v76
    buffer_load_dwordx4 v16, s[20:23], 0 offen offset:0 lds
    s_waitcnt lgkmcnt(10)
    v_mfma_f32_16x16x32_bf16 v[164:167], a[24:27], v[28:31], v[164:167]
    s_waitcnt lgkmcnt(8)
    v_mfma_f32_16x16x32_bf16 v[168:171], a[28:31], v[28:31], v[168:171]
    ds_read_b64_tr_b16 a[48:49], v36 offset:3072
    ds_read_b64_tr_b16 a[50:51], v36 offset:11264
    ds_read_b64_tr_b16 a[52:53], v37 offset:3072
    ds_read_b64_tr_b16 a[54:55], v37 offset:11264
    ds_read_b64_tr_b16 a[56:57], v38 offset:3072
    buffer_load_dwordx4 v16, s[20:23], s53 offen offset:1024 lds
    ds_read_b64_tr_b16 a[58:59], v38 offset:11264
    ds_read_b64_tr_b16 a[60:61], v39 offset:3072
    ds_read_b64_tr_b16 a[62:63], v39 offset:11264
    s_waitcnt lgkmcnt(14)
    v_mfma_f32_16x16x32_bf16 v[156:159], a[32:35], v[28:31], v[156:159]
    s_waitcnt lgkmcnt(12)
    v_mfma_f32_16x16x32_bf16 v[160:163], a[36:39], v[28:31], v[160:163]
    s_waitcnt lgkmcnt(10)
    v_mfma_f32_16x16x32_bf16 v[164:167], a[40:43], v[28:31], v[164:167]
    buffer_load_dwordx4 v16, s[20:23], s54 offen offset:2048 lds
    s_waitcnt lgkmcnt(8)
    v_mfma_f32_16x16x32_bf16 v[168:171], a[44:47], v[28:31], v[168:171]
    ds_read_b64_tr_b16 a[64:65], v36 offset:16384
    ds_read_b64_tr_b16 a[66:67], v36 offset:24576
    ds_read_b64_tr_b16 a[68:69], v37 offset:16384
    ds_read_b64_tr_b16 a[70:71], v37 offset:24576
    ds_read_b64_tr_b16 a[72:73], v38 offset:16384
    ds_read_b64_tr_b16 a[74:75], v38 offset:24576
    ds_read_b64_tr_b16 a[76:77], v39 offset:16384
    buffer_load_dwordx4 v16, s[20:23], s55 offen offset:3072 lds
    ds_read_b64_tr_b16 a[78:79], v39 offset:24576
    s_waitcnt lgkmcnt(14)
    v_mfma_f32_16x16x32_bf16 v[156:159], a[48:51], v[28:31], v[156:159]
    s_waitcnt lgkmcnt(12)
    v_mfma_f32_16x16x32_bf16 v[160:163], a[52:55], v[28:31], v[160:163]
    s_waitcnt lgkmcnt(10)
    v_mfma_f32_16x16x32_bf16 v[164:167], a[56:59], v[28:31], v[164:167]
    s_waitcnt lgkmcnt(8)
    v_mfma_f32_16x16x32_bf16 v[168:171], a[60:63], v[28:31], v[168:171]
    s_add_u32 m0, s48, 0x20000
    s_add_u32 s3, s77, 0x0
    buffer_load_dwordx4 v196, s[24:27], s3 offen offset:0 lds
    ds_read_b64_tr_b16 a[80:81], v36 offset:17408
    ds_read_b64_tr_b16 a[82:83], v36 offset:25600
    ds_read_b64_tr_b16 a[84:85], v37 offset:17408
    ds_read_b64_tr_b16 a[86:87], v37 offset:25600
    ds_read_b64_tr_b16 a[88:89], v38 offset:17408
    ds_read_b64_tr_b16 a[90:91], v38 offset:25600
    ds_read_b64_tr_b16 a[92:93], v39 offset:17408
    ds_read_b64_tr_b16 a[94:95], v39 offset:25600
    buffer_load_dwordx4 v197, s[24:27], s3 offen offset:1024 lds
    s_waitcnt lgkmcnt(14)
    v_mfma_f32_16x16x32_bf16 v[156:159], a[64:67], v[28:31], v[156:159]
    s_waitcnt lgkmcnt(12)
    v_mfma_f32_16x16x32_bf16 v[160:163], a[68:71], v[28:31], v[160:163]
    s_waitcnt lgkmcnt(10)
    v_mfma_f32_16x16x32_bf16 v[164:167], a[72:75], v[28:31], v[164:167]
    s_waitcnt lgkmcnt(8)
    v_mfma_f32_16x16x32_bf16 v[168:171], a[76:79], v[28:31], v[168:171]
    ds_read_b64_tr_b16 a[96:97], v36 offset:18432
    buffer_load_dwordx4 v198, s[24:27], s3 offen offset:2048 lds
    ds_read_b64_tr_b16 a[98:99], v36 offset:26624
    ds_read_b64_tr_b16 a[100:101], v37 offset:18432
    ds_read_b64_tr_b16 a[102:103], v37 offset:26624
    ds_read_b64_tr_b16 a[104:105], v38 offset:18432
    ds_read_b64_tr_b16 a[106:107], v38 offset:26624
    ds_read_b64_tr_b16 a[108:109], v39 offset:18432
    ds_read_b64_tr_b16 a[110:111], v39 offset:26624
    s_waitcnt lgkmcnt(14)
    v_mfma_f32_16x16x32_bf16 v[156:159], a[80:83], v[28:31], v[156:159]
    buffer_load_dwordx4 v199, s[24:27], s3 offen offset:3072 lds
    s_waitcnt lgkmcnt(12)
    v_mfma_f32_16x16x32_bf16 v[160:163], a[84:87], v[28:31], v[160:163]
    s_waitcnt lgkmcnt(10)
    v_mfma_f32_16x16x32_bf16 v[164:167], a[88:91], v[28:31], v[164:167]
    s_waitcnt lgkmcnt(8)
    v_mfma_f32_16x16x32_bf16 v[168:171], a[92:95], v[28:31], v[168:171]
    ds_read_b64_tr_b16 a[112:113], v36 offset:19456
    ds_read_b64_tr_b16 a[114:115], v36 offset:27648
    ds_read_b64_tr_b16 a[116:117], v37 offset:19456
    s_add_u32 m0, s48, 0x21000
    s_nop 0
    buffer_load_dwordx4 v200, s[24:27], s3 offen offset:0 lds
    ds_read_b64_tr_b16 a[118:119], v37 offset:27648
    ds_read_b64_tr_b16 a[120:121], v38 offset:19456
    ds_read_b64_tr_b16 a[122:123], v38 offset:27648
    ds_read_b64_tr_b16 a[124:125], v39 offset:19456
    ds_read_b64_tr_b16 a[126:127], v39 offset:27648
    s_waitcnt lgkmcnt(14)
    v_mfma_f32_16x16x32_bf16 v[156:159], a[96:99], v[28:31], v[156:159]
    s_waitcnt lgkmcnt(12)
    v_mfma_f32_16x16x32_bf16 v[160:163], a[100:103], v[28:31], v[160:163]
    buffer_load_dwordx4 v201, s[24:27], s3 offen offset:1024 lds
    s_waitcnt lgkmcnt(10)
    v_mfma_f32_16x16x32_bf16 v[164:167], a[104:107], v[28:31], v[164:167]
    s_waitcnt lgkmcnt(8)
    v_mfma_f32_16x16x32_bf16 v[168:171], a[108:111], v[28:31], v[168:171]
    s_waitcnt vmcnt(15)
    buffer_store_dwordx3 v[180:182], v26, s[40:43], s56 offen offset:256 sc1
    ds_read_b64_tr_b16 a[128:129], v36 offset:32768
    ds_read_b64_tr_b16 a[130:131], v36 offset:40960
    ds_read_b64_tr_b16 a[132:133], v37 offset:32768
    ds_read_b64_tr_b16 a[134:135], v37 offset:40960
    ds_read_b64_tr_b16 a[136:137], v38 offset:32768
    ds_read_b64_tr_b16 a[138:139], v38 offset:40960
    ds_read_b64_tr_b16 a[140:141], v39 offset:32768
    ds_read_b64_tr_b16 a[142:143], v39 offset:40960
    s_waitcnt lgkmcnt(14)
    v_mfma_f32_16x16x32_bf16 v[156:159], a[112:115], v[28:31], v[156:159]
    s_waitcnt lgkmcnt(12)
    v_mfma_f32_16x16x32_bf16 v[160:163], a[116:119], v[28:31], v[160:163]
    s_waitcnt lgkmcnt(10)
    v_mfma_f32_16x16x32_bf16 v[164:167], a[120:123], v[28:31], v[164:167]
    s_waitcnt lgkmcnt(8)
    v_mfma_f32_16x16x32_bf16 v[168:171], a[124:127], v[28:31], v[168:171]
    ds_read_b64_tr_b16 a[144:145], v36 offset:33792
    ds_read_b64_tr_b16 a[146:147], v36 offset:41984
    ds_read_b64_tr_b16 a[148:149], v37 offset:33792
    ds_read_b64_tr_b16 a[150:151], v37 offset:41984
    ds_read_b64_tr_b16 a[152:153], v38 offset:33792
    ds_read_b64_tr_b16 a[154:155], v38 offset:41984
    ds_read_b64_tr_b16 a[156:157], v39 offset:33792
    ds_read_b64_tr_b16 a[158:159], v39 offset:41984
    s_waitcnt lgkmcnt(14)
    v_mfma_f32_16x16x32_bf16 v[156:159], a[128:131], v[28:31], v[156:159]
    s_waitcnt lgkmcnt(12)
    v_mfma_f32_16x16x32_bf16 v[160:163], a[132:135], v[28:31], v[160:163]
    s_waitcnt lgkmcnt(10)
    v_mfma_f32_16x16x32_bf16 v[164:167], a[136:139], v[28:31], v[164:167]
    s_waitcnt lgkmcnt(8)
    v_mfma_f32_16x16x32_bf16 v[168:171], a[140:143], v[28:31], v[168:171]
    ds_read_b64_tr_b16 a[160:161], v36 offset:34816
    ds_read_b64_tr_b16 a[162:163], v36 offset:43008
    ds_read_b64_tr_b16 a[164:165], v37 offset:34816
    ds_read_b64_tr_b16 a[166:167], v37 offset:43008
    ds_read_b64_tr_b16 a[168:169], v38 offset:34816
    ds_read_b64_tr_b16 a[170:171], v38 offset:43008
    ds_read_b64_tr_b16 a[172:173], v39 offset:34816
    ds_read_b64_tr_b16 a[174:175], v39 offset:43008
    buffer_load_dwordx3 v[172:174], v13, s[40:43], s70 offen offset:256 sc1
    buffer_load_dwordx3 v[176:178], v13, s[40:43], s71 offen offset:256 sc1
    ds_read_b64_tr_b16 a[176:177], v36 offset:35840
    ds_read_b64_tr_b16 a[178:179], v36 offset:44032
    ds_read_b64_tr_b16 a[180:181], v37 offset:35840
    ds_read_b64_tr_b16 a[182:183], v37 offset:44032
    ds_read_b64_tr_b16 a[184:185], v38 offset:35840
    ds_read_b64_tr_b16 a[186:187], v38 offset:44032
    ds_read_b64_tr_b16 a[188:189], v39 offset:35840
    ds_read_b64_tr_b16 a[190:191], v39 offset:44032
    ds_read_b64_tr_b16 a[192:193], v36 offset:49152
    ds_read_b64_tr_b16 a[194:195], v36 offset:57344
    ds_read_b64_tr_b16 a[196:197], v37 offset:49152
    ds_read_b64_tr_b16 a[198:199], v37 offset:57344
    ds_read_b64_tr_b16 a[200:201], v38 offset:49152
    ds_read_b64_tr_b16 a[202:203], v38 offset:57344
    ds_read_b64_tr_b16 a[204:205], v39 offset:49152
    ds_read_b64_tr_b16 a[206:207], v39 offset:57344
    ds_read_b64_tr_b16 a[208:209], v36 offset:50176
    ds_read_b64_tr_b16 a[210:211], v36 offset:58368
    ds_read_b64_tr_b16 a[212:213], v37 offset:50176
    ds_read_b64_tr_b16 a[214:215], v37 offset:58368
    ds_read_b64_tr_b16 a[216:217], v38 offset:50176
    ds_read_b64_tr_b16 a[218:219], v38 offset:58368
    ds_read_b64_tr_b16 a[220:221], v39 offset:50176
    ds_read_b64_tr_b16 a[222:223], v39 offset:58368
    ds_read_b64_tr_b16 a[224:225], v36 offset:51200
    ds_read_b64_tr_b16 a[226:227], v36 offset:59392
    ds_read_b64_tr_b16 a[228:229], v37 offset:51200
    ds_read_b64_tr_b16 a[230:231], v37 offset:59392
    ds_read_b64_tr_b16 a[232:233], v38 offset:51200
    ds_read_b64_tr_b16 a[234:235], v38 offset:59392
    ds_read_b64_tr_b16 a[236:237], v39 offset:51200
    ds_read_b64_tr_b16 a[238:239], v39 offset:59392
    ds_read_b64_tr_b16 a[240:241], v36 offset:52224
    ds_read_b64_tr_b16 a[242:243], v36 offset:60416
    ds_read_b64_tr_b16 a[244:245], v37 offset:52224
    ds_read_b64_tr_b16 a[246:247], v37 offset:60416
    ds_read_b64_tr_b16 a[248:249], v38 offset:52224
    ds_read_b64_tr_b16 a[250:251], v38 offset:60416
    ds_read_b64_tr_b16 a[252:253], v39 offset:52224
    ds_read_b64_tr_b16 a[254:255], v39 offset:60416
    s_waitcnt vmcnt(1)
    v_cmp_ne_u32 vcc, s95, v174
    s_waitcnt vmcnt(0)
    v_cmp_ne_u32 s[74:75], s95, v178
    s_or_b64 vcc, vcc, s[74:75]
    s_cbranch_vccz polled_48
    s_mov_b32 s57, 0x40000
poll_47:
    buffer_load_dwordx3 v[172:174], v13, s[40:43], s70 offen offset:256 sc1
    buffer_load_dwordx3 v[176:178], v13, s[40:43], s71 offen offset:256 sc1
    s_waitcnt vmcnt(1)
    v_cmp_ne_u32 vcc, s95, v174
    s_waitcnt vmcnt(0)
    v_cmp_ne_u32 s[74:75], s95, v178
    s_or_b64 vcc, vcc, s[74:75]
    s_cbranch_vccz polled_48
    s_sub_u32 s57, s57, 1
    s_cbranch_scc0 poll_47
polled_48:
    buffer_load_dwordx4 v[92:95], v1, s[40:43], s58 offen offset:0 sc1
    s_waitcnt lgkmcnt(15)
    v_mfma_f32_16x16x32_bf16 v[156:159], a[144:147], v[28:31], v[156:159]
    v_add_f32 v172, v172, v176
    v_add_f32 v173, v173, v177
    v_mfma_f32_16x16x32_bf16 v[160:163], a[148:151], v[28:31], v[160:163]
    v_permlane32_swap_b32 v172, v173
    v_add_f32 v172, v172, v173
    v_mfma_f32_16x16x32_bf16 v[164:167], a[152:155], v[28:31], v[164:167]
    v_mov_b32 v173, v172
    s_nop 1
    v_permlane16_swap_b32 v172, v173
    v_mfma_f32_16x16x32_bf16 v[168:171], a[156:159], v[28:31], v[168:171]
    v_add_f32 v172, v172, v173
    v_mov_b32 v173, v172
    buffer_load_dwordx4 v[96:99], v1, s[40:43], s58 offen offset:1024 sc1
    v_mfma_f32_16x16x32_bf16 v[156:159], a[160:163], v[28:31], v[156:159]
    v_permlane32_swap_b32 v172, v173
    v_mul_f32 v7, 0x3b000000, v172
    v_mfma_f32_16x16x32_bf16 v[160:163], a[164:167], v[28:31], v[160:163]
    v_mul_f32 v173, 0x3b000000, v173
    v_fma_f32 v173, -v7, v7, v173
    v_mfma_f32_16x16x32_bf16 v[164:167], a[168:171], v[28:31], v[164:167]
    v_max_f32 v173, 0, v173
    v_add_f32 v12, 0x3727c5ac, v173
    v_mfma_f32_16x16x32_bf16 v[168:171], a[172:175], v[28:31], v[168:171]
    v_rsq_f32 v12, v12
    s_nop 0
    v_mul_f32 v192, v12, v12
    buffer_load_dwordx4 v[100:103], v1, s[40:43], s58 offen offset:2048 sc1
    v_mfma_f32_16x16x32_bf16 v[156:159], a[176:179], v[28:31], v[156:159]
    v_mul_f32 v192, v192, v173
    v_add_f32 v192, 0x3727c5ac, v192
    v_mfma_f32_16x16x32_bf16 v[160:163], a[180:183], v[28:31], v[160:163]
    v_rsq_f32 v192, v192
    s_nop 0
    v_mul_f32 v192, v192, v12
    v_mfma_f32_16x16x32_bf16 v[164:167], a[184:187], v[28:31], v[164:167]
    v_mul_f32 v22, 0xc0135761, v192
    v_mul_f32 v23, v192, v192
    v_mfma_f32_16x16x32_bf16 v[168:171], a[188:191], v[28:31], v[168:171]
    v_mul_f32 v23, v23, v22
    v_mul_f32 v23, 0x3d372713, v23
    buffer_load_dwordx4 v[104:107], v1, s[40:43], s58 offen offset:3072 sc1
    s_waitcnt lgkmcnt(0)
    s_barrier
    v_mfma_f32_16x16x32_bf16 v[156:159], a[192:195], v[28:31], v[156:159]
    v_rcp_f32 v72, v192
    v_mfma_f32_16x16x32_bf16 v[160:163], a[196:199], v[28:31], v[160:163]
    v_mfma_f32_16x16x32_bf16 v[164:167], a[200:203], v[28:31], v[164:167]
    v_mfma_f32_16x16x32_bf16 v[168:171], a[204:207], v[28:31], v[168:171]
    buffer_load_dwordx4 v[108:111], v1, s[40:43], s59 offen offset:0 sc1
    v_mfma_f32_16x16x32_bf16 v[156:159], a[208:211], v[28:31], v[156:159]
    v_mfma_f32_16x16x32_bf16 v[160:163], a[212:215], v[28:31], v[160:163]
    v_mfma_f32_16x16x32_bf16 v[164:167], a[216:219], v[28:31], v[164:167]
    v_mfma_f32_16x16x32_bf16 v[168:171], a[220:223], v[28:31], v[168:171]
    buffer_load_dwordx4 v[112:115], v1, s[40:43], s59 offen offset:1024 sc1
    v_mfma_f32_16x16x32_bf16 v[156:159], a[224:227], v[28:31], v[156:159]
    v_mfma_f32_16x16x32_bf16 v[160:163], a[228:231], v[28:31], v[160:163]
    v_mfma_f32_16x16x32_bf16 v[164:167], a[232:235], v[28:31], v[164:167]
    v_mfma_f32_16x16x32_bf16 v[168:171], a[236:239], v[28:31], v[168:171]
    buffer_load_dwordx4 v[116:119], v1, s[40:43], s59 offen offset:2048 sc1
    v_mfma_f32_16x16x32_bf16 v[156:159], a[240:243], v[28:31], v[156:159]
    v_mfma_f32_16x16x32_bf16 v[160:163], a[244:247], v[28:31], v[160:163]
    v_mfma_f32_16x16x32_bf16 v[164:167], a[248:251], v[28:31], v[164:167]
    v_mfma_f32_16x16x32_bf16 v[168:171], a[252:255], v[28:31], v[168:171]
    buffer_load_dwordx4 v[120:123], v1, s[40:43], s59 offen offset:3072 sc1
    v_mul_f32 v56, -v7, v156
    v_mul_f32 v57, -v7, v157
    v_mul_f32 v58, -v7, v158
    v_mul_f32 v59, -v7, v159
    v_mul_f32 v60, -v7, v160
    v_mul_f32 v61, -v7, v161
    v_mul_f32 v62, -v7, v162
    v_mul_f32 v63, -v7, v163
    v_mul_f32 v64, -v7, v164
    v_mul_f32 v65, -v7, v165
    v_mul_f32 v66, -v7, v166
    v_mul_f32 v67, -v7, v167
    v_mul_f32 v68, -v7, v168
    v_mul_f32 v69, -v7, v169
    v_mul_f32 v70, -v7, v170
    v_mul_f32 v71, -v7, v171
    buffer_load_dwordx4 v[124:127], v1, s[40:43], s60 offen offset:0 sc1
    s_waitcnt vmcnt(8)
    v_mfma_f32_16x16x32_bf16 v[56:59], a[0:3], v[92:95], v[56:59]
    s_lshr_b32 s72, s90, 5
    buffer_load_dwordx4 v[128:131], v1, s[40:43], s60 offen offset:1024 sc1
    v_mfma_f32_16x16x32_bf16 v[60:63], a[4:7], v[92:95], v[60:63]
    s_lshr_b32 s72, 0x02fe01ff, s72
    v_mfma_f32_16x16x32_bf16 v[64:67], a[8:11], v[92:95], v[64:67]
    s_sext_i32_i8 s72, s72
    v_mfma_f32_16x16x32_bf16 v[68:71], a[12:15], v[92:95], v[68:71]
    s_add_u32 s72, s72, s79
    s_waitcnt vmcnt(8)
    v_mfma_f32_16x16x32_bf16 v[56:59], a[16:19], v[96:99], v[56:59]
    v_add_u32 v192, s72, v5
    buffer_load_dwordx4 v[132:135], v1, s[40:43], s60 offen offset:2048 sc1
    v_mfma_f32_16x16x32_bf16 v[60:63], a[20:23], v[96:99], v[60:63]
    v_lshrrev_b32 v193, 6, v192
    v_mfma_f32_16x16x32_bf16 v[64:67], a[24:27], v[96:99], v[64:67]
    v_cmp_eq_u32 vcc, s44, v193
    v_mfma_f32_16x16x32_bf16 v[68:71], a[28:31], v[96:99], v[68:71]
    v_mov_b32 v194, 0x70000
    s_waitcnt vmcnt(8)
    v_mfma_f32_16x16x32_bf16 v[56:59], a[32:35], v[100:103], v[56:59]
    v_mov_b32 v195, 0x30000
    buffer_load_dwordx4 v[136:139], v1, s[40:43], s60 offen offset:3072 sc1
    v_mfma_f32_16x16x32_bf16 v[60:63], a[36:39], v[100:103], v[60:63]
    v_cndmask_b32 v194, v194, v195, vcc
    v_mfma_f32_16x16x32_bf16 v[64:67], a[40:43], v[100:103], v[64:67]
    v_lshl_add_u32 v194, v193, 20, v194
    v_mfma_f32_16x16x32_bf16 v[68:71], a[44:47], v[100:103], v[68:71]
    v_bfe_u32 v193, v192, 4, 2
    s_waitcnt vmcnt(8)
    v_mfma_f32_16x16x32_bf16 v[56:59], a[48:51], v[104:107], v[56:59]
    v_lshl_add_u32 v194, v193, 14, v194
    buffer_load_dwordx4 v[140:143], v1, s[40:43], s61 offen offset:0 sc1
    v_mfma_f32_16x16x32_bf16 v[60:63], a[52:55], v[104:107], v[60:63]
    v_and_b32 v193, 15, v192
    v_mfma_f32_16x16x32_bf16 v[64:67], a[56:59], v[104:107], v[64:67]
    v_lshl_add_u32 v193, v4, 4, v193
    v_mfma_f32_16x16x32_bf16 v[68:71], a[60:63], v[104:107], v[68:71]
    v_and_b32 v195, 1, v192
    s_waitcnt vmcnt(8)
    v_mfma_f32_16x16x32_bf16 v[56:59], a[64:67], v[108:111], v[56:59]
    v_lshl_add_u32 v195, v4, 1, v195
    buffer_load_dwordx4 v[144:147], v1, s[40:43], s61 offen offset:1024 sc1
    v_mfma_f32_16x16x32_bf16 v[60:63], a[68:71], v[108:111], v[60:63]
    v_cndmask_b32 v193, v195, v193, vcc
    v_mfma_f32_16x16x32_bf16 v[64:67], a[72:75], v[108:111], v[64:67]
    v_lshl_add_u32 v194, v193, 4, v194
    v_mfma_f32_16x16x32_bf16 v[68:71], a[76:79], v[108:111], v[68:71]
    v_mov_b32 v193, 0x40000000
    s_waitcnt vmcnt(8)
    v_mfma_f32_16x16x32_bf16 v[56:59], a[80:83], v[112:115], v[56:59]
    v_cmp_gt_u32 vcc, 0x800, v192
    buffer_load_dwordx4 v[148:151], v1, s[40:43], s61 offen offset:2048 sc1
    v_mfma_f32_16x16x32_bf16 v[60:63], a[84:87], v[112:115], v[60:63]
    v_cndmask_b32 v205, v193, v194, vcc
    v_mfma_f32_16x16x32_bf16 v[64:67], a[88:91], v[112:115], v[64:67]
    s_lshr_b32 s72, s91, 5
    v_mfma_f32_16x16x32_bf16 v[68:71], a[92:95], v[112:115], v[68:71]
    s_lshr_b32 s72, 0x02fe01ff, s72
    s_waitcnt vmcnt(8)
    v_mfma_f32_16x16x32_bf16 v[56:59], a[96:99], v[116:119], v[56:59]
    s_sext_i32_i8 s72, s72
    buffer_load_dwordx4 v[152:155], v1, s[40:43], s61 offen offset:3072 sc1
    v_mfma_f32_16x16x32_bf16 v[60:63], a[100:103], v[116:119], v[60:63]
    s_add_u32 s72, s72, s79
    v_mfma_f32_16x16x32_bf16 v[64:67], a[104:107], v[116:119], v[64:67]
    v_add_u32 v192, s72, v5
    v_mfma_f32_16x16x32_bf16 v[68:71], a[108:111], v[116:119], v[68:71]
    v_lshrrev_b32 v193, 6, v192
    s_waitcnt vmcnt(8)
    v_mfma_f32_16x16x32_bf16 v[56:59], a[112:115], v[120:123], v[56:59]
    v_cmp_eq_u32 vcc, s44, v193
    v_mfma_f32_16x16x32_bf16 v[60:63], a[116:119], v[120:123], v[60:63]
    buffer_load_dwordx4 v202, s[24:27], s3 offen offset:2048 lds
    v_mfma_f32_16x16x32_bf16 v[64:67], a[120:123], v[120:123], v[64:67]
    v_mov_b32 v194, 0x70000
    v_mfma_f32_16x16x32_bf16 v[68:71], a[124:127], v[120:123], v[68:71]
    v_mov_b32 v195, 0x30000
    s_waitcnt vmcnt(8)
    v_mfma_f32_16x16x32_bf16 v[56:59], a[128:131], v[124:127], v[56:59]
    v_cndmask_b32 v194, v194, v195, vcc
    v_mfma_f32_16x16x32_bf16 v[60:63], a[132:135], v[124:127], v[60:63]
    v_lshl_add_u32 v194, v193, 20, v194
    v_mfma_f32_16x16x32_bf16 v[64:67], a[136:139], v[124:127], v[64:67]
    s_add_u32 m0, s48, 0x10000
    s_add_u32 s3, s77, 0x38000
    buffer_load_dwordx4 v196, s[24:27], s3 offen offset:0 lds
    v_mfma_f32_16x16x32_bf16 v[68:71], a[140:143], v[124:127], v[68:71]
    v_bfe_u32 v193, v192, 4, 2
    s_waitcnt vmcnt(8)
    v_mfma_f32_16x16x32_bf16 v[56:59], a[144:147], v[128:131], v[56:59]
    v_lshl_add_u32 v194, v193, 14, v194
    v_mfma_f32_16x16x32_bf16 v[60:63], a[148:151], v[128:131], v[60:63]
    v_and_b32 v193, 15, v192
    v_mfma_f32_16x16x32_bf16 v[64:67], a[152:155], v[128:131], v[64:67]
    v_lshl_add_u32 v193, v4, 4, v193
    v_mfma_f32_16x16x32_bf16 v[68:71], a[156:159], v[128:131], v[68:71]
    buffer_load_dwordx4 v197, s[24:27], s3 offen offset:1024 lds
    s_waitcnt vmcnt(8)
    v_mfma_f32_16x16x32_bf16 v[56:59], a[160:163], v[132:135], v[56:59]
    v_and_b32 v195, 1, v192
    v_mfma_f32_16x16x32_bf16 v[60:63], a[164:167], v[132:135], v[60:63]
    v_lshl_add_u32 v195, v4, 1, v195
    v_mfma_f32_16x16x32_bf16 v[64:67], a[168:171], v[132:135], v[64:67]
    v_cndmask_b32 v193, v195, v193, vcc
    v_mfma_f32_16x16x32_bf16 v[68:71], a[172:175], v[132:135], v[68:71]
    v_lshl_add_u32 v194, v193, 4, v194
    s_waitcnt vmcnt(7)
    v_mfma_f32_16x16x32_bf16 v[56:59], a[176:179], v[136:139], v[56:59]
    buffer_load_dwordx4 v198, s[24:27], s3 offen offset:2048 lds
    v_mfma_f32_16x16x32_bf16 v[60:63], a[180:183], v[136:139], v[60:63]
    v_mov_b32 v193, 0x40000000
    v_mfma_f32_16x16x32_bf16 v[64:67], a[184:187], v[136:139], v[64:67]
    v_cmp_gt_u32 vcc, 0x800, v192
    v_mfma_f32_16x16x32_bf16 v[68:71], a[188:191], v[136:139], v[68:71]
    v_cndmask_b32 v206, v193, v194, vcc
    s_waitcnt vmcnt(7)
    v_mfma_f32_16x16x32_bf16 v[56:59], a[192:195], v[140:143], v[56:59]
    v_mfma_f32_16x16x32_bf16 v[60:63], a[196:199], v[140:143], v[60:63]
    buffer_load_dwordx4 v199, s[24:27], s3 offen offset:3072 lds
    v_mfma_f32_16x16x32_bf16 v[64:67], a[200:203], v[140:143], v[64:67]
    v_mfma_f32_16x16x32_bf16 v[68:71], a[204:207], v[140:143], v[68:71]
    s_waitcnt vmcnt(7)
    v_mfma_f32_16x16x32_bf16 v[56:59], a[208:211], v[144:147], v[56:59]
    v_mfma_f32_16x16x32_bf16 v[60:63], a[212:215], v[144:147], v[60:63]
    v_mfma_f32_16x16x32_bf16 v[64:67], a[216:219], v[144:147], v[64:67]
    s_add_u32 m0, s48, 0x11000
    s_nop 0
    buffer_load_dwordx4 v200, s[24:27], s3 offen offset:0 lds
    v_mfma_f32_16x16x32_bf16 v[68:71], a[220:223], v[144:147], v[68:71]
    s_waitcnt vmcnt(7)
    v_mfma_f32_16x16x32_bf16 v[56:59], a[224:227], v[148:151], v[56:59]
    v_mfma_f32_16x16x32_bf16 v[60:63], a[228:231], v[148:151], v[60:63]
    v_mfma_f32_16x16x32_bf16 v[64:67], a[232:235], v[148:151], v[64:67]
    v_mfma_f32_16x16x32_bf16 v[68:71], a[236:239], v[148:151], v[68:71]
    buffer_load_dwordx4 v201, s[24:27], s3 offen offset:1024 lds
    s_waitcnt vmcnt(7)
    v_mfma_f32_16x16x32_bf16 v[56:59], a[240:243], v[152:155], v[56:59]
    v_mfma_f32_16x16x32_bf16 v[60:63], a[244:247], v[152:155], v[60:63]
    v_mfma_f32_16x16x32_bf16 v[64:67], a[248:251], v[152:155], v[64:67]
    v_mfma_f32_16x16x32_bf16 v[68:71], a[252:255], v[152:155], v[68:71]
    s_add_u32 s71, s94, 0x30000
    v_pk_mul_f32 v[188:189], v[56:57], v[56:57]
    buffer_load_dwordx4 v202, s[24:27], s3 offen offset:2048 lds
    v_pk_mul_f32 v[190:191], v[58:59], v[58:59]
    v_pk_fma_f32 v[188:189], v[188:189], v[22:23], v[22:23] op_sel:[0,1,0] op_sel_hi:[1,1,0]
    v_pk_fma_f32 v[190:191], v[190:191], v[22:23], v[22:23] op_sel:[0,1,0] op_sel_hi:[1,1,0]
    v_pk_mul_f32 v[188:189], v[188:189], v[56:57]
    v_pk_mul_f32 v[190:191], v[190:191], v[58:59]
    v_exp_f32 v188, v188
    v_exp_f32 v189, v189
    v_exp_f32 v190, v190
    v_exp_f32 v191, v191
    v_pk_fma_f32 v[188:189], v[188:189], v[72:73], v[72:73] op_sel_hi:[1,0,0]
    v_pk_fma_f32 v[190:191], v[190:191], v[72:73], v[72:73] op_sel_hi:[1,0,0]
    s_lshl2_add_u32 s3, s2, s46
    s_mul_i32 s3, s3, 1792
    buffer_load_dword v6, v89, s[28:31], s3 offen
    v_rcp_f32 v188, v188
    v_rcp_f32 v189, v189
    v_rcp_f32 v190, v190
    v_rcp_f32 v191, v191
    v_pk_mul_f32 v[56:57], v[56:57], v[188:189]
    v_pk_mul_f32 v[58:59], v[58:59], v[190:191]
    v_cvt_pk_bf16_f32 v172, v56, v57
    v_cvt_pk_bf16_f32 v173, v58, v59
    v_pk_mul_f32 v[188:189], v[60:61], v[60:61]
    v_pk_mul_f32 v[190:191], v[62:63], v[62:63]
    v_pk_fma_f32 v[188:189], v[188:189], v[22:23], v[22:23] op_sel:[0,1,0] op_sel_hi:[1,1,0]
    v_pk_fma_f32 v[190:191], v[190:191], v[22:23], v[22:23] op_sel:[0,1,0] op_sel_hi:[1,1,0]
    v_pk_mul_f32 v[188:189], v[188:189], v[60:61]
    v_pk_mul_f32 v[190:191], v[190:191], v[62:63]
    v_exp_f32 v188, v188
    v_exp_f32 v189, v189
    v_exp_f32 v190, v190
    v_exp_f32 v191, v191
    v_pk_fma_f32 v[188:189], v[188:189], v[72:73], v[72:73] op_sel_hi:[1,0,0]
    v_pk_fma_f32 v[190:191], v[190:191], v[72:73], v[72:73] op_sel_hi:[1,0,0]
    v_rcp_f32 v188, v188
    v_rcp_f32 v189, v189
    v_rcp_f32 v190, v190
    v_rcp_f32 v191, v191
    v_pk_mul_f32 v[60:61], v[60:61], v[188:189]
    v_pk_mul_f32 v[62:63], v[62:63], v[190:191]
    v_cvt_pk_bf16_f32 v174, v60, v61
    v_cvt_pk_bf16_f32 v175, v62, v63
    buffer_store_dwordx4 v[172:175], v1, s[40:43], s71 offen offset:0 sc1
    v_pk_mul_f32 v[188:189], v[64:65], v[64:65]
    v_pk_mul_f32 v[190:191], v[66:67], v[66:67]
    v_pk_fma_f32 v[188:189], v[188:189], v[22:23], v[22:23] op_sel:[0,1,0] op_sel_hi:[1,1,0]
    v_pk_fma_f32 v[190:191], v[190:191], v[22:23], v[22:23] op_sel:[0,1,0] op_sel_hi:[1,1,0]
    v_pk_mul_f32 v[188:189], v[188:189], v[64:65]
    v_pk_mul_f32 v[190:191], v[190:191], v[66:67]
    v_exp_f32 v188, v188
    v_exp_f32 v189, v189
    v_exp_f32 v190, v190
    v_exp_f32 v191, v191
    v_pk_fma_f32 v[188:189], v[188:189], v[72:73], v[72:73] op_sel_hi:[1,0,0]
    v_pk_fma_f32 v[190:191], v[190:191], v[72:73], v[72:73] op_sel_hi:[1,0,0]
    v_rcp_f32 v188, v188
    v_rcp_f32 v189, v189
    v_rcp_f32 v190, v190
    v_rcp_f32 v191, v191
    v_pk_mul_f32 v[64:65], v[64:65], v[188:189]
    v_pk_mul_f32 v[66:67], v[66:67], v[190:191]
    v_cvt_pk_bf16_f32 v176, v64, v65
    v_cvt_pk_bf16_f32 v177, v66, v67
    v_pk_mul_f32 v[188:189], v[68:69], v[68:69]
    v_pk_mul_f32 v[190:191], v[70:71], v[70:71]
    v_pk_fma_f32 v[188:189], v[188:189], v[22:23], v[22:23] op_sel:[0,1,0] op_sel_hi:[1,1,0]
    v_pk_fma_f32 v[190:191], v[190:191], v[22:23], v[22:23] op_sel:[0,1,0] op_sel_hi:[1,1,0]
    v_pk_mul_f32 v[188:189], v[188:189], v[68:69]
    v_pk_mul_f32 v[190:191], v[190:191], v[70:71]
    v_exp_f32 v188, v188
    v_exp_f32 v189, v189
    v_exp_f32 v190, v190
    v_exp_f32 v191, v191
    v_pk_fma_f32 v[188:189], v[188:189], v[72:73], v[72:73] op_sel_hi:[1,0,0]
    v_pk_fma_f32 v[190:191], v[190:191], v[72:73], v[72:73] op_sel_hi:[1,0,0]
    v_rcp_f32 v188, v188
    v_rcp_f32 v189, v189
    v_rcp_f32 v190, v190
    v_rcp_f32 v191, v191
    v_pk_mul_f32 v[68:69], v[68:69], v[188:189]
    v_pk_mul_f32 v[70:71], v[70:71], v[190:191]
    v_cvt_pk_bf16_f32 v178, v68, v69
    v_cvt_pk_bf16_f32 v179, v70, v71
    buffer_store_dwordx4 v[176:179], v1, s[40:43], s71 offen offset:1024 sc1
    buffer_store_dwordx4 v[172:175], v18, s[40:43], s76 offen offset:0 sc1
    buffer_store_dwordx4 v[176:179], v18, s[40:43], s76 offen offset:1024 sc1
    s_barrier
    ds_read_b64_tr_b16 a[0:1], v32 offset:0
    ds_read_b64_tr_b16 a[2:3], v32 offset:8192
    ds_read_b64_tr_b16 a[4:5], v33 offset:0
    ds_read_b64_tr_b16 a[6:7], v33 offset:8192
    ds_read_b64_tr_b16 a[8:9], v34 offset:0
    ds_read_b64_tr_b16 a[10:11], v34 offset:8192
    ds_read_b64_tr_b16 a[12:13], v35 offset:0
    ds_read_b64_tr_b16 a[14:15], v35 offset:8192
    ds_read_b64_tr_b16 a[16:17], v32 offset:1024
    v_mul_f32 v192, -v7, v12
    ds_read_b64_tr_b16 a[18:19], v32 offset:9216
    v_fma_f32 v56, v40, v12, v192
    ds_read_b64_tr_b16 a[20:21], v33 offset:1024
    v_fma_f32 v57, v41, v12, v192
    ds_read_b64_tr_b16 a[22:23], v33 offset:9216
    v_fma_f32 v58, v42, v12, v192
    ds_read_b64_tr_b16 a[24:25], v34 offset:1024
    v_fma_f32 v59, v43, v12, v192
    ds_read_b64_tr_b16 a[26:27], v34 offset:9216
    v_fma_f32 v60, v44, v12, v192
    ds_read_b64_tr_b16 a[28:29], v35 offset:1024
    v_fma_f32 v61, v45, v12, v192
    ds_read_b64_tr_b16 a[30:31], v35 offset:9216
    v_fma_f32 v62, v46, v12, v192
    ds_read_b64_tr_b16 a[32:33], v32 offset:2048
    v_fma_f32 v63, v47, v12, v192
    ds_read_b64_tr_b16 a[34:35], v32 offset:10240
    v_fma_f32 v64, v48, v12, v192
    ds_read_b64_tr_b16 a[36:37], v33 offset:2048
    v_fma_f32 v65, v49, v12, v192
    ds_read_b64_tr_b16 a[38:39], v33 offset:10240
    v_fma_f32 v66, v50, v12, v192
    ds_read_b64_tr_b16 a[40:41], v34 offset:2048
    v_fma_f32 v67, v51, v12, v192
    ds_read_b64_tr_b16 a[42:43], v34 offset:10240
    v_fma_f32 v68, v52, v12, v192
    ds_read_b64_tr_b16 a[44:45], v35 offset:2048
    v_fma_f32 v69, v53, v12, v192
    ds_read_b64_tr_b16 a[46:47], v35 offset:10240
    v_fma_f32 v70, v54, v12, v192
    ds_read_b64_tr_b16 a[48:49], v32 offset:3072
    v_fma_f32 v71, v55, v12, v192
    ds_read_b64_tr_b16 a[50:51], v32 offset:11264
    v_and_b32 v192, 2, v0
    ds_read_b64_tr_b16 a[52:53], v33 offset:3072
    v_subrev_u32 v192, 1, v192
    ds_read_b64_tr_b16 a[54:55], v33 offset:11264
    v_cmp_gt_u32 vcc, 8, v0
    ds_read_b64_tr_b16 a[56:57], v34 offset:3072
    s_nop 0
    v_cndmask_b32 v192, v192, v3, vcc
    ds_read_b64_tr_b16 a[58:59], v34 offset:11264
    v_add_u32 v192, s46, v192
    ds_read_b64_tr_b16 a[60:61], v35 offset:3072
    v_med3_i32 v192, v192, 0, 3
    ds_read_b64_tr_b16 a[62:63], v35 offset:11264
    v_and_b32 v193, 7, v0
    ds_read_b64_tr_b16 a[64:65], v32 offset:16384
    v_lshlrev_b32 v193, 12, v193
    ds_read_b64_tr_b16 a[66:67], v32 offset:24576
    v_lshl_add_u32 v17, v192, 10, v193
    ds_read_b64_tr_b16 a[68:69], v33 offset:16384
    s_add_u32 s70, s78, 0x28084
    ds_read_b64_tr_b16 a[70:71], v33 offset:24576
    s_lshl_b32 s58, s88, 4
    ds_read_b64_tr_b16 a[72:73], v34 offset:16384
    s_lshl_b32 s59, s89, 4
    ds_read_b64_tr_b16 a[74:75], v34 offset:24576
    s_lshl_b32 s60, s90, 4
    ds_read_b64_tr_b16 a[76:77], v35 offset:16384
    s_lshl_b32 s61, s91, 4
    ds_read_b64_tr_b16 a[78:79], v35 offset:24576
    ds_read_b64_tr_b16 a[80:81], v32 offset:17408
    ds_read_b64_tr_b16 a[82:83], v32 offset:25600
    ds_read_b64_tr_b16 a[84:85], v33 offset:17408
    ds_read_b64_tr_b16 a[86:87], v33 offset:25600
    ds_read_b64_tr_b16 a[88:89], v34 offset:17408
    ds_read_b64_tr_b16 a[90:91], v34 offset:25600
    ds_read_b64_tr_b16 a[92:93], v35 offset:17408
    ds_read_b64_tr_b16 a[94:95], v35 offset:25600
    ds_read_b64_tr_b16 a[96:97], v32 offset:18432
    ds_read_b64_tr_b16 a[98:99], v32 offset:26624
    ds_read_b64_tr_b16 a[100:101], v33 offset:18432
    ds_read_b64_tr_b16 a[102:103], v33 offset:26624
    ds_read_b64_tr_b16 a[104:105], v34 offset:18432
    ds_read_b64_tr_b16 a[106:107], v34 offset:26624
    ds_read_b64_tr_b16 a[108:109], v35 offset:18432
    ds_read_b64_tr_b16 a[110:111], v35 offset:26624
    ds_read_b64_tr_b16 a[112:113], v32 offset:19456
    ds_read_b64_tr_b16 a[114:115], v32 offset:27648
    ds_read_b64_tr_b16 a[116:117], v33 offset:19456
    ds_read_b64_tr_b16 a[118:119], v33 offset:27648
    ds_read_b64_tr_b16 a[120:121], v34 offset:19456
    ds_read_b64_tr_b16 a[122:123], v34 offset:27648
    ds_read_b64_tr_b16 a[124:125], v35 offset:19456
    ds_read_b64_tr_b16 a[126:127], v35 offset:27648
    ds_read_b64_tr_b16 a[128:129], v32 offset:32768
    ds_read_b64_tr_b16 a[130:131], v32 offset:40960
    ds_read_b64_tr_b16 a[132:133], v33 offset:32768
    ds_read_b64_tr_b16 a[134:135], v33 offset:40960
    ds_read_b64_tr_b16 a[136:137], v34 offset:32768
    ds_read_b64_tr_b16 a[138:139], v34 offset:40960
    ds_read_b64_tr_b16 a[140:141], v35 offset:32768
    ds_read_b64_tr_b16 a[142:143], v35 offset:40960
    s_waitcnt vmcnt(2)
    buffer_store_dword v24, v2, s[40:43], s56 offen offset:132 sc1
    ds_read_b64_tr_b16 a[144:145], v32 offset:33792
    ds_read_b64_tr_b16 a[146:147], v32 offset:41984
    ds_read_b64_tr_b16 a[148:149], v33 offset:33792
    ds_read_b64_tr_b16 a[150:151], v33 offset:41984
    ds_read_b64_tr_b16 a[152:153], v34 offset:33792
    ds_read_b64_tr_b16 a[154:155], v34 offset:41984
    ds_read_b64_tr_b16 a[156:157], v35 offset:33792
    ds_read_b64_tr_b16 a[158:159], v35 offset:41984
    ds_read_b64_tr_b16 a[160:161], v32 offset:34816
    ds_read_b64_tr_b16 a[162:163], v32 offset:43008
    ds_read_b64_tr_b16 a[164:165], v33 offset:34816
    ds_read_b64_tr_b16 a[166:167], v33 offset:43008
    ds_read_b64_tr_b16 a[168:169], v34 offset:34816
    ds_read_b64_tr_b16 a[170:171], v34 offset:43008
    ds_read_b64_tr_b16 a[172:173], v35 offset:34816
    ds_read_b64_tr_b16 a[174:175], v35 offset:43008
    ds_read_b64_tr_b16 a[176:177], v32 offset:35840
    ds_read_b64_tr_b16 a[178:179], v32 offset:44032
    ds_read_b64_tr_b16 a[180:181], v33 offset:35840
    ds_read_b64_tr_b16 a[182:183], v33 offset:44032
    ds_read_b64_tr_b16 a[184:185], v34 offset:35840
    ds_read_b64_tr_b16 a[186:187], v34 offset:44032
    ds_read_b64_tr_b16 a[188:189], v35 offset:35840
    ds_read_b64_tr_b16 a[190:191], v35 offset:44032
    buffer_load_dword v8, v17, s[40:43], s70 offen sc1
    s_add_u32 s3, s77, 0xa8000
    buffer_load_dword v6, v21, s[24:27], s3 offen
    ds_read_b64_tr_b16 a[192:193], v32 offset:49152
    ds_read_b64_tr_b16 a[194:195], v32 offset:57344
    ds_read_b64_tr_b16 a[196:197], v33 offset:49152
    ds_read_b64_tr_b16 a[198:199], v33 offset:57344
    ds_read_b64_tr_b16 a[200:201], v34 offset:49152
    ds_read_b64_tr_b16 a[202:203], v34 offset:57344
    ds_read_b64_tr_b16 a[204:205], v35 offset:49152
    ds_read_b64_tr_b16 a[206:207], v35 offset:57344
    ds_read_b64_tr_b16 a[208:209], v32 offset:50176
    ds_read_b64_tr_b16 a[210:211], v32 offset:58368
    ds_read_b64_tr_b16 a[212:213], v33 offset:50176
    ds_read_b64_tr_b16 a[214:215], v33 offset:58368
    ds_read_b64_tr_b16 a[216:217], v34 offset:50176
    ds_read_b64_tr_b16 a[218:219], v34 offset:58368
    ds_read_b64_tr_b16 a[220:221], v35 offset:50176
    ds_read_b64_tr_b16 a[222:223], v35 offset:58368
    ds_read_b64_tr_b16 a[224:225], v32 offset:51200
    ds_read_b64_tr_b16 a[226:227], v32 offset:59392
    ds_read_b64_tr_b16 a[228:229], v33 offset:51200
    ds_read_b64_tr_b16 a[230:231], v33 offset:59392
    ds_read_b64_tr_b16 a[232:233], v34 offset:51200
    ds_read_b64_tr_b16 a[234:235], v34 offset:59392
    ds_read_b64_tr_b16 a[236:237], v35 offset:51200
    ds_read_b64_tr_b16 a[238:239], v35 offset:59392
    ds_read_b64_tr_b16 a[240:241], v32 offset:52224
    ds_read_b64_tr_b16 a[242:243], v32 offset:60416
    ds_read_b64_tr_b16 a[244:245], v33 offset:52224
    ds_read_b64_tr_b16 a[246:247], v33 offset:60416
    ds_read_b64_tr_b16 a[248:249], v34 offset:52224
    ds_read_b64_tr_b16 a[250:251], v34 offset:60416
    ds_read_b64_tr_b16 a[252:253], v35 offset:52224
    ds_read_b64_tr_b16 a[254:255], v35 offset:60416
    s_waitcnt vmcnt(1)
    v_cmp_ne_u32 vcc, s95, v8
    s_nop 0
    s_cbranch_vccz polled_50
    s_mov_b32 s57, 0x40000
poll_49:
    buffer_load_dword v8, v17, s[40:43], s70 offen sc1
    s_waitcnt vmcnt(0)
    v_cmp_ne_u32 vcc, s95, v8
    s_nop 0
    s_cbranch_vccz polled_50
    s_sub_u32 s57, s57, 1
    s_cbranch_scc0 poll_49
polled_50:
    buffer_load_dwordx4 v[92:95], v203, s[40:43], s58 offen offset:0 sc1
    s_and_b32 s70, s46, 1
    s_lshr_b32 s72, s46, 1
    v_lshrrev_b32 v192, 2, v0
    v_mul_u32_u24 v192, 0x1c0, v192
    v_and_b32 v193, 3, v0
    v_lshl_add_u32 v192, v193, 3, v192
    s_mul_i32 s71, s70, 224
    v_add_u32 v192, s71, v192
    v_and_b32 v193, 16, v0
    v_lshlrev_b32 v193, 1, v193
    s_lshl_b32 s71, s70, 1
    s_sub_u32 s71, 1, s71
    buffer_load_dwordx4 v[96:99], v203, s[40:43], s58 offen offset:1024 sc1
    v_mul_i32_i24 v193, s71, v193
    s_mul_i32 s71, s72, 14336
    s_sub_u32 s73, 14336, s71
    v_add_u32 v194, v192, v193
    v_sub_u32 v195, v192, v193
    v_add_u32 v32, s71, v194
    v_add_u32 v33, s71, v195
    v_add_u32 v34, s73, v194
    v_add_u32 v35, s73, v195
    s_mul_i32 s71, s72, 74752
    s_add_u32 s71, s71, 57344
    v_add_u32 v74, s71, v1
    buffer_load_dwordx4 v[100:103], v203, s[40:43], s58 offen offset:2048 sc1
    s_lshl_b32 s73, s72, 11
    s_sub_u32 s71, s71, s73
    v_add_u32 v75, s71, v1
    s_lshl_b32 s71, s46, 10
    s_add_u32 s71, s71, 0x27000
    v_add_u32 v80, s71, v1
    v_xor_b32 v81, 0x800, v80
    s_add_u32 s71, s93, 0
    s_and_b32 s71, s71, 3
    s_mul_i32 s84, s71, 114688
    s_and_b32 s70, s71, 1
    s_and_b32 s73, s46, 2
    buffer_load_dwordx4 v[104:107], v203, s[40:43], s58 offen offset:3072 sc1
    s_waitcnt lgkmcnt(0)
    s_barrier
    s_or_b32 s70, s70, s73
    s_lshl_b32 s70, s70, 14
    s_lshr_b32 s71, s71, 1
    s_lshl1_add_u32 s71, s46, s71
    s_lshl_b32 s71, s71, 11
    s_add_u32 s80, s70, s71
    s_add_u32 s71, s93, 1
    s_and_b32 s71, s71, 3
    s_mul_i32 s85, s71, 114688
    s_and_b32 s70, s71, 1
    s_and_b32 s73, s46, 2
    s_or_b32 s70, s70, s73
    buffer_load_dwordx4 v[108:111], v204, s[40:43], s59 offen offset:0 sc1
    s_lshl_b32 s70, s70, 14
    s_lshr_b32 s71, s71, 1
    s_lshl1_add_u32 s71, s46, s71
    s_lshl_b32 s71, s71, 11
    s_add_u32 s81, s70, s71
    s_add_u32 s71, s93, 2
    s_and_b32 s71, s71, 3
    s_mul_i32 s86, s71, 114688
    s_and_b32 s70, s71, 1
    s_and_b32 s73, s46, 2
    s_or_b32 s70, s70, s73
    s_lshl_b32 s70, s70, 14
    buffer_load_dwordx4 v[112:115], v204, s[40:43], s59 offen offset:1024 sc1
    s_lshr_b32 s71, s71, 1
    s_lshl1_add_u32 s71, s46, s71
    s_lshl_b32 s71, s71, 11
    s_add_u32 s82, s70, s71
    s_add_u32 s71, s93, 3
    s_and_b32 s71, s71, 3
    s_mul_i32 s87, s71, 114688
    s_and_b32 s70, s71, 1
    s_and_b32 s73, s46, 2
    s_or_b32 s70, s70, s73
    s_lshl_b32 s70, s70, 14
    s_lshr_b32 s71, s71, 1
    buffer_load_dwordx4 v[116:119], v204, s[40:43], s59 offen offset:2048 sc1
    s_lshl1_add_u32 s71, s46, s71
    s_lshl_b32 s71, s71, 11
    s_add_u32 s83, s70, s71
    s_mul_i32 s70, s46, 458752
    s_lshl_b32 s71, s45, 7
    s_add_u32 s70, s70, s71
    v_lshl_add_u32 v192, v0, 10, s70
    v_mov_b32 v193, 0x40000000
    v_cmp_gt_u32 vcc, 16, v0
    s_nop 1
    v_cndmask_b32 v27, v193, v192, vcc
    v_lshlrev_b32 v193, 1, v15
    v_and_b32 v193, 4, v193
    buffer_load_dwordx4 v[120:123], v204, s[40:43], s59 offen offset:3072 sc1
    v_and_b32 v194, 7, v0
    v_xor_b32 v193, v193, v194
    v_lshl_add_u32 v193, v193, 4, s70
    v_add_u32 v192, 0x60, v15
    v_lshl_add_u32 v78, v192, 10, v193
    v_lshrrev_b32 v192, 5, v0
    v_and_b32 v194, 3, v15
    v_lshl_add_u32 v192, v192, 4, v194
    v_lshl_add_u32 v77, v192, 10, v193
    s_mov_b32 s50, 3072
    s_mov_b32 s51, 6144
    s_mov_b32 s52, 9216
    buffer_load_dwordx4 v[124:127], v205, s[40:43], s60 offen offset:0 sc1
    s_mov_b32 s53, 7168
    s_waitcnt vmcnt(8)
    v_mfma_f32_16x16x32_bf16 v[56:59], a[0:3], v[92:95], v[56:59]
    buffer_load_dwordx4 v[128:131], v205, s[40:43], s60 offen offset:1024 sc1
    v_mfma_f32_16x16x32_bf16 v[60:63], a[4:7], v[92:95], v[60:63]
    v_mfma_f32_16x16x32_bf16 v[64:67], a[8:11], v[92:95], v[64:67]
    v_mfma_f32_16x16x32_bf16 v[68:71], a[12:15], v[92:95], v[68:71]
    s_waitcnt vmcnt(8)
    v_mfma_f32_16x16x32_bf16 v[56:59], a[16:19], v[96:99], v[56:59]
    buffer_load_dwordx4 v[132:135], v205, s[40:43], s60 offen offset:2048 sc1
    v_mfma_f32_16x16x32_bf16 v[60:63], a[20:23], v[96:99], v[60:63]
    v_mfma_f32_16x16x32_bf16 v[64:67], a[24:27], v[96:99], v[64:67]
    v_mfma_f32_16x16x32_bf16 v[68:71], a[28:31], v[96:99], v[68:71]
    s_waitcnt vmcnt(8)
    v_mfma_f32_16x16x32_bf16 v[56:59], a[32:35], v[100:103], v[56:59]
    buffer_load_dwordx4 v[136:139], v205, s[40:43], s60 offen offset:3072 sc1
    v_mfma_f32_16x16x32_bf16 v[60:63], a[36:39], v[100:103], v[60:63]
    v_mfma_f32_16x16x32_bf16 v[64:67], a[40:43], v[100:103], v[64:67]
    v_mfma_f32_16x16x32_bf16 v[68:71], a[44:47], v[100:103], v[68:71]
    s_waitcnt vmcnt(8)
    v_mfma_f32_16x16x32_bf16 v[56:59], a[48:51], v[104:107], v[56:59]
    buffer_load_dwordx4 v[140:143], v206, s[40:43], s61 offen offset:0 sc1
    v_mfma_f32_16x16x32_bf16 v[60:63], a[52:55], v[104:107], v[60:63]
    v_mfma_f32_16x16x32_bf16 v[64:67], a[56:59], v[104:107], v[64:67]
    v_mfma_f32_16x16x32_bf16 v[68:71], a[60:63], v[104:107], v[68:71]
    s_waitcnt vmcnt(8)
    v_mfma_f32_16x16x32_bf16 v[56:59], a[64:67], v[108:111], v[56:59]
    buffer_load_dwordx4 v[144:147], v206, s[40:43], s61 offen offset:1024 sc1
    v_mfma_f32_16x16x32_bf16 v[60:63], a[68:71], v[108:111], v[60:63]
    v_mfma_f32_16x16x32_bf16 v[64:67], a[72:75], v[108:111], v[64:67]
    v_mfma_f32_16x16x32_bf16 v[68:71], a[76:79], v[108:111], v[68:71]
    s_waitcnt vmcnt(8)
    v_mfma_f32_16x16x32_bf16 v[56:59], a[80:83], v[112:115], v[56:59]
    buffer_load_dwordx4 v[148:151], v206, s[40:43], s61 offen offset:2048 sc1
    v_mfma_f32_16x16x32_bf16 v[60:63], a[84:87], v[112:115], v[60:63]
    v_mfma_f32_16x16x32_bf16 v[64:67], a[88:91], v[112:115], v[64:67]
    v_mfma_f32_16x16x32_bf16 v[68:71], a[92:95], v[112:115], v[68:71]
    s_waitcnt vmcnt(8)
    v_mfma_f32_16x16x32_bf16 v[56:59], a[96:99], v[116:119], v[56:59]
    buffer_load_dwordx4 v[152:155], v206, s[40:43], s61 offen offset:3072 sc1
    v_mfma_f32_16x16x32_bf16 v[60:63], a[100:103], v[116:119], v[60:63]
    v_mfma_f32_16x16x32_bf16 v[64:67], a[104:107], v[116:119], v[64:67]
    v_mfma_f32_16x16x32_bf16 v[68:71], a[108:111], v[116:119], v[68:71]
    s_waitcnt vmcnt(8)
    v_mfma_f32_16x16x32_bf16 v[56:59], a[112:115], v[120:123], v[56:59]
    v_mfma_f32_16x16x32_bf16 v[60:63], a[116:119], v[120:123], v[60:63]
    s_add_u32 m0, s48, 0x17000
    s_add_u32 s3, s77, 0x70000
    buffer_load_dwordx4 v196, s[24:27], s3 offen offset:0 lds
    v_mfma_f32_16x16x32_bf16 v[64:67], a[120:123], v[120:123], v[64:67]
    v_mfma_f32_16x16x32_bf16 v[68:71], a[124:127], v[120:123], v[68:71]
    s_waitcnt vmcnt(8)
    v_mfma_f32_16x16x32_bf16 v[56:59], a[128:131], v[124:127], v[56:59]
    v_mfma_f32_16x16x32_bf16 v[60:63], a[132:135], v[124:127], v[60:63]
    v_mfma_f32_16x16x32_bf16 v[64:67], a[136:139], v[124:127], v[64:67]
    buffer_load_dwordx4 v197, s[24:27], s3 offen offset:1024 lds
    v_mfma_f32_16x16x32_bf16 v[68:71], a[140:143], v[124:127], v[68:71]
    s_waitcnt vmcnt(8)
    v_mfma_f32_16x16x32_bf16 v[56:59], a[144:147], v[128:131], v[56:59]
    v_mfma_f32_16x16x32_bf16 v[60:63], a[148:151], v[128:131], v[60:63]
    v_mfma_f32_16x16x32_bf16 v[64:67], a[152:155], v[128:131], v[64:67]
    v_mfma_f32_16x16x32_bf16 v[68:71], a[156:159], v[128:131], v[68:71]
    buffer_load_dwordx4 v198, s[24:27], s3 offen offset:2048 lds
    s_waitcnt vmcnt(8)
    v_mfma_f32_16x16x32_bf16 v[56:59], a[160:163], v[132:135], v[56:59]
    v_mfma_f32_16x16x32_bf16 v[60:63], a[164:167], v[132:135], v[60:63]
    v_mfma_f32_16x16x32_bf16 v[64:67], a[168:171], v[132:135], v[64:67]
    v_mfma_f32_16x16x32_bf16 v[68:71], a[172:175], v[132:135], v[68:71]
    s_waitcnt vmcnt(7)
    v_mfma_f32_16x16x32_bf16 v[56:59], a[176:179], v[136:139], v[56:59]
    buffer_load_dwordx4 v199, s[24:27], s3 offen offset:3072 lds
    v_mfma_f32_16x16x32_bf16 v[60:63], a[180:183], v[136:139], v[60:63]
    v_mfma_f32_16x16x32_bf16 v[64:67], a[184:187], v[136:139], v[64:67]
    v_mfma_f32_16x16x32_bf16 v[68:71], a[188:191], v[136:139], v[68:71]
    s_waitcnt vmcnt(7)
    v_mfma_f32_16x16x32_bf16 v[56:59], a[192:195], v[140:143], v[56:59]
    v_mfma_f32_16x16x32_bf16 v[60:63], a[196:199], v[140:143], v[60:63]
    s_add_u32 m0, s48, 0x18000
    s_nop 0
    buffer_load_dwordx4 v200, s[24:27], s3 offen offset:0 lds
    v_mfma_f32_16x16x32_bf16 v[64:67], a[200:203], v[140:143], v[64:67]
    v_mfma_f32_16x16x32_bf16 v[68:71], a[204:207], v[140:143], v[68:71]
    s_waitcnt vmcnt(7)
    v_mfma_f32_16x16x32_bf16 v[56:59], a[208:211], v[144:147], v[56:59]
    v_mfma_f32_16x16x32_bf16 v[60:63], a[212:215], v[144:147], v[60:63]
    v_mfma_f32_16x16x32_bf16 v[64:67], a[216:219], v[144:147], v[64:67]
    buffer_load_dwordx4 v201, s[24:27], s3 offen offset:1024 lds
    v_mfma_f32_16x16x32_bf16 v[68:71], a[220:223], v[144:147], v[68:71]
    s_waitcnt vmcnt(7)
    v_mfma_f32_16x16x32_bf16 v[56:59], a[224:227], v[148:151], v[56:59]
    v_mfma_f32_16x16x32_bf16 v[60:63], a[228:231], v[148:151], v[60:63]
    v_mfma_f32_16x16x32_bf16 v[64:67], a[232:235], v[148:151], v[64:67]
    v_mfma_f32_16x16x32_bf16 v[68:71], a[236:239], v[148:151], v[68:71]
    buffer_load_dwordx4 v202, s[24:27], s3 offen offset:2048 lds
    s_waitcnt vmcnt(7)
    v_mfma_f32_16x16x32_bf16 v[56:59], a[240:243], v[152:155], v[56:59]
    v_mfma_f32_16x16x32_bf16 v[60:63], a[244:247], v[152:155], v[60:63]
    v_mfma_f32_16x16x32_bf16 v[64:67], a[248:251], v[152:155], v[64:67]
    v_mfma_f32_16x16x32_bf16 v[68:71], a[252:255], v[152:155], v[68:71]
    v_cmp_u_f32 vcc, v56, v56
    s_nop 0
    s_cbranch_vccnz retry_51
back_52:
    s_add_u32 s71, s96, 0x10000
    v_cvt_pk_bf16_f32 v172, v56, v57
    s_add_u32 m0, s48, 0x0
    s_add_u32 s3, s77, 0xa8000
    buffer_load_dwordx4 v196, s[24:27], s3 offen offset:0 lds
    v_cvt_pk_bf16_f32 v173, v58, v59
    v_cvt_pk_bf16_f32 v174, v60, v61
    v_cvt_pk_bf16_f32 v175, v62, v63
    buffer_store_dwordx4 v[172:175], v1, s[40:43], s71 offen offset:0 sc1
    v_cvt_pk_bf16_f32 v176, v64, v65
    v_cvt_pk_bf16_f32 v177, v66, v67
    v_cvt_pk_bf16_f32 v178, v68, v69
    v_cvt_pk_bf16_f32 v179, v70, v71
    buffer_store_dwordx4 v[176:179], v1, s[40:43], s71 offen offset:1024 sc1
    v_mfma_f32_16x16x32_bf16 v[184:187], v[172:175], v[172:175], 0
    v_mfma_f32_16x16x32_bf16 v[180:183], v[28:31], v[172:175], 0
    v_mfma_f32_16x16x32_bf16 v[184:187], v[176:179], v[176:179], v[184:187]
    v_mfma_f32_16x16x32_bf16 v[180:183], v[28:31], v[176:179], v[180:183]
    s_barrier
    v_add_u32 v36, 0x20000, v32
    buffer_load_dwordx4 v197, s[24:27], s3 offen offset:1024 lds
    v_add_u32 v37, 0x20000, v33
    v_add_u32 v38, 0x20000, v34
    v_add_u32 v39, 0x20000, v35
    ds_read_b64_tr_b16 a[128:129], v36 offset:0
    ds_read_b64_tr_b16 a[130:131], v36 offset:7168
    ds_read_b64_tr_b16 a[132:133], v37 offset:32
    ds_read_b64_tr_b16 a[134:135], v37 offset:7200
    ds_read_b64_tr_b16 a[136:137], v36 offset:64
    v_cndmask_b32 v181, v184, v185, s[64:65]
    ds_read_b64_tr_b16 a[138:139], v36 offset:7232
    buffer_load_dwordx4 v198, s[24:27], s3 offen offset:2048 lds
    ds_read_b64_tr_b16 a[140:141], v37 offset:96
    v_cndmask_b32 v181, v181, v186, s[66:67]
    ds_read_b64_tr_b16 a[142:143], v37 offset:7264
    v_cndmask_b32 v181, v181, v187, s[68:69]
    ds_read_b64_tr_b16 a[144:145], v36 offset:128
    v_mov_b32 v182, s95
    ds_read_b64_tr_b16 a[146:147], v36 offset:7296
    v_add_f32 v40, v40, v56
    ds_read_b64_tr_b16 a[148:149], v37 offset:160
    v_add_f32 v41, v41, v57
    ds_read_b64_tr_b16 a[150:151], v37 offset:7328
    buffer_load_dwordx4 v199, s[24:27], s3 offen offset:3072 lds
    ds_read_b64_tr_b16 a[152:153], v36 offset:192
    v_add_f32 v42, v42, v58
    ds_read_b64_tr_b16 a[154:155], v36 offset:7360
    v_add_f32 v43, v43, v59
    ds_read_b64_tr_b16 a[156:157], v38 offset:0
    v_add_f32 v44, v44, v60
    ds_read_b64_tr_b16 a[158:159], v38 offset:7168
    v_add_f32 v45, v45, v61
    ds_read_b64_tr_b16 a[160:161], v39 offset:32
    v_add_f32 v46, v46, v62
    ds_read_b64_tr_b16 a[162:163], v39 offset:7200
    s_add_u32 m0, s48, 0x1000
    s_nop 0
    buffer_load_dwordx4 v200, s[24:27], s3 offen offset:0 lds
    ds_read_b64_tr_b16 a[164:165], v38 offset:64
    v_add_f32 v47, v47, v63
    ds_read_b64_tr_b16 a[166:167], v38 offset:7232
    v_add_f32 v48, v48, v64
    ds_read_b64_tr_b16 a[168:169], v39 offset:96
    v_add_f32 v49, v49, v65
    ds_read_b64_tr_b16 a[170:171], v39 offset:7264
    v_add_f32 v50, v50, v66
    ds_read_b64_tr_b16 a[172:173], v38 offset:128
    v_add_f32 v51, v51, v67
    ds_read_b64_tr_b16 a[174:175], v38 offset:7296
    buffer_load_dwordx4 v201, s[24:27], s3 offen offset:1024 lds
    ds_read_b64_tr_b16 a[176:177], v39 offset:160
    v_add_f32 v52, v52, v68
    ds_read_b64_tr_b16 a[178:179], v39 offset:7328
    v_add_f32 v53, v53, v69
    ds_read_b64_tr_b16 a[180:181], v38 offset:192
    v_add_f32 v54, v54, v70
    ds_read_b64_tr_b16 a[182:183], v38 offset:7360
    v_add_f32 v55, v55, v71
    v_add_u32 v36, 0x10000, v32
    v_add_u32 v37, 0x10000, v33
    v_add_u32 v38, 0x10000, v34
    buffer_load_dwordx4 v202, s[24:27], s3 offen offset:2048 lds
    v_add_u32 v39, 0x10000, v35
    ds_read_b64_tr_b16 a[184:185], v36 offset:0
    v_cmp_eq_u32 vcc, 0, v5
    ds_read_b64_tr_b16 a[186:187], v36 offset:7168
    s_nop 0
    v_cndmask_b32 v204, v3, v28, vcc
    ds_read_b64_tr_b16 a[188:189], v37 offset:32
    v_cndmask_b32 v205, v3, v28, vcc
    ds_read_b64_tr_b16 a[190:191], v37 offset:7200
    v_cndmask_b32 v206, v3, v28, vcc
    ds_read_b64_tr_b16 a[192:193], v36 offset:64
    s_add_u32 m0, s48, 0x7000
    s_sub_u32 s3, 0xe0000, s77
    buffer_load_dwordx4 v196, s[24:27], s3 offen offset:0 lds
    ds_read_b64_tr_b16 a[194:195], v36 offset:7232
    v_cndmask_b32 v207, v3, v28, vcc
    ds_read_b64_tr_b16 a[196:197], v37 offset:96
    v_cmp_eq_u32 vcc, 1, v5
    ds_read_b64_tr_b16 a[198:199], v37 offset:7264
    s_nop 0
    v_cndmask_b32 v208, v3, v28, vcc
    ds_read_b64_tr_b16 a[200:201], v36 offset:128
    v_cndmask_b32 v209, v3, v28, vcc
    ds_read_b64_tr_b16 a[202:203], v36 offset:7296
    v_cndmask_b32 v210, v3, v28, vcc
    ds_read_b64_tr_b16 a[204:205], v37 offset:160
    buffer_load_dwordx4 v197, s[24:27], s3 offen offset:1024 lds
    ds_read_b64_tr_b16 a[206:207], v37 offset:7328
    v_cndmask_b32 v211, v3, v28, vcc
    ds_read_b64_tr_b16 a[208:209], v36 offset:192
    v_cmp_eq_u32 vcc, 2, v5
    ds_read_b64_tr_b16 a[210:211], v36 offset:7360
    s_nop 0
    v_cndmask_b32 v212, v3, v28, vcc
    ds_read_b64_tr_b16 a[212:213], v38 offset:0
    v_cndmask_b32 v213, v3, v28, vcc
    ds_read_b64_tr_b16 a[214:215], v38 offset:7168
    v_cndmask_b32 v214, v3, v28, vcc
    ds_read_b64_tr_b16 a[216:217], v39 offset:32
    buffer_load_dwordx4 v198, s[24:27], s3 offen offset:2048 lds
    ds_read_b64_tr_b16 a[218:219], v39 offset:7200
    v_cndmask_b32 v215, v3, v28, vcc
    ds_read_b64_tr_b16 a[220:221], v38 offset:64
    v_cmp_eq_u32 vcc, 3, v5
    ds_read_b64_tr_b16 a[222:223], v38 offset:7232
    s_nop 0
    v_cndmask_b32 v216, v3, v28, vcc
    ds_read_b64_tr_b16 a[224:225], v39 offset:96
    v_cndmask_b32 v217, v3, v28, vcc
    ds_read_b64_tr_b16 a[226:227], v39 offset:7264
    v_cndmask_b32 v218, v3, v28, vcc
    ds_read_b64_tr_b16 a[228:229], v38 offset:128
    buffer_load_dwordx4 v199, s[24:27], s3 offen offset:3072 lds
    ds_read_b64_tr_b16 a[230:231], v38 offset:7296
    v_cndmask_b32 v219, v3, v28, vcc
    ds_read_b64_tr_b16 a[232:233], v39 offset:160
    v_cmp_eq_u32 vcc, 4, v5
    ds_read_b64_tr_b16 a[234:235], v39 offset:7328
    s_nop 0
    v_cndmask_b32 v220, v3, v28, vcc
    ds_read_b64_tr_b16 a[236:237], v38 offset:192
    v_cndmask_b32 v221, v3, v28, vcc
    ds_read_b64_tr_b16 a[238:239], v38 offset:7360
    v_cndmask_b32 v222, v3, v28, vcc
    v_cndmask_b32 v223, v3, v28, vcc
    s_add_u32 m0, s48, 0x8000
    s_nop 0
    buffer_load_dwordx4 v200, s[24:27], s3 offen offset:0 lds
    v_cmp_eq_u32 vcc, 5, v5
    s_nop 1
    v_cndmask_b32 v224, v3, v28, vcc
    v_cndmask_b32 v225, v3, v28, vcc
    v_cndmask_b32 v226, v3, v28, vcc
    v_cndmask_b32 v227, v3, v28, vcc
    v_cmp_eq_u32 vcc, 6, v5
    s_nop 1
    v_cndmask_b32 v228, v3, v28, vcc
    v_cndmask_b32 v229, v3, v28, vcc
    v_cndmask_b32 v230, v3, v28, vcc
    v_cndmask_b32 v231, v3, v28, vcc
    s_lshr_b32 s72, s46, 1
    s_lshl_b32 s71, s72, 11
    s_add_u32 s70, s78, s71
    s_add_u32 s70, s70, 0x28000
    s_add_u32 s71, s70, 0x4000
    s_mul_i32 s72, s72, 40960
    s_lshl_b32 s73, s46, 14
    s_add_u32 s72, s72, s73
    s_and_b32 s73, s44, 1
    s_lshl_b32 s73, s73, 13
    s_xor_b32 s58, s73, 0x0
    s_add_u32 s58, s58, s97
    s_add_u32 s58, s58, 0x10000
    s_xor_b32 s59, s73, 0x1000
    s_add_u32 s59, s59, s97
    s_add_u32 s59, s59, 0x10000
    s_xor_b32 s60, s73, 0x2000
    s_add_u32 s60, s60, s97
    s_add_u32 s60, s60, 0x10000
    s_xor_b32 s61, s73, 0x3000
    s_add_u32 s61, s61, s97
    s_add_u32 s61, s61, 0x10000
    s_waitcnt lgkmcnt(15)
    v_mfma_f32_16x16x32_bf16 v[84:87], a[128:131], v[204:207], 0
    buffer_load_dwordx4 v201, s[24:27], s3 offen offset:1024 lds
    v_mfma_f32_16x16x32_bf16 v[84:87], a[132:135], v[208:211], v[84:87]
    v_mfma_f32_16x16x32_bf16 v[84:87], a[136:139], v[212:215], v[84:87]
    v_mfma_f32_16x16x32_bf16 v[84:87], a[140:143], v[216:219], v[84:87]
    v_mfma_f32_16x16x32_bf16 v[84:87], a[144:147], v[220:223], v[84:87]
    v_mfma_f32_16x16x32_bf16 v[84:87], a[148:151], v[224:227], v[84:87]
    buffer_load_dwordx4 v202, s[24:27], s3 offen offset:2048 lds
    v_mfma_f32_16x16x32_bf16 v[84:87], a[152:155], v[228:231], v[84:87]
    s_waitcnt vmcnt(13)
    buffer_store_dwordx3 v[180:182], v26, s[40:43], s56 offen offset:512 sc1
    s_waitcnt lgkmcnt(0)
    s_barrier
    v_mfma_f32_16x16x32_bf16 v[84:87], a[184:187], v[204:207], v[84:87]
    v_mfma_f32_16x16x32_bf16 v[84:87], a[188:191], v[208:211], v[84:87]
    v_mfma_f32_16x16x32_bf16 v[84:87], a[192:195], v[212:215], v[84:87]
    v_mfma_f32_16x16x32_bf16 v[84:87], a[196:199], v[216:219], v[84:87]
    v_mfma_f32_16x16x32_bf16 v[84:87], a[200:203], v[220:223], v[84:87]
    v_mfma_f32_16x16x32_bf16 v[84:87], a[204:207], v[224:227], v[84:87]
    v_mfma_f32_16x16x32_bf16 v[84:87], a[208:211], v[228:231], v[84:87]
    buffer_load_dwordx3 v[56:58], v13, s[40:43], s70 offen offset:512 sc1
    buffer_load_dwordx3 v[60:62], v13, s[40:43], s71 offen offset:512 sc1
    buffer_load_dwordx3 v[64:66], v13, s[40:43], s70 offen offset:1536 sc1
    buffer_load_dwordx3 v[68:70], v13, s[40:43], s71 offen offset:1536 sc1
    v_add_u32 v36, 0x17000, v32
    v_add_u32 v37, 0x17000, v33
    v_add_u32 v38, 0x17000, v34
    v_add_u32 v39, 0x17000, v35
    ds_read_b64_tr_b16 v[152:153], v36 offset:0
    ds_read_b64_tr_b16 v[154:155], v36 offset:7168
    ds_read_b64_tr_b16 v[156:157], v37 offset:32
    ds_read_b64_tr_b16 v[158:159], v37 offset:7200
    ds_read_b64_tr_b16 v[160:161], v36 offset:64
    ds_read_b64_tr_b16 v[162:163], v36 offset:7232
    ds_read_b64_tr_b16 v[164:165], v37 offset:96
    ds_read_b64_tr_b16 v[166:167], v37 offset:7264
    ds_read_b64_tr_b16 v[168:169], v36 offset:128
    ds_read_b64_tr_b16 v[170:171], v36 offset:7296
    ds_read_b64_tr_b16 v[172:173], v37 offset:160
    ds_read_b64_tr_b16 v[174:175], v37 offset:7328
    ds_read_b64_tr_b16 v[176:177], v36 offset:192
    ds_read_b64_tr_b16 v[178:179], v36 offset:7360
    ds_read_b64_tr_b16 v[180:181], v38 offset:0
    ds_read_b64_tr_b16 v[182:183], v38 offset:7168
    ds_read_b64_tr_b16 v[184:185], v39 offset:32
    ds_read_b64_tr_b16 v[186:187], v39 offset:7200
    ds_read_b64_tr_b16 v[232:233], v38 offset:64
    ds_read_b64_tr_b16 v[234:235], v38 offset:7232
    ds_read_b64_tr_b16 v[236:237], v39 offset:96
    ds_read_b64_tr_b16 v[238:239], v39 offset:7264
    ds_read_b64_tr_b16 v[240:241], v38 offset:128
    ds_read_b64_tr_b16 v[242:243], v38 offset:7296
    ds_read_b64_tr_b16 v[244:245], v39 offset:160
    ds_read_b64_tr_b16 v[246:247], v39 offset:7328
    ds_read_b64_tr_b16 v[248:249], v38 offset:192
    ds_read_b64_tr_b16 v[250:251], v38 offset:7360
    s_waitcnt lgkmcnt(15)
    v_mfma_f32_16x16x32_bf16 v[84:87], v[152:155], v[204:207], v[84:87]
    v_mfma_f32_16x16x32_bf16 v[84:87], v[156:159], v[208:211], v[84:87]
    v_mfma_f32_16x16x32_bf16 v[84:87], v[160:163], v[212:215], v[84:87]
    v_mfma_f32_16x16x32_bf16 v[84:87], v[164:167], v[216:219], v[84:87]
    v_mfma_f32_16x16x32_bf16 v[84:87], v[168:171], v[220:223], v[84:87]
    v_mfma_f32_16x16x32_bf16 v[84:87], v[172:175], v[224:227], v[84:87]
    s_waitcnt lgkmcnt(14)
    v_mfma_f32_16x16x32_bf16 v[84:87], v[176:179], v[228:231], v[84:87]
    s_waitcnt vmcnt(3)
    v_cmp_ne_u32 vcc, s95, v58
    s_waitcnt vmcnt(2)
    v_cmp_ne_u32 s[74:75], s95, v62
    s_or_b64 vcc, vcc, s[74:75]
    s_waitcnt vmcnt(1)
    v_cmp_ne_u32 s[74:75], s95, v66
    s_or_b64 vcc, vcc, s[74:75]
    s_waitcnt vmcnt(0)
    v_cmp_ne_u32 s[74:75], s95, v70
    s_or_b64 vcc, vcc, s[74:75]
    s_cbranch_vccz polled_54
    s_mov_b32 s57, 0x40000
poll_53:
    buffer_load_dwordx3 v[56:58], v13, s[40:43], s70 offen offset:512 sc1
    buffer_load_dwordx3 v[60:62], v13, s[40:43], s71 offen offset:512 sc1
    buffer_load_dwordx3 v[64:66], v13, s[40:43], s70 offen offset:1536 sc1
    buffer_load_dwordx3 v[68:70], v13, s[40:43], s71 offen offset:1536 sc1
    s_waitcnt vmcnt(3)
    v_cmp_ne_u32 vcc, s95, v58
    s_waitcnt vmcnt(2)
    v_cmp_ne_u32 s[74:75], s95, v62
    s_or_b64 vcc, vcc, s[74:75]
    s_waitcnt vmcnt(1)
    v_cmp_ne_u32 s[74:75], s95, v66
    s_or_b64 vcc, vcc, s[74:75]
    s_waitcnt vmcnt(0)
    v_cmp_ne_u32 s[74:75], s95, v70
    s_or_b64 vcc, vcc, s[74:75]
    s_cbranch_vccz polled_54
    s_sub_u32 s57, s57, 1
    s_cbranch_scc0 poll_53
polled_54:
    buffer_inv sc1
    s_waitcnt vmcnt(0)
    s_add_u32 m0, s72, 0xe000
    s_nop 0
    buffer_load_dwordx4 v1, s[40:43], s58 offen offset:0 sc1 lds
    buffer_load_dwordx4 v1, s[40:43], s58 offen offset:1024 sc1 lds
    buffer_load_dwordx4 v1, s[40:43], s58 offen offset:2048 sc1 lds
    buffer_load_dwordx4 v1, s[40:43], s58 offen offset:3072 sc1 lds
    v_add_f32 v56, v56, v60
    v_add_f32 v64, v64, v68
    v_add_f32 v57, v57, v61
    v_add_f32 v65, v65, v69
    s_nop 0
    v_permlane32_swap_b32 v56, v57
    v_permlane32_swap_b32 v64, v65
    v_add_f32 v56, v56, v57
    v_add_f32 v64, v64, v65
    v_mov_b32 v57, v56
    v_mov_b32 v65, v64
    s_nop 0
    v_permlane16_swap_b32 v56, v57
    v_permlane16_swap_b32 v64, v65
    v_add_f32 v56, v56, v57
    s_add_u32 m0, s72, 0xf000
    s_nop 0
    buffer_load_dwordx4 v1, s[40:43], s59 offen offset:0 sc1 lds
    v_add_f32 v64, v64, v65
    v_mov_b32 v57, v56
    v_mov_b32 v65, v64
    s_nop 0
    v_permlane32_swap_b32 v56, v57
    v_permlane32_swap_b32 v64, v65
    v_mul_f32 v7, 0x3b000000, v56
    v_mul_f32 v148, 0x3b000000, v64
    v_mul_f32 v57, 0x3b000000, v57
    v_mul_f32 v65, 0x3b000000, v65
    v_fma_f32 v57, -v7, v7, v57
    v_fma_f32 v65, -v148, v148, v65
    v_max_f32 v57, 0, v57
    v_max_f32 v65, 0, v65
    buffer_load_dwordx4 v1, s[40:43], s59 offen offset:1024 sc1 lds
    v_add_f32 v192, 0x3727c5ac, v57
    v_add_f32 v193, 0x3727c5ac, v65
    v_rsq_f32 v192, v192
    v_rsq_f32 v193, v193
    v_mul_f32 v22, 0xc0135761, v192
    v_mul_f32 v82, 0xc0135761, v193
    v_mul_f32 v23, v192, v192
    v_mul_f32 v83, v193, v193
    v_mul_f32 v23, v23, v22
    v_mul_f32 v83, v83, v82
    v_mul_f32 v23, 0x3d372713, v23
    buffer_load_dwordx4 v1, s[40:43], s59 offen offset:2048 sc1 lds
    v_mul_f32 v83, 0x3d372713, v83
    v_rcp_f32 v72, v192
    v_rcp_f32 v90, v193
    v_mov_b32 v149, v7
    s_lshl_b32 s70, s46, 8
    v_lshl_add_u32 v56, v5, 4, s70
    v_lshl_add_u32 v56, v4, 10, v56
    v_add_u32 v57, 0x1e000, v56
    s_lshr_b32 s70, s46, 1
    s_lshl_b32 s70, s70, 9
    s_bitcmp1_b32 s46, 0
    s_cselect_b32 s73, 0x10000, 0
    s_add_u32 s70, s70, s73
    s_add_u32 s70, s70, 0xe000
    v_and_b32 v9, 31, v0
    buffer_load_dwordx4 v1, s[40:43], s59 offen offset:3072 sc1 lds
    v_lshl_add_u32 v9, v9, 4, s70
    v_lshrrev_b32 v10, 5, v0
    v_lshl_add_u32 v21, v10, 10, v9
    s_and_b32 s70, s46, 1
    v_bfe_u32 v8, v0, 2, 2
    v_lshl_add_u32 v9, v10, 3, v8
    v_lshlrev_b32 v9, 7, v9
    v_lshlrev_b32 v8, 5, v8
    v_and_b32 v8, 64, v8
    s_lshl_b32 s70, s70, 6
    v_xor_b32 v8, s70, v8
    v_add3_u32 v9, v9, v8, s49
    v_and_b32 v8, 16, v0
    s_add_u32 m0, s72, 0x10000
    s_nop 0
    buffer_load_dwordx4 v1, s[40:43], s60 offen offset:0 sc1 lds
    v_lshl_add_u32 v9, v8, 1, v9
    v_and_b32 v8, 3, v0
    v_lshl_add_u32 v58, v8, 3, v9
    v_xor_b32 v59, 64, v58
    buffer_load_dwordx4 v1, s[40:43], s60 offen offset:1024 sc1 lds
    buffer_load_dwordx4 v1, s[40:43], s60 offen offset:2048 sc1 lds
    buffer_load_dwordx4 v1, s[40:43], s60 offen offset:3072 sc1 lds
    s_add_u32 m0, s72, 0x11000
    s_nop 0
    buffer_load_dwordx4 v1, s[40:43], s61 offen offset:0 sc1 lds
    s_waitcnt vmcnt(7)
    s_waitcnt lgkmcnt(0)
    s_barrier
    ds_read_b128 a[0:3], v74 offset:0
    ds_read_b128 a[4:7], v74 offset:16384
    ds_read_b128 a[8:11], v75 offset:1024
    ds_read_b128 a[12:15], v75 offset:17408
    s_waitcnt lgkmcnt(3)
    v_mfma_f32_16x16x32_bf16 v[92:95], a[128:131], a[0:3], 0
    ds_read_b128 a[16:19], v74 offset:2048
    s_waitcnt lgkmcnt(3)
    v_mfma_f32_16x16x32_bf16 v[96:99], a[128:131], a[4:7], 0
    ds_read_b128 a[20:23], v74 offset:18432
    ds_read_b128 a[24:27], v75 offset:3072
    buffer_load_dwordx4 v1, s[40:43], s61 offen offset:1024 sc1 lds
    v_mfma_f32_16x16x32_bf16 v[100:103], a[132:135], a[0:3], 0
    ds_read_b128 a[28:31], v75 offset:19456
    v_mfma_f32_16x16x32_bf16 v[104:107], a[132:135], a[4:7], 0
    ds_read_b128 a[32:35], v74 offset:4096
    ds_read_b128 a[36:39], v74 offset:20480
    v_mfma_f32_16x16x32_bf16 v[108:111], a[136:139], a[0:3], 0
    ds_read_b128 a[40:43], v75 offset:5120
    v_mfma_f32_16x16x32_bf16 v[112:115], a[136:139], a[4:7], 0
    ds_read_b128 a[44:47], v75 offset:21504
    buffer_load_dwordx4 v1, s[40:43], s61 offen offset:2048 sc1 lds
    v_mfma_f32_16x16x32_bf16 v[116:119], a[140:143], a[0:3], 0
    v_mfma_f32_16x16x32_bf16 v[120:123], a[140:143], a[4:7], 0
    v_mfma_f32_16x16x32_bf16 v[124:127], a[144:147], a[0:3], 0
    v_mfma_f32_16x16x32_bf16 v[128:131], a[144:147], a[4:7], 0
    v_mfma_f32_16x16x32_bf16 v[132:135], a[148:151], a[0:3], 0
    buffer_load_dwordx4 v1, s[40:43], s61 offen offset:3072 sc1 lds
    v_mfma_f32_16x16x32_bf16 v[136:139], a[148:151], a[4:7], 0
    v_mfma_f32_16x16x32_bf16 v[140:143], a[152:155], a[0:3], 0
    v_mfma_f32_16x16x32_bf16 v[144:147], a[152:155], a[4:7], 0
    s_waitcnt lgkmcnt(9)
    v_mfma_f32_16x16x32_bf16 v[92:95], a[156:159], a[8:11], v[92:95]
    s_waitcnt lgkmcnt(8)
    v_mfma_f32_16x16x32_bf16 v[96:99], a[156:159], a[12:15], v[96:99]
    buffer_load_dword v6, v27, s[28:31], s84 offen
    v_mfma_f32_16x16x32_bf16 v[100:103], a[160:163], a[8:11], v[100:103]
    v_mfma_f32_16x16x32_bf16 v[104:107], a[160:163], a[12:15], v[104:107]
    v_mfma_f32_16x16x32_bf16 v[108:111], a[164:167], a[8:11], v[108:111]
    v_mfma_f32_16x16x32_bf16 v[112:115], a[164:167], a[12:15], v[112:115]
    v_mfma_f32_16x16x32_bf16 v[116:119], a[168:171], a[8:11], v[116:119]
    s_add_u32 m0, s48, 0x17000
    s_sub_u32 s3, 0x118000, s77
    buffer_load_dwordx4 v196, s[24:27], s3 offen offset:0 lds
    v_mfma_f32_16x16x32_bf16 v[120:123], a[168:171], a[12:15], v[120:123]
    v_mfma_f32_16x16x32_bf16 v[124:127], a[172:175], a[8:11], v[124:127]
    v_mfma_f32_16x16x32_bf16 v[128:131], a[172:175], a[12:15], v[128:131]
    v_mfma_f32_16x16x32_bf16 v[132:135], a[176:179], a[8:11], v[132:135]
    v_mfma_f32_16x16x32_bf16 v[136:139], a[176:179], a[12:15], v[136:139]
    buffer_load_dwordx4 v197, s[24:27], s3 offen offset:1024 lds
    v_mfma_f32_16x16x32_bf16 v[140:143], a[180:183], a[8:11], v[140:143]
    v_mfma_f32_16x16x32_bf16 v[144:147], a[180:183], a[12:15], v[144:147]
    s_waitcnt vmcnt(3)
    s_waitcnt lgkmcnt(0)
    s_barrier
    v_mfma_f32_16x16x32_bf16 v[92:95], a[184:187], a[16:19], v[92:95]
    ds_read_b128 a[48:51], v74 offset:6144
    v_mfma_f32_16x16x32_bf16 v[96:99], a[184:187], a[20:23], v[96:99]
    ds_read_b128 a[52:55], v74 offset:22528
    ds_read_b128 a[56:59], v75 offset:7168
    buffer_load_dwordx4 v198, s[24:27], s3 offen offset:2048 lds
    v_mfma_f32_16x16x32_bf16 v[100:103], a[188:191], a[16:19], v[100:103]
    ds_read_b128 a[60:63], v75 offset:23552
    v_mfma_f32_16x16x32_bf16 v[104:107], a[188:191], a[20:23], v[104:107]
    ds_read_b128 a[64:67], v74 offset:8192
    ds_read_b128 a[68:71], v74 offset:24576
    v_mfma_f32_16x16x32_bf16 v[108:111], a[192:195], a[16:19], v[108:111]
    ds_read_b128 a[72:75], v75 offset:9216
    v_mfma_f32_16x16x32_bf16 v[112:115], a[192:195], a[20:23], v[112:115]
    ds_read_b128 a[76:79], v75 offset:25600
    ds_read_b128 a[80:83], v74 offset:10240
    buffer_load_dwordx4 v199, s[24:27], s3 offen offset:3072 lds
    v_mfma_f32_16x16x32_bf16 v[116:119], a[196:199], a[16:19], v[116:119]
    ds_read_b128 a[84:87], v74 offset:26624
    v_mfma_f32_16x16x32_bf16 v[120:123], a[196:199], a[20:23], v[120:123]
    ds_read_b128 a[88:91], v75 offset:11264
    ds_read_b128 a[92:95], v75 offset:27648
    v_mfma_f32_16x16x32_bf16 v[124:127], a[200:203], a[16:19], v[124:127]
    ds_read_b128 a[96:99], v74 offset:12288
    v_mfma_f32_16x16x32_bf16 v[128:131], a[200:203], a[20:23], v[128:131]
    ds_read_b128 a[100:103], v74 offset:28672
    ds_read_b128 a[104:107], v75 offset:13312
    s_add_u32 m0, s48, 0x18000
    s_nop 0
    buffer_load_dwordx4 v200, s[24:27], s3 offen offset:0 lds
    v_mfma_f32_16x16x32_bf16 v[132:135], a[204:207], a[16:19], v[132:135]
    ds_read_b128 a[108:111], v75 offset:29696
    v_mfma_f32_16x16x32_bf16 v[136:139], a[204:207], a[20:23], v[136:139]
    ds_read_b128 a[112:115], v74 offset:14336
    ds_read_b128 a[116:119], v74 offset:30720
    v_mfma_f32_16x16x32_bf16 v[140:143], a[208:211], a[16:19], v[140:143]
    ds_read_b128 a[120:123], v75 offset:15360
    v_mfma_f32_16x16x32_bf16 v[144:147], a[208:211], a[20:23], v[144:147]
    ds_read_b128 a[124:127], v75 offset:31744
    buffer_load_dwordx4 v201, s[24:27], s3 offen offset:1024 lds
    v_mfma_f32_16x16x32_bf16 v[92:95], a[212:215], a[24:27], v[92:95]
    v_mfma_f32_16x16x32_bf16 v[96:99], a[212:215], a[28:31], v[96:99]
    v_mfma_f32_16x16x32_bf16 v[100:103], a[216:219], a[24:27], v[100:103]
    v_mfma_f32_16x16x32_bf16 v[104:107], a[216:219], a[28:31], v[104:107]
    v_mfma_f32_16x16x32_bf16 v[108:111], a[220:223], a[24:27], v[108:111]
    buffer_load_dwordx4 v202, s[24:27], s3 offen offset:2048 lds
    v_mfma_f32_16x16x32_bf16 v[112:115], a[220:223], a[28:31], v[112:115]
    v_mfma_f32_16x16x32_bf16 v[116:119], a[224:227], a[24:27], v[116:119]
    v_mfma_f32_16x16x32_bf16 v[120:123], a[224:227], a[28:31], v[120:123]
    v_mfma_f32_16x16x32_bf16 v[124:127], a[228:231], a[24:27], v[124:127]
    v_mfma_f32_16x16x32_bf16 v[128:131], a[228:231], a[28:31], v[128:131]
    s_add_u32 s3, s84, 0x4000
    buffer_load_dword v6, v27, s[28:31], s3 offen
    v_mfma_f32_16x16x32_bf16 v[132:135], a[232:235], a[24:27], v[132:135]
    v_mfma_f32_16x16x32_bf16 v[136:139], a[232:235], a[28:31], v[136:139]
    v_mfma_f32_16x16x32_bf16 v[140:143], a[236:239], a[24:27], v[140:143]
    v_mfma_f32_16x16x32_bf16 v[144:147], a[236:239], a[28:31], v[144:147]
    s_waitcnt lgkmcnt(0)
    s_barrier
    v_mfma_f32_16x16x32_bf16 v[92:95], v[152:155], a[32:35], v[92:95]
    v_add_u32 v36, 0x0, v32
    s_add_u32 s3, s84, 0x18000
    buffer_load_dword v6, v27, s[28:31], s3 offen
    v_mfma_f32_16x16x32_bf16 v[96:99], v[152:155], a[36:39], v[96:99]
    v_add_u32 v37, 0x0, v33
    v_add_u32 v38, 0x0, v34
    v_mfma_f32_16x16x32_bf16 v[100:103], v[156:159], a[32:35], v[100:103]
    v_add_u32 v39, 0x0, v35
    v_mfma_f32_16x16x32_bf16 v[104:107], v[156:159], a[36:39], v[104:107]
    ds_read_b64_tr_b16 a[184:185], v36 offset:0
    ds_read_b64_tr_b16 a[186:187], v36 offset:7168
    v_mfma_f32_16x16x32_bf16 v[108:111], v[160:163], a[32:35], v[108:111]
    ds_read_b64_tr_b16 a[188:189], v37 offset:32
    buffer_store_dword v24, v2, s[40:43], s56 offen offset:148 sc1
    v_mfma_f32_16x16x32_bf16 v[112:115], v[160:163], a[36:39], v[112:115]
    ds_read_b64_tr_b16 a[190:191], v37 offset:7200
    ds_read_b64_tr_b16 a[192:193], v36 offset:64
    v_mfma_f32_16x16x32_bf16 v[116:119], v[164:167], a[32:35], v[116:119]
    ds_read_b64_tr_b16 a[194:195], v36 offset:7232
    v_mfma_f32_16x16x32_bf16 v[120:123], v[164:167], a[36:39], v[120:123]
    ds_read_b64_tr_b16 a[196:197], v37 offset:96
    ds_read_b64_tr_b16 a[198:199], v37 offset:7264
    v_mfma_f32_16x16x32_bf16 v[124:127], v[168:171], a[32:35], v[124:127]
    ds_read_b64_tr_b16 a[200:201], v36 offset:128
    s_add_u32 m0, s48, 0x10000
    s_sub_u32 s3, 0x150000, s77
    buffer_load_dwordx4 v196, s[24:27], s3 offen offset:0 lds
    v_mfma_f32_16x16x32_bf16 v[128:131], v[168:171], a[36:39], v[128:131]
    ds_read_b64_tr_b16 a[202:203], v36 offset:7296
    ds_read_b64_tr_b16 a[204:205], v37 offset:160
    v_mfma_f32_16x16x32_bf16 v[132:135], v[172:175], a[32:35], v[132:135]
    ds_read_b64_tr_b16 a[206:207], v37 offset:7328
    v_mfma_f32_16x16x32_bf16 v[136:139], v[172:175], a[36:39], v[136:139]
    ds_read_b64_tr_b16 a[208:209], v36 offset:192
    ds_read_b64_tr_b16 a[210:211], v36 offset:7360
    v_mfma_f32_16x16x32_bf16 v[140:143], v[176:179], a[32:35], v[140:143]
    ds_read_b64_tr_b16 a[212:213], v38 offset:0
    buffer_load_dwordx4 v197, s[24:27], s3 offen offset:1024 lds
    v_mfma_f32_16x16x32_bf16 v[144:147], v[176:179], a[36:39], v[144:147]
    ds_read_b64_tr_b16 a[214:215], v38 offset:7168
    ds_read_b64_tr_b16 a[216:217], v39 offset:32
    v_mfma_f32_16x16x32_bf16 v[92:95], v[180:183], a[40:43], v[92:95]
    ds_read_b64_tr_b16 a[218:219], v39 offset:7200
    v_mfma_f32_16x16x32_bf16 v[96:99], v[180:183], a[44:47], v[96:99]
    ds_read_b64_tr_b16 a[220:221], v38 offset:64
    ds_read_b64_tr_b16 a[222:223], v38 offset:7232
    v_mfma_f32_16x16x32_bf16 v[100:103], v[184:187], a[40:43], v[100:103]
    ds_read_b64_tr_b16 a[224:225], v39 offset:96
    buffer_load_dwordx4 v198, s[24:27], s3 offen offset:2048 lds
    v_mfma_f32_16x16x32_bf16 v[104:107], v[184:187], a[44:47], v[104:107]
    ds_read_b64_tr_b16 a[226:227], v39 offset:7264
    ds_read_b64_tr_b16 a[228:229], v38 offset:128
    v_mfma_f32_16x16x32_bf16 v[108:111], v[232:235], a[40:43], v[108:111]
    ds_read_b64_tr_b16 a[230:231], v38 offset:7296
    v_mfma_f32_16x16x32_bf16 v[112:115], v[232:235], a[44:47], v[112:115]
    ds_read_b64_tr_b16 a[232:233], v39 offset:160
    ds_read_b64_tr_b16 a[234:235], v39 offset:7328
    v_mfma_f32_16x16x32_bf16 v[116:119], v[236:239], a[40:43], v[116:119]
    ds_read_b64_tr_b16 a[236:237], v38 offset:192
    buffer_load_dwordx4 v199, s[24:27], s3 offen offset:3072 lds
    v_mfma_f32_16x16x32_bf16 v[120:123], v[236:239], a[44:47], v[120:123]
    ds_read_b64_tr_b16 a[238:239], v38 offset:7360
    ds_write_b128 v56, v[40:43] offset:57344
    v_mfma_f32_16x16x32_bf16 v[124:127], v[240:243], a[40:43], v[124:127]
    ds_write_b128 v56, v[44:47] offset:61440
    v_mfma_f32_16x16x32_bf16 v[128:131], v[240:243], a[44:47], v[128:131]
    ds_write_b128 v57, v[48:51] offset:0
    ds_write_b128 v57, v[52:55] offset:4096
    s_add_u32 m0, s48, 0x11000
    s_nop 0
    buffer_load_dwordx4 v200, s[24:27], s3 offen offset:0 lds
    v_mfma_f32_16x16x32_bf16 v[132:135], v[244:247], a[40:43], v[132:135]
    v_mfma_f32_16x16x32_bf16 v[136:139], v[244:247], a[44:47], v[136:139]
    v_mfma_f32_16x16x32_bf16 v[140:143], v[248:251], a[40:43], v[140:143]
    v_mfma_f32_16x16x32_bf16 v[144:147], v[248:251], a[44:47], v[144:147]
    s_waitcnt lgkmcnt(0)
    s_barrier
    v_mfma_f32_16x16x32_bf16 v[92:95], a[184:187], a[48:51], v[92:95]
    v_add_u32 v36, 0x7000, v32
    buffer_load_dwordx4 v201, s[24:27], s3 offen offset:1024 lds
    v_mfma_f32_16x16x32_bf16 v[96:99], a[184:187], a[52:55], v[96:99]
    v_add_u32 v37, 0x7000, v33
    v_add_u32 v38, 0x7000, v34
    v_mfma_f32_16x16x32_bf16 v[84:87], a[184:187], v[204:207], v[84:87]
    v_add_u32 v39, 0x7000, v35
    v_mfma_f32_16x16x32_bf16 v[100:103], a[188:191], a[48:51], v[100:103]
    ds_read_b64_tr_b16 a[128:129], v36 offset:0
    ds_read_b64_tr_b16 a[130:131], v36 offset:7168
    v_mfma_f32_16x16x32_bf16 v[104:107], a[188:191], a[52:55], v[104:107]
    ds_read_b64_tr_b16 a[132:133], v37 offset:32
    buffer_load_dwordx4 v202, s[24:27], s3 offen offset:2048 lds
    v_mfma_f32_16x16x32_bf16 v[84:87], a[188:191], v[208:211], v[84:87]
    ds_read_b64_tr_b16 a[134:135], v37 offset:7200
    ds_read_b64_tr_b16 a[136:137], v36 offset:64
    v_mfma_f32_16x16x32_bf16 v[108:111], a[192:195], a[48:51], v[108:111]
    ds_read_b64_tr_b16 a[138:139], v36 offset:7232
    v_mfma_f32_16x16x32_bf16 v[112:115], a[192:195], a[52:55], v[112:115]
    ds_read_b64_tr_b16 a[140:141], v37 offset:96
    ds_read_b64_tr_b16 a[142:143], v37 offset:7264
    v_mfma_f32_16x16x32_bf16 v[84:87], a[192:195], v[212:215], v[84:87]
    ds_read_b64_tr_b16 a[144:145], v36 offset:128
    s_add_u32 m0, s48, 0x20000
    s_sub_u32 s3, 0x188000, s77
    buffer_load_dwordx4 v196, s[24:27], s3 offen offset:0 lds
    v_mfma_f32_16x16x32_bf16 v[116:119], a[196:199], a[48:51], v[116:119]
    ds_read_b64_tr_b16 a[146:147], v36 offset:7296
    ds_read_b64_tr_b16 a[148:149], v37 offset:160
    v_mfma_f32_16x16x32_bf16 v[120:123], a[196:199], a[52:55], v[120:123]
    ds_read_b64_tr_b16 a[150:151], v37 offset:7328
    v_mfma_f32_16x16x32_bf16 v[84:87], a[196:199], v[216:219], v[84:87]
    ds_read_b64_tr_b16 a[152:153], v36 offset:192
    ds_read_b64_tr_b16 a[154:155], v36 offset:7360
    v_mfma_f32_16x16x32_bf16 v[124:127], a[200:203], a[48:51], v[124:127]
    ds_read_b64_tr_b16 a[156:157], v38 offset:0
    buffer_load_dwordx4 v197, s[24:27], s3 offen offset:1024 lds
    v_mfma_f32_16x16x32_bf16 v[128:131], a[200:203], a[52:55], v[128:131]
    ds_read_b64_tr_b16 a[158:159], v38 offset:7168
    ds_read_b64_tr_b16 a[160:161], v39 offset:32
    v_mfma_f32_16x16x32_bf16 v[84:87], a[200:203], v[220:223], v[84:87]
    ds_read_b64_tr_b16 a[162:163], v39 offset:7200
    v_mfma_f32_16x16x32_bf16 v[132:135], a[204:207], a[48:51], v[132:135]
    ds_read_b64_tr_b16 a[164:165], v38 offset:64
    ds_read_b64_tr_b16 a[166:167], v38 offset:7232
    v_mfma_f32_16x16x32_bf16 v[136:139], a[204:207], a[52:55], v[136:139]
    ds_read_b64_tr_b16 a[168:169], v39 offset:96
    buffer_load_dwordx4 v198, s[24:27], s3 offen offset:2048 lds
    v_mfma_f32_16x16x32_bf16 v[84:87], a[204:207], v[224:227], v[84:87]
    ds_read_b64_tr_b16 a[170:171], v39 offset:7264
    ds_read_b64_tr_b16 a[172:173], v38 offset:128
    v_mfma_f32_16x16x32_bf16 v[140:143], a[208:211], a[48:51], v[140:143]
    ds_read_b64_tr_b16 a[174:175], v38 offset:7296
    v_mfma_f32_16x16x32_bf16 v[144:147], a[208:211], a[52:55], v[144:147]
    ds_read_b64_tr_b16 a[176:177], v39 offset:160
    ds_read_b64_tr_b16 a[178:179], v39 offset:7328
    v_mfma_f32_16x16x32_bf16 v[84:87], a[208:211], v[228:231], v[84:87]
    ds_read_b64_tr_b16 a[180:181], v38 offset:192
    buffer_load_dwordx4 v199, s[24:27], s3 offen offset:3072 lds
    v_mfma_f32_16x16x32_bf16 v[92:95], a[212:215], a[56:59], v[92:95]
    ds_read_b64_tr_b16 a[182:183], v38 offset:7360
    ds_read_b128 v[40:43], v21 offset:0
    v_mfma_f32_16x16x32_bf16 v[96:99], a[212:215], a[60:63], v[96:99]
    ds_read_b128 v[44:47], v21 offset:2048
    v_mfma_f32_16x16x32_bf16 v[100:103], a[216:219], a[56:59], v[100:103]
    ds_read_b128 v[48:51], v21 offset:4096
    ds_read_b128 v[52:55], v21 offset:6144
    s_add_u32 m0, s48, 0x21000
    s_nop 0
    buffer_load_dwordx4 v200, s[24:27], s3 offen offset:0 lds
    v_mfma_f32_16x16x32_bf16 v[104:107], a[216:219], a[60:63], v[104:107]
    v_mfma_f32_16x16x32_bf16 v[108:111], a[220:223], a[56:59], v[108:111]
    v_mfma_f32_16x16x32_bf16 v[112:115], a[220:223], a[60:63], v[112:115]
    v_mfma_f32_16x16x32_bf16 v[116:119], a[224:227], a[56:59], v[116:119]
    v_mfma_f32_16x16x32_bf16 v[120:123], a[224:227], a[60:63], v[120:123]
    buffer_load_dwordx4 v201, s[24:27], s3 offen offset:1024 lds
    v_mfma_f32_16x16x32_bf16 v[124:127], a[228:231], a[56:59], v[124:127]
    v_mfma_f32_16x16x32_bf16 v[128:131], a[228:231], a[60:63], v[128:131]
    v_mfma_f32_16x16x32_bf16 v[132:135], a[232:235], a[56:59], v[132:135]
    v_mfma_f32_16x16x32_bf16 v[136:139], a[232:235], a[60:63], v[136:139]
    v_mfma_f32_16x16x32_bf16 v[140:143], a[236:239], a[56:59], v[140:143]
    buffer_load_dwordx4 v202, s[24:27], s3 offen offset:2048 lds
    v_mfma_f32_16x16x32_bf16 v[144:147], a[236:239], a[60:63], v[144:147]
    s_waitcnt vmcnt(17)
    s_waitcnt lgkmcnt(0)
    s_barrier
    v_mfma_f32_16x16x32_bf16 v[92:95], a[128:131], a[64:67], v[92:95]
    v_add_u32 v36, 0x17000, v32
    v_mfma_f32_16x16x32_bf16 v[96:99], a[128:131], a[68:71], v[96:99]
    v_add_u32 v37, 0x17000, v33
    v_add_u32 v38, 0x17000, v34
    v_mfma_f32_16x16x32_bf16 v[84:87], a[128:131], v[204:207], v[84:87]
    v_add_u32 v39, 0x17000, v35
    s_add_u32 m0, s49, 0x0
    s_add_u32 s3, s84, 0x8000
    v_add_u32 v20, s3, v77
    buffer_load_dwordx4 v20, s[28:31], 0 offen offset:0 lds
    v_mfma_f32_16x16x32_bf16 v[100:103], a[132:135], a[64:67], v[100:103]
    ds_read_b64_tr_b16 a[184:185], v36 offset:0
    ds_read_b64_tr_b16 a[186:187], v36 offset:7168
    v_mfma_f32_16x16x32_bf16 v[104:107], a[132:135], a[68:71], v[104:107]
    ds_read_b64_tr_b16 a[188:189], v37 offset:32
    v_mfma_f32_16x16x32_bf16 v[84:87], a[132:135], v[208:211], v[84:87]
    ds_read_b64_tr_b16 a[190:191], v37 offset:7200
    ds_read_b64_tr_b16 a[192:193], v36 offset:64
    v_mfma_f32_16x16x32_bf16 v[108:111], a[136:139], a[64:67], v[108:111]
    ds_read_b64_tr_b16 a[194:195], v36 offset:7232
    buffer_load_dwordx4 v20, s[28:31], s50 offen offset:1024 lds
    v_mfma_f32_16x16x32_bf16 v[112:115], a[136:139], a[68:71], v[112:115]
    ds_read_b64_tr_b16 a[196:197], v37 offset:96
    ds_read_b64_tr_b16 a[198:199], v37 offset:7264
    v_mfma_f32_16x16x32_bf16 v[84:87], a[136:139], v[212:215], v[84:87]
    ds_read_b64_tr_b16 a[200:201], v36 offset:128
    v_mfma_f32_16x16x32_bf16 v[116:119], a[140:143], a[64:67], v[116:119]
    ds_read_b64_tr_b16 a[202:203], v36 offset:7296
    ds_read_b64_tr_b16 a[204:205], v37 offset:160
    v_mfma_f32_16x16x32_bf16 v[120:123], a[140:143], a[68:71], v[120:123]
    ds_read_b64_tr_b16 a[206:207], v37 offset:7328
    buffer_load_dwordx4 v20, s[28:31], s51 offen offset:2048 lds
    v_mfma_f32_16x16x32_bf16 v[84:87], a[140:143], v[216:219], v[84:87]
    ds_read_b64_tr_b16 a[208:209], v36 offset:192
    ds_read_b64_tr_b16 a[210:211], v36 offset:7360
    v_mfma_f32_16x16x32_bf16 v[124:127], a[144:147], a[64:67], v[124:127]
    ds_read_b64_tr_b16 a[212:213], v38 offset:0
    v_mfma_f32_16x16x32_bf16 v[128:131], a[144:147], a[68:71], v[128:131]
    ds_read_b64_tr_b16 a[214:215], v38 offset:7168
    ds_read_b64_tr_b16 a[216:217], v39 offset:32
    v_mfma_f32_16x16x32_bf16 v[84:87], a[144:147], v[220:223], v[84:87]
    ds_read_b64_tr_b16 a[218:219], v39 offset:7200
    buffer_load_dwordx4 v20, s[28:31], s52 offen offset:3072 lds
    v_mfma_f32_16x16x32_bf16 v[132:135], a[148:151], a[64:67], v[132:135]
    ds_read_b64_tr_b16 a[220:221], v38 offset:64
    ds_read_b64_tr_b16 a[222:223], v38 offset:7232
    v_mfma_f32_16x16x32_bf16 v[136:139], a[148:151], a[68:71], v[136:139]
    ds_read_b64_tr_b16 a[224:225], v39 offset:96
    v_mfma_f32_16x16x32_bf16 v[84:87], a[148:151], v[224:227], v[84:87]
    ds_read_b64_tr_b16 a[226:227], v39 offset:7264
    ds_read_b64_tr_b16 a[228:229], v38 offset:128
    v_mfma_f32_16x16x32_bf16 v[140:143], a[152:155], a[64:67], v[140:143]
    ds_read_b64_tr_b16 a[230:231], v38 offset:7296
    s_add_u32 m0, s49, 0x4000
    v_add_u32 v20, s84, v77
    buffer_load_dwordx4 v20, s[28:31], 0 offen offset:0 lds
    v_mfma_f32_16x16x32_bf16 v[144:147], a[152:155], a[68:71], v[144:147]
    ds_read_b64_tr_b16 a[232:233], v39 offset:160
    ds_read_b64_tr_b16 a[234:235], v39 offset:7328
    v_mfma_f32_16x16x32_bf16 v[84:87], a[152:155], v[228:231], v[84:87]
    ds_read_b64_tr_b16 a[236:237], v38 offset:192
    v_mfma_f32_16x16x32_bf16 v[92:95], a[156:159], a[72:75], v[92:95]
    ds_read_b64_tr_b16 a[238:239], v38 offset:7360
    v_mfma_f32_16x16x32_bf16 v[96:99], a[156:159], a[76:79], v[96:99]
    v_mfma_f32_16x16x32_bf16 v[100:103], a[160:163], a[72:75], v[100:103]
    buffer_load_dwordx4 v20, s[28:31], s50 offen offset:1024 lds
    v_mfma_f32_16x16x32_bf16 v[104:107], a[160:163], a[76:79], v[104:107]
    v_mfma_f32_16x16x32_bf16 v[108:111], a[164:167], a[72:75], v[108:111]
    v_mfma_f32_16x16x32_bf16 v[112:115], a[164:167], a[76:79], v[112:115]
    v_mfma_f32_16x16x32_bf16 v[116:119], a[168:171], a[72:75], v[116:119]
    v_mfma_f32_16x16x32_bf16 v[120:123], a[168:171], a[76:79], v[120:123]
    buffer_load_dwordx4 v20, s[28:31], s51 offen offset:2048 lds
    v_mfma_f32_16x16x32_bf16 v[124:127], a[172:175], a[72:75], v[124:127]
    v_mfma_f32_16x16x32_bf16 v[128:131], a[172:175], a[76:79], v[128:131]
    v_mfma_f32_16x16x32_bf16 v[132:135], a[176:179], a[72:75], v[132:135]
    v_mfma_f32_16x16x32_bf16 v[136:139], a[176:179], a[76:79], v[136:139]
    v_mfma_f32_16x16x32_bf16 v[140:143], a[180:183], a[72:75], v[140:143]
    buffer_load_dwordx4 v20, s[28:31], s52 offen offset:3072 lds
    v_mfma_f32_16x16x32_bf16 v[144:147], a[180:183], a[76:79], v[144:147]
    s_waitcnt vmcnt(15)
    s_waitcnt lgkmcnt(0)
    s_barrier
    v_mfma_f32_16x16x32_bf16 v[92:95], a[184:187], a[80:83], v[92:95]
    v_add_u32 v36, 0x10000, v32
    v_lshrrev_b32 v192, 5, v0
    v_mfma_f32_16x16x32_bf16 v[96:99], a[184:187], a[84:87], v[96:99]
    v_add_u32 v37, 0x10000, v33
    v_add_u32 v38, 0x10000, v34
    v_mfma_f32_16x16x32_bf16 v[84:87], a[184:187], v[204:207], v[84:87]
    v_add_u32 v39, 0x10000, v35
    s_add_u32 m0, s49, 0x8000
    v_add_u32 v20, s85, v77
    buffer_load_dwordx4 v20, s[28:31], 0 offen offset:0 lds
    v_mfma_f32_16x16x32_bf16 v[100:103], a[188:191], a[80:83], v[100:103]
    ds_read_b64_tr_b16 a[128:129], v36 offset:0
    ds_read_b64_tr_b16 a[130:131], v36 offset:7168
    v_mfma_f32_16x16x32_bf16 v[104:107], a[188:191], a[84:87], v[104:107]
    ds_read_b64_tr_b16 a[132:133], v37 offset:32
    v_bfe_u32 v193, v0, 4, 1
    v_mfma_f32_16x16x32_bf16 v[84:87], a[188:191], v[208:211], v[84:87]
    ds_read_b64_tr_b16 a[134:135], v37 offset:7200
    ds_read_b64_tr_b16 a[136:137], v36 offset:64
    v_mfma_f32_16x16x32_bf16 v[108:111], a[192:195], a[80:83], v[108:111]
    ds_read_b64_tr_b16 a[138:139], v36 offset:7232
    buffer_load_dwordx4 v20, s[28:31], s50 offen offset:1024 lds
    v_mfma_f32_16x16x32_bf16 v[112:115], a[192:195], a[84:87], v[112:115]
    ds_read_b64_tr_b16 a[140:141], v37 offset:96
    ds_read_b64_tr_b16 a[142:143], v37 offset:7264
    v_mfma_f32_16x16x32_bf16 v[84:87], a[192:195], v[212:215], v[84:87]
    ds_read_b64_tr_b16 a[144:145], v36 offset:128
    v_lshlrev_b32 v194, 4, v5
    v_mfma_f32_16x16x32_bf16 v[116:119], a[196:199], a[80:83], v[116:119]
    ds_read_b64_tr_b16 a[146:147], v36 offset:7296
    ds_read_b64_tr_b16 a[148:149], v37 offset:160
    v_mfma_f32_16x16x32_bf16 v[120:123], a[196:199], a[84:87], v[120:123]
    ds_read_b64_tr_b16 a[150:151], v37 offset:7328
    buffer_load_dwordx4 v20, s[28:31], s51 offen offset:2048 lds
    v_mfma_f32_16x16x32_bf16 v[84:87], a[196:199], v[216:219], v[84:87]
    ds_read_b64_tr_b16 a[152:153], v36 offset:192
    ds_read_b64_tr_b16 a[154:155], v36 offset:7360
    v_mfma_f32_16x16x32_bf16 v[124:127], a[200:203], a[80:83], v[124:127]
    ds_read_b64_tr_b16 a[156:157], v38 offset:0
    v_lshl_add_u32 v195, v192, 10, v194
    v_mfma_f32_16x16x32_bf16 v[128:131], a[200:203], a[84:87], v[128:131]
    ds_read_b64_tr_b16 a[158:159], v38 offset:7168
    ds_read_b64_tr_b16 a[160:161], v39 offset:32
    v_mfma_f32_16x16x32_bf16 v[84:87], a[200:203], v[220:223], v[84:87]
    ds_read_b64_tr_b16 a[162:163], v39 offset:7200
    buffer_load_dwordx4 v20, s[28:31], s52 offen offset:3072 lds
    v_mfma_f32_16x16x32_bf16 v[132:135], a[204:207], a[80:83], v[132:135]
    ds_read_b64_tr_b16 a[164:165], v38 offset:64
    ds_read_b64_tr_b16 a[166:167], v38 offset:7232
    v_mfma_f32_16x16x32_bf16 v[136:139], a[204:207], a[84:87], v[136:139]
    ds_read_b64_tr_b16 a[168:169], v39 offset:96
    v_lshl_add_u32 v60, v193, 9, v195
    v_mfma_f32_16x16x32_bf16 v[84:87], a[204:207], v[224:227], v[84:87]
    ds_read_b64_tr_b16 a[170:171], v39 offset:7264
    ds_read_b64_tr_b16 a[172:173], v38 offset:128
    v_mfma_f32_16x16x32_bf16 v[140:143], a[208:211], a[80:83], v[140:143]
    ds_read_b64_tr_b16 a[174:175], v38 offset:7296
    s_add_u32 m0, s49, 0xc000
    v_add_u32 v20, s86, v77
    buffer_load_dwordx4 v20, s[28:31], 0 offen offset:0 lds
    v_mfma_f32_16x16x32_bf16 v[144:147], a[208:211], a[84:87], v[144:147]
    ds_read_b64_tr_b16 a[176:177], v39 offset:160
    ds_read_b64_tr_b16 a[178:179], v39 offset:7328
    v_mfma_f32_16x16x32_bf16 v[84:87], a[208:211], v[228:231], v[84:87]
    ds_read_b64_tr_b16 a[180:181], v38 offset:192
    v_lshl_add_u32 v195, v192, 9, v194
    v_mfma_f32_16x16x32_bf16 v[92:95], a[212:215], a[88:91], v[92:95]
    ds_read_b64_tr_b16 a[182:183], v38 offset:7360
    v_lshl_add_u32 v61, v193, 3, v195
    v_mfma_f32_16x16x32_bf16 v[96:99], a[212:215], a[92:95], v[96:99]
    s_add_u32 s62, s78, 0x28000
    v_and_b32 v192, 7, v0
    v_mfma_f32_16x16x32_bf16 v[100:103], a[216:219], a[88:91], v[100:103]
    buffer_load_dwordx4 v20, s[28:31], s50 offen offset:1024 lds
    s_lshl_b32 s70, s46, 13
    v_mfma_f32_16x16x32_bf16 v[104:107], a[216:219], a[92:95], v[104:107]
    v_lshl_add_u32 v17, v192, 10, s70
    s_lshl_b32 s70, s46, 10
    v_mfma_f32_16x16x32_bf16 v[108:111], a[220:223], a[88:91], v[108:111]
    v_lshl_add_u32 v13, v192, 12, s70
    s_lshl_b32 s73, s46, 14
    v_mfma_f32_16x16x32_bf16 v[112:115], a[220:223], a[92:95], v[112:115]
    s_sub_u32 s70, s63, s73
    s_add_u32 s70, s70, 0x30000
    v_mfma_f32_16x16x32_bf16 v[116:119], a[224:227], a[88:91], v[116:119]
    buffer_load_dwordx4 v20, s[28:31], s51 offen offset:2048 lds
    v_add_u32 v62, s70, v1
    v_mfma_f32_16x16x32_bf16 v[120:123], a[224:227], a[92:95], v[120:123]
    s_sub_u32 s70, s97, s73
    s_add_u32 s70, s70, 0x0
    v_mfma_f32_16x16x32_bf16 v[124:127], a[228:231], a[88:91], v[124:127]
    v_add_u32 v63, s70, v1
    s_sub_u32 s70, s97, s73
    v_mfma_f32_16x16x32_bf16 v[128:131], a[228:231], a[92:95], v[128:131]
    s_add_u32 s70, s70, 0x10000
    v_add_u32 v64, s70, v1
    v_mfma_f32_16x16x32_bf16 v[132:135], a[232:235], a[88:91], v[132:135]
    buffer_load_dwordx4 v20, s[28:31], s52 offen offset:3072 lds
    s_sub_u32 s70, s63, s73
    v_mfma_f32_16x16x32_bf16 v[136:139], a[232:235], a[92:95], v[136:139]
    s_add_u32 s70, s70, 0x80000
    v_add_u32 v65, s70, v1
    v_mfma_f32_16x16x32_bf16 v[140:143], a[236:239], a[88:91], v[140:143]
    s_xor_b32 s58, s80, 0x8000
    s_xor_b32 s59, s81, 0x8000
    v_mfma_f32_16x16x32_bf16 v[144:147], a[236:239], a[92:95], v[144:147]
    s_xor_b32 s60, s82, 0x8000
    s_xor_b32 s61, s83, 0x8000
    s_waitcnt vmcnt(16)
    s_waitcnt lgkmcnt(0)
    s_barrier
    v_mfma_f32_16x16x32_bf16 v[92:95], a[128:131], a[96:99], v[92:95]
    v_add_u32 v36, 0x20000, v32
    s_add_u32 m0, s49, 0x18000
    v_add_u32 v20, s87, v77
    buffer_load_dwordx4 v20, s[28:31], 0 offen offset:0 lds
    v_mfma_f32_16x16x32_bf16 v[96:99], a[128:131], a[100:103], v[96:99]
    v_add_u32 v37, 0x20000, v33
    v_add_u32 v38, 0x20000, v34
    v_mfma_f32_16x16x32_bf16 v[84:87], a[128:131], v[204:207], v[84:87]
    v_add_u32 v39, 0x20000, v35
    v_mfma_f32_16x16x32_bf16 v[100:103], a[132:135], a[96:99], v[100:103]
    ds_read_b64_tr_b16 a[184:185], v36 offset:0
    ds_read_b64_tr_b16 a[186:187], v36 offset:7168
    v_mfma_f32_16x16x32_bf16 v[104:107], a[132:135], a[100:103], v[104:107]
    ds_read_b64_tr_b16 a[188:189], v37 offset:32
    buffer_load_dwordx4 v20, s[28:31], s50 offen offset:1024 lds
    v_mfma_f32_16x16x32_bf16 v[84:87], a[132:135], v[208:211], v[84:87]
    ds_read_b64_tr_b16 a[190:191], v37 offset:7200
    ds_read_b64_tr_b16 a[192:193], v36 offset:64
    v_mfma_f32_16x16x32_bf16 v[108:111], a[136:139], a[96:99], v[108:111]
    ds_read_b64_tr_b16 a[194:195], v36 offset:7232
    v_mfma_f32_16x16x32_bf16 v[112:115], a[136:139], a[100:103], v[112:115]
    ds_read_b64_tr_b16 a[196:197], v37 offset:96
    ds_read_b64_tr_b16 a[198:199], v37 offset:7264
    v_mfma_f32_16x16x32_bf16 v[84:87], a[136:139], v[212:215], v[84:87]
    ds_read_b64_tr_b16 a[200:201], v36 offset:128
    buffer_load_dwordx4 v20, s[28:31], s51 offen offset:2048 lds
    v_mfma_f32_16x16x32_bf16 v[116:119], a[140:143], a[96:99], v[116:119]
    ds_read_b64_tr_b16 a[202:203], v36 offset:7296
    ds_read_b64_tr_b16 a[204:205], v37 offset:160
    v_mfma_f32_16x16x32_bf16 v[120:123], a[140:143], a[100:103], v[120:123]
    ds_read_b64_tr_b16 a[206:207], v37 offset:7328
    v_mfma_f32_16x16x32_bf16 v[84:87], a[140:143], v[216:219], v[84:87]
    ds_read_b64_tr_b16 a[208:209], v36 offset:192
    ds_read_b64_tr_b16 a[210:211], v36 offset:7360
    v_mfma_f32_16x16x32_bf16 v[124:127], a[144:147], a[96:99], v[124:127]
    ds_read_b64_tr_b16 a[212:213], v38 offset:0
    buffer_load_dwordx4 v20, s[28:31], s52 offen offset:3072 lds
    v_mfma_f32_16x16x32_bf16 v[128:131], a[144:147], a[100:103], v[128:131]
    ds_read_b64_tr_b16 a[214:215], v38 offset:7168
    ds_read_b64_tr_b16 a[216:217], v39 offset:32
    v_mfma_f32_16x16x32_bf16 v[84:87], a[144:147], v[220:223], v[84:87]
    ds_read_b64_tr_b16 a[218:219], v39 offset:7200
    v_mfma_f32_16x16x32_bf16 v[132:135], a[148:151], a[96:99], v[132:135]
    ds_read_b64_tr_b16 a[220:221], v38 offset:64
    ds_read_b64_tr_b16 a[222:223], v38 offset:7232
    v_mfma_f32_16x16x32_bf16 v[136:139], a[148:151], a[100:103], v[136:139]
    ds_read_b64_tr_b16 a[224:225], v39 offset:96
    s_add_u32 m0, s49, 0x1c000
    s_add_u32 s3, s84, 0x10000
    v_add_u32 v20, s3, v77
    buffer_load_dwordx4 v20, s[28:31], 0 offen offset:0 lds
    v_mfma_f32_16x16x32_bf16 v[84:87], a[148:151], v[224:227], v[84:87]
    ds_read_b64_tr_b16 a[226:227], v39 offset:7264
    ds_read_b64_tr_b16 a[228:229], v38 offset:128
    v_mfma_f32_16x16x32_bf16 v[140:143], a[152:155], a[96:99], v[140:143]
    ds_read_b64_tr_b16 a[230:231], v38 offset:7296
    v_mfma_f32_16x16x32_bf16 v[144:147], a[152:155], a[100:103], v[144:147]
    ds_read_b64_tr_b16 a[232:233], v39 offset:160
    ds_read_b64_tr_b16 a[234:235], v39 offset:7328
    v_mfma_f32_16x16x32_bf16 v[84:87], a[152:155], v[228:231], v[84:87]
    ds_read_b64_tr_b16 a[236:237], v38 offset:192
    buffer_load_dwordx4 v20, s[28:31], s50 offen offset:1024 lds
    v_mfma_f32_16x16x32_bf16 v[92:95], a[156:159], a[104:107], v[92:95]
    ds_read_b64_tr_b16 a[238:239], v38 offset:7360
    v_mfma_f32_16x16x32_bf16 v[96:99], a[156:159], a[108:111], v[96:99]
    s_waitcnt lgkmcnt(15)
    v_mfma_f32_16x16x32_bf16 v[84:87], a[184:187], v[204:207], v[84:87]
    v_mfma_f32_16x16x32_bf16 v[84:87], a[188:191], v[208:211], v[84:87]
    v_mfma_f32_16x16x32_bf16 v[100:103], a[160:163], a[104:107], v[100:103]
    buffer_load_dwordx4 v20, s[28:31], s51 offen offset:2048 lds
    v_mfma_f32_16x16x32_bf16 v[104:107], a[160:163], a[108:111], v[104:107]
    v_mfma_f32_16x16x32_bf16 v[84:87], a[192:195], v[212:215], v[84:87]
    v_mfma_f32_16x16x32_bf16 v[84:87], a[196:199], v[216:219], v[84:87]
    v_mfma_f32_16x16x32_bf16 v[108:111], a[164:167], a[104:107], v[108:111]
    v_mfma_f32_16x16x32_bf16 v[112:115], a[164:167], a[108:111], v[112:115]
    buffer_load_dwordx4 v20, s[28:31], s52 offen offset:3072 lds
    v_mfma_f32_16x16x32_bf16 v[84:87], a[200:203], v[220:223], v[84:87]
    v_mfma_f32_16x16x32_bf16 v[84:87], a[204:207], v[224:227], v[84:87]
    v_mfma_f32_16x16x32_bf16 v[116:119], a[168:171], a[104:107], v[116:119]
    v_mfma_f32_16x16x32_bf16 v[120:123], a[168:171], a[108:111], v[120:123]
    s_waitcnt lgkmcnt(14)
    v_mfma_f32_16x16x32_bf16 v[84:87], a[208:211], v[228:231], v[84:87]
    s_add_u32 m0, s49, 0x10000
    s_add_u32 s3, s85, 0x8000
    v_add_u32 v20, s3, v77
    buffer_load_dwordx4 v20, s[28:31], 0 offen offset:0 lds
    v_mfma_f32_16x16x32_bf16 v[124:127], a[172:175], a[104:107], v[124:127]
    v_mfma_f32_16x16x32_bf16 v[128:131], a[172:175], a[108:111], v[128:131]
    v_mfma_f32_16x16x32_bf16 v[132:135], a[176:179], a[104:107], v[132:135]
    v_mfma_f32_16x16x32_bf16 v[136:139], a[176:179], a[108:111], v[136:139]
    ds_write_b128 v80, v[84:87]
    buffer_load_dwordx4 v20, s[28:31], s50 offen offset:1024 lds
    v_mfma_f32_16x16x32_bf16 v[140:143], a[180:183], a[104:107], v[140:143]
    v_mfma_f32_16x16x32_bf16 v[144:147], a[180:183], a[108:111], v[144:147]
    s_waitcnt lgkmcnt(0)
    s_barrier
    ds_read_b128 v[68:71], v81
    v_mfma_f32_16x16x32_bf16 v[92:95], a[184:187], a[112:115], v[92:95]
    v_mfma_f32_16x16x32_bf16 v[96:99], a[184:187], a[116:119], v[96:99]
    buffer_load_dwordx4 v20, s[28:31], s51 offen offset:2048 lds
    v_mfma_f32_16x16x32_bf16 v[100:103], a[188:191], a[112:115], v[100:103]
    v_mfma_f32_16x16x32_bf16 v[104:107], a[188:191], a[116:119], v[104:107]
    v_mfma_f32_16x16x32_bf16 v[108:111], a[192:195], a[112:115], v[108:111]
    v_mfma_f32_16x16x32_bf16 v[112:115], a[192:195], a[116:119], v[112:115]
    s_waitcnt lgkmcnt(0)
    v_pk_add_f32 v[84:85], v[84:85], v[68:69]
    v_mfma_f32_16x16x32_bf16 v[116:119], a[196:199], a[112:115], v[116:119]
    buffer_load_dwordx4 v20, s[28:31], s52 offen offset:3072 lds
    v_pk_add_f32 v[86:87], v[86:87], v[70:71]
    v_mfma_f32_16x16x32_bf16 v[120:123], a[196:199], a[116:119], v[120:123]
    v_mfma_f32_16x16x32_bf16 v[124:127], a[200:203], a[112:115], v[124:127]
    v_mov_b32_dpp v204, v84 row_newbcast:0 row_mask:0xf bank_mask:0xf
    v_mov_b32_dpp v205, v85 row_newbcast:0 row_mask:0xf bank_mask:0xf
    v_mfma_f32_16x16x32_bf16 v[128:131], a[200:203], a[116:119], v[128:131]
    v_mov_b32_dpp v206, v86 row_newbcast:0 row_mask:0xf bank_mask:0xf
    v_mov_b32_dpp v207, v87 row_newbcast:0 row_mask:0xf bank_mask:0xf
    s_waitcnt vmcnt(24)
    s_waitcnt vmcnt(20)
    s_waitcnt vmcnt(16)
    v_mfma_f32_16x16x32_bf16 v[132:135], a[204:207], a[112:115], v[132:135]
    v_add_u32 v38, 0x0, v58
    s_add_u32 m0, s49, 0x14000
    s_add_u32 s3, s86, 0x8000
    v_add_u32 v20, s3, v77
    buffer_load_dwordx4 v20, s[28:31], 0 offen offset:0 lds
    v_mfma_f32_16x16x32_bf16 v[136:139], a[204:207], a[116:119], v[136:139]
    v_add_u32 v39, 0x0, v59
    ds_read_b64_tr_b16 a[64:65], v38 offset:0
    v_mfma_f32_16x16x32_bf16 v[140:143], a[208:211], a[112:115], v[140:143]
    ds_read_b64_tr_b16 a[66:67], v38 offset:512
    v_mov_b32_dpp v208, v84 row_newbcast:1 row_mask:0xf bank_mask:0xf
    v_mfma_f32_16x16x32_bf16 v[144:147], a[208:211], a[116:119], v[144:147]
    ds_read_b64_tr_b16 a[68:69], v39 offset:0
    ds_read_b64_tr_b16 a[70:71], v39 offset:512
    v_mfma_f32_16x16x32_bf16 v[92:95], a[212:215], a[120:123], v[92:95]
    ds_read_b64_tr_b16 a[72:73], v38 offset:2048
    buffer_load_dwordx4 v20, s[28:31], s50 offen offset:1024 lds
    v_mfma_f32_16x16x32_bf16 v[96:99], a[212:215], a[124:127], v[96:99]
    ds_read_b64_tr_b16 a[74:75], v38 offset:2560
    ds_read_b64_tr_b16 a[76:77], v39 offset:2048
    v_mfma_f32_16x16x32_bf16 v[100:103], a[216:219], a[120:123], v[100:103]
    ds_read_b64_tr_b16 a[78:79], v39 offset:2560
    v_mov_b32_dpp v209, v85 row_newbcast:1 row_mask:0xf bank_mask:0xf
    v_mfma_f32_16x16x32_bf16 v[104:107], a[216:219], a[124:127], v[104:107]
    v_add_u32 v36, 0x4000, v58
    v_add_u32 v37, 0x4000, v59
    v_mfma_f32_16x16x32_bf16 v[108:111], a[220:223], a[120:123], v[108:111]
    ds_read_b64_tr_b16 a[0:1], v36 offset:0
    buffer_load_dwordx4 v20, s[28:31], s51 offen offset:2048 lds
    v_mfma_f32_16x16x32_bf16 v[112:115], a[220:223], a[124:127], v[112:115]
    ds_read_b64_tr_b16 a[2:3], v36 offset:512
    ds_read_b64_tr_b16 a[4:5], v37 offset:0
    v_mfma_f32_16x16x32_bf16 v[116:119], a[224:227], a[120:123], v[116:119]
    ds_read_b64_tr_b16 a[6:7], v37 offset:512
    v_mov_b32_dpp v210, v86 row_newbcast:1 row_mask:0xf bank_mask:0xf
    v_mfma_f32_16x16x32_bf16 v[120:123], a[224:227], a[124:127], v[120:123]
    ds_read_b64_tr_b16 a[8:9], v36 offset:2048
    ds_read_b64_tr_b16 a[10:11], v36 offset:2560
    v_mfma_f32_16x16x32_bf16 v[124:127], a[228:231], a[120:123], v[124:127]
    ds_read_b64_tr_b16 a[12:13], v37 offset:2048
    buffer_load_dwordx4 v20, s[28:31], s52 offen offset:3072 lds
    v_mfma_f32_16x16x32_bf16 v[128:131], a[228:231], a[124:127], v[128:131]
    ds_read_b64_tr_b16 a[14:15], v37 offset:2560
    v_add_u32 v38, 0x8000, v58
    v_mfma_f32_16x16x32_bf16 v[132:135], a[232:235], a[120:123], v[132:135]
    v_add_u32 v39, 0x8000, v59
    v_mov_b32_dpp v211, v87 row_newbcast:1 row_mask:0xf bank_mask:0xf
    v_mfma_f32_16x16x32_bf16 v[136:139], a[232:235], a[124:127], v[136:139]
    ds_read_b64_tr_b16 a[16:17], v38 offset:0
    ds_read_b64_tr_b16 a[18:19], v38 offset:512
    v_mfma_f32_16x16x32_bf16 v[140:143], a[236:239], a[120:123], v[140:143]
    ds_read_b64_tr_b16 a[20:21], v39 offset:0
    s_add_u32 m0, s49, 0x20000
    s_add_u32 s3, s87, 0x8000
    v_add_u32 v20, s3, v77
    buffer_load_dwordx4 v20, s[28:31], 0 offen offset:0 lds
    v_mfma_f32_16x16x32_bf16 v[144:147], a[236:239], a[124:127], v[144:147]
    ds_read_b64_tr_b16 a[22:23], v39 offset:512
    ds_read_b64_tr_b16 a[24:25], v38 offset:2048
    v_mov_b32_dpp v212, v84 row_newbcast:2 row_mask:0xf bank_mask:0xf
    v_mov_b32_dpp v213, v85 row_newbcast:2 row_mask:0xf bank_mask:0xf
    v_mov_b32_dpp v214, v86 row_newbcast:2 row_mask:0xf bank_mask:0xf
    v_mov_b32_dpp v215, v87 row_newbcast:2 row_mask:0xf bank_mask:0xf
    v_mov_b32_dpp v216, v84 row_newbcast:3 row_mask:0xf bank_mask:0xf
    v_mov_b32_dpp v217, v85 row_newbcast:3 row_mask:0xf bank_mask:0xf
    v_mov_b32_dpp v218, v86 row_newbcast:3 row_mask:0xf bank_mask:0xf
    v_mov_b32_dpp v219, v87 row_newbcast:3 row_mask:0xf bank_mask:0xf
    v_mov_b32_dpp v220, v84 row_newbcast:4 row_mask:0xf bank_mask:0xf
    v_mov_b32_dpp v221, v85 row_newbcast:4 row_mask:0xf bank_mask:0xf
    v_mov_b32_dpp v222, v86 row_newbcast:4 row_mask:0xf bank_mask:0xf
    buffer_load_dwordx4 v20, s[28:31], s50 offen offset:1024 lds
    v_mov_b32_dpp v223, v87 row_newbcast:4 row_mask:0xf bank_mask:0xf
    v_mov_b32_dpp v224, v84 row_newbcast:5 row_mask:0xf bank_mask:0xf
    v_mov_b32_dpp v225, v85 row_newbcast:5 row_mask:0xf bank_mask:0xf
    v_mov_b32_dpp v226, v86 row_newbcast:5 row_mask:0xf bank_mask:0xf
    v_mov_b32_dpp v227, v87 row_newbcast:5 row_mask:0xf bank_mask:0xf
    v_mov_b32_dpp v228, v84 row_newbcast:6 row_mask:0xf bank_mask:0xf
    v_mov_b32_dpp v229, v85 row_newbcast:6 row_mask:0xf bank_mask:0xf
    v_mov_b32_dpp v230, v86 row_newbcast:6 row_mask:0xf bank_mask:0xf
    v_mov_b32_dpp v231, v87 row_newbcast:6 row_mask:0xf bank_mask:0xf
    buffer_load_dword v69, v13, s[40:43], s62 offen offset:148 sc1
    v_pk_fma_f32 v[92:93], v[204:205], v[148:149], v[92:93] op_sel:[0,1,0] op_sel_hi:[1,1,1] neg_lo:[0,1,0] neg_hi:[0,1,0]
    v_pk_fma_f32 v[94:95], v[206:207], v[148:149], v[94:95] op_sel:[0,1,0] op_sel_hi:[1,1,1] neg_lo:[0,1,0] neg_hi:[0,1,0]
    v_pk_mul_f32 v[188:189], v[92:93], v[92:93]
    v_pk_mul_f32 v[190:191], v[94:95], v[94:95]
    ds_read_b64_tr_b16 a[26:27], v38 offset:2560
    v_pk_fma_f32 v[188:189], v[188:189], v[22:23], v[22:23] op_sel:[0,1,0] op_sel_hi:[1,1,0]
    buffer_load_dwordx4 v20, s[28:31], s51 offen offset:2048 lds
    v_pk_fma_f32 v[190:191], v[190:191], v[22:23], v[22:23] op_sel:[0,1,0] op_sel_hi:[1,1,0]
    v_pk_mul_f32 v[188:189], v[188:189], v[92:93]
    v_pk_mul_f32 v[190:191], v[190:191], v[94:95]
    ds_read_b64_tr_b16 a[28:29], v39 offset:2048
    v_exp_f32 v188, v188
    buffer_load_dwordx4 v20, s[28:31], s52 offen offset:3072 lds
    v_exp_f32 v189, v189
    v_exp_f32 v190, v190
    v_exp_f32 v191, v191
    ds_read_b64_tr_b16 a[30:31], v39 offset:2560
    v_pk_fma_f32 v[188:189], v[188:189], v[72:73], v[72:73] op_sel_hi:[1,0,0]
    v_pk_fma_f32 v[190:191], v[190:191], v[72:73], v[72:73] op_sel_hi:[1,0,0]
    v_rcp_f32 v188, v188
    v_rcp_f32 v189, v189
    v_rcp_f32 v190, v190
    v_rcp_f32 v191, v191
    v_pk_mul_f32 v[92:93], v[92:93], v[188:189]
    v_pk_mul_f32 v[94:95], v[94:95], v[190:191]
    v_cvt_pk_bf16_f32 v92, v92, v93
    v_cvt_pk_bf16_f32 v93, v94, v95
    s_waitcnt vmcnt(21)
    v_pk_fma_f32 v[100:101], v[208:209], v[148:149], v[100:101] op_sel:[0,1,0] op_sel_hi:[1,1,1] neg_lo:[0,1,0] neg_hi:[0,1,0]
    v_add_u32 v36, 0xc000, v58
    v_pk_fma_f32 v[102:103], v[210:211], v[148:149], v[102:103] op_sel:[0,1,0] op_sel_hi:[1,1,1] neg_lo:[0,1,0] neg_hi:[0,1,0]
    v_pk_mul_f32 v[188:189], v[100:101], v[100:101]
    v_pk_mul_f32 v[190:191], v[102:103], v[102:103]
    v_pk_fma_f32 v[188:189], v[188:189], v[22:23], v[22:23] op_sel:[0,1,0] op_sel_hi:[1,1,0]
    v_add_u32 v37, 0xc000, v59
    v_pk_fma_f32 v[190:191], v[190:191], v[22:23], v[22:23] op_sel:[0,1,0] op_sel_hi:[1,1,0]
    v_pk_mul_f32 v[188:189], v[188:189], v[100:101]
    v_pk_mul_f32 v[190:191], v[190:191], v[102:103]
    v_exp_f32 v188, v188
    ds_read_b64_tr_b16 a[32:33], v36 offset:0
    v_exp_f32 v189, v189
    v_exp_f32 v190, v190
    v_exp_f32 v191, v191
    v_pk_fma_f32 v[188:189], v[188:189], v[72:73], v[72:73] op_sel_hi:[1,0,0]
    ds_read_b64_tr_b16 a[34:35], v36 offset:512
    v_pk_fma_f32 v[190:191], v[190:191], v[72:73], v[72:73] op_sel_hi:[1,0,0]
    v_rcp_f32 v188, v188
    v_rcp_f32 v189, v189
    v_rcp_f32 v190, v190
    ds_read_b64_tr_b16 a[36:37], v37 offset:0
    v_rcp_f32 v191, v191
    v_pk_mul_f32 v[100:101], v[100:101], v[188:189]
    v_pk_mul_f32 v[102:103], v[102:103], v[190:191]
    v_cvt_pk_bf16_f32 v94, v100, v101
    ds_read_b64_tr_b16 a[38:39], v37 offset:512
    v_cvt_pk_bf16_f32 v95, v102, v103
    s_add_u32 s71, s94, 0x30000
    buffer_store_dwordx4 v[92:95], v60, s[40:43], s71 offen offset:0 sc1
    s_waitcnt vmcnt(18)
    v_pk_fma_f32 v[96:97], v[204:205], v[148:149], v[96:97] op_sel_hi:[1,0,1] neg_lo:[0,1,0] neg_hi:[0,1,0]
    v_pk_fma_f32 v[98:99], v[206:207], v[148:149], v[98:99] op_sel_hi:[1,0,1] neg_lo:[0,1,0] neg_hi:[0,1,0]
    v_pk_mul_f32 v[188:189], v[96:97], v[96:97]
    ds_read_b64_tr_b16 a[40:41], v36 offset:2048
    v_pk_mul_f32 v[190:191], v[98:99], v[98:99]
    v_pk_fma_f32 v[188:189], v[188:189], v[82:83], v[82:83] op_sel:[0,1,0] op_sel_hi:[1,1,0]
    s_waitcnt lgkmcnt(15)
    s_add_u32 m0, s49, 0x0
    s_add_u32 s3, s85, 0x10000
    v_add_u32 v20, s3, v77
    buffer_load_dwordx4 v20, s[28:31], 0 offen offset:0 lds
    v_pk_fma_f32 v[190:191], v[190:191], v[82:83], v[82:83] op_sel:[0,1,0] op_sel_hi:[1,1,0]
    v_pk_mul_f32 v[188:189], v[188:189], v[96:97]
    ds_read_b64_tr_b16 a[42:43], v36 offset:2560
    v_pk_mul_f32 v[190:191], v[190:191], v[98:99]
    v_exp_f32 v188, v188
    buffer_load_dwordx4 v20, s[28:31], s50 offen offset:1024 lds
    v_exp_f32 v189, v189
    v_exp_f32 v190, v190
    ds_read_b64_tr_b16 a[44:45], v37 offset:2048
    v_exp_f32 v191, v191
    buffer_load_dwordx4 v20, s[28:31], s51 offen offset:2048 lds
    v_pk_fma_f32 v[188:189], v[188:189], v[90:91], v[90:91] op_sel_hi:[1,0,0]
    v_pk_fma_f32 v[190:191], v[190:191], v[90:91], v[90:91] op_sel_hi:[1,0,0]
    v_rcp_f32 v188, v188
    ds_read_b64_tr_b16 a[46:47], v37 offset:2560
    v_rcp_f32 v189, v189
    buffer_load_dwordx4 v20, s[28:31], s52 offen offset:3072 lds
    v_rcp_f32 v190, v190
    v_rcp_f32 v191, v191
    v_pk_mul_f32 v[96:97], v[96:97], v[188:189]
    v_add_u32 v38, 0x18000, v58
    v_pk_mul_f32 v[98:99], v[98:99], v[190:191]
    v_cvt_pk_bf16_f32 v96, v96, v97
    v_cvt_pk_bf16_f32 v97, v98, v99
    v_pk_fma_f32 v[104:105], v[208:209], v[148:149], v[104:105] op_sel_hi:[1,0,1] neg_lo:[0,1,0] neg_hi:[0,1,0]
    v_add_u32 v39, 0x18000, v59
    s_waitcnt lgkmcnt(15)
    s_add_u32 m0, s49, 0x4000
    s_add_u32 s3, s86, 0x10000
    v_add_u32 v20, s3, v77
    buffer_load_dwordx4 v20, s[28:31], 0 offen offset:0 lds
    v_pk_fma_f32 v[106:107], v[210:211], v[148:149], v[106:107] op_sel_hi:[1,0,1] neg_lo:[0,1,0] neg_hi:[0,1,0]
    v_pk_mul_f32 v[188:189], v[104:105], v[104:105]
    v_pk_mul_f32 v[190:191], v[106:107], v[106:107]
    v_pk_fma_f32 v[188:189], v[188:189], v[82:83], v[82:83] op_sel:[0,1,0] op_sel_hi:[1,1,0]
    ds_read_b64_tr_b16 a[48:49], v38 offset:0
    v_pk_fma_f32 v[190:191], v[190:191], v[82:83], v[82:83] op_sel:[0,1,0] op_sel_hi:[1,1,0]
    buffer_load_dwordx4 v20, s[28:31], s50 offen offset:1024 lds
    v_pk_mul_f32 v[188:189], v[188:189], v[104:105]
    v_pk_mul_f32 v[190:191], v[190:191], v[106:107]
    v_exp_f32 v188, v188
    ds_read_b64_tr_b16 a[50:51], v38 offset:512
    v_exp_f32 v189, v189
    buffer_load_dwordx4 v20, s[28:31], s51 offen offset:2048 lds
    v_exp_f32 v190, v190
    v_exp_f32 v191, v191
    v_pk_fma_f32 v[188:189], v[188:189], v[90:91], v[90:91] op_sel_hi:[1,0,0]
    ds_read_b64_tr_b16 a[52:53], v39 offset:0
    buffer_load_dwordx4 v20, s[28:31], s52 offen offset:3072 lds
    v_pk_fma_f32 v[190:191], v[190:191], v[90:91], v[90:91] op_sel_hi:[1,0,0]
    v_rcp_f32 v188, v188
    v_rcp_f32 v189, v189
    v_rcp_f32 v190, v190
    ds_read_b64_tr_b16 a[54:55], v39 offset:512
    v_rcp_f32 v191, v191
    v_pk_mul_f32 v[104:105], v[104:105], v[188:189]
    v_pk_mul_f32 v[106:107], v[106:107], v[190:191]
    v_cvt_pk_bf16_f32 v98, v104, v105
    ds_read_b64_tr_b16 a[56:57], v38 offset:2048
    v_cvt_pk_bf16_f32 v99, v106, v107
    buffer_store_dwordx4 v[96:99], v60, s[40:43], s71 offen offset:256 sc1
    v_pk_fma_f32 v[108:109], v[212:213], v[148:149], v[108:109] op_sel:[0,1,0] op_sel_hi:[1,1,1] neg_lo:[0,1,0] neg_hi:[0,1,0]
    v_pk_fma_f32 v[110:111], v[214:215], v[148:149], v[110:111] op_sel:[0,1,0] op_sel_hi:[1,1,1] neg_lo:[0,1,0] neg_hi:[0,1,0]
    v_pk_mul_f32 v[188:189], v[108:109], v[108:109]
    ds_read_b64_tr_b16 a[58:59], v38 offset:2560
    v_pk_mul_f32 v[190:191], v[110:111], v[110:111]
    v_pk_fma_f32 v[188:189], v[188:189], v[22:23], v[22:23] op_sel:[0,1,0] op_sel_hi:[1,1,0]
    s_waitcnt lgkmcnt(14)
    s_add_u32 m0, s49, 0x8000
    s_add_u32 s3, s87, 0x10000
    v_add_u32 v20, s3, v77
    buffer_load_dwordx4 v20, s[28:31], 0 offen offset:0 lds
    v_pk_fma_f32 v[190:191], v[190:191], v[22:23], v[22:23] op_sel:[0,1,0] op_sel_hi:[1,1,0]
    v_pk_mul_f32 v[188:189], v[188:189], v[108:109]
    ds_read_b64_tr_b16 a[60:61], v39 offset:2048
    v_pk_mul_f32 v[190:191], v[190:191], v[110:111]
    v_exp_f32 v188, v188
    buffer_load_dwordx4 v20, s[28:31], s50 offen offset:1024 lds
    v_exp_f32 v189, v189
    v_exp_f32 v190, v190
    ds_read_b64_tr_b16 a[62:63], v39 offset:2560
    v_exp_f32 v191, v191
    buffer_load_dwordx4 v20, s[28:31], s51 offen offset:2048 lds
    v_pk_fma_f32 v[188:189], v[188:189], v[72:73], v[72:73] op_sel_hi:[1,0,0]
    v_pk_fma_f32 v[190:191], v[190:191], v[72:73], v[72:73] op_sel_hi:[1,0,0]
    v_rcp_f32 v188, v188
    v_rcp_f32 v189, v189
    buffer_load_dwordx4 v20, s[28:31], s52 offen offset:3072 lds
    v_rcp_f32 v190, v190
    v_rcp_f32 v191, v191
    v_pk_mul_f32 v[108:109], v[108:109], v[188:189]
    v_pk_mul_f32 v[110:111], v[110:111], v[190:191]
    v_cvt_pk_bf16_f32 v108, v108, v109
    v_cvt_pk_bf16_f32 v109, v110, v111
    v_pk_fma_f32 v[116:117], v[216:217], v[148:149], v[116:117] op_sel:[0,1,0] op_sel_hi:[1,1,1] neg_lo:[0,1,0] neg_hi:[0,1,0]
    s_waitcnt lgkmcnt(8)
    s_add_u32 m0, s49, 0xc000
    v_add_u32 v20, s84, v78
    buffer_load_dwordx4 v20, s[28:31], 0 offen offset:0 lds
    v_pk_fma_f32 v[118:119], v[218:219], v[148:149], v[118:119] op_sel:[0,1,0] op_sel_hi:[1,1,1] neg_lo:[0,1,0] neg_hi:[0,1,0]
    v_pk_mul_f32 v[188:189], v[116:117], v[116:117]
    v_pk_mul_f32 v[190:191], v[118:119], v[118:119]
    v_pk_fma_f32 v[188:189], v[188:189], v[22:23], v[22:23] op_sel:[0,1,0] op_sel_hi:[1,1,0]
    v_pk_fma_f32 v[190:191], v[190:191], v[22:23], v[22:23] op_sel:[0,1,0] op_sel_hi:[1,1,0]
    v_pk_mul_f32 v[188:189], v[188:189], v[116:117]
    buffer_load_dwordx4 v20, s[28:31], s53 offen offset:1024 lds
    v_pk_mul_f32 v[190:191], v[190:191], v[118:119]
    v_exp_f32 v188, v188
    v_exp_f32 v189, v189
    v_exp_f32 v190, v190
    s_add_u32 m0, s49, 0xc800
    v_add_u32 v20, s85, v78
    buffer_load_dwordx4 v20, s[28:31], 0 offen offset:0 lds
    v_exp_f32 v191, v191
    v_pk_fma_f32 v[188:189], v[188:189], v[72:73], v[72:73] op_sel_hi:[1,0,0]
    v_pk_fma_f32 v[190:191], v[190:191], v[72:73], v[72:73] op_sel_hi:[1,0,0]
    v_rcp_f32 v188, v188
    buffer_load_dwordx4 v20, s[28:31], s53 offen offset:1024 lds
    v_rcp_f32 v189, v189
    v_rcp_f32 v190, v190
    v_rcp_f32 v191, v191
    v_pk_mul_f32 v[116:117], v[116:117], v[188:189]
    v_pk_mul_f32 v[118:119], v[118:119], v[190:191]
    v_cvt_pk_bf16_f32 v110, v116, v117
    v_cvt_pk_bf16_f32 v111, v118, v119
    s_add_u32 s71, s96, 0x0
    buffer_store_dwordx4 v[108:111], v60, s[40:43], s71 offen offset:0 sc1
    s_waitcnt vmcnt(9)
    buffer_store_dword v24, v2, s[40:43], s56 offen offset:136 sc1
    v_pk_fma_f32 v[112:113], v[212:213], v[148:149], v[112:113] op_sel_hi:[1,0,1] neg_lo:[0,1,0] neg_hi:[0,1,0]
    v_pk_fma_f32 v[114:115], v[214:215], v[148:149], v[114:115] op_sel_hi:[1,0,1] neg_lo:[0,1,0] neg_hi:[0,1,0]
    v_pk_mul_f32 v[188:189], v[112:113], v[112:113]
    v_pk_mul_f32 v[190:191], v[114:115], v[114:115]
    v_pk_fma_f32 v[188:189], v[188:189], v[82:83], v[82:83] op_sel:[0,1,0] op_sel_hi:[1,1,0]
    v_pk_fma_f32 v[190:191], v[190:191], v[82:83], v[82:83] op_sel:[0,1,0] op_sel_hi:[1,1,0]
    s_waitcnt lgkmcnt(0)
    s_add_u32 m0, s49, 0x18000
    v_add_u32 v20, s86, v78
    buffer_load_dwordx4 v20, s[28:31], 0 offen offset:0 lds
    v_pk_mul_f32 v[188:189], v[188:189], v[112:113]
    v_pk_mul_f32 v[190:191], v[190:191], v[114:115]
    v_exp_f32 v188, v188
    v_exp_f32 v189, v189
    buffer_load_dwordx4 v20, s[28:31], s53 offen offset:1024 lds
    v_exp_f32 v190, v190
    v_exp_f32 v191, v191
    v_pk_fma_f32 v[188:189], v[188:189], v[90:91], v[90:91] op_sel_hi:[1,0,0]
    v_pk_fma_f32 v[190:191], v[190:191], v[90:91], v[90:91] op_sel_hi:[1,0,0]
    s_add_u32 m0, s49, 0x18800
    v_add_u32 v20, s87, v78
    buffer_load_dwordx4 v20, s[28:31], 0 offen offset:0 lds
    v_rcp_f32 v188, v188
    v_rcp_f32 v189, v189
    v_rcp_f32 v190, v190
    buffer_load_dwordx4 v20, s[28:31], s53 offen offset:1024 lds
    v_rcp_f32 v191, v191
    v_pk_mul_f32 v[112:113], v[112:113], v[188:189]
    v_pk_mul_f32 v[114:115], v[114:115], v[190:191]
    v_cvt_pk_bf16_f32 v112, v112, v113
    v_cvt_pk_bf16_f32 v113, v114, v115
    v_pk_fma_f32 v[120:121], v[216:217], v[148:149], v[120:121] op_sel_hi:[1,0,1] neg_lo:[0,1,0] neg_hi:[0,1,0]
    v_pk_fma_f32 v[122:123], v[218:219], v[148:149], v[122:123] op_sel_hi:[1,0,1] neg_lo:[0,1,0] neg_hi:[0,1,0]
    v_pk_mul_f32 v[188:189], v[120:121], v[120:121]
    v_pk_mul_f32 v[190:191], v[122:123], v[122:123]
    v_pk_fma_f32 v[188:189], v[188:189], v[82:83], v[82:83] op_sel:[0,1,0] op_sel_hi:[1,1,0]
    v_pk_fma_f32 v[190:191], v[190:191], v[82:83], v[82:83] op_sel:[0,1,0] op_sel_hi:[1,1,0]
    v_pk_mul_f32 v[188:189], v[188:189], v[120:121]
    v_pk_mul_f32 v[190:191], v[190:191], v[122:123]
    v_exp_f32 v188, v188
    v_exp_f32 v189, v189
    v_exp_f32 v190, v190
    v_exp_f32 v191, v191
    v_pk_fma_f32 v[188:189], v[188:189], v[90:91], v[90:91] op_sel_hi:[1,0,0]
    v_pk_fma_f32 v[190:191], v[190:191], v[90:91], v[90:91] op_sel_hi:[1,0,0]
    v_rcp_f32 v188, v188
    v_rcp_f32 v189, v189
    v_rcp_f32 v190, v190
    v_rcp_f32 v191, v191
    v_pk_mul_f32 v[120:121], v[120:121], v[188:189]
    v_pk_mul_f32 v[122:123], v[122:123], v[190:191]
    v_cvt_pk_bf16_f32 v114, v120, v121
    v_cvt_pk_bf16_f32 v115, v122, v123
    buffer_store_dwordx4 v[112:115], v60, s[40:43], s71 offen offset:256 sc1
    v_cmp_ne_u32 vcc, s95, v69
    s_nop 0
    s_cbranch_vccz polled_56
    s_mov_b32 s57, 0x40000
poll_55:
    buffer_load_dword v69, v13, s[40:43], s62 offen offset:148 sc1
    s_waitcnt vmcnt(0)
    v_cmp_ne_u32 vcc, s95, v69
    s_nop 0
    s_cbranch_vccz polled_56
    s_sub_u32 s57, s57, 1
    s_cbranch_scc0 poll_55
polled_56:
    buffer_load_dword v66, v17, s[40:43], s62 offen offset:136 sc1
    v_pk_fma_f32 v[124:125], v[220:221], v[148:149], v[124:125] op_sel:[0,1,0] op_sel_hi:[1,1,1] neg_lo:[0,1,0] neg_hi:[0,1,0]
    v_pk_fma_f32 v[126:127], v[222:223], v[148:149], v[126:127] op_sel:[0,1,0] op_sel_hi:[1,1,1] neg_lo:[0,1,0] neg_hi:[0,1,0]
    v_pk_mul_f32 v[188:189], v[124:125], v[124:125]
    v_pk_mul_f32 v[190:191], v[126:127], v[126:127]
    v_pk_fma_f32 v[188:189], v[188:189], v[22:23], v[22:23] op_sel:[0,1,0] op_sel_hi:[1,1,0]
    v_pk_fma_f32 v[190:191], v[190:191], v[22:23], v[22:23] op_sel:[0,1,0] op_sel_hi:[1,1,0]
    v_pk_mul_f32 v[188:189], v[188:189], v[124:125]
    v_pk_mul_f32 v[190:191], v[190:191], v[126:127]
    v_exp_f32 v188, v188
    v_exp_f32 v189, v189
    v_exp_f32 v190, v190
    v_exp_f32 v191, v191
    v_pk_fma_f32 v[188:189], v[188:189], v[72:73], v[72:73] op_sel_hi:[1,0,0]
    v_pk_fma_f32 v[190:191], v[190:191], v[72:73], v[72:73] op_sel_hi:[1,0,0]
    v_rcp_f32 v188, v188
    v_rcp_f32 v189, v189
    v_rcp_f32 v190, v190
    v_rcp_f32 v191, v191
    v_pk_mul_f32 v[124:125], v[124:125], v[188:189]
    v_pk_mul_f32 v[126:127], v[126:127], v[190:191]
    v_cvt_pk_bf16_f32 v124, v124, v125
    v_cvt_pk_bf16_f32 v125, v126, v127
    v_pk_fma_f32 v[132:133], v[224:225], v[148:149], v[132:133] op_sel:[0,1,0] op_sel_hi:[1,1,1] neg_lo:[0,1,0] neg_hi:[0,1,0]
    v_add_u32 v36, 0x1c000, v58
    v_pk_fma_f32 v[134:135], v[226:227], v[148:149], v[134:135] op_sel:[0,1,0] op_sel_hi:[1,1,1] neg_lo:[0,1,0] neg_hi:[0,1,0]
    v_pk_mul_f32 v[188:189], v[132:133], v[132:133]
    v_pk_mul_f32 v[190:191], v[134:135], v[134:135]
    v_pk_fma_f32 v[188:189], v[188:189], v[22:23], v[22:23] op_sel:[0,1,0] op_sel_hi:[1,1,0]
    v_add_u32 v37, 0x1c000, v59
    v_pk_fma_f32 v[190:191], v[190:191], v[22:23], v[22:23] op_sel:[0,1,0] op_sel_hi:[1,1,0]
    v_pk_mul_f32 v[188:189], v[188:189], v[132:133]
    v_pk_mul_f32 v[190:191], v[190:191], v[134:135]
    v_exp_f32 v188, v188
    ds_read_b64_tr_b16 a[128:129], v36 offset:0
    v_exp_f32 v189, v189
    v_exp_f32 v190, v190
    v_exp_f32 v191, v191
    v_pk_fma_f32 v[188:189], v[188:189], v[72:73], v[72:73] op_sel_hi:[1,0,0]
    ds_read_b64_tr_b16 a[130:131], v36 offset:512
    v_pk_fma_f32 v[190:191], v[190:191], v[72:73], v[72:73] op_sel_hi:[1,0,0]
    v_rcp_f32 v188, v188
    v_rcp_f32 v189, v189
    v_rcp_f32 v190, v190
    ds_read_b64_tr_b16 a[132:133], v37 offset:0
    v_rcp_f32 v191, v191
    v_pk_mul_f32 v[132:133], v[132:133], v[188:189]
    v_pk_mul_f32 v[134:135], v[134:135], v[190:191]
    v_cvt_pk_bf16_f32 v126, v132, v133
    ds_read_b64_tr_b16 a[134:135], v37 offset:512
    v_cvt_pk_bf16_f32 v127, v134, v135
    s_add_u32 s71, s96, 0x10000
    buffer_store_dwordx4 v[124:127], v60, s[40:43], s71 offen offset:0 sc1
    s_waitcnt vmcnt(1)
    v_cmp_ne_u32 vcc, s95, v66
    s_nop 0
    s_cbranch_vccz polled_58
    s_mov_b32 s57, 0x40000
poll_57:
    buffer_load_dword v66, v17, s[40:43], s62 offen offset:136 sc1
    s_waitcnt vmcnt(0)
    v_cmp_ne_u32 vcc, s95, v66
    s_nop 0
    s_cbranch_vccz polled_58
    s_sub_u32 s57, s57, 1
    s_cbranch_scc0 poll_57
polled_58:
    buffer_store_dword v24, v2, s[40:43], s56 offen offset:140 sc1
    v_pk_fma_f32 v[128:129], v[220:221], v[148:149], v[128:129] op_sel_hi:[1,0,1] neg_lo:[0,1,0] neg_hi:[0,1,0]
    v_pk_fma_f32 v[130:131], v[222:223], v[148:149], v[130:131] op_sel_hi:[1,0,1] neg_lo:[0,1,0] neg_hi:[0,1,0]
    v_pk_mul_f32 v[188:189], v[128:129], v[128:129]
    ds_read_b64_tr_b16 a[136:137], v36 offset:2048
    v_pk_mul_f32 v[190:191], v[130:131], v[130:131]
    v_pk_fma_f32 v[188:189], v[188:189], v[82:83], v[82:83] op_sel:[0,1,0] op_sel_hi:[1,1,0]
    buffer_load_dwordx4 a[224:227], v62, s[40:43], s80 offen offset:0 sc1
    v_pk_fma_f32 v[190:191], v[190:191], v[82:83], v[82:83] op_sel:[0,1,0] op_sel_hi:[1,1,0]
    v_pk_mul_f32 v[188:189], v[188:189], v[128:129]
    ds_read_b64_tr_b16 a[138:139], v36 offset:2560
    v_pk_mul_f32 v[190:191], v[190:191], v[130:131]
    v_exp_f32 v188, v188
    buffer_load_dwordx4 a[228:231], v62, s[40:43], s58 offen offset:0 sc1
    v_exp_f32 v189, v189
    v_exp_f32 v190, v190
    ds_read_b64_tr_b16 a[140:141], v37 offset:2048
    v_exp_f32 v191, v191
    buffer_load_dwordx4 a[232:235], v62, s[40:43], s80 offen offset:1024 sc1
    v_pk_fma_f32 v[188:189], v[188:189], v[90:91], v[90:91] op_sel_hi:[1,0,0]
    v_pk_fma_f32 v[190:191], v[190:191], v[90:91], v[90:91] op_sel_hi:[1,0,0]
    v_rcp_f32 v188, v188
    ds_read_b64_tr_b16 a[142:143], v37 offset:2560
    v_rcp_f32 v189, v189
    buffer_load_dwordx4 a[236:239], v62, s[40:43], s58 offen offset:1024 sc1
    v_rcp_f32 v190, v190
    v_rcp_f32 v191, v191
    v_pk_mul_f32 v[128:129], v[128:129], v[188:189]
    v_pk_mul_f32 v[130:131], v[130:131], v[190:191]
    buffer_load_dwordx4 a[240:243], v62, s[40:43], s81 offen offset:0 sc1
    v_cvt_pk_bf16_f32 v128, v128, v129
    v_cvt_pk_bf16_f32 v129, v130, v131
    v_pk_fma_f32 v[136:137], v[224:225], v[148:149], v[136:137] op_sel_hi:[1,0,1] neg_lo:[0,1,0] neg_hi:[0,1,0]
    v_add_u32 v38, 0x10000, v58
    v_pk_fma_f32 v[138:139], v[226:227], v[148:149], v[138:139] op_sel_hi:[1,0,1] neg_lo:[0,1,0] neg_hi:[0,1,0]
    v_pk_mul_f32 v[188:189], v[136:137], v[136:137]
    buffer_load_dwordx4 a[244:247], v62, s[40:43], s59 offen offset:0 sc1
    v_pk_mul_f32 v[190:191], v[138:139], v[138:139]
    v_pk_fma_f32 v[188:189], v[188:189], v[82:83], v[82:83] op_sel:[0,1,0] op_sel_hi:[1,1,0]
    v_add_u32 v39, 0x10000, v59
    v_pk_fma_f32 v[190:191], v[190:191], v[82:83], v[82:83] op_sel:[0,1,0] op_sel_hi:[1,1,0]
    v_pk_mul_f32 v[188:189], v[188:189], v[136:137]
    v_pk_mul_f32 v[190:191], v[190:191], v[138:139]
    buffer_load_dwordx4 a[248:251], v62, s[40:43], s81 offen offset:1024 sc1
    v_exp_f32 v188, v188
    ds_read_b64_tr_b16 a[80:81], v38 offset:0
    v_exp_f32 v189, v189
    v_exp_f32 v190, v190
    buffer_load_dwordx4 a[252:255], v62, s[40:43], s59 offen offset:1024 sc1
    v_exp_f32 v191, v191
    v_pk_fma_f32 v[188:189], v[188:189], v[90:91], v[90:91] op_sel_hi:[1,0,0]
    ds_read_b64_tr_b16 a[82:83], v38 offset:512
    v_pk_fma_f32 v[190:191], v[190:191], v[90:91], v[90:91] op_sel_hi:[1,0,0]
    v_rcp_f32 v188, v188
    buffer_load_dwordx4 v[84:87], v62, s[40:43], s82 offen offset:0 sc1
    v_rcp_f32 v189, v189
    v_rcp_f32 v190, v190
    ds_read_b64_tr_b16 a[84:85], v39 offset:0
    v_rcp_f32 v191, v191
    buffer_load_dwordx4 v[152:155], v62, s[40:43], s60 offen offset:0 sc1
    v_pk_mul_f32 v[136:137], v[136:137], v[188:189]
    v_pk_mul_f32 v[138:139], v[138:139], v[190:191]
    v_cvt_pk_bf16_f32 v130, v136, v137
    ds_read_b64_tr_b16 a[86:87], v39 offset:512
    v_cvt_pk_bf16_f32 v131, v138, v139
    buffer_store_dwordx4 v[128:131], v60, s[40:43], s71 offen offset:256 sc1
    buffer_load_dword v67, v17, s[40:43], s62 offen offset:140 sc1
    v_pk_fma_f32 v[140:141], v[228:229], v[148:149], v[140:141] op_sel:[0,1,0] op_sel_hi:[1,1,1] neg_lo:[0,1,0] neg_hi:[0,1,0]
    v_pk_fma_f32 v[142:143], v[230:231], v[148:149], v[142:143] op_sel:[0,1,0] op_sel_hi:[1,1,1] neg_lo:[0,1,0] neg_hi:[0,1,0]
    v_pk_mul_f32 v[188:189], v[140:141], v[140:141]
    ds_read_b64_tr_b16 a[88:89], v38 offset:2048
    v_pk_mul_f32 v[190:191], v[142:143], v[142:143]
    v_pk_fma_f32 v[188:189], v[188:189], v[22:23], v[22:23] op_sel:[0,1,0] op_sel_hi:[1,1,0]
    buffer_load_dwordx4 v[156:159], v62, s[40:43], s82 offen offset:1024 sc1
    v_pk_fma_f32 v[190:191], v[190:191], v[22:23], v[22:23] op_sel:[0,1,0] op_sel_hi:[1,1,0]
    v_pk_mul_f32 v[188:189], v[188:189], v[140:141]
    ds_read_b64_tr_b16 a[90:91], v38 offset:2560
    v_pk_mul_f32 v[190:191], v[190:191], v[142:143]
    v_exp_f32 v188, v188
    buffer_load_dwordx4 v[160:163], v62, s[40:43], s60 offen offset:1024 sc1
    v_exp_f32 v189, v189
    v_exp_f32 v190, v190
    ds_read_b64_tr_b16 a[92:93], v39 offset:2048
    v_exp_f32 v191, v191
    buffer_load_dwordx4 v[164:167], v62, s[40:43], s83 offen offset:0 sc1
    v_pk_fma_f32 v[188:189], v[188:189], v[72:73], v[72:73] op_sel_hi:[1,0,0]
    v_pk_fma_f32 v[190:191], v[190:191], v[72:73], v[72:73] op_sel_hi:[1,0,0]
    v_rcp_f32 v188, v188
    ds_read_b64_tr_b16 a[94:95], v39 offset:2560
    v_rcp_f32 v189, v189
    buffer_load_dwordx4 v[168:171], v62, s[40:43], s61 offen offset:0 sc1
    v_rcp_f32 v190, v190
    v_rcp_f32 v191, v191
    v_pk_mul_f32 v[140:141], v[140:141], v[188:189]
    v_add_u32 v36, 0x14000, v58
    buffer_load_dwordx4 v[172:175], v62, s[40:43], s83 offen offset:1024 sc1
    v_pk_mul_f32 v[142:143], v[142:143], v[190:191]
    v_cvt_pk_bf16_f32 v140, v140, v141
    v_cvt_pk_bf16_f32 v141, v142, v143
    s_add_u32 s71, s94, 0x80000
    buffer_store_dwordx2 v[140:141], v61, s[40:43], s71 offen offset:0 sc1
    v_pk_fma_f32 v[144:145], v[228:229], v[148:149], v[144:145] op_sel_hi:[1,0,1] neg_lo:[0,1,0] neg_hi:[0,1,0]
    v_add_u32 v37, 0x14000, v59
    v_pk_fma_f32 v[146:147], v[230:231], v[148:149], v[146:147] op_sel_hi:[1,0,1] neg_lo:[0,1,0] neg_hi:[0,1,0]
    v_pk_mul_f32 v[188:189], v[144:145], v[144:145]
    v_pk_mul_f32 v[190:191], v[146:147], v[146:147]
    v_pk_fma_f32 v[188:189], v[188:189], v[82:83], v[82:83] op_sel:[0,1,0] op_sel_hi:[1,1,0]
    ds_read_b64_tr_b16 a[96:97], v36 offset:0
    buffer_load_dwordx4 v[176:179], v62, s[40:43], s61 offen offset:1024 sc1
    v_pk_fma_f32 v[190:191], v[190:191], v[82:83], v[82:83] op_sel:[0,1,0] op_sel_hi:[1,1,0]
    v_pk_mul_f32 v[188:189], v[188:189], v[144:145]
    v_pk_mul_f32 v[190:191], v[190:191], v[146:147]
    v_exp_f32 v188, v188
    ds_read_b64_tr_b16 a[98:99], v36 offset:512
    v_exp_f32 v189, v189
    v_exp_f32 v190, v190
    v_exp_f32 v191, v191
    v_pk_fma_f32 v[188:189], v[188:189], v[90:91], v[90:91] op_sel_hi:[1,0,0]
    ds_read_b64_tr_b16 a[100:101], v37 offset:0
    v_pk_fma_f32 v[190:191], v[190:191], v[90:91], v[90:91] op_sel_hi:[1,0,0]
    v_rcp_f32 v188, v188
    v_rcp_f32 v189, v189
    v_rcp_f32 v190, v190
    ds_read_b64_tr_b16 a[102:103], v37 offset:512
    v_rcp_f32 v191, v191
    v_pk_mul_f32 v[144:145], v[144:145], v[188:189]
    v_pk_mul_f32 v[146:147], v[146:147], v[190:191]
    v_cvt_pk_bf16_f32 v144, v144, v145
    ds_read_b64_tr_b16 a[104:105], v36 offset:2048
    v_cvt_pk_bf16_f32 v145, v146, v147
    buffer_store_dwordx2 v[144:145], v61, s[40:43], s71 offen offset:256 sc1
    s_waitcnt vmcnt(8)
    v_cmp_ne_u32 vcc, s95, v67
    s_nop 0
    s_cbranch_vccz polled_60
    s_mov_b32 s57, 0x40000
poll_59:
    buffer_load_dword v67, v17, s[40:43], s62 offen offset:140 sc1
    s_waitcnt vmcnt(0)
    v_cmp_ne_u32 vcc, s95, v67
    s_nop 0
    s_cbranch_vccz polled_60
    s_sub_u32 s57, s57, 1
    s_cbranch_scc0 poll_59
polled_60:
    v_mfma_f32_32x32x16_bf16 v[40:55], a[0:3], a[224:227], v[40:55]
    ds_read_b64_tr_b16 a[106:107], v36 offset:2560
    ds_read_b64_tr_b16 a[108:109], v37 offset:2048
    buffer_load_dwordx4 v[180:183], v63, s[40:43], s80 offen offset:0 sc1
    v_mfma_f32_32x32x16_bf16 v[204:219], a[4:7], a[224:227], 0
    ds_read_b64_tr_b16 a[110:111], v37 offset:2560
    v_add_u32 v38, 0x20000, v58
    v_add_u32 v39, 0x20000, v59
    buffer_load_dwordx4 v[184:187], v63, s[40:43], s58 offen offset:0 sc1
    v_mfma_f32_32x32x16_bf16 v[92:107], a[0:3], a[228:231], 0
    ds_read_b64_tr_b16 a[112:113], v38 offset:0
    ds_read_b64_tr_b16 a[114:115], v38 offset:512
    v_mfma_f32_32x32x16_bf16 v[108:123], a[4:7], a[228:231], 0
    ds_read_b64_tr_b16 a[116:117], v39 offset:0
    ds_read_b64_tr_b16 a[118:119], v39 offset:512
    ds_read_b64_tr_b16 a[120:121], v38 offset:2048
    buffer_load_dwordx4 v[232:235], v63, s[40:43], s80 offen offset:1024 sc1
    v_mfma_f32_32x32x16_bf16 v[92:107], a[8:11], a[236:239], v[92:107]
    ds_read_b64_tr_b16 a[122:123], v38 offset:2560
    ds_read_b64_tr_b16 a[124:125], v39 offset:2048
    buffer_load_dwordx4 v[236:239], v63, s[40:43], s58 offen offset:1024 sc1
    v_mfma_f32_32x32x16_bf16 v[108:123], a[12:15], a[236:239], v[108:123]
    ds_read_b64_tr_b16 a[126:127], v39 offset:2560
    buffer_load_dwordx4 v[240:243], v63, s[40:43], s81 offen offset:0 sc1
    v_mfma_f32_32x32x16_bf16 v[204:219], a[12:15], a[232:235], v[204:219]
    buffer_load_dwordx4 v[244:247], v63, s[40:43], s59 offen offset:0 sc1
    v_mfma_f32_32x32x16_bf16 v[40:55], a[8:11], a[232:235], v[40:55]
    buffer_load_dwordx4 v[248:251], v63, s[40:43], s81 offen offset:1024 sc1
    s_waitcnt vmcnt(7)
    buffer_store_dword v24, v2, s[40:43], s56 offen offset:144 sc1
    v_mfma_f32_32x32x16_bf16 v[92:107], a[16:19], a[244:247], v[92:107]
    v_mfma_f32_32x32x16_bf16 v[108:123], a[20:23], a[244:247], v[108:123]
    buffer_load_dwordx4 v[252:255], v63, s[40:43], s59 offen offset:1024 sc1
    v_mfma_f32_32x32x16_bf16 v[204:219], a[20:23], a[240:243], v[204:219]
    buffer_load_dwordx4 v[124:127], v63, s[40:43], s82 offen offset:0 sc1
    v_mfma_f32_32x32x16_bf16 v[40:55], a[16:19], a[240:243], v[40:55]
    buffer_load_dwordx4 v[128:131], v63, s[40:43], s60 offen offset:0 sc1
    v_mfma_f32_32x32x16_bf16 v[92:107], a[24:27], a[252:255], v[92:107]
    buffer_load_dwordx4 v[132:135], v63, s[40:43], s82 offen offset:1024 sc1
    v_mfma_f32_32x32x16_bf16 v[108:123], a[28:31], a[252:255], v[108:123]
    buffer_load_dwordx4 v[136:139], v63, s[40:43], s60 offen offset:1024 sc1
    v_mfma_f32_32x32x16_bf16 v[204:219], a[28:31], a[248:251], v[204:219]
    buffer_load_dwordx4 v[140:143], v63, s[40:43], s83 offen offset:0 sc1
    v_mfma_f32_32x32x16_bf16 v[40:55], a[24:27], a[248:251], v[40:55]
    buffer_load_dwordx4 v[144:147], v63, s[40:43], s61 offen offset:0 sc1
    v_mfma_f32_32x32x16_bf16 v[92:107], a[32:35], v[152:155], v[92:107]
    buffer_load_dwordx4 v[220:223], v63, s[40:43], s83 offen offset:1024 sc1
    v_mfma_f32_32x32x16_bf16 v[108:123], a[36:39], v[152:155], v[108:123]
    buffer_load_dwordx4 v[224:227], v63, s[40:43], s61 offen offset:1024 sc1
    v_mfma_f32_32x32x16_bf16 v[204:219], a[36:39], v[84:87], v[204:219]
    v_mfma_f32_32x32x16_bf16 v[40:55], a[32:35], v[84:87], v[40:55]
    v_mfma_f32_32x32x16_bf16 v[92:107], a[40:43], v[160:163], v[92:107]
    s_lshl_b32 s70, s44, 6
    s_lshr_b32 s73, s46, 1
    s_lshl_b32 s73, s73, 5
    s_add_u32 s70, s70, s73
    v_and_b32 v192, 15, v0
    v_mfma_f32_32x32x16_bf16 v[108:123], a[44:47], v[160:163], v[108:123]
    v_add_u32 v192, s70, v192
    v_lshlrev_b32 v192, 10, v192
    v_and_b32 v9, 16, v0
    v_lshl_add_u32 v192, v9, 1, v192
    v_lshrrev_b32 v9, 5, v0
    v_mfma_f32_32x32x16_bf16 v[204:219], a[44:47], v[156:159], v[204:219]
    v_lshl_add_u32 v192, v9, 4, v192
    s_lshl_b32 s70, s45, 7
    s_and_b32 s73, s46, 1
    s_lshl_b32 s73, s73, 6
    s_add_u32 s73, s70, s73
    v_mfma_f32_32x32x16_bf16 v[40:55], a[40:43], v[156:159], v[40:55]
    s_add_u32 s72, s73, 0x4000
    v_add_u32 v60, s49, v1
    v_xor_b32 v193, 4096, v60
    v_xor_b32 v194, 8192, v60
    v_xor_b32 v195, 12288, v60
    v_mfma_f32_32x32x16_bf16 v[92:107], a[48:51], v[168:171], v[92:107]
    v_mfma_f32_32x32x16_bf16 v[108:123], a[52:55], v[168:171], v[108:123]
    v_mfma_f32_32x32x16_bf16 v[204:219], a[52:55], v[164:167], v[204:219]
    v_mfma_f32_32x32x16_bf16 v[40:55], a[48:51], v[164:167], v[40:55]
    v_mfma_f32_32x32x16_bf16 v[92:107], a[56:59], v[176:179], v[92:107]
    v_mfma_f32_32x32x16_bf16 v[108:123], a[60:63], v[176:179], v[108:123]
    v_mfma_f32_32x32x16_bf16 v[204:219], a[60:63], v[172:175], v[204:219]
    v_mfma_f32_32x32x16_bf16 v[40:55], a[56:59], v[172:175], v[40:55]
    buffer_load_dword v68, v17, s[40:43], s62 offen offset:144 sc1
    s_waitcnt vmcnt(16)
    v_mfma_f32_32x32x16_bf16 v[92:107], a[64:67], v[184:187], v[92:107]
    v_mfma_f32_32x32x16_bf16 v[108:123], a[68:71], v[184:187], v[108:123]
    v_mfma_f32_32x32x16_bf16 v[204:219], a[68:71], v[180:183], v[204:219]
    v_mfma_f32_32x32x16_bf16 v[40:55], a[64:67], v[180:183], v[40:55]
    s_waitcnt vmcnt(14)
    v_mfma_f32_32x32x16_bf16 v[92:107], a[72:75], v[236:239], v[92:107]
    v_mfma_f32_32x32x16_bf16 v[108:123], a[76:79], v[236:239], v[108:123]
    v_mfma_f32_32x32x16_bf16 v[204:219], a[76:79], v[232:235], v[204:219]
    v_mfma_f32_32x32x16_bf16 v[40:55], a[72:75], v[232:235], v[40:55]
    s_waitcnt vmcnt(12) lgkmcnt(15)
    v_mfma_f32_32x32x16_bf16 v[92:107], a[80:83], v[244:247], v[92:107]
    v_mfma_f32_32x32x16_bf16 v[108:123], a[84:87], v[244:247], v[108:123]
    v_mfma_f32_32x32x16_bf16 v[204:219], a[84:87], v[240:243], v[204:219]
    v_mfma_f32_32x32x16_bf16 v[40:55], a[80:83], v[240:243], v[40:55]
    s_waitcnt vmcnt(0)
    v_cmp_ne_u32 vcc, s95, v68
    s_nop 0
    s_cbranch_vccz polled_62
    s_mov_b32 s57, 0x40000
poll_61:
    buffer_load_dword v68, v17, s[40:43], s62 offen offset:144 sc1
    s_waitcnt vmcnt(0)
    v_cmp_ne_u32 vcc, s95, v68
    s_nop 0
    s_cbranch_vccz polled_62
    s_sub_u32 s57, s57, 1
    s_cbranch_scc0 poll_61
polled_62:
    v_mfma_f32_32x32x16_bf16 v[92:107], a[88:91], v[252:255], v[92:107]
    buffer_load_dwordx4 v[228:231], v64, s[40:43], s80 offen offset:0 sc1
    v_mfma_f32_32x32x16_bf16 v[108:123], a[92:95], v[252:255], v[108:123]
    buffer_load_dwordx4 a[228:231], v64, s[40:43], s58 offen offset:0 sc1
    v_mfma_f32_32x32x16_bf16 v[204:219], a[92:95], v[248:251], v[204:219]
    buffer_load_dwordx4 a[224:227], v64, s[40:43], s80 offen offset:1024 sc1
    v_mfma_f32_32x32x16_bf16 v[40:55], a[88:91], v[248:251], v[40:55]
    buffer_load_dwordx4 a[236:239], v64, s[40:43], s58 offen offset:1024 sc1
    s_waitcnt lgkmcnt(14)
    v_mfma_f32_32x32x16_bf16 v[92:107], a[96:99], v[128:131], v[92:107]
    v_add_u32 v36, 0x0, v58
    v_add_u32 v37, 0x0, v59
    buffer_load_dwordx4 a[232:235], v64, s[40:43], s81 offen offset:0 sc1
    s_waitcnt lgkmcnt(12)
    v_mfma_f32_32x32x16_bf16 v[108:123], a[100:103], v[128:131], v[108:123]
    ds_read_b64_tr_b16 a[144:145], v36 offset:0
    ds_read_b64_tr_b16 a[146:147], v36 offset:512
    ds_read_b64_tr_b16 a[148:149], v37 offset:0
    buffer_load_dwordx4 a[244:247], v64, s[40:43], s59 offen offset:0 sc1
    v_mfma_f32_32x32x16_bf16 v[204:219], a[100:103], v[124:127], v[204:219]
    ds_read_b64_tr_b16 a[150:151], v37 offset:512
    ds_read_b64_tr_b16 a[152:153], v36 offset:2048
    buffer_load_dwordx4 a[240:243], v64, s[40:43], s81 offen offset:1024 sc1
    v_mfma_f32_32x32x16_bf16 v[40:55], a[96:99], v[124:127], v[40:55]
    ds_read_b64_tr_b16 a[154:155], v36 offset:2560
    ds_read_b64_tr_b16 a[156:157], v37 offset:2048
    ds_read_b64_tr_b16 a[158:159], v37 offset:2560
    buffer_load_dwordx4 a[252:255], v64, s[40:43], s59 offen offset:1024 sc1
    s_waitcnt lgkmcnt(15)
    v_mfma_f32_32x32x16_bf16 v[92:107], a[104:107], v[136:139], v[92:107]
    v_add_u32 v38, 0x4000, v58
    v_add_u32 v39, 0x4000, v59
    buffer_load_dwordx4 a[248:251], v64, s[40:43], s82 offen offset:0 sc1
    v_mfma_f32_32x32x16_bf16 v[108:123], a[108:111], v[136:139], v[108:123]
    ds_read_b64_tr_b16 a[160:161], v38 offset:0
    ds_read_b64_tr_b16 a[162:163], v38 offset:512
    ds_read_b64_tr_b16 a[164:165], v39 offset:0
    buffer_load_dwordx4 v[152:155], v64, s[40:43], s60 offen offset:0 sc1
    v_mfma_f32_32x32x16_bf16 v[204:219], a[108:111], v[132:135], v[204:219]
    ds_read_b64_tr_b16 a[166:167], v39 offset:512
    ds_read_b64_tr_b16 a[168:169], v38 offset:2048
    buffer_load_dwordx4 v[84:87], v64, s[40:43], s82 offen offset:1024 sc1
    v_mfma_f32_32x32x16_bf16 v[40:55], a[104:107], v[132:135], v[40:55]
    ds_read_b64_tr_b16 a[170:171], v38 offset:2560
    ds_read_b64_tr_b16 a[172:173], v39 offset:2048
    ds_read_b64_tr_b16 a[174:175], v39 offset:2560
    buffer_load_dwordx4 v[160:163], v64, s[40:43], s60 offen offset:1024 sc1
    s_waitcnt lgkmcnt(15)
    v_mfma_f32_32x32x16_bf16 v[92:107], a[112:115], v[144:147], v[92:107]
    v_mfma_f32_32x32x16_bf16 v[108:123], a[116:119], v[144:147], v[108:123]
    buffer_load_dwordx4 v[156:159], v64, s[40:43], s83 offen offset:0 sc1
    v_mfma_f32_32x32x16_bf16 v[204:219], a[116:119], v[140:143], v[204:219]
    buffer_load_dwordx4 v[168:171], v64, s[40:43], s61 offen offset:0 sc1
    v_mfma_f32_32x32x16_bf16 v[92:107], a[120:123], v[224:227], v[92:107]
    v_add_u32 v36, 0x8000, v58
    v_add_u32 v37, 0x8000, v59
    buffer_load_dwordx4 v[164:167], v64, s[40:43], s83 offen offset:1024 sc1
    v_mfma_f32_32x32x16_bf16 v[108:123], a[124:127], v[224:227], v[108:123]
    ds_read_b64_tr_b16 a[176:177], v36 offset:0
    ds_read_b64_tr_b16 a[178:179], v36 offset:512
    ds_read_b64_tr_b16 a[180:181], v37 offset:0
    buffer_load_dwordx4 v[176:179], v64, s[40:43], s61 offen offset:1024 sc1
    v_mfma_f32_32x32x16_bf16 v[204:219], a[124:127], v[220:223], v[204:219]
    ds_read_b64_tr_b16 a[182:183], v37 offset:512
    ds_read_b64_tr_b16 a[184:185], v36 offset:2048
    buffer_load_dwordx4 v[172:175], v65, s[40:43], s80 offen offset:0 sc1
    s_waitcnt vmcnt(15)
    v_mfma_f32_32x32x16_bf16 v[92:107], a[128:131], a[228:231], v[92:107]
    ds_read_b64_tr_b16 a[186:187], v36 offset:2560
    ds_read_b64_tr_b16 a[188:189], v37 offset:2048
    ds_read_b64_tr_b16 a[190:191], v37 offset:2560
    buffer_load_dwordx4 v[184:187], v65, s[40:43], s58 offen offset:0 sc1
    v_mfma_f32_32x32x16_bf16 v[108:123], a[132:135], a[228:231], v[108:123]
    v_mfma_f32_32x32x16_bf16 v[204:219], a[132:135], v[228:231], v[204:219]
    buffer_load_dwordx4 v[180:183], v65, s[40:43], s81 offen offset:0 sc1
    s_waitcnt vmcnt(15)
    v_mfma_f32_32x32x16_bf16 v[92:107], a[136:139], a[236:239], v[92:107]
    v_add_u32 v38, 0xc000, v58
    v_add_u32 v39, 0xc000, v59
    buffer_load_dwordx4 v[236:239], v65, s[40:43], s59 offen offset:0 sc1
    v_mfma_f32_32x32x16_bf16 v[108:123], a[140:143], a[236:239], v[108:123]
    ds_read_b64_tr_b16 a[192:193], v38 offset:0
    ds_read_b64_tr_b16 a[194:195], v38 offset:512
    ds_read_b64_tr_b16 a[196:197], v39 offset:0
    buffer_load_dwordx4 v[232:235], v65, s[40:43], s82 offen offset:0 sc1
    v_mfma_f32_32x32x16_bf16 v[204:219], a[140:143], a[224:227], v[204:219]
    ds_read_b64_tr_b16 a[198:199], v39 offset:512
    ds_read_b64_tr_b16 a[200:201], v38 offset:2048
    buffer_load_dwordx4 v[244:247], v65, s[40:43], s60 offen offset:0 sc1
    s_waitcnt vmcnt(16) lgkmcnt(15)
    v_mfma_f32_32x32x16_bf16 v[92:107], a[144:147], a[244:247], v[92:107]
    ds_read_b64_tr_b16 a[202:203], v38 offset:2560
    ds_read_b64_tr_b16 a[204:205], v39 offset:2048
    ds_read_b64_tr_b16 a[206:207], v39 offset:2560
    buffer_load_dwordx4 v[240:243], v65, s[40:43], s83 offen offset:0 sc1
    v_mfma_f32_32x32x16_bf16 v[108:123], a[148:151], a[244:247], v[108:123]
    v_mfma_f32_32x32x16_bf16 v[204:219], a[148:151], a[232:235], v[204:219]
    buffer_load_dwordx4 v[252:255], v65, s[40:43], s61 offen offset:0 sc1
    s_waitcnt vmcnt(16)
    v_mfma_f32_32x32x16_bf16 v[92:107], a[152:155], a[252:255], v[92:107]
    v_add_u32 v36, 0x18000, v58
    v_add_u32 v37, 0x18000, v59
    v_mfma_f32_32x32x16_bf16 v[108:123], a[156:159], a[252:255], v[108:123]
    ds_read_b64_tr_b16 a[208:209], v36 offset:0
    ds_read_b64_tr_b16 a[210:211], v36 offset:512
    ds_read_b64_tr_b16 a[212:213], v37 offset:0
    v_mfma_f32_32x32x16_bf16 v[204:219], a[156:159], a[240:243], v[204:219]
    ds_read_b64_tr_b16 a[214:215], v37 offset:512
    ds_read_b64_tr_b16 a[216:217], v36 offset:2048
    s_waitcnt vmcnt(14)
    v_mfma_f32_32x32x16_bf16 v[92:107], a[160:163], v[152:155], v[92:107]
    ds_read_b64_tr_b16 a[218:219], v36 offset:2560
    ds_read_b64_tr_b16 a[220:221], v37 offset:2048
    ds_read_b64_tr_b16 a[222:223], v37 offset:2560
    v_mfma_f32_32x32x16_bf16 v[108:123], a[164:167], v[152:155], v[108:123]
    s_waitcnt vmcnt(12)
    v_mfma_f32_32x32x16_bf16 v[92:107], a[168:171], v[160:163], v[92:107]
    s_waitcnt lgkmcnt(15)
    v_mfma_f32_32x32x16_bf16 v[108:123], a[172:175], v[160:163], v[108:123]
    s_waitcnt vmcnt(10)
    v_mfma_f32_32x32x16_bf16 v[92:107], a[176:179], v[168:171], v[92:107]
    v_mfma_f32_32x32x16_bf16 v[108:123], a[180:183], v[168:171], v[108:123]
    s_waitcnt vmcnt(8)
    v_mfma_f32_32x32x16_bf16 v[92:107], a[184:187], v[176:179], v[92:107]
    v_mfma_f32_32x32x16_bf16 v[108:123], a[188:191], v[176:179], v[108:123]
    s_waitcnt vmcnt(6) lgkmcnt(14)
    v_mfma_f32_32x32x16_bf16 v[92:107], a[192:195], v[184:187], v[92:107]
    s_waitcnt lgkmcnt(12)
    v_mfma_f32_32x32x16_bf16 v[108:123], a[196:199], v[184:187], v[108:123]
    s_waitcnt vmcnt(4) lgkmcnt(10)
    v_mfma_f32_32x32x16_bf16 v[92:107], a[200:203], v[236:239], v[92:107]
    s_waitcnt lgkmcnt(8)
    v_mfma_f32_32x32x16_bf16 v[108:123], a[204:207], v[236:239], v[108:123]
    s_waitcnt vmcnt(2) lgkmcnt(6)
    v_mfma_f32_32x32x16_bf16 v[92:107], a[208:211], v[244:247], v[92:107]
    s_waitcnt lgkmcnt(4)
    v_mfma_f32_32x32x16_bf16 v[108:123], a[212:215], v[244:247], v[108:123]
    s_waitcnt vmcnt(0) lgkmcnt(2)
    v_mfma_f32_32x32x16_bf16 v[92:107], a[216:219], v[252:255], v[92:107]
    s_waitcnt lgkmcnt(0)
    v_mfma_f32_32x32x16_bf16 v[108:123], a[220:223], v[252:255], v[108:123]
    v_mfma_f32_32x32x16_bf16 v[204:219], a[164:167], a[248:251], v[204:219]
    ds_write_b128 v60, v[92:95] offset:16384
    v_mfma_f32_32x32x16_bf16 v[204:219], a[172:175], v[84:87], v[204:219]
    ds_write_b128 v60, v[96:99] offset:17408
    v_mfma_f32_32x32x16_bf16 v[204:219], a[180:183], v[156:159], v[204:219]
    ds_write_b128 v60, v[100:103] offset:18432
    v_mfma_f32_32x32x16_bf16 v[204:219], a[188:191], v[164:167], v[204:219]
    ds_write_b128 v60, v[104:107] offset:19456
    v_mfma_f32_32x32x16_bf16 v[204:219], a[196:199], v[172:175], v[204:219]
    ds_write_b128 v60, v[108:111] offset:32768
    v_mfma_f32_32x32x16_bf16 v[204:219], a[204:207], v[180:183], v[204:219]
    ds_write_b128 v60, v[112:115] offset:33792
    v_mfma_f32_32x32x16_bf16 v[204:219], a[212:215], v[232:235], v[204:219]
    ds_write_b128 v60, v[116:119] offset:34816
    v_mfma_f32_32x32x16_bf16 v[204:219], a[220:223], v[240:243], v[204:219]
    ds_write_b128 v60, v[120:123] offset:35840
    v_mfma_f32_32x32x16_bf16 v[40:55], a[112:115], v[140:143], v[40:55]
    v_mfma_f32_32x32x16_bf16 v[40:55], a[120:123], v[220:223], v[40:55]
    v_mfma_f32_32x32x16_bf16 v[40:55], a[128:131], v[228:231], v[40:55]
    ds_write_b128 v60, v[204:207] offset:0
    v_mfma_f32_32x32x16_bf16 v[40:55], a[136:139], a[224:227], v[40:55]
    ds_write_b128 v60, v[208:211] offset:1024
    v_mfma_f32_32x32x16_bf16 v[40:55], a[144:147], a[232:235], v[40:55]
    ds_write_b128 v60, v[212:215] offset:2048
    v_mfma_f32_32x32x16_bf16 v[40:55], a[152:155], a[240:243], v[40:55]
    ds_write_b128 v60, v[216:219] offset:3072
    s_waitcnt lgkmcnt(0)
    s_barrier
    ds_read_b128 v[204:207], v193 offset:0
    ds_read_b128 v[208:211], v193 offset:1024
    ds_read_b128 v[212:215], v193 offset:2048
    ds_read_b128 v[216:219], v193 offset:3072
    ds_read_b128 v[92:95], v194 offset:16384
    ds_read_b128 v[96:99], v194 offset:17408
    ds_read_b128 v[100:103], v194 offset:18432
    ds_read_b128 v[104:107], v194 offset:19456
    ds_read_b128 v[108:111], v195 offset:32768
    ds_read_b128 v[112:115], v195 offset:33792
    ds_read_b128 v[116:119], v195 offset:34816
    ds_read_b128 v[120:123], v195 offset:35840
    v_mfma_f32_32x32x16_bf16 v[40:55], a[160:163], a[248:251], v[40:55]
    v_mfma_f32_32x32x16_bf16 v[40:55], a[168:171], v[84:87], v[40:55]
    v_mfma_f32_32x32x16_bf16 v[40:55], a[176:179], v[156:159], v[40:55]
    s_waitcnt lgkmcnt(7)
    v_pk_add_f32 v[204:205], v[204:205], v[92:93]
    v_pk_add_f32 v[206:207], v[206:207], v[94:95]
    s_waitcnt lgkmcnt(6)
    v_pk_add_f32 v[208:209], v[208:209], v[96:97]
    v_pk_add_f32 v[210:211], v[210:211], v[98:99]
    s_waitcnt lgkmcnt(5)
    v_pk_add_f32 v[212:213], v[212:213], v[100:101]
    v_mfma_f32_32x32x16_bf16 v[40:55], a[184:187], v[164:167], v[40:55]
    v_pk_add_f32 v[214:215], v[214:215], v[102:103]
    s_waitcnt lgkmcnt(4)
    v_pk_add_f32 v[216:217], v[216:217], v[104:105]
    v_pk_add_f32 v[218:219], v[218:219], v[106:107]
    s_waitcnt lgkmcnt(3)
    v_pk_add_f32 v[204:205], v[204:205], v[108:109]
    v_pk_add_f32 v[206:207], v[206:207], v[110:111]
    v_mfma_f32_32x32x16_bf16 v[40:55], a[192:195], v[172:175], v[40:55]
    s_waitcnt lgkmcnt(2)
    v_pk_add_f32 v[208:209], v[208:209], v[112:113]
    v_pk_add_f32 v[210:211], v[210:211], v[114:115]
    s_waitcnt lgkmcnt(1)
    v_pk_add_f32 v[212:213], v[212:213], v[116:117]
    v_pk_add_f32 v[214:215], v[214:215], v[118:119]
    s_waitcnt lgkmcnt(0)
    v_pk_add_f32 v[216:217], v[216:217], v[120:121]
    v_mfma_f32_32x32x16_bf16 v[40:55], a[200:203], v[180:183], v[40:55]
    v_pk_add_f32 v[218:219], v[218:219], v[122:123]
    v_mfma_f32_32x32x16_bf16 v[40:55], a[208:211], v[232:235], v[40:55]
    v_mfma_f32_32x32x16_bf16 v[40:55], a[216:219], v[240:243], v[40:55]
    s_nop 11
    v_pk_add_f32 v[40:41], v[40:41], v[204:205]
    v_pk_add_f32 v[42:43], v[42:43], v[206:207]
    v_pk_add_f32 v[44:45], v[44:45], v[208:209]
    v_pk_add_f32 v[46:47], v[46:47], v[210:211]
    v_cvt_pk_bf16_f32 v92, v40, v41
    v_cvt_pk_bf16_f32 v93, v42, v43
    v_cvt_pk_bf16_f32 v94, v44, v45
    v_cvt_pk_bf16_f32 v95, v46, v47
    s_nop 0
    v_permlane32_swap_b32 v92, v94
    v_permlane32_swap_b32 v93, v95
    v_pk_add_f32 v[48:49], v[48:49], v[212:213]
    v_pk_add_f32 v[50:51], v[50:51], v[214:215]
    v_pk_add_f32 v[52:53], v[52:53], v[216:217]
    v_pk_add_f32 v[54:55], v[54:55], v[218:219]
    v_cvt_pk_bf16_f32 v96, v48, v49
    v_cvt_pk_bf16_f32 v97, v50, v51
    v_cvt_pk_bf16_f32 v98, v52, v53
    v_cvt_pk_bf16_f32 v99, v54, v55
    s_nop 0
    v_permlane32_swap_b32 v96, v98
    v_permlane32_swap_b32 v97, v99
    s_nop 0
    v_permlane16_swap_b32 v92, v96
    v_permlane16_swap_b32 v93, v97
    v_permlane16_swap_b32 v94, v98
    v_permlane16_swap_b32 v95, v99
    buffer_store_dwordx4 v[92:95], v192, s[32:35], s73 offen sc1
    buffer_store_dwordx4 v[96:99], v192, s[32:35], s72 offen sc1
    s_endpgm
SAFE_SOFTMAX:
    s_lshl_b32 s73, s44, 1
    s_add_u32 s73, s73, 0
    s_min_u32 s73, s73, 8
    v_mov_b32 v128, 0xff800000
    s_mov_b32 s74, 0
fbmax_63:
    s_lshl_b32 s70, s44, 1
    s_add_u32 s70, s70, 0
    s_sub_u32 s70, s70, s74
    s_lshr_b32 s71, s70, 1
    s_sub_u32 s71, s44, s71
    s_lshl_b32 s71, s71, 20
    s_sub_u32 s71, s94, s71
    s_and_b32 s70, s70, 1
    s_lshl_b32 s72, s70, 10
    s_add_u32 s72, s72, s71
    buffer_load_dwordx4 v[116:119], v1, s[40:43], s72 offen sc1
    s_waitcnt vmcnt(2)
    buffer_load_dwordx4 v[120:123], v27, s[40:43], s72 offen offset:0 sc1
    s_waitcnt vmcnt(2)
    buffer_load_dwordx4 v[124:127], v27, s[40:43], s72 offen offset:512 sc1
    s_waitcnt vmcnt(2)
    v_mfma_f32_32x32x16_bf16 v[100:115], v[116:119], v[92:95], 0
    s_lshl_b32 s70, s74, 5
    v_add_u32 v129, s70, v43
    v_mov_b32 v131, 0xff800000
    v_subrev_u32 v130, 0, v129
    v_cmp_gt_u32 vcc, 0x100, v130
    s_nop 6
    v_cndmask_b32 v100, v131, v100, vcc
    v_subrev_u32 v130, 1, v129
    v_cmp_gt_u32 vcc, 0x100, v130
    s_nop 1
    v_cndmask_b32 v101, v131, v101, vcc
    v_subrev_u32 v130, 2, v129
    v_cmp_gt_u32 vcc, 0x100, v130
    s_nop 1
    v_cndmask_b32 v102, v131, v102, vcc
    v_subrev_u32 v130, 3, v129
    v_cmp_gt_u32 vcc, 0x100, v130
    s_nop 1
    v_cndmask_b32 v103, v131, v103, vcc
    v_subrev_u32 v130, 8, v129
    v_cmp_gt_u32 vcc, 0x100, v130
    s_nop 1
    v_cndmask_b32 v104, v131, v104, vcc
    v_subrev_u32 v130, 9, v129
    v_cmp_gt_u32 vcc, 0x100, v130
    s_nop 1
    v_cndmask_b32 v105, v131, v105, vcc
    v_subrev_u32 v130, 10, v129
    v_cmp_gt_u32 vcc, 0x100, v130
    s_nop 1
    v_cndmask_b32 v106, v131, v106, vcc
    v_subrev_u32 v130, 11, v129
    v_cmp_gt_u32 vcc, 0x100, v130
    s_nop 1
    v_cndmask_b32 v107, v131, v107, vcc
    v_subrev_u32 v130, 16, v129
    v_cmp_gt_u32 vcc, 0x100, v130
    s_nop 1
    v_cndmask_b32 v108, v131, v108, vcc
    v_subrev_u32 v130, 17, v129
    v_cmp_gt_u32 vcc, 0x100, v130
    s_nop 1
    v_cndmask_b32 v109, v131, v109, vcc
    v_subrev_u32 v130, 18, v129
    v_cmp_gt_u32 vcc, 0x100, v130
    s_nop 1
    v_cndmask_b32 v110, v131, v110, vcc
    v_subrev_u32 v130, 19, v129
    v_cmp_gt_u32 vcc, 0x100, v130
    s_nop 1
    v_cndmask_b32 v111, v131, v111, vcc
    v_subrev_u32 v130, 24, v129
    v_cmp_gt_u32 vcc, 0x100, v130
    s_nop 1
    v_cndmask_b32 v112, v131, v112, vcc
    v_subrev_u32 v130, 25, v129
    v_cmp_gt_u32 vcc, 0x100, v130
    s_nop 1
    v_cndmask_b32 v113, v131, v113, vcc
    v_subrev_u32 v130, 26, v129
    v_cmp_gt_u32 vcc, 0x100, v130
    s_nop 1
    v_cndmask_b32 v114, v131, v114, vcc
    v_subrev_u32 v130, 27, v129
    v_cmp_gt_u32 vcc, 0x100, v130
    s_nop 1
    v_cndmask_b32 v115, v131, v115, vcc
    v_max_f32 v128, v128, v100
    v_max_f32 v128, v128, v101
    v_max_f32 v128, v128, v102
    v_max_f32 v128, v128, v103
    v_max_f32 v128, v128, v104
    v_max_f32 v128, v128, v105
    v_max_f32 v128, v128, v106
    v_max_f32 v128, v128, v107
    v_max_f32 v128, v128, v108
    v_max_f32 v128, v128, v109
    v_max_f32 v128, v128, v110
    v_max_f32 v128, v128, v111
    v_max_f32 v128, v128, v112
    v_max_f32 v128, v128, v113
    v_max_f32 v128, v128, v114
    v_max_f32 v128, v128, v115
    s_add_u32 s74, s74, 1
    s_cmp_le_u32 s74, s73
    s_cbranch_scc1 fbmax_63
    v_mov_b32 v130, v128
    s_nop 1
    v_permlane32_swap_b32 v130, v128
    v_max_f32 v128, v128, v130
    v_mov_b32 v156, 0
    v_mov_b32 v157, 0
    v_mov_b32 v158, 0
    v_mov_b32 v159, 0
    v_mov_b32 v160, 0
    v_mov_b32 v161, 0
    v_mov_b32 v162, 0
    v_mov_b32 v163, 0
    v_mov_b32 v164, 0
    v_mov_b32 v165, 0
    v_mov_b32 v166, 0
    v_mov_b32 v167, 0
    v_mov_b32 v168, 0
    v_mov_b32 v169, 0
    v_mov_b32 v170, 0
    v_mov_b32 v171, 0
    s_mov_b32 s74, 0
fbsum_64:
    s_lshl_b32 s70, s44, 1
    s_add_u32 s70, s70, 0
    s_sub_u32 s70, s70, s74
    s_lshr_b32 s71, s70, 1
    s_sub_u32 s71, s44, s71
    s_lshl_b32 s71, s71, 20
    s_sub_u32 s71, s94, s71
    s_and_b32 s70, s70, 1
    s_lshl_b32 s72, s70, 10
    s_add_u32 s72, s72, s71
    buffer_load_dwordx4 v[116:119], v1, s[40:43], s72 offen sc1
    s_waitcnt vmcnt(2)
    buffer_load_dwordx4 v[120:123], v27, s[40:43], s72 offen offset:0 sc1
    s_waitcnt vmcnt(2)
    buffer_load_dwordx4 v[124:127], v27, s[40:43], s72 offen offset:512 sc1
    s_waitcnt vmcnt(2)
    v_mfma_f32_32x32x16_bf16 v[100:115], v[116:119], v[92:95], 0
    s_lshl_b32 s70, s74, 5
    v_add_u32 v129, s70, v43
    v_mov_b32 v131, 0xff800000
    v_subrev_u32 v130, 0, v129
    v_cmp_gt_u32 vcc, 0x100, v130
    s_nop 6
    v_cndmask_b32 v100, v131, v100, vcc
    v_subrev_u32 v130, 1, v129
    v_cmp_gt_u32 vcc, 0x100, v130
    s_nop 1
    v_cndmask_b32 v101, v131, v101, vcc
    v_subrev_u32 v130, 2, v129
    v_cmp_gt_u32 vcc, 0x100, v130
    s_nop 1
    v_cndmask_b32 v102, v131, v102, vcc
    v_subrev_u32 v130, 3, v129
    v_cmp_gt_u32 vcc, 0x100, v130
    s_nop 1
    v_cndmask_b32 v103, v131, v103, vcc
    v_subrev_u32 v130, 8, v129
    v_cmp_gt_u32 vcc, 0x100, v130
    s_nop 1
    v_cndmask_b32 v104, v131, v104, vcc
    v_subrev_u32 v130, 9, v129
    v_cmp_gt_u32 vcc, 0x100, v130
    s_nop 1
    v_cndmask_b32 v105, v131, v105, vcc
    v_subrev_u32 v130, 10, v129
    v_cmp_gt_u32 vcc, 0x100, v130
    s_nop 1
    v_cndmask_b32 v106, v131, v106, vcc
    v_subrev_u32 v130, 11, v129
    v_cmp_gt_u32 vcc, 0x100, v130
    s_nop 1
    v_cndmask_b32 v107, v131, v107, vcc
    v_subrev_u32 v130, 16, v129
    v_cmp_gt_u32 vcc, 0x100, v130
    s_nop 1
    v_cndmask_b32 v108, v131, v108, vcc
    v_subrev_u32 v130, 17, v129
    v_cmp_gt_u32 vcc, 0x100, v130
    s_nop 1
    v_cndmask_b32 v109, v131, v109, vcc
    v_subrev_u32 v130, 18, v129
    v_cmp_gt_u32 vcc, 0x100, v130
    s_nop 1
    v_cndmask_b32 v110, v131, v110, vcc
    v_subrev_u32 v130, 19, v129
    v_cmp_gt_u32 vcc, 0x100, v130
    s_nop 1
    v_cndmask_b32 v111, v131, v111, vcc
    v_subrev_u32 v130, 24, v129
    v_cmp_gt_u32 vcc, 0x100, v130
    s_nop 1
    v_cndmask_b32 v112, v131, v112, vcc
    v_subrev_u32 v130, 25, v129
    v_cmp_gt_u32 vcc, 0x100, v130
    s_nop 1
    v_cndmask_b32 v113, v131, v113, vcc
    v_subrev_u32 v130, 26, v129
    v_cmp_gt_u32 vcc, 0x100, v130
    s_nop 1
    v_cndmask_b32 v114, v131, v114, vcc
    v_subrev_u32 v130, 27, v129
    v_cmp_gt_u32 vcc, 0x100, v130
    s_nop 1
    v_cndmask_b32 v115, v131, v115, vcc
    v_sub_f32 v100, v100, v128
    v_exp_f32 v100, v100
    v_sub_f32 v101, v101, v128
    v_exp_f32 v101, v101
    v_sub_f32 v102, v102, v128
    v_exp_f32 v102, v102
    v_sub_f32 v103, v103, v128
    v_exp_f32 v103, v103
    v_sub_f32 v104, v104, v128
    v_exp_f32 v104, v104
    v_sub_f32 v105, v105, v128
    v_exp_f32 v105, v105
    v_sub_f32 v106, v106, v128
    v_exp_f32 v106, v106
    v_sub_f32 v107, v107, v128
    v_exp_f32 v107, v107
    v_sub_f32 v108, v108, v128
    v_exp_f32 v108, v108
    v_sub_f32 v109, v109, v128
    v_exp_f32 v109, v109
    v_sub_f32 v110, v110, v128
    v_exp_f32 v110, v110
    v_sub_f32 v111, v111, v128
    v_exp_f32 v111, v111
    v_sub_f32 v112, v112, v128
    v_exp_f32 v112, v112
    v_sub_f32 v113, v113, v128
    v_exp_f32 v113, v113
    v_sub_f32 v114, v114, v128
    v_exp_f32 v114, v114
    v_sub_f32 v115, v115, v128
    v_exp_f32 v115, v115
    v_cvt_pk_bf16_f32 v32, v100, v101
    v_cvt_pk_bf16_f32 v33, v102, v103
    v_cvt_pk_bf16_f32 v34, v104, v105
    v_cvt_pk_bf16_f32 v35, v106, v107
    v_cvt_pk_bf16_f32 v36, v108, v109
    v_cvt_pk_bf16_f32 v37, v110, v111
    v_cvt_pk_bf16_f32 v38, v112, v113
    v_cvt_pk_bf16_f32 v39, v114, v115
    s_waitcnt vmcnt(1)
    v_mfma_f32_32x32x16_bf16 v[156:171], v[120:123], v[32:35], v[156:171]
    s_waitcnt vmcnt(0)
    v_mfma_f32_32x32x16_bf16 v[156:171], v[124:127], v[36:39], v[156:171]
    s_add_u32 s74, s74, 1
    s_cmp_le_u32 s74, s73
    s_cbranch_scc1 fbsum_64
    s_nop 8
    v_rcp_f32 v164, v164
    s_nop 0
    v_pk_mul_f32 v[156:157], v[156:157], v[164:165] op_sel_hi:[1,0]
    v_pk_mul_f32 v[158:159], v[158:159], v[164:165] op_sel_hi:[1,0]
    v_pk_mul_f32 v[160:161], v[160:161], v[164:165] op_sel_hi:[1,0]
    v_pk_mul_f32 v[162:163], v[162:163], v[164:165] op_sel_hi:[1,0]
    v_cvt_pk_bf16_f32 v212, v156, v157
    v_cvt_pk_bf16_f32 v213, v158, v159
    v_cvt_pk_bf16_f32 v214, v160, v161
    v_cvt_pk_bf16_f32 v215, v162, v163
    s_lshl_b32 s73, s44, 1
    s_add_u32 s73, s73, 1
    s_min_u32 s73, s73, 8
    v_mov_b32 v128, 0xff800000
    s_mov_b32 s74, 0
fbmax_65:
    s_lshl_b32 s70, s44, 1
    s_add_u32 s70, s70, 1
    s_sub_u32 s70, s70, s74
    s_lshr_b32 s71, s70, 1
    s_sub_u32 s71, s44, s71
    s_lshl_b32 s71, s71, 20
    s_sub_u32 s71, s94, s71
    s_and_b32 s70, s70, 1
    s_lshl_b32 s72, s70, 10
    s_add_u32 s72, s72, s71
    buffer_load_dwordx4 v[116:119], v1, s[40:43], s72 offen sc1
    s_waitcnt vmcnt(2)
    buffer_load_dwordx4 v[120:123], v27, s[40:43], s72 offen offset:0 sc1
    s_waitcnt vmcnt(2)
    buffer_load_dwordx4 v[124:127], v27, s[40:43], s72 offen offset:512 sc1
    s_waitcnt vmcnt(2)
    v_mfma_f32_32x32x16_bf16 v[100:115], v[116:119], v[96:99], 0
    s_lshl_b32 s70, s74, 5
    v_add_u32 v129, s70, v43
    v_mov_b32 v131, 0xff800000
    v_subrev_u32 v130, 0, v129
    v_cmp_gt_u32 vcc, 0x100, v130
    s_nop 6
    v_cndmask_b32 v100, v131, v100, vcc
    v_subrev_u32 v130, 1, v129
    v_cmp_gt_u32 vcc, 0x100, v130
    s_nop 1
    v_cndmask_b32 v101, v131, v101, vcc
    v_subrev_u32 v130, 2, v129
    v_cmp_gt_u32 vcc, 0x100, v130
    s_nop 1
    v_cndmask_b32 v102, v131, v102, vcc
    v_subrev_u32 v130, 3, v129
    v_cmp_gt_u32 vcc, 0x100, v130
    s_nop 1
    v_cndmask_b32 v103, v131, v103, vcc
    v_subrev_u32 v130, 8, v129
    v_cmp_gt_u32 vcc, 0x100, v130
    s_nop 1
    v_cndmask_b32 v104, v131, v104, vcc
    v_subrev_u32 v130, 9, v129
    v_cmp_gt_u32 vcc, 0x100, v130
    s_nop 1
    v_cndmask_b32 v105, v131, v105, vcc
    v_subrev_u32 v130, 10, v129
    v_cmp_gt_u32 vcc, 0x100, v130
    s_nop 1
    v_cndmask_b32 v106, v131, v106, vcc
    v_subrev_u32 v130, 11, v129
    v_cmp_gt_u32 vcc, 0x100, v130
    s_nop 1
    v_cndmask_b32 v107, v131, v107, vcc
    v_subrev_u32 v130, 16, v129
    v_cmp_gt_u32 vcc, 0x100, v130
    s_nop 1
    v_cndmask_b32 v108, v131, v108, vcc
    v_subrev_u32 v130, 17, v129
    v_cmp_gt_u32 vcc, 0x100, v130
    s_nop 1
    v_cndmask_b32 v109, v131, v109, vcc
    v_subrev_u32 v130, 18, v129
    v_cmp_gt_u32 vcc, 0x100, v130
    s_nop 1
    v_cndmask_b32 v110, v131, v110, vcc
    v_subrev_u32 v130, 19, v129
    v_cmp_gt_u32 vcc, 0x100, v130
    s_nop 1
    v_cndmask_b32 v111, v131, v111, vcc
    v_subrev_u32 v130, 24, v129
    v_cmp_gt_u32 vcc, 0x100, v130
    s_nop 1
    v_cndmask_b32 v112, v131, v112, vcc
    v_subrev_u32 v130, 25, v129
    v_cmp_gt_u32 vcc, 0x100, v130
    s_nop 1
    v_cndmask_b32 v113, v131, v113, vcc
    v_subrev_u32 v130, 26, v129
    v_cmp_gt_u32 vcc, 0x100, v130
    s_nop 1
    v_cndmask_b32 v114, v131, v114, vcc
    v_subrev_u32 v130, 27, v129
    v_cmp_gt_u32 vcc, 0x100, v130
    s_nop 1
    v_cndmask_b32 v115, v131, v115, vcc
    v_max_f32 v128, v128, v100
    v_max_f32 v128, v128, v101
    v_max_f32 v128, v128, v102
    v_max_f32 v128, v128, v103
    v_max_f32 v128, v128, v104
    v_max_f32 v128, v128, v105
    v_max_f32 v128, v128, v106
    v_max_f32 v128, v128, v107
    v_max_f32 v128, v128, v108
    v_max_f32 v128, v128, v109
    v_max_f32 v128, v128, v110
    v_max_f32 v128, v128, v111
    v_max_f32 v128, v128, v112
    v_max_f32 v128, v128, v113
    v_max_f32 v128, v128, v114
    v_max_f32 v128, v128, v115
    s_add_u32 s74, s74, 1
    s_cmp_le_u32 s74, s73
    s_cbranch_scc1 fbmax_65
    v_mov_b32 v130, v128
    s_nop 1
    v_permlane32_swap_b32 v130, v128
    v_max_f32 v128, v128, v130
    v_mov_b32 v188, 0
    v_mov_b32 v189, 0
    v_mov_b32 v190, 0
    v_mov_b32 v191, 0
    v_mov_b32 v192, 0
    v_mov_b32 v193, 0
    v_mov_b32 v194, 0
    v_mov_b32 v195, 0
    v_mov_b32 v196, 0
    v_mov_b32 v197, 0
    v_mov_b32 v198, 0
    v_mov_b32 v199, 0
    v_mov_b32 v200, 0
    v_mov_b32 v201, 0
    v_mov_b32 v202, 0
    v_mov_b32 v203, 0
    s_mov_b32 s74, 0
fbsum_66:
    s_lshl_b32 s70, s44, 1
    s_add_u32 s70, s70, 1
    s_sub_u32 s70, s70, s74
    s_lshr_b32 s71, s70, 1
    s_sub_u32 s71, s44, s71
    s_lshl_b32 s71, s71, 20
    s_sub_u32 s71, s94, s71
    s_and_b32 s70, s70, 1
    s_lshl_b32 s72, s70, 10
    s_add_u32 s72, s72, s71
    buffer_load_dwordx4 v[116:119], v1, s[40:43], s72 offen sc1
    s_waitcnt vmcnt(2)
    buffer_load_dwordx4 v[120:123], v27, s[40:43], s72 offen offset:0 sc1
    s_waitcnt vmcnt(2)
    buffer_load_dwordx4 v[124:127], v27, s[40:43], s72 offen offset:512 sc1
    s_waitcnt vmcnt(2)
    v_mfma_f32_32x32x16_bf16 v[100:115], v[116:119], v[96:99], 0
    s_lshl_b32 s70, s74, 5
    v_add_u32 v129, s70, v43
    v_mov_b32 v131, 0xff800000
    v_subrev_u32 v130, 0, v129
    v_cmp_gt_u32 vcc, 0x100, v130
    s_nop 6
    v_cndmask_b32 v100, v131, v100, vcc
    v_subrev_u32 v130, 1, v129
    v_cmp_gt_u32 vcc, 0x100, v130
    s_nop 1
    v_cndmask_b32 v101, v131, v101, vcc
    v_subrev_u32 v130, 2, v129
    v_cmp_gt_u32 vcc, 0x100, v130
    s_nop 1
    v_cndmask_b32 v102, v131, v102, vcc
    v_subrev_u32 v130, 3, v129
    v_cmp_gt_u32 vcc, 0x100, v130
    s_nop 1
    v_cndmask_b32 v103, v131, v103, vcc
    v_subrev_u32 v130, 8, v129
    v_cmp_gt_u32 vcc, 0x100, v130
    s_nop 1
    v_cndmask_b32 v104, v131, v104, vcc
    v_subrev_u32 v130, 9, v129
    v_cmp_gt_u32 vcc, 0x100, v130
    s_nop 1
    v_cndmask_b32 v105, v131, v105, vcc
    v_subrev_u32 v130, 10, v129
    v_cmp_gt_u32 vcc, 0x100, v130
    s_nop 1
    v_cndmask_b32 v106, v131, v106, vcc
    v_subrev_u32 v130, 11, v129
    v_cmp_gt_u32 vcc, 0x100, v130
    s_nop 1
    v_cndmask_b32 v107, v131, v107, vcc
    v_subrev_u32 v130, 16, v129
    v_cmp_gt_u32 vcc, 0x100, v130
    s_nop 1
    v_cndmask_b32 v108, v131, v108, vcc
    v_subrev_u32 v130, 17, v129
    v_cmp_gt_u32 vcc, 0x100, v130
    s_nop 1
    v_cndmask_b32 v109, v131, v109, vcc
    v_subrev_u32 v130, 18, v129
    v_cmp_gt_u32 vcc, 0x100, v130
    s_nop 1
    v_cndmask_b32 v110, v131, v110, vcc
    v_subrev_u32 v130, 19, v129
    v_cmp_gt_u32 vcc, 0x100, v130
    s_nop 1
    v_cndmask_b32 v111, v131, v111, vcc
    v_subrev_u32 v130, 24, v129
    v_cmp_gt_u32 vcc, 0x100, v130
    s_nop 1
    v_cndmask_b32 v112, v131, v112, vcc
    v_subrev_u32 v130, 25, v129
    v_cmp_gt_u32 vcc, 0x100, v130
    s_nop 1
    v_cndmask_b32 v113, v131, v113, vcc
    v_subrev_u32 v130, 26, v129
    v_cmp_gt_u32 vcc, 0x100, v130
    s_nop 1
    v_cndmask_b32 v114, v131, v114, vcc
    v_subrev_u32 v130, 27, v129
    v_cmp_gt_u32 vcc, 0x100, v130
    s_nop 1
    v_cndmask_b32 v115, v131, v115, vcc
    v_sub_f32 v100, v100, v128
    v_exp_f32 v100, v100
    v_sub_f32 v101, v101, v128
    v_exp_f32 v101, v101
    v_sub_f32 v102, v102, v128
    v_exp_f32 v102, v102
    v_sub_f32 v103, v103, v128
    v_exp_f32 v103, v103
    v_sub_f32 v104, v104, v128
    v_exp_f32 v104, v104
    v_sub_f32 v105, v105, v128
    v_exp_f32 v105, v105
    v_sub_f32 v106, v106, v128
    v_exp_f32 v106, v106
    v_sub_f32 v107, v107, v128
    v_exp_f32 v107, v107
    v_sub_f32 v108, v108, v128
    v_exp_f32 v108, v108
    v_sub_f32 v109, v109, v128
    v_exp_f32 v109, v109
    v_sub_f32 v110, v110, v128
    v_exp_f32 v110, v110
    v_sub_f32 v111, v111, v128
    v_exp_f32 v111, v111
    v_sub_f32 v112, v112, v128
    v_exp_f32 v112, v112
    v_sub_f32 v113, v113, v128
    v_exp_f32 v113, v113
    v_sub_f32 v114, v114, v128
    v_exp_f32 v114, v114
    v_sub_f32 v115, v115, v128
    v_exp_f32 v115, v115
    v_cvt_pk_bf16_f32 v32, v100, v101
    v_cvt_pk_bf16_f32 v33, v102, v103
    v_cvt_pk_bf16_f32 v34, v104, v105
    v_cvt_pk_bf16_f32 v35, v106, v107
    v_cvt_pk_bf16_f32 v36, v108, v109
    v_cvt_pk_bf16_f32 v37, v110, v111
    v_cvt_pk_bf16_f32 v38, v112, v113
    v_cvt_pk_bf16_f32 v39, v114, v115
    s_waitcnt vmcnt(1)
    v_mfma_f32_32x32x16_bf16 v[188:203], v[120:123], v[32:35], v[188:203]
    s_waitcnt vmcnt(0)
    v_mfma_f32_32x32x16_bf16 v[188:203], v[124:127], v[36:39], v[188:203]
    s_add_u32 s74, s74, 1
    s_cmp_le_u32 s74, s73
    s_cbranch_scc1 fbsum_66
    s_nop 8
    v_rcp_f32 v196, v196
    s_nop 0
    v_pk_mul_f32 v[188:189], v[188:189], v[196:197] op_sel_hi:[1,0]
    v_pk_mul_f32 v[190:191], v[190:191], v[196:197] op_sel_hi:[1,0]
    v_pk_mul_f32 v[192:193], v[192:193], v[196:197] op_sel_hi:[1,0]
    v_pk_mul_f32 v[194:195], v[194:195], v[196:197] op_sel_hi:[1,0]
    v_cvt_pk_bf16_f32 v216, v188, v189
    v_cvt_pk_bf16_f32 v217, v190, v191
    v_cvt_pk_bf16_f32 v218, v192, v193
    v_cvt_pk_bf16_f32 v219, v194, v195
    s_branch SOFTMAX_DONE
retry_19:
    s_mov_b32 s57, 0x40000
again_67:
    buffer_load_dwordx4 v[92:95], v1, s[40:43], s58 offen offset:0 sc1
    buffer_load_dwordx4 v[96:99], v1, s[40:43], s58 offen offset:1024 sc1
    buffer_load_dwordx4 v[100:103], v1, s[40:43], s58 offen offset:2048 sc1
    buffer_load_dwordx4 v[104:107], v1, s[40:43], s58 offen offset:3072 sc1
    buffer_load_dwordx4 v[108:111], v1, s[40:43], s59 offen offset:0 sc1
    buffer_load_dwordx4 v[112:115], v1, s[40:43], s59 offen offset:1024 sc1
    buffer_load_dwordx4 v[116:119], v1, s[40:43], s59 offen offset:2048 sc1
    buffer_load_dwordx4 v[120:123], v1, s[40:43], s59 offen offset:3072 sc1
    buffer_load_dwordx4 v[124:127], v1, s[40:43], s60 offen offset:0 sc1
    buffer_load_dwordx4 v[128:131], v1, s[40:43], s60 offen offset:1024 sc1
    buffer_load_dwordx4 v[132:135], v1, s[40:43], s60 offen offset:2048 sc1
    buffer_load_dwordx4 v[136:139], v1, s[40:43], s60 offen offset:3072 sc1
    buffer_load_dwordx4 v[140:143], v1, s[40:43], s61 offen offset:0 sc1
    buffer_load_dwordx4 v[144:147], v1, s[40:43], s61 offen offset:1024 sc1
    buffer_load_dwordx4 v[148:151], v1, s[40:43], s61 offen offset:2048 sc1
    buffer_load_dwordx4 v[152:155], v1, s[40:43], s61 offen offset:3072 sc1
    s_waitcnt vmcnt(15)
    v_cmp_eq_u32 vcc, -1, v92
    s_waitcnt vmcnt(14)
    v_cmp_eq_u32 s[74:75], -1, v96
    s_or_b64 vcc, vcc, s[74:75]
    s_waitcnt vmcnt(13)
    v_cmp_eq_u32 s[74:75], -1, v100
    s_or_b64 vcc, vcc, s[74:75]
    s_waitcnt vmcnt(12)
    v_cmp_eq_u32 s[74:75], -1, v104
    s_or_b64 vcc, vcc, s[74:75]
    s_waitcnt vmcnt(11)
    v_cmp_eq_u32 s[74:75], -1, v108
    s_or_b64 vcc, vcc, s[74:75]
    s_waitcnt vmcnt(10)
    v_cmp_eq_u32 s[74:75], -1, v112
    s_or_b64 vcc, vcc, s[74:75]
    s_waitcnt vmcnt(9)
    v_cmp_eq_u32 s[74:75], -1, v116
    s_or_b64 vcc, vcc, s[74:75]
    s_waitcnt vmcnt(8)
    v_cmp_eq_u32 s[74:75], -1, v120
    s_or_b64 vcc, vcc, s[74:75]
    s_waitcnt vmcnt(7)
    v_cmp_eq_u32 s[74:75], -1, v124
    s_or_b64 vcc, vcc, s[74:75]
    s_waitcnt vmcnt(6)
    v_cmp_eq_u32 s[74:75], -1, v128
    s_or_b64 vcc, vcc, s[74:75]
    s_waitcnt vmcnt(5)
    v_cmp_eq_u32 s[74:75], -1, v132
    s_or_b64 vcc, vcc, s[74:75]
    s_waitcnt vmcnt(4)
    v_cmp_eq_u32 s[74:75], -1, v136
    s_or_b64 vcc, vcc, s[74:75]
    s_waitcnt vmcnt(3)
    v_cmp_eq_u32 s[74:75], -1, v140
    s_or_b64 vcc, vcc, s[74:75]
    s_waitcnt vmcnt(2)
    v_cmp_eq_u32 s[74:75], -1, v144
    s_or_b64 vcc, vcc, s[74:75]
    s_waitcnt vmcnt(1)
    v_cmp_eq_u32 s[74:75], -1, v148
    s_or_b64 vcc, vcc, s[74:75]
    s_waitcnt vmcnt(0)
    v_cmp_eq_u32 s[74:75], -1, v152
    s_or_b64 vcc, vcc, s[74:75]
    s_cbranch_vccz have_68
    s_sub_u32 s57, s57, 1
    s_cbranch_scc0 again_67
have_68:
    v_lshlrev_b32 v40, 16, v80
    v_and_b32 v41, 0xffff0000, v80
    v_lshlrev_b32 v42, 16, v81
    v_and_b32 v43, 0xffff0000, v81
    v_lshlrev_b32 v44, 16, v82
    v_and_b32 v45, 0xffff0000, v82
    v_lshlrev_b32 v46, 16, v83
    v_and_b32 v47, 0xffff0000, v83
    v_lshlrev_b32 v48, 16, v84
    v_and_b32 v49, 0xffff0000, v84
    v_lshlrev_b32 v50, 16, v85
    v_and_b32 v51, 0xffff0000, v85
    v_lshlrev_b32 v52, 16, v86
    v_and_b32 v53, 0xffff0000, v86
    v_lshlrev_b32 v54, 16, v87
    v_and_b32 v55, 0xffff0000, v87
    v_mfma_f32_16x16x32_bf16 v[40:43], a[0:3], v[92:95], v[40:43]
    v_mfma_f32_16x16x32_bf16 v[44:47], a[4:7], v[92:95], v[44:47]
    v_mfma_f32_16x16x32_bf16 v[48:51], a[8:11], v[92:95], v[48:51]
    v_mfma_f32_16x16x32_bf16 v[52:55], a[12:15], v[92:95], v[52:55]
    v_mfma_f32_16x16x32_bf16 v[40:43], a[16:19], v[96:99], v[40:43]
    v_mfma_f32_16x16x32_bf16 v[44:47], a[20:23], v[96:99], v[44:47]
    v_mfma_f32_16x16x32_bf16 v[48:51], a[24:27], v[96:99], v[48:51]
    v_mfma_f32_16x16x32_bf16 v[52:55], a[28:31], v[96:99], v[52:55]
    v_mfma_f32_16x16x32_bf16 v[40:43], a[32:35], v[100:103], v[40:43]
    v_mfma_f32_16x16x32_bf16 v[44:47], a[36:39], v[100:103], v[44:47]
    v_mfma_f32_16x16x32_bf16 v[48:51], a[40:43], v[100:103], v[48:51]
    v_mfma_f32_16x16x32_bf16 v[52:55], a[44:47], v[100:103], v[52:55]
    v_mfma_f32_16x16x32_bf16 v[40:43], a[48:51], v[104:107], v[40:43]
    v_mfma_f32_16x16x32_bf16 v[44:47], a[52:55], v[104:107], v[44:47]
    v_mfma_f32_16x16x32_bf16 v[48:51], a[56:59], v[104:107], v[48:51]
    v_mfma_f32_16x16x32_bf16 v[52:55], a[60:63], v[104:107], v[52:55]
    v_mfma_f32_16x16x32_bf16 v[40:43], a[64:67], v[108:111], v[40:43]
    v_mfma_f32_16x16x32_bf16 v[44:47], a[68:71], v[108:111], v[44:47]
    v_mfma_f32_16x16x32_bf16 v[48:51], a[72:75], v[108:111], v[48:51]
    v_mfma_f32_16x16x32_bf16 v[52:55], a[76:79], v[108:111], v[52:55]
    v_mfma_f32_16x16x32_bf16 v[40:43], a[80:83], v[112:115], v[40:43]
    v_mfma_f32_16x16x32_bf16 v[44:47], a[84:87], v[112:115], v[44:47]
    v_mfma_f32_16x16x32_bf16 v[48:51], a[88:91], v[112:115], v[48:51]
    v_mfma_f32_16x16x32_bf16 v[52:55], a[92:95], v[112:115], v[52:55]
    v_mfma_f32_16x16x32_bf16 v[40:43], a[96:99], v[116:119], v[40:43]
    v_mfma_f32_16x16x32_bf16 v[44:47], a[100:103], v[116:119], v[44:47]
    v_mfma_f32_16x16x32_bf16 v[48:51], a[104:107], v[116:119], v[48:51]
    v_mfma_f32_16x16x32_bf16 v[52:55], a[108:111], v[116:119], v[52:55]
    v_mfma_f32_16x16x32_bf16 v[40:43], a[112:115], v[120:123], v[40:43]
    v_mfma_f32_16x16x32_bf16 v[44:47], a[116:119], v[120:123], v[44:47]
    v_mfma_f32_16x16x32_bf16 v[48:51], a[120:123], v[120:123], v[48:51]
    v_mfma_f32_16x16x32_bf16 v[52:55], a[124:127], v[120:123], v[52:55]
    v_mfma_f32_16x16x32_bf16 v[40:43], a[128:131], v[124:127], v[40:43]
    v_mfma_f32_16x16x32_bf16 v[44:47], a[132:135], v[124:127], v[44:47]
    v_mfma_f32_16x16x32_bf16 v[48:51], a[136:139], v[124:127], v[48:51]
    v_mfma_f32_16x16x32_bf16 v[52:55], a[140:143], v[124:127], v[52:55]
    v_mfma_f32_16x16x32_bf16 v[40:43], a[144:147], v[128:131], v[40:43]
    v_mfma_f32_16x16x32_bf16 v[44:47], a[148:151], v[128:131], v[44:47]
    v_mfma_f32_16x16x32_bf16 v[48:51], a[152:155], v[128:131], v[48:51]
    v_mfma_f32_16x16x32_bf16 v[52:55], a[156:159], v[128:131], v[52:55]
    v_mfma_f32_16x16x32_bf16 v[40:43], a[160:163], v[132:135], v[40:43]
    v_mfma_f32_16x16x32_bf16 v[44:47], a[164:167], v[132:135], v[44:47]
    v_mfma_f32_16x16x32_bf16 v[48:51], a[168:171], v[132:135], v[48:51]
    v_mfma_f32_16x16x32_bf16 v[52:55], a[172:175], v[132:135], v[52:55]
    v_mfma_f32_16x16x32_bf16 v[40:43], a[176:179], v[136:139], v[40:43]
    v_mfma_f32_16x16x32_bf16 v[44:47], a[180:183], v[136:139], v[44:47]
    v_mfma_f32_16x16x32_bf16 v[48:51], a[184:187], v[136:139], v[48:51]
    v_mfma_f32_16x16x32_bf16 v[52:55], a[188:191], v[136:139], v[52:55]
    v_mfma_f32_16x16x32_bf16 v[40:43], a[192:195], v[140:143], v[40:43]
    v_mfma_f32_16x16x32_bf16 v[44:47], a[196:199], v[140:143], v[44:47]
    v_mfma_f32_16x16x32_bf16 v[48:51], a[200:203], v[140:143], v[48:51]
    v_mfma_f32_16x16x32_bf16 v[52:55], a[204:207], v[140:143], v[52:55]
    v_mfma_f32_16x16x32_bf16 v[40:43], a[208:211], v[144:147], v[40:43]
    v_mfma_f32_16x16x32_bf16 v[44:47], a[212:215], v[144:147], v[44:47]
    v_mfma_f32_16x16x32_bf16 v[48:51], a[216:219], v[144:147], v[48:51]
    v_mfma_f32_16x16x32_bf16 v[52:55], a[220:223], v[144:147], v[52:55]
    v_mfma_f32_16x16x32_bf16 v[40:43], a[224:227], v[148:151], v[40:43]
    v_mfma_f32_16x16x32_bf16 v[44:47], a[228:231], v[148:151], v[44:47]
    v_mfma_f32_16x16x32_bf16 v[48:51], a[232:235], v[148:151], v[48:51]
    v_mfma_f32_16x16x32_bf16 v[52:55], a[236:239], v[148:151], v[52:55]
    v_mfma_f32_16x16x32_bf16 v[40:43], a[240:243], v[152:155], v[40:43]
    v_mfma_f32_16x16x32_bf16 v[44:47], a[244:247], v[152:155], v[44:47]
    v_mfma_f32_16x16x32_bf16 v[48:51], a[248:251], v[152:155], v[48:51]
    v_mfma_f32_16x16x32_bf16 v[52:55], a[252:255], v[152:155], v[52:55]
    s_branch back_20
retry_23:
    s_mov_b32 s57, 0x40000
again_69:
    buffer_load_dwordx4 v[92:95], v1, s[40:43], s58 offen offset:0 sc1
    buffer_load_dwordx4 v[96:99], v1, s[40:43], s58 offen offset:1024 sc1
    buffer_load_dwordx4 v[100:103], v1, s[40:43], s58 offen offset:2048 sc1
    buffer_load_dwordx4 v[104:107], v1, s[40:43], s58 offen offset:3072 sc1
    buffer_load_dwordx4 v[108:111], v1, s[40:43], s59 offen offset:0 sc1
    buffer_load_dwordx4 v[112:115], v1, s[40:43], s59 offen offset:1024 sc1
    buffer_load_dwordx4 v[116:119], v1, s[40:43], s59 offen offset:2048 sc1
    buffer_load_dwordx4 v[120:123], v1, s[40:43], s59 offen offset:3072 sc1
    buffer_load_dwordx4 v[124:127], v1, s[40:43], s60 offen offset:0 sc1
    buffer_load_dwordx4 v[128:131], v1, s[40:43], s60 offen offset:1024 sc1
    buffer_load_dwordx4 v[132:135], v1, s[40:43], s60 offen offset:2048 sc1
    buffer_load_dwordx4 v[136:139], v1, s[40:43], s60 offen offset:3072 sc1
    buffer_load_dwordx4 v[140:143], v1, s[40:43], s61 offen offset:0 sc1
    buffer_load_dwordx4 v[144:147], v1, s[40:43], s61 offen offset:1024 sc1
    buffer_load_dwordx4 v[148:151], v1, s[40:43], s61 offen offset:2048 sc1
    buffer_load_dwordx4 v[152:155], v1, s[40:43], s61 offen offset:3072 sc1
    s_waitcnt vmcnt(15)
    v_cmp_eq_u32 vcc, -1, v92
    s_waitcnt vmcnt(14)
    v_cmp_eq_u32 s[74:75], -1, v96
    s_or_b64 vcc, vcc, s[74:75]
    s_waitcnt vmcnt(13)
    v_cmp_eq_u32 s[74:75], -1, v100
    s_or_b64 vcc, vcc, s[74:75]
    s_waitcnt vmcnt(12)
    v_cmp_eq_u32 s[74:75], -1, v104
    s_or_b64 vcc, vcc, s[74:75]
    s_waitcnt vmcnt(11)
    v_cmp_eq_u32 s[74:75], -1, v108
    s_or_b64 vcc, vcc, s[74:75]
    s_waitcnt vmcnt(10)
    v_cmp_eq_u32 s[74:75], -1, v112
    s_or_b64 vcc, vcc, s[74:75]
    s_waitcnt vmcnt(9)
    v_cmp_eq_u32 s[74:75], -1, v116
    s_or_b64 vcc, vcc, s[74:75]
    s_waitcnt vmcnt(8)
    v_cmp_eq_u32 s[74:75], -1, v120
    s_or_b64 vcc, vcc, s[74:75]
    s_waitcnt vmcnt(7)
    v_cmp_eq_u32 s[74:75], -1, v124
    s_or_b64 vcc, vcc, s[74:75]
    s_waitcnt vmcnt(6)
    v_cmp_eq_u32 s[74:75], -1, v128
    s_or_b64 vcc, vcc, s[74:75]
    s_waitcnt vmcnt(5)
    v_cmp_eq_u32 s[74:75], -1, v132
    s_or_b64 vcc, vcc, s[74:75]
    s_waitcnt vmcnt(4)
    v_cmp_eq_u32 s[74:75], -1, v136
    s_or_b64 vcc, vcc, s[74:75]
    s_waitcnt vmcnt(3)
    v_cmp_eq_u32 s[74:75], -1, v140
    s_or_b64 vcc, vcc, s[74:75]
    s_waitcnt vmcnt(2)
    v_cmp_eq_u32 s[74:75], -1, v144
    s_or_b64 vcc, vcc, s[74:75]
    s_waitcnt vmcnt(1)
    v_cmp_eq_u32 s[74:75], -1, v148
    s_or_b64 vcc, vcc, s[74:75]
    s_waitcnt vmcnt(0)
    v_cmp_eq_u32 s[74:75], -1, v152
    s_or_b64 vcc, vcc, s[74:75]
    s_cbranch_vccz have_70
    s_sub_u32 s57, s57, 1
    s_cbranch_scc0 again_69
have_70:
    v_mul_f32 v56, -v7, v156
    v_mul_f32 v57, -v7, v157
    v_mul_f32 v58, -v7, v158
    v_mul_f32 v59, -v7, v159
    v_mul_f32 v60, -v7, v160
    v_mul_f32 v61, -v7, v161
    v_mul_f32 v62, -v7, v162
    v_mul_f32 v63, -v7, v163
    v_mul_f32 v64, -v7, v164
    v_mul_f32 v65, -v7, v165
    v_mul_f32 v66, -v7, v166
    v_mul_f32 v67, -v7, v167
    v_mul_f32 v68, -v7, v168
    v_mul_f32 v69, -v7, v169
    v_mul_f32 v70, -v7, v170
    v_mul_f32 v71, -v7, v171
    v_mfma_f32_16x16x32_bf16 v[56:59], a[0:3], v[92:95], v[56:59]
    v_mfma_f32_16x16x32_bf16 v[60:63], a[4:7], v[92:95], v[60:63]
    v_mfma_f32_16x16x32_bf16 v[64:67], a[8:11], v[92:95], v[64:67]
    v_mfma_f32_16x16x32_bf16 v[68:71], a[12:15], v[92:95], v[68:71]
    v_mfma_f32_16x16x32_bf16 v[56:59], a[16:19], v[96:99], v[56:59]
    v_mfma_f32_16x16x32_bf16 v[60:63], a[20:23], v[96:99], v[60:63]
    v_mfma_f32_16x16x32_bf16 v[64:67], a[24:27], v[96:99], v[64:67]
    v_mfma_f32_16x16x32_bf16 v[68:71], a[28:31], v[96:99], v[68:71]
    v_mfma_f32_16x16x32_bf16 v[56:59], a[32:35], v[100:103], v[56:59]
    v_mfma_f32_16x16x32_bf16 v[60:63], a[36:39], v[100:103], v[60:63]
    v_mfma_f32_16x16x32_bf16 v[64:67], a[40:43], v[100:103], v[64:67]
    v_mfma_f32_16x16x32_bf16 v[68:71], a[44:47], v[100:103], v[68:71]
    v_mfma_f32_16x16x32_bf16 v[56:59], a[48:51], v[104:107], v[56:59]
    v_mfma_f32_16x16x32_bf16 v[60:63], a[52:55], v[104:107], v[60:63]
    v_mfma_f32_16x16x32_bf16 v[64:67], a[56:59], v[104:107], v[64:67]
    v_mfma_f32_16x16x32_bf16 v[68:71], a[60:63], v[104:107], v[68:71]
    v_mfma_f32_16x16x32_bf16 v[56:59], a[64:67], v[108:111], v[56:59]
    v_mfma_f32_16x16x32_bf16 v[60:63], a[68:71], v[108:111], v[60:63]
    v_mfma_f32_16x16x32_bf16 v[64:67], a[72:75], v[108:111], v[64:67]
    v_mfma_f32_16x16x32_bf16 v[68:71], a[76:79], v[108:111], v[68:71]
    v_mfma_f32_16x16x32_bf16 v[56:59], a[80:83], v[112:115], v[56:59]
    v_mfma_f32_16x16x32_bf16 v[60:63], a[84:87], v[112:115], v[60:63]
    v_mfma_f32_16x16x32_bf16 v[64:67], a[88:91], v[112:115], v[64:67]
    v_mfma_f32_16x16x32_bf16 v[68:71], a[92:95], v[112:115], v[68:71]
    v_mfma_f32_16x16x32_bf16 v[56:59], a[96:99], v[116:119], v[56:59]
    v_mfma_f32_16x16x32_bf16 v[60:63], a[100:103], v[116:119], v[60:63]
    v_mfma_f32_16x16x32_bf16 v[64:67], a[104:107], v[116:119], v[64:67]
    v_mfma_f32_16x16x32_bf16 v[68:71], a[108:111], v[116:119], v[68:71]
    v_mfma_f32_16x16x32_bf16 v[56:59], a[112:115], v[120:123], v[56:59]
    v_mfma_f32_16x16x32_bf16 v[60:63], a[116:119], v[120:123], v[60:63]
    v_mfma_f32_16x16x32_bf16 v[64:67], a[120:123], v[120:123], v[64:67]
    v_mfma_f32_16x16x32_bf16 v[68:71], a[124:127], v[120:123], v[68:71]
    v_mfma_f32_16x16x32_bf16 v[56:59], a[128:131], v[124:127], v[56:59]
    v_mfma_f32_16x16x32_bf16 v[60:63], a[132:135], v[124:127], v[60:63]
    v_mfma_f32_16x16x32_bf16 v[64:67], a[136:139], v[124:127], v[64:67]
    v_mfma_f32_16x16x32_bf16 v[68:71], a[140:143], v[124:127], v[68:71]
    v_mfma_f32_16x16x32_bf16 v[56:59], a[144:147], v[128:131], v[56:59]
    v_mfma_f32_16x16x32_bf16 v[60:63], a[148:151], v[128:131], v[60:63]
    v_mfma_f32_16x16x32_bf16 v[64:67], a[152:155], v[128:131], v[64:67]
    v_mfma_f32_16x16x32_bf16 v[68:71], a[156:159], v[128:131], v[68:71]
    v_mfma_f32_16x16x32_bf16 v[56:59], a[160:163], v[132:135], v[56:59]
    v_mfma_f32_16x16x32_bf16 v[60:63], a[164:167], v[132:135], v[60:63]
    v_mfma_f32_16x16x32_bf16 v[64:67], a[168:171], v[132:135], v[64:67]
    v_mfma_f32_16x16x32_bf16 v[68:71], a[172:175], v[132:135], v[68:71]
    v_mfma_f32_16x16x32_bf16 v[56:59], a[176:179], v[136:139], v[56:59]
    v_mfma_f32_16x16x32_bf16 v[60:63], a[180:183], v[136:139], v[60:63]
    v_mfma_f32_16x16x32_bf16 v[64:67], a[184:187], v[136:139], v[64:67]
    v_mfma_f32_16x16x32_bf16 v[68:71], a[188:191], v[136:139], v[68:71]
    v_mfma_f32_16x16x32_bf16 v[56:59], a[192:195], v[140:143], v[56:59]
    v_mfma_f32_16x16x32_bf16 v[60:63], a[196:199], v[140:143], v[60:63]
    v_mfma_f32_16x16x32_bf16 v[64:67], a[200:203], v[140:143], v[64:67]
    v_mfma_f32_16x16x32_bf16 v[68:71], a[204:207], v[140:143], v[68:71]
    v_mfma_f32_16x16x32_bf16 v[56:59], a[208:211], v[144:147], v[56:59]
    v_mfma_f32_16x16x32_bf16 v[60:63], a[212:215], v[144:147], v[60:63]
    v_mfma_f32_16x16x32_bf16 v[64:67], a[216:219], v[144:147], v[64:67]
    v_mfma_f32_16x16x32_bf16 v[68:71], a[220:223], v[144:147], v[68:71]
    v_mfma_f32_16x16x32_bf16 v[56:59], a[224:227], v[148:151], v[56:59]
    v_mfma_f32_16x16x32_bf16 v[60:63], a[228:231], v[148:151], v[60:63]
    v_mfma_f32_16x16x32_bf16 v[64:67], a[232:235], v[148:151], v[64:67]
    v_mfma_f32_16x16x32_bf16 v[68:71], a[236:239], v[148:151], v[68:71]
    v_mfma_f32_16x16x32_bf16 v[56:59], a[240:243], v[152:155], v[56:59]
    v_mfma_f32_16x16x32_bf16 v[60:63], a[244:247], v[152:155], v[60:63]
    v_mfma_f32_16x16x32_bf16 v[64:67], a[248:251], v[152:155], v[64:67]
    v_mfma_f32_16x16x32_bf16 v[68:71], a[252:255], v[152:155], v[68:71]
    s_branch back_24
retry_29:
    s_mov_b32 s57, 0x40000
again_71:
    buffer_load_dwordx4 v[92:95], v203, s[40:43], s58 offen offset:0 sc1
    buffer_load_dwordx4 v[96:99], v203, s[40:43], s58 offen offset:1024 sc1
    buffer_load_dwordx4 v[100:103], v203, s[40:43], s58 offen offset:2048 sc1
    buffer_load_dwordx4 v[104:107], v203, s[40:43], s58 offen offset:3072 sc1
    buffer_load_dwordx4 v[108:111], v204, s[40:43], s59 offen offset:0 sc1
    buffer_load_dwordx4 v[112:115], v204, s[40:43], s59 offen offset:1024 sc1
    buffer_load_dwordx4 v[116:119], v204, s[40:43], s59 offen offset:2048 sc1
    buffer_load_dwordx4 v[120:123], v204, s[40:43], s59 offen offset:3072 sc1
    buffer_load_dwordx4 v[124:127], v205, s[40:43], s60 offen offset:0 sc1
    buffer_load_dwordx4 v[128:131], v205, s[40:43], s60 offen offset:1024 sc1
    buffer_load_dwordx4 v[132:135], v205, s[40:43], s60 offen offset:2048 sc1
    buffer_load_dwordx4 v[136:139], v205, s[40:43], s60 offen offset:3072 sc1
    buffer_load_dwordx4 v[140:143], v206, s[40:43], s61 offen offset:0 sc1
    buffer_load_dwordx4 v[144:147], v206, s[40:43], s61 offen offset:1024 sc1
    buffer_load_dwordx4 v[148:151], v206, s[40:43], s61 offen offset:2048 sc1
    buffer_load_dwordx4 v[152:155], v206, s[40:43], s61 offen offset:3072 sc1
    s_waitcnt vmcnt(15)
    v_cmp_eq_u32 vcc, -1, v92
    s_waitcnt vmcnt(14)
    v_cmp_eq_u32 s[74:75], -1, v96
    s_or_b64 vcc, vcc, s[74:75]
    s_waitcnt vmcnt(13)
    v_cmp_eq_u32 s[74:75], -1, v100
    s_or_b64 vcc, vcc, s[74:75]
    s_waitcnt vmcnt(12)
    v_cmp_eq_u32 s[74:75], -1, v104
    s_or_b64 vcc, vcc, s[74:75]
    s_waitcnt vmcnt(11)
    v_cmp_eq_u32 s[74:75], -1, v108
    s_or_b64 vcc, vcc, s[74:75]
    s_waitcnt vmcnt(10)
    v_cmp_eq_u32 s[74:75], -1, v112
    s_or_b64 vcc, vcc, s[74:75]
    s_waitcnt vmcnt(9)
    v_cmp_eq_u32 s[74:75], -1, v116
    s_or_b64 vcc, vcc, s[74:75]
    s_waitcnt vmcnt(8)
    v_cmp_eq_u32 s[74:75], -1, v120
    s_or_b64 vcc, vcc, s[74:75]
    s_waitcnt vmcnt(7)
    v_cmp_eq_u32 s[74:75], -1, v124
    s_or_b64 vcc, vcc, s[74:75]
    s_waitcnt vmcnt(6)
    v_cmp_eq_u32 s[74:75], -1, v128
    s_or_b64 vcc, vcc, s[74:75]
    s_waitcnt vmcnt(5)
    v_cmp_eq_u32 s[74:75], -1, v132
    s_or_b64 vcc, vcc, s[74:75]
    s_waitcnt vmcnt(4)
    v_cmp_eq_u32 s[74:75], -1, v136
    s_or_b64 vcc, vcc, s[74:75]
    s_waitcnt vmcnt(3)
    v_cmp_eq_u32 s[74:75], -1, v140
    s_or_b64 vcc, vcc, s[74:75]
    s_waitcnt vmcnt(2)
    v_cmp_eq_u32 s[74:75], -1, v144
    s_or_b64 vcc, vcc, s[74:75]
    s_waitcnt vmcnt(1)
    v_cmp_eq_u32 s[74:75], -1, v148
    s_or_b64 vcc, vcc, s[74:75]
    s_waitcnt vmcnt(0)
    v_cmp_eq_u32 s[74:75], -1, v152
    s_or_b64 vcc, vcc, s[74:75]
    s_cbranch_vccz have_72
    s_sub_u32 s57, s57, 1
    s_cbranch_scc0 again_71
have_72:
    v_mul_f32 v192, -v7, v12
    v_fma_f32 v56, v40, v12, v192
    v_fma_f32 v57, v41, v12, v192
    v_fma_f32 v58, v42, v12, v192
    v_fma_f32 v59, v43, v12, v192
    v_fma_f32 v60, v44, v12, v192
    v_fma_f32 v61, v45, v12, v192
    v_fma_f32 v62, v46, v12, v192
    v_fma_f32 v63, v47, v12, v192
    v_fma_f32 v64, v48, v12, v192
    v_fma_f32 v65, v49, v12, v192
    v_fma_f32 v66, v50, v12, v192
    v_fma_f32 v67, v51, v12, v192
    v_fma_f32 v68, v52, v12, v192
    v_fma_f32 v69, v53, v12, v192
    v_fma_f32 v70, v54, v12, v192
    v_fma_f32 v71, v55, v12, v192
    v_mfma_f32_16x16x32_bf16 v[56:59], a[0:3], v[92:95], v[56:59]
    v_mfma_f32_16x16x32_bf16 v[60:63], a[4:7], v[92:95], v[60:63]
    v_mfma_f32_16x16x32_bf16 v[64:67], a[8:11], v[92:95], v[64:67]
    v_mfma_f32_16x16x32_bf16 v[68:71], a[12:15], v[92:95], v[68:71]
    v_mfma_f32_16x16x32_bf16 v[56:59], a[16:19], v[96:99], v[56:59]
    v_mfma_f32_16x16x32_bf16 v[60:63], a[20:23], v[96:99], v[60:63]
    v_mfma_f32_16x16x32_bf16 v[64:67], a[24:27], v[96:99], v[64:67]
    v_mfma_f32_16x16x32_bf16 v[68:71], a[28:31], v[96:99], v[68:71]
    v_mfma_f32_16x16x32_bf16 v[56:59], a[32:35], v[100:103], v[56:59]
    v_mfma_f32_16x16x32_bf16 v[60:63], a[36:39], v[100:103], v[60:63]
    v_mfma_f32_16x16x32_bf16 v[64:67], a[40:43], v[100:103], v[64:67]
    v_mfma_f32_16x16x32_bf16 v[68:71], a[44:47], v[100:103], v[68:71]
    v_mfma_f32_16x16x32_bf16 v[56:59], a[48:51], v[104:107], v[56:59]
    v_mfma_f32_16x16x32_bf16 v[60:63], a[52:55], v[104:107], v[60:63]
    v_mfma_f32_16x16x32_bf16 v[64:67], a[56:59], v[104:107], v[64:67]
    v_mfma_f32_16x16x32_bf16 v[68:71], a[60:63], v[104:107], v[68:71]
    v_mfma_f32_16x16x32_bf16 v[56:59], a[64:67], v[108:111], v[56:59]
    v_mfma_f32_16x16x32_bf16 v[60:63], a[68:71], v[108:111], v[60:63]
    v_mfma_f32_16x16x32_bf16 v[64:67], a[72:75], v[108:111], v[64:67]
    v_mfma_f32_16x16x32_bf16 v[68:71], a[76:79], v[108:111], v[68:71]
    v_mfma_f32_16x16x32_bf16 v[56:59], a[80:83], v[112:115], v[56:59]
    v_mfma_f32_16x16x32_bf16 v[60:63], a[84:87], v[112:115], v[60:63]
    v_mfma_f32_16x16x32_bf16 v[64:67], a[88:91], v[112:115], v[64:67]
    v_mfma_f32_16x16x32_bf16 v[68:71], a[92:95], v[112:115], v[68:71]
    v_mfma_f32_16x16x32_bf16 v[56:59], a[96:99], v[116:119], v[56:59]
    v_mfma_f32_16x16x32_bf16 v[60:63], a[100:103], v[116:119], v[60:63]
    v_mfma_f32_16x16x32_bf16 v[64:67], a[104:107], v[116:119], v[64:67]
    v_mfma_f32_16x16x32_bf16 v[68:71], a[108:111], v[116:119], v[68:71]
    v_mfma_f32_16x16x32_bf16 v[56:59], a[112:115], v[120:123], v[56:59]
    v_mfma_f32_16x16x32_bf16 v[60:63], a[116:119], v[120:123], v[60:63]
    v_mfma_f32_16x16x32_bf16 v[64:67], a[120:123], v[120:123], v[64:67]
    v_mfma_f32_16x16x32_bf16 v[68:71], a[124:127], v[120:123], v[68:71]
    v_mfma_f32_16x16x32_bf16 v[56:59], a[128:131], v[124:127], v[56:59]
    v_mfma_f32_16x16x32_bf16 v[60:63], a[132:135], v[124:127], v[60:63]
    v_mfma_f32_16x16x32_bf16 v[64:67], a[136:139], v[124:127], v[64:67]
    v_mfma_f32_16x16x32_bf16 v[68:71], a[140:143], v[124:127], v[68:71]
    v_mfma_f32_16x16x32_bf16 v[56:59], a[144:147], v[128:131], v[56:59]
    v_mfma_f32_16x16x32_bf16 v[60:63], a[148:151], v[128:131], v[60:63]
    v_mfma_f32_16x16x32_bf16 v[64:67], a[152:155], v[128:131], v[64:67]
    v_mfma_f32_16x16x32_bf16 v[68:71], a[156:159], v[128:131], v[68:71]
    v_mfma_f32_16x16x32_bf16 v[56:59], a[160:163], v[132:135], v[56:59]
    v_mfma_f32_16x16x32_bf16 v[60:63], a[164:167], v[132:135], v[60:63]
    v_mfma_f32_16x16x32_bf16 v[64:67], a[168:171], v[132:135], v[64:67]
    v_mfma_f32_16x16x32_bf16 v[68:71], a[172:175], v[132:135], v[68:71]
    v_mfma_f32_16x16x32_bf16 v[56:59], a[176:179], v[136:139], v[56:59]
    v_mfma_f32_16x16x32_bf16 v[60:63], a[180:183], v[136:139], v[60:63]
    v_mfma_f32_16x16x32_bf16 v[64:67], a[184:187], v[136:139], v[64:67]
    v_mfma_f32_16x16x32_bf16 v[68:71], a[188:191], v[136:139], v[68:71]
    v_mfma_f32_16x16x32_bf16 v[56:59], a[192:195], v[140:143], v[56:59]
    v_mfma_f32_16x16x32_bf16 v[60:63], a[196:199], v[140:143], v[60:63]
    v_mfma_f32_16x16x32_bf16 v[64:67], a[200:203], v[140:143], v[64:67]
    v_mfma_f32_16x16x32_bf16 v[68:71], a[204:207], v[140:143], v[68:71]
    v_mfma_f32_16x16x32_bf16 v[56:59], a[208:211], v[144:147], v[56:59]
    v_mfma_f32_16x16x32_bf16 v[60:63], a[212:215], v[144:147], v[60:63]
    v_mfma_f32_16x16x32_bf16 v[64:67], a[216:219], v[144:147], v[64:67]
    v_mfma_f32_16x16x32_bf16 v[68:71], a[220:223], v[144:147], v[68:71]
    v_mfma_f32_16x16x32_bf16 v[56:59], a[224:227], v[148:151], v[56:59]
    v_mfma_f32_16x16x32_bf16 v[60:63], a[228:231], v[148:151], v[60:63]
    v_mfma_f32_16x16x32_bf16 v[64:67], a[232:235], v[148:151], v[64:67]
    v_mfma_f32_16x16x32_bf16 v[68:71], a[236:239], v[148:151], v[68:71]
    v_mfma_f32_16x16x32_bf16 v[56:59], a[240:243], v[152:155], v[56:59]
    v_mfma_f32_16x16x32_bf16 v[60:63], a[244:247], v[152:155], v[60:63]
    v_mfma_f32_16x16x32_bf16 v[64:67], a[248:251], v[152:155], v[64:67]
    v_mfma_f32_16x16x32_bf16 v[68:71], a[252:255], v[152:155], v[68:71]
    s_branch back_30
retry_51:
    s_mov_b32 s57, 0x40000
again_73:
    buffer_load_dwordx4 v[92:95], v203, s[40:43], s58 offen offset:0 sc1
    buffer_load_dwordx4 v[96:99], v203, s[40:43], s58 offen offset:1024 sc1
    buffer_load_dwordx4 v[100:103], v203, s[40:43], s58 offen offset:2048 sc1
    buffer_load_dwordx4 v[104:107], v203, s[40:43], s58 offen offset:3072 sc1
    buffer_load_dwordx4 v[108:111], v204, s[40:43], s59 offen offset:0 sc1
    buffer_load_dwordx4 v[112:115], v204, s[40:43], s59 offen offset:1024 sc1
    buffer_load_dwordx4 v[116:119], v204, s[40:43], s59 offen offset:2048 sc1
    buffer_load_dwordx4 v[120:123], v204, s[40:43], s59 offen offset:3072 sc1
    buffer_load_dwordx4 v[124:127], v205, s[40:43], s60 offen offset:0 sc1
    buffer_load_dwordx4 v[128:131], v205, s[40:43], s60 offen offset:1024 sc1
    buffer_load_dwordx4 v[132:135], v205, s[40:43], s60 offen offset:2048 sc1
    buffer_load_dwordx4 v[136:139], v205, s[40:43], s60 offen offset:3072 sc1
    buffer_load_dwordx4 v[140:143], v206, s[40:43], s61 offen offset:0 sc1
    buffer_load_dwordx4 v[144:147], v206, s[40:43], s61 offen offset:1024 sc1
    buffer_load_dwordx4 v[148:151], v206, s[40:43], s61 offen offset:2048 sc1
    buffer_load_dwordx4 v[152:155], v206, s[40:43], s61 offen offset:3072 sc1
    s_waitcnt vmcnt(15)
    v_cmp_eq_u32 vcc, -1, v92
    s_waitcnt vmcnt(14)
    v_cmp_eq_u32 s[74:75], -1, v96
    s_or_b64 vcc, vcc, s[74:75]
    s_waitcnt vmcnt(13)
    v_cmp_eq_u32 s[74:75], -1, v100
    s_or_b64 vcc, vcc, s[74:75]
    s_waitcnt vmcnt(12)
    v_cmp_eq_u32 s[74:75], -1, v104
    s_or_b64 vcc, vcc, s[74:75]
    s_waitcnt vmcnt(11)
    v_cmp_eq_u32 s[74:75], -1, v108
    s_or_b64 vcc, vcc, s[74:75]
    s_waitcnt vmcnt(10)
    v_cmp_eq_u32 s[74:75], -1, v112
    s_or_b64 vcc, vcc, s[74:75]
    s_waitcnt vmcnt(9)
    v_cmp_eq_u32 s[74:75], -1, v116
    s_or_b64 vcc, vcc, s[74:75]
    s_waitcnt vmcnt(8)
    v_cmp_eq_u32 s[74:75], -1, v120
    s_or_b64 vcc, vcc, s[74:75]
    s_waitcnt vmcnt(7)
    v_cmp_eq_u32 s[74:75], -1, v124
    s_or_b64 vcc, vcc, s[74:75]
    s_waitcnt vmcnt(6)
    v_cmp_eq_u32 s[74:75], -1, v128
    s_or_b64 vcc, vcc, s[74:75]
    s_waitcnt vmcnt(5)
    v_cmp_eq_u32 s[74:75], -1, v132
    s_or_b64 vcc, vcc, s[74:75]
    s_waitcnt vmcnt(4)
    v_cmp_eq_u32 s[74:75], -1, v136
    s_or_b64 vcc, vcc, s[74:75]
    s_waitcnt vmcnt(3)
    v_cmp_eq_u32 s[74:75], -1, v140
    s_or_b64 vcc, vcc, s[74:75]
    s_waitcnt vmcnt(2)
    v_cmp_eq_u32 s[74:75], -1, v144
    s_or_b64 vcc, vcc, s[74:75]
    s_waitcnt vmcnt(1)
    v_cmp_eq_u32 s[74:75], -1, v148
    s_or_b64 vcc, vcc, s[74:75]
    s_waitcnt vmcnt(0)
    v_cmp_eq_u32 s[74:75], -1, v152
    s_or_b64 vcc, vcc, s[74:75]
    s_cbranch_vccz have_74
    s_sub_u32 s57, s57, 1
    s_cbranch_scc0 again_73
have_74:
    v_mul_f32 v192, -v7, v12
    v_fma_f32 v56, v40, v12, v192
    v_fma_f32 v57, v41, v12, v192
    v_fma_f32 v58, v42, v12, v192
    v_fma_f32 v59, v43, v12, v192
    v_fma_f32 v60, v44, v12, v192
    v_fma_f32 v61, v45, v12, v192
    v_fma_f32 v62, v46, v12, v192
    v_fma_f32 v63, v47, v12, v192
    v_fma_f32 v64, v48, v12, v192
    v_fma_f32 v65, v49, v12, v192
    v_fma_f32 v66, v50, v12, v192
    v_fma_f32 v67, v51, v12, v192
    v_fma_f32 v68, v52, v12, v192
    v_fma_f32 v69, v53, v12, v192
    v_fma_f32 v70, v54, v12, v192
    v_fma_f32 v71, v55, v12, v192
    v_mfma_f32_16x16x32_bf16 v[56:59], a[0:3], v[92:95], v[56:59]
    v_mfma_f32_16x16x32_bf16 v[60:63], a[4:7], v[92:95], v[60:63]
    v_mfma_f32_16x16x32_bf16 v[64:67], a[8:11], v[92:95], v[64:67]
    v_mfma_f32_16x16x32_bf16 v[68:71], a[12:15], v[92:95], v[68:71]
    v_mfma_f32_16x16x32_bf16 v[56:59], a[16:19], v[96:99], v[56:59]
    v_mfma_f32_16x16x32_bf16 v[60:63], a[20:23], v[96:99], v[60:63]
    v_mfma_f32_16x16x32_bf16 v[64:67], a[24:27], v[96:99], v[64:67]
    v_mfma_f32_16x16x32_bf16 v[68:71], a[28:31], v[96:99], v[68:71]
    v_mfma_f32_16x16x32_bf16 v[56:59], a[32:35], v[100:103], v[56:59]
    v_mfma_f32_16x16x32_bf16 v[60:63], a[36:39], v[100:103], v[60:63]
    v_mfma_f32_16x16x32_bf16 v[64:67], a[40:43], v[100:103], v[64:67]
    v_mfma_f32_16x16x32_bf16 v[68:71], a[44:47], v[100:103], v[68:71]
    v_mfma_f32_16x16x32_bf16 v[56:59], a[48:51], v[104:107], v[56:59]
    v_mfma_f32_16x16x32_bf16 v[60:63], a[52:55], v[104:107], v[60:63]
    v_mfma_f32_16x16x32_bf16 v[64:67], a[56:59], v[104:107], v[64:67]
    v_mfma_f32_16x16x32_bf16 v[68:71], a[60:63], v[104:107], v[68:71]
    v_mfma_f32_16x16x32_bf16 v[56:59], a[64:67], v[108:111], v[56:59]
    v_mfma_f32_16x16x32_bf16 v[60:63], a[68:71], v[108:111], v[60:63]
    v_mfma_f32_16x16x32_bf16 v[64:67], a[72:75], v[108:111], v[64:67]
    v_mfma_f32_16x16x32_bf16 v[68:71], a[76:79], v[108:111], v[68:71]
    v_mfma_f32_16x16x32_bf16 v[56:59], a[80:83], v[112:115], v[56:59]
    v_mfma_f32_16x16x32_bf16 v[60:63], a[84:87], v[112:115], v[60:63]
    v_mfma_f32_16x16x32_bf16 v[64:67], a[88:91], v[112:115], v[64:67]
    v_mfma_f32_16x16x32_bf16 v[68:71], a[92:95], v[112:115], v[68:71]
    v_mfma_f32_16x16x32_bf16 v[56:59], a[96:99], v[116:119], v[56:59]
    v_mfma_f32_16x16x32_bf16 v[60:63], a[100:103], v[116:119], v[60:63]
    v_mfma_f32_16x16x32_bf16 v[64:67], a[104:107], v[116:119], v[64:67]
    v_mfma_f32_16x16x32_bf16 v[68:71], a[108:111], v[116:119], v[68:71]
    v_mfma_f32_16x16x32_bf16 v[56:59], a[112:115], v[120:123], v[56:59]
    v_mfma_f32_16x16x32_bf16 v[60:63], a[116:119], v[120:123], v[60:63]
    v_mfma_f32_16x16x32_bf16 v[64:67], a[120:123], v[120:123], v[64:67]
    v_mfma_f32_16x16x32_bf16 v[68:71], a[124:127], v[120:123], v[68:71]
    v_mfma_f32_16x16x32_bf16 v[56:59], a[128:131], v[124:127], v[56:59]
    v_mfma_f32_16x16x32_bf16 v[60:63], a[132:135], v[124:127], v[60:63]
    v_mfma_f32_16x16x32_bf16 v[64:67], a[136:139], v[124:127], v[64:67]
    v_mfma_f32_16x16x32_bf16 v[68:71], a[140:143], v[124:127], v[68:71]
    v_mfma_f32_16x16x32_bf16 v[56:59], a[144:147], v[128:131], v[56:59]
    v_mfma_f32_16x16x32_bf16 v[60:63], a[148:151], v[128:131], v[60:63]
    v_mfma_f32_16x16x32_bf16 v[64:67], a[152:155], v[128:131], v[64:67]
    v_mfma_f32_16x16x32_bf16 v[68:71], a[156:159], v[128:131], v[68:71]
    v_mfma_f32_16x16x32_bf16 v[56:59], a[160:163], v[132:135], v[56:59]
    v_mfma_f32_16x16x32_bf16 v[60:63], a[164:167], v[132:135], v[60:63]
    v_mfma_f32_16x16x32_bf16 v[64:67], a[168:171], v[132:135], v[64:67]
    v_mfma_f32_16x16x32_bf16 v[68:71], a[172:175], v[132:135], v[68:71]
    v_mfma_f32_16x16x32_bf16 v[56:59], a[176:179], v[136:139], v[56:59]
    v_mfma_f32_16x16x32_bf16 v[60:63], a[180:183], v[136:139], v[60:63]
    v_mfma_f32_16x16x32_bf16 v[64:67], a[184:187], v[136:139], v[64:67]
    v_mfma_f32_16x16x32_bf16 v[68:71], a[188:191], v[136:139], v[68:71]
    v_mfma_f32_16x16x32_bf16 v[56:59], a[192:195], v[140:143], v[56:59]
    v_mfma_f32_16x16x32_bf16 v[60:63], a[196:199], v[140:143], v[60:63]
    v_mfma_f32_16x16x32_bf16 v[64:67], a[200:203], v[140:143], v[64:67]
    v_mfma_f32_16x16x32_bf16 v[68:71], a[204:207], v[140:143], v[68:71]
    v_mfma_f32_16x16x32_bf16 v[56:59], a[208:211], v[144:147], v[56:59]
    v_mfma_f32_16x16x32_bf16 v[60:63], a[212:215], v[144:147], v[60:63]
    v_mfma_f32_16x16x32_bf16 v[64:67], a[216:219], v[144:147], v[64:67]
    v_mfma_f32_16x16x32_bf16 v[68:71], a[220:223], v[144:147], v[68:71]
    v_mfma_f32_16x16x32_bf16 v[56:59], a[224:227], v[148:151], v[56:59]
    v_mfma_f32_16x16x32_bf16 v[60:63], a[228:231], v[148:151], v[60:63]
    v_mfma_f32_16x16x32_bf16 v[64:67], a[232:235], v[148:151], v[64:67]
    v_mfma_f32_16x16x32_bf16 v[68:71], a[236:239], v[148:151], v[68:71]
    v_mfma_f32_16x16x32_bf16 v[56:59], a[240:243], v[152:155], v[56:59]
    v_mfma_f32_16x16x32_bf16 v[60:63], a[244:247], v[152:155], v[60:63]
    v_mfma_f32_16x16x32_bf16 v[64:67], a[248:251], v[152:155], v[64:67]
    v_mfma_f32_16x16x32_bf16 v[68:71], a[252:255], v[152:155], v[68:71]
    s_branch back_52
KEND:
    s_endpgm
.section .rodata,"a"
.p2align 6
.amdhsa_kernel sequential_preLN__sliding_block__mixer_s_mlp__prompt_kernel
  .amdhsa_next_free_vgpr 512
  .amdhsa_next_free_sgpr 102
  .amdhsa_accum_offset 256
  .amdhsa_group_segment_fixed_size 0
  .amdhsa_kernarg_size 88
  .amdhsa_user_sgpr_count 2
  .amdhsa_user_sgpr_kernarg_segment_ptr 1
  .amdhsa_system_sgpr_workgroup_id_x 1
.end_amdhsa_kernel
```
